```python
import torch

def _softmax(x, axis=-1):
    return torch.softmax(x, dim=axis)

def _gelu(x):
    return torch.nn.functional.gelu(x, approximate='tanh')

def _silu(x):
    return torch.nn.functional.silu(x)

def _sigmoid(x):
    return torch.sigmoid(x)

def _layernorm(x, axis=-1, eps=1e-05):
    m = x.mean(dim=axis, keepdim=True)
    v = x.var(dim=axis, keepdim=True, unbiased=False)
    return (x - m) / torch.sqrt(v + eps)

def _scatter_add(tgt, idx, src, axis=0):
    return tgt.clone().index_add_(axis, idx, src)

def _segment_sum(src, seg, n):
    out = torch.zeros((n,) + src.shape[1:], dtype=src.dtype)
    return out.index_add_(0, seg, src)

def _pad(x, pw):
    flat = tuple((v for pair in reversed(pw) for v in pair))
    return torch.nn.functional.pad(x, flat)
kernel_name = 'gated_mix__mha_block__memory_aug_recurrent_mem_tr__prompt'

def setup_inputs():

    _w = lambda a: (lambda t: t.to(torch.bfloat16) if t.is_floating_point() else t)(torch.as_tensor(a))

    def _A_setup():
        B, S, D, H = (1, 2048, 640, 32)
        return {'x': _w((lambda *s: torch.randn(*s, dtype=torch.bfloat16) * 0.05)(B, S, D)), 'wqkv': _w((lambda *s: torch.randn(*s, dtype=torch.bfloat16) * 0.8)(D, 3 * D)), 'wo': _w((lambda *s: torch.randn(*s, dtype=torch.bfloat16) * 0.05)(D, D))}
    _A_in = _A_setup()

    def _B_setup():
        B, S, Dm = (1, 2048, 640)
        H, Dh = (32, 128)
        M, seg = (8, 32)
        seg = min(seg, S)
        S = S // seg * seg
        return {'x': _w((lambda *s: torch.randn(*s, dtype=torch.bfloat16) * 0.05)(B, S, Dm)), 'mem0': _w((lambda *s: torch.randn(*s, dtype=torch.bfloat16) * 0.8)(B, M, Dm)), 'Wq': _w((lambda *s: torch.randn(*s, dtype=torch.bfloat16) * 3.2)(Dm, H, Dh) * Dm ** (-0.5)), 'Wk': _w((lambda *s: torch.randn(*s, dtype=torch.bfloat16) * 3.2)(Dm, H, Dh) * Dm ** (-0.5)), 'Wv': _w((lambda *s: torch.randn(*s, dtype=torch.bfloat16) * 0.8)(Dm, H, Dh) * Dm ** (-0.5)), 'Wo': _w((lambda *s: torch.randn(*s, dtype=torch.bfloat16) * 0.8)(H, Dh, Dm) * (H * Dh) ** (-0.5)), 'seg_len': seg}
    _B_in = _B_setup()
    return {'A_x': _A_in['x'], 'A_wqkv': _A_in['wqkv'], 'A_wo': _A_in['wo'], 'B_x': _B_in['x'], 'B_mem0': _B_in['mem0'], 'B_Wq': _B_in['Wq'], 'B_Wk': _B_in['Wk'], 'B_Wv': _B_in['Wv'], 'B_Wo': _B_in['Wo'], 'B_seg_len': _B_in['seg_len'], 'gate_w': _w((lambda *s: torch.randn(*s, dtype=torch.bfloat16) * 0.05)(640) * 16.0)}

def reference(A_x, A_wqkv, A_wo, B_x, B_mem0, B_Wq, B_Wk, B_Wv, B_Wo, B_seg_len, gate_w):

    def _A_ref(x, wqkv, wo):
        B, S, D = x.shape
        H = 32
        Dh = D // H
        qkv = (lambda x, *d: x.permute(*d))((x @ wqkv).reshape(B, S, 3, H, Dh), 2, 0, 3, 1, 4)
        q, k, v = (qkv[0], qkv[1], qkv[2])
        scores = torch.einsum('bhqd,bhkd->bhqk', q, k) * Dh ** (-0.5)
        p = _softmax(scores, axis=-1)
        o = torch.einsum('bhqk,bhkd->bhqd', p, v)
        return (lambda x, *d: x.permute(*d))(o, 0, 2, 1, 3).reshape(B, S, D) @ wo

    def _B_ref(x, mem0, Wq, Wk, Wv, Wo, seg_len):
        B, S, Dm = x.shape
        H, Dh = (Wq.shape[1], Wq.shape[2])
        M = mem0.shape[1]
        scale = Dh ** (-0.5)
        n_seg = S // seg_len
        L = M + seg_len
        idx = torch.arange(L)
        mask = (idx[:, None] < M) | (idx[:, None] >= idx[None, :])
        mem = mem0
        outs = []
        for s in range(n_seg):
            xs = x[:, s * seg_len:(s + 1) * seg_len, :].clone()
            h = torch.concatenate([mem, xs], axis=1)
            q = torch.einsum('btd,dhe->bhte', h, Wq)
            k = torch.einsum('btd,dhe->bhte', h, Wk)
            v = torch.einsum('btd,dhe->bhte', h, Wv)
            scores = torch.einsum('bhqe,bhke->bhqk', q, k) * scale
            scores = torch.where(mask[None, None], scores, -1000000000.0)
            p = _softmax(scores, axis=-1)
            o = torch.einsum('bhqk,bhke->bhqe', p, v)
            o = torch.einsum('bhte,hed->btd', o, Wo)
            mem = o[:, :M, :].clone()
            outs.append(o[:, M:, :])
        return torch.concatenate(outs, axis=1)
    x = A_x
    g = _sigmoid((x * gate_w).sum(-1, keepdims=True))
    a = _A_ref(x, A_wqkv, A_wo)
    b = _B_ref(x, B_mem0, B_Wq, B_Wk, B_Wv, B_Wo, B_seg_len)
    return g * a + (1 - g) * b
```

```asm
; @launch grid=(256,1,1) block=(256,1,1) lds=163840
.amdgcn_target "amdgcn-amd-amdhsa--gfx950"
.text
.globl gated_mix__mha_block__memory_aug_recurrent_mem_tr__prompt_kernel
.p2align 8
.type gated_mix__mha_block__memory_aug_recurrent_mem_tr__prompt_kernel,@function
gated_mix__mha_block__memory_aug_recurrent_mem_tr__prompt_kernel:
    s_cmp_ge_u32 s2, 256
    s_cbranch_scc1 L_end
    s_mov_b32 s88, 0
    s_getreg_b32 s7, hwreg(HW_REG_XCC_ID, 0, 4)
    s_cmp_eq_u32 s7, 1
    s_cselect_b32 s6, 1, 0
    s_cbranch_scc1 L_isx
    s_cmp_lg_u32 s7, 0
    s_cbranch_scc1 L_worker
L_isx:
    s_load_dwordx2 s[16:17], s[0:1], 96
    s_waitcnt lgkmcnt(0)
    s_mul_i32 s7, s6, 248
    v_mov_b32 v1, s7
    v_mov_b32 v2, 1
    v_cmp_eq_u32 vcc, 0, v0
    s_nop 0
    s_and_saveexec_b64 s[18:19], vcc
    s_cbranch_execz L_noat
    s_waitcnt lgkmcnt(0)
    global_atomic_add v3, v1, v2, s[16:17] sc0 sc1
    s_waitcnt vmcnt(0)
    v_mov_b32 v1, 0
    s_waitcnt vmcnt(0)
    ds_write_b32 v1, v3
    s_waitcnt lgkmcnt(0)
L_noat:
    s_mov_b64 exec, s[18:19]
    s_barrier
    v_mov_b32 v1, 0
    ds_read_b32 v3, v1
    s_waitcnt lgkmcnt(0)
    s_waitcnt lgkmcnt(0)
    v_readfirstlane_b32 s3, v3
    s_barrier
    s_cmp_ge_u32 s3, 32
    s_cbranch_scc1 L_worker
    s_mov_b32 s91, 1
L_chain:
    s_load_dwordx2 s[16:17], s[0:1], 104
    v_and_b32 v1, 63, v0
    v_lshrrev_b32 v10, 6, v0
    s_nop 0
    v_readfirstlane_b32 s4, v10
    s_waitcnt lgkmcnt(0)
    s_mov_b32 s8, s16
    s_and_b32 s9, s17, 0xffff
    s_mov_b32 s10, 268435456
    s_mov_b32 s11, 0x00020000
    s_and_b32 s36, s3, 1
    s_lshr_b32 s27, s3, 1
    s_lshl_b32 s30, s6, 4
    s_add_u32 s27, s27, s30
    v_and_b32 v10, 8, v1
    v_mov_b32 v2, 0x4444
    v_mov_b32 v11, 0xeeee
    v_cmp_ne_u32 vcc, 0, v10
    s_nop 1
    v_cndmask_b32 v2, v2, v11, vcc
    s_mov_b64 s[48:49], vcc
    v_lshlrev_b32 v6, 4, v1
    v_lshrrev_b32 v10, 4, v1
    v_lshlrev_b32 v3, 3, v10
    v_bfe_u32 v10, v1, 3, 1
    v_lshl_add_u32 v3, v10, 2, v3
    v_bfe_u32 v10, v1, 1, 1
    v_lshl_add_u32 v3, v10, 1, v3
    v_bfe_u32 v10, v1, 2, 1
    v_add_u32 v3, v10, v3
    v_lshlrev_b32 v3, 4, v3
    v_and_b32 v10, 1, v1
    v_lshl_add_u32 v3, v10, 3, v3
    v_lshrrev_b32 v5, 2, v1
    v_lshlrev_b32 v5, 4, v5
    v_lshl_add_u32 v5, v10, 3, v5
    v_lshrrev_b32 v10, 5, v1
    v_lshlrev_b32 v10, 4, v10
    v_and_b32 v11, 15, v1
    v_add_u32 v10, v10, v11
    v_lshlrev_b32 v7, 5, v10
    s_lshl_b32 s30, s4, 5
    v_add_u32 v10, s30, v10
    v_lshlrev_b32 v4, 4, v10
    v_bfe_u32 v10, v1, 4, 1
    v_lshl_add_u32 v4, v10, 3, v4
    v_lshl_add_u32 v7, v10, 4, v7
    v_lshrrev_b32 v10, 4, v1
    v_mul_u32_u24 v8, 81920, v10
    v_lshl_add_u32 v8, v11, 4, v8
    v_lshrrev_b32 v10, 1, v11
    v_lshlrev_b32 v9, 4, v10
    v_and_b32 v10, 1, v1
    v_lshl_add_u32 v9, v10, 3, v9
    v_bfe_u32 v10, v1, 4, 1
    v_lshl_add_u32 v9, v10, 2, v9
    v_lshlrev_b32 v14, 2, v1
    v_add_u32 v189, 8192, v14
    s_lshr_b32 s30, s4, 1
    s_lshl_b32 s30, s30, 10
    s_and_b32 s31, s4, 1
    s_lshl_b32 s31, s31, 3
    s_add_u32 s30, s30, s31
    v_add_u32 v13, s30, v6
    s_lshl_b32 s30, s4, 10
    v_add_u32 v12, s30, v6
    s_lshr_b32 s30, s3, 1
    s_mul_i32 s28, s30, 3
    s_add_u32 s28, s28, 32
    s_lshl_b32 s31, s30, 1
    s_cmp_eq_u32 s36, 1
    s_cselect_b32 s28, s31, s28
    s_cselect_b32 s31, 2, 3
    s_add_u32 s28, s28, s4
    s_cmp_lt_u32 s4, s31
    s_cselect_b32 s37, 1, 0
    s_mul_i32 s30, s6, 327680
    s_lshl_b32 s31, s28, 8
    s_add_u32 s32, s30, s31
    s_add_u32 s32, s32, 131072
    s_add_u32 s33, s32, 20480
    s_add_u32 s34, s33, 20480
    s_add_u32 s35, s34, 20480
    s_mul_i32 s39, s6, 40960
    s_add_u32 s39, s39, 0
    s_lshl_b32 s38, s28, 7
    s_add_u32 s38, s38, s39
    s_lshl_b32 s30, s4, 10
    s_add_u32 s39, s39, s30
    s_cmp_lt_u32 s4, 2
    s_cselect_b32 s42, 8192, 0
    s_mul_i32 s30, s6, 80
    s_add_u32 s30, s30, s28
    s_lshr_b32 s43, s30, 5
    s_lshl_b32 s43, s43, 14
    s_and_b32 s30, s30, 31
    s_lshl_b32 s30, s30, 8
    s_add_u32 s43, s43, s30
    s_add_u32 s43, s43, 2097152
    s_xor_b32 s30, s6, 1
    s_mul_i32 s30, s30, 80
    s_add_u32 s30, s30, s28
    s_lshr_b32 s44, s30, 5
    s_lshl_b32 s44, s44, 14
    s_and_b32 s30, s30, 31
    s_lshl_b32 s30, s30, 8
    s_add_u32 s44, s44, s30
    s_add_u32 s44, s44, 2097152
    s_mul_i32 s26, s27, 20480
    s_add_u32 s26, s26, 131072
    s_lshl_b32 s30, s4, 10
    s_add_u32 s26, s26, s30
    s_mov_b32 s29, 0x3e0293ee
    s_mov_b32 s94, 0x21800000
    s_mov_b32 s95, 0x3c000000
    s_lshl_b32 s45, s27, 13
    s_add_u32 s47, s45, 2555904
    s_add_u32 s45, s45, 2228224
    s_and_b32 s30, s4, 1
    s_lshl_b32 s30, s30, 12
    s_lshr_b32 s31, s4, 1
    s_lshl_b32 s31, s31, 11
    s_add_u32 s57, s30, s31
    v_add_u32 v191, s57, v6
    s_add_u32 s57, s57, 16777216
    s_lshr_b32 s30, s4, 1
    s_lshl_b32 s30, s30, 10
    v_add_u32 v188, s30, v5
    s_lshl_b32 s58, s4, 11
    s_add_u32 s58, s58, 33554432
    s_add_u32 s50, s26, 0
    s_add_u32 s51, s26, 4096
    s_add_u32 s52, s26, 8192
    s_add_u32 s53, s26, 12288
    s_add_u32 s54, s26, 16384
    v_mov_b32 v16, 1
    v_mov_b32 v17, 1
    v_mov_b32 v18, 1
    v_mov_b32 v19, 1
    s_cmp_eq_u32 s36, 1
    s_cbranch_scc1 initb_1
    buffer_store_dwordx4 v[16:19], v6, s[8:11], s50 offen sc1
    buffer_store_dwordx4 v[16:19], v6, s[8:11], s51 offen sc1
    buffer_store_dwordx4 v[16:19], v6, s[8:11], s52 offen sc1
    buffer_store_dwordx4 v[16:19], v6, s[8:11], s53 offen sc1
    buffer_store_dwordx4 v[16:19], v6, s[8:11], s54 offen sc1
    s_branch initd_2
initb_1:
    s_nop 0
    v_mov_b32 v16, -1
    v_mov_b32 v17, -1
    v_mov_b32 v18, -1
    v_mov_b32 v19, -1
    s_lshl_b32 s30, s4, 10
    s_add_u32 s31, s45, s30
    s_add_u32 s31, s31, 0
    buffer_store_dwordx4 v[16:19], v6, s[8:11], s31 offen sc1
    s_add_u32 s31, s45, s30
    s_add_u32 s31, s31, 4096
    buffer_store_dwordx4 v[16:19], v6, s[8:11], s31 offen sc1
    s_add_u32 s31, s47, s30
    s_add_u32 s31, s31, 0
    buffer_store_dwordx4 v[16:19], v6, s[8:11], s31 offen sc1
    s_add_u32 s31, s47, s30
    s_add_u32 s31, s31, 4096
    buffer_store_dwordx4 v[16:19], v6, s[8:11], s31 offen sc1
    s_nop 1
    v_mov_b32 v16, 1
initd_2:
    v_mov_b32 v20, -1
    s_cmp_eq_u32 s37, 0
    s_cbranch_scc1 noarm_3
    s_add_u32 s31, s38, 0
    buffer_store_dword v20, v9, s[8:11], s31 offen sc1
    s_add_u32 s31, s38, 10240
    buffer_store_dword v20, v9, s[8:11], s31 offen sc1
    s_add_u32 s31, s38, 20480
    buffer_store_dword v20, v9, s[8:11], s31 offen sc1
    s_add_u32 s31, s38, 30720
    buffer_store_dword v20, v9, s[8:11], s31 offen sc1
    buffer_store_dword v16, v14, s[8:11], s43 offen sc1
    buffer_store_dword v16, v189, s[8:11], s43 offen sc1
noarm_3:
    s_cmp_lg_u32 s4, 0
    s_cbranch_scc1 nofz_4
    s_cmp_lg_u32 s36, 1
    s_cbranch_scc1 nofz_4
    v_lshlrev_b32 v10, 7, v1
    v_mov_b32 v11, 0
    s_lshl_b32 s30, s27, 2
    s_add_u32 s30, s30, 1048576
    buffer_store_dword v11, v10, s[8:11], s30 offen sc1
nofz_4:
    s_load_dwordx2 s[16:17], s[0:1], 32
    s_waitcnt lgkmcnt(0)
    s_mov_b32 s60, s16
    s_and_b32 s61, s17, 0xffff
    s_mov_b32 s62, 10240
    s_mov_b32 s63, 0x00020000
    v_lshlrev_b32 v10, 1, v0
    s_mov_b32 s30, 0
    buffer_load_ushort v120, v10, s[60:63], s30 offen
    s_mov_b32 s30, 1280
    buffer_load_ushort v121, v10, s[60:63], s30 offen
    s_mov_b32 s30, 2560
    buffer_load_ushort v122, v10, s[60:63], s30 offen
    s_mov_b32 s30, 3840
    buffer_load_ushort v123, v10, s[60:63], s30 offen
    s_mov_b32 s30, 5120
    buffer_load_ushort v124, v10, s[60:63], s30 offen
    s_mov_b32 s30, 6400
    buffer_load_ushort v125, v10, s[60:63], s30 offen
    s_mov_b32 s30, 7680
    buffer_load_ushort v126, v10, s[60:63], s30 offen
    s_mov_b32 s30, 8960
    buffer_load_ushort v127, v10, s[60:63], s30 offen
    s_mov_b32 s30, 512
    buffer_load_ushort v128, v10, s[60:63], s30 offen
    s_mov_b32 s30, 1792
    buffer_load_ushort v129, v10, s[60:63], s30 offen
    s_mov_b32 s30, 3072
    buffer_load_ushort v130, v10, s[60:63], s30 offen
    s_mov_b32 s30, 4352
    buffer_load_ushort v131, v10, s[60:63], s30 offen
    s_mov_b32 s30, 5632
    buffer_load_ushort v132, v10, s[60:63], s30 offen
    s_mov_b32 s30, 6912
    buffer_load_ushort v133, v10, s[60:63], s30 offen
    s_mov_b32 s30, 8192
    buffer_load_ushort v134, v10, s[60:63], s30 offen
    s_mov_b32 s30, 9472
    buffer_load_ushort v135, v10, s[60:63], s30 offen
    s_mov_b32 s30, 1024
    buffer_load_ushort v136, v10, s[60:63], s30 offen
    s_mov_b32 s30, 2304
    buffer_load_ushort v137, v10, s[60:63], s30 offen
    s_mov_b32 s30, 3584
    buffer_load_ushort v138, v10, s[60:63], s30 offen
    s_mov_b32 s30, 4864
    buffer_load_ushort v139, v10, s[60:63], s30 offen
    s_mov_b32 s30, 6144
    buffer_load_ushort v140, v10, s[60:63], s30 offen
    s_mov_b32 s30, 7424
    buffer_load_ushort v141, v10, s[60:63], s30 offen
    s_mov_b32 s30, 8704
    buffer_load_ushort v142, v10, s[60:63], s30 offen
    s_mov_b32 s30, 9984
    buffer_load_ushort v143, v10, s[60:63], s30 offen
    v_lshrrev_b32 v10, 4, v1
    s_lshl_b32 s30, s4, 4
    v_add_u32 v10, s30, v10
    v_and_b32 v11, 15, v1
    v_lshlrev_b32 v96, 13, v10
    v_lshl_add_u32 v96, v11, 4, v96
    v_mul_u32_u24 v97, 1280, v10
    v_lshl_add_u32 v97, v11, 4, v97
    v_lshlrev_b32 v98, 8, v10
    v_and_b32 v10, 3, v10
    v_lshlrev_b32 v10, 1, v10
    s_lshr_b32 s30, s4, 1
    s_lshl_b32 s30, s30, 3
    v_add_u32 v10, s30, v10
    v_xor_b32 v10, v10, v11
    v_lshl_add_u32 v98, v10, 4, v98
    v_lshrrev_b32 v10, 4, v1
    v_and_b32 v11, 1, v10
    v_lshlrev_b32 v99, 3, v11
    v_bfe_u32 v10, v1, 2, 2
    v_lshl_add_u32 v99, v10, 1, v99
    s_lshl_b32 s30, s4, 2
    s_add_u32 s30, s30, 0
    v_bfe_u32 v10, v1, 1, 1
    v_add_u32 v10, s30, v10
    v_xor_b32 v99, v10, v99
    v_lshlrev_b32 v99, 4, v99
    v_and_b32 v10, 1, v1
    v_lshl_add_u32 v99, v10, 3, v99
    v_bfe_u32 v10, v1, 2, 2
    v_lshl_add_u32 v10, v11, 5, v10
    v_lshrrev_b32 v11, 5, v1
    v_lshl_add_u32 v100, v11, 3, v10
    v_lshlrev_b32 v100, 8, v100
    v_add_u32 v100, v100, v99
    v_lshl_add_u32 v102, v11, 2, v10
    v_lshlrev_b32 v102, 8, v102
    v_add_u32 v102, v102, v99
    v_lshrrev_b32 v10, 4, v1
    v_and_b32 v11, 1, v10
    v_lshlrev_b32 v99, 3, v11
    v_bfe_u32 v10, v1, 2, 2
    v_lshl_add_u32 v99, v10, 1, v99
    s_lshl_b32 s30, s4, 2
    s_add_u32 s30, s30, 2
    v_bfe_u32 v10, v1, 1, 1
    v_add_u32 v10, s30, v10
    v_xor_b32 v99, v10, v99
    v_lshlrev_b32 v99, 4, v99
    v_and_b32 v10, 1, v1
    v_lshl_add_u32 v99, v10, 3, v99
    v_bfe_u32 v10, v1, 2, 2
    v_lshl_add_u32 v10, v11, 5, v10
    v_lshrrev_b32 v11, 5, v1
    v_lshl_add_u32 v101, v11, 3, v10
    v_lshlrev_b32 v101, 8, v101
    v_add_u32 v101, v101, v99
    v_lshl_add_u32 v103, v11, 2, v10
    v_lshlrev_b32 v103, 8, v103
    v_add_u32 v103, v103, v99
    s_lshl_b32 s68, s27, 8
    s_mul_i32 s69, s27, 163840
    s_cmp_eq_u32 s36, 1
    s_cbranch_scc1 prob_5
    s_load_dwordx2 s[16:17], s[0:1], 40
    s_waitcnt lgkmcnt(0)
    s_mov_b32 s84, s16
    s_and_b32 s85, s17, 0xffff
    s_mov_b32 s86, 5242880
    s_mov_b32 s87, 0x00020000
    s_load_dwordx2 s[16:17], s[0:1], 64
    s_waitcnt lgkmcnt(0)
    s_mov_b32 s64, s16
    s_and_b32 s65, s17, 0xffff
    s_mov_b32 s66, 5242880
    s_mov_b32 s67, 0x00020000
    s_add_u32 s30, s68, 0
    buffer_load_dwordx4 v[16:19], v96, s[84:87], s30 offen
    s_add_u32 s30, s68, 32768
    buffer_load_dwordx4 v[20:23], v96, s[84:87], s30 offen
    s_add_u32 s30, s68, 65536
    buffer_load_dwordx4 v[24:27], v96, s[84:87], s30 offen
    s_add_u32 s30, s68, 98304
    buffer_load_dwordx4 v[28:31], v96, s[84:87], s30 offen
    s_add_u32 s30, s68, 524288
    buffer_load_dwordx4 v[32:35], v96, s[84:87], s30 offen
    s_add_u32 s30, s68, 557056
    buffer_load_dwordx4 v[36:39], v96, s[84:87], s30 offen
    s_add_u32 s30, s68, 589824
    buffer_load_dwordx4 v[40:43], v96, s[84:87], s30 offen
    s_add_u32 s30, s68, 622592
    buffer_load_dwordx4 v[44:47], v96, s[84:87], s30 offen
    s_add_u32 s30, s68, 1048576
    buffer_load_dwordx4 v[48:51], v96, s[84:87], s30 offen
    s_add_u32 s30, s68, 1081344
    buffer_load_dwordx4 v[52:55], v96, s[84:87], s30 offen
    s_add_u32 s30, s68, 1114112
    buffer_load_dwordx4 v[56:59], v96, s[84:87], s30 offen
    s_add_u32 s30, s68, 1146880
    buffer_load_dwordx4 v[60:63], v96, s[84:87], s30 offen
    s_add_u32 s30, s68, 1572864
    buffer_load_dwordx4 v[64:67], v96, s[84:87], s30 offen
    s_add_u32 s30, s68, 1605632
    buffer_load_dwordx4 v[68:71], v96, s[84:87], s30 offen
    s_add_u32 s30, s68, 1638400
    buffer_load_dwordx4 v[72:75], v96, s[84:87], s30 offen
    s_add_u32 s30, s68, 1671168
    buffer_load_dwordx4 v[76:79], v96, s[84:87], s30 offen
    s_add_u32 s30, s68, 2097152
    buffer_load_dwordx4 v[80:83], v96, s[84:87], s30 offen
    s_add_u32 s30, s68, 2129920
    buffer_load_dwordx4 v[84:87], v96, s[84:87], s30 offen
    s_add_u32 s30, s68, 2162688
    buffer_load_dwordx4 v[88:91], v96, s[84:87], s30 offen
    s_add_u32 s30, s68, 2195456
    buffer_load_dwordx4 v[92:95], v96, s[84:87], s30 offen
    s_waitcnt vmcnt(19)
    ds_write_b128 v98, v[16:19] offset:16384
    s_waitcnt vmcnt(18)
    ds_write_b128 v98, v[20:23] offset:17408
    s_waitcnt vmcnt(17)
    ds_write_b128 v98, v[24:27] offset:18432
    s_waitcnt vmcnt(16)
    ds_write_b128 v98, v[28:31] offset:19456
    s_waitcnt lgkmcnt(0)
    s_add_u32 s30, s68, 2621440
    buffer_load_dwordx4 v[16:19], v96, s[84:87], s30 offen
    s_add_u32 s30, s68, 2654208
    buffer_load_dwordx4 v[20:23], v96, s[84:87], s30 offen
    s_add_u32 s30, s68, 2686976
    buffer_load_dwordx4 v[24:27], v96, s[84:87], s30 offen
    s_add_u32 s30, s68, 2719744
    buffer_load_dwordx4 v[28:31], v96, s[84:87], s30 offen
    s_barrier
    ds_read_b64_tr_b16 a[0:1], v100 offset:16384
    ds_read_b64_tr_b16 a[2:3], v100 offset:17408
    ds_read_b64_tr_b16 a[4:5], v100 offset:20480
    ds_read_b64_tr_b16 a[6:7], v100 offset:21504
    ds_read_b64_tr_b16 a[8:9], v101 offset:16384
    ds_read_b64_tr_b16 a[10:11], v101 offset:17408
    ds_read_b64_tr_b16 a[12:13], v101 offset:20480
    ds_read_b64_tr_b16 a[14:15], v101 offset:21504
    s_waitcnt lgkmcnt(0)
    s_waitcnt vmcnt(19)
    ds_write_b128 v98, v[32:35] offset:32768
    s_waitcnt vmcnt(18)
    ds_write_b128 v98, v[36:39] offset:33792
    s_waitcnt vmcnt(17)
    ds_write_b128 v98, v[40:43] offset:34816
    s_waitcnt vmcnt(16)
    ds_write_b128 v98, v[44:47] offset:35840
    s_waitcnt lgkmcnt(0)
    s_add_u32 s30, s68, 3145728
    buffer_load_dwordx4 v[32:35], v96, s[84:87], s30 offen
    s_add_u32 s30, s68, 3178496
    buffer_load_dwordx4 v[36:39], v96, s[84:87], s30 offen
    s_add_u32 s30, s68, 3211264
    buffer_load_dwordx4 v[40:43], v96, s[84:87], s30 offen
    s_add_u32 s30, s68, 3244032
    buffer_load_dwordx4 v[44:47], v96, s[84:87], s30 offen
    s_barrier
    ds_read_b64_tr_b16 a[16:17], v100 offset:32768
    ds_read_b64_tr_b16 a[18:19], v100 offset:33792
    ds_read_b64_tr_b16 a[20:21], v100 offset:36864
    ds_read_b64_tr_b16 a[22:23], v100 offset:37888
    ds_read_b64_tr_b16 a[24:25], v101 offset:32768
    ds_read_b64_tr_b16 a[26:27], v101 offset:33792
    ds_read_b64_tr_b16 a[28:29], v101 offset:36864
    ds_read_b64_tr_b16 a[30:31], v101 offset:37888
    s_waitcnt lgkmcnt(0)
    s_waitcnt vmcnt(19)
    ds_write_b128 v98, v[48:51] offset:16384
    s_waitcnt vmcnt(18)
    ds_write_b128 v98, v[52:55] offset:17408
    s_waitcnt vmcnt(17)
    ds_write_b128 v98, v[56:59] offset:18432
    s_waitcnt vmcnt(16)
    ds_write_b128 v98, v[60:63] offset:19456
    s_waitcnt lgkmcnt(0)
    s_add_u32 s30, s68, 3670016
    buffer_load_dwordx4 v[48:51], v96, s[84:87], s30 offen
    s_add_u32 s30, s68, 3702784
    buffer_load_dwordx4 v[52:55], v96, s[84:87], s30 offen
    s_add_u32 s30, s68, 3735552
    buffer_load_dwordx4 v[56:59], v96, s[84:87], s30 offen
    s_add_u32 s30, s68, 3768320
    buffer_load_dwordx4 v[60:63], v96, s[84:87], s30 offen
    s_barrier
    ds_read_b64_tr_b16 a[32:33], v100 offset:16384
    ds_read_b64_tr_b16 a[34:35], v100 offset:17408
    ds_read_b64_tr_b16 a[36:37], v100 offset:20480
    ds_read_b64_tr_b16 a[38:39], v100 offset:21504
    ds_read_b64_tr_b16 a[40:41], v101 offset:16384
    ds_read_b64_tr_b16 a[42:43], v101 offset:17408
    ds_read_b64_tr_b16 a[44:45], v101 offset:20480
    ds_read_b64_tr_b16 a[46:47], v101 offset:21504
    s_waitcnt lgkmcnt(0)
    s_waitcnt vmcnt(19)
    ds_write_b128 v98, v[64:67] offset:32768
    s_waitcnt vmcnt(18)
    ds_write_b128 v98, v[68:71] offset:33792
    s_waitcnt vmcnt(17)
    ds_write_b128 v98, v[72:75] offset:34816
    s_waitcnt vmcnt(16)
    ds_write_b128 v98, v[76:79] offset:35840
    s_waitcnt lgkmcnt(0)
    s_add_u32 s30, s68, 4194304
    buffer_load_dwordx4 v[64:67], v96, s[84:87], s30 offen
    s_add_u32 s30, s68, 4227072
    buffer_load_dwordx4 v[68:71], v96, s[84:87], s30 offen
    s_add_u32 s30, s68, 4259840
    buffer_load_dwordx4 v[72:75], v96, s[84:87], s30 offen
    s_add_u32 s30, s68, 4292608
    buffer_load_dwordx4 v[76:79], v96, s[84:87], s30 offen
    s_barrier
    ds_read_b64_tr_b16 a[48:49], v100 offset:32768
    ds_read_b64_tr_b16 a[50:51], v100 offset:33792
    ds_read_b64_tr_b16 a[52:53], v100 offset:36864
    ds_read_b64_tr_b16 a[54:55], v100 offset:37888
    ds_read_b64_tr_b16 a[56:57], v101 offset:32768
    ds_read_b64_tr_b16 a[58:59], v101 offset:33792
    ds_read_b64_tr_b16 a[60:61], v101 offset:36864
    ds_read_b64_tr_b16 a[62:63], v101 offset:37888
    s_waitcnt lgkmcnt(0)
    s_waitcnt vmcnt(19)
    ds_write_b128 v98, v[80:83] offset:16384
    s_waitcnt vmcnt(18)
    ds_write_b128 v98, v[84:87] offset:17408
    s_waitcnt vmcnt(17)
    ds_write_b128 v98, v[88:91] offset:18432
    s_waitcnt vmcnt(16)
    ds_write_b128 v98, v[92:95] offset:19456
    s_waitcnt lgkmcnt(0)
    s_add_u32 s30, s68, 4718592
    buffer_load_dwordx4 v[80:83], v96, s[84:87], s30 offen
    s_add_u32 s30, s68, 4751360
    buffer_load_dwordx4 v[84:87], v96, s[84:87], s30 offen
    s_add_u32 s30, s68, 4784128
    buffer_load_dwordx4 v[88:91], v96, s[84:87], s30 offen
    s_add_u32 s30, s68, 4816896
    buffer_load_dwordx4 v[92:95], v96, s[84:87], s30 offen
    s_barrier
    ds_read_b64_tr_b16 a[64:65], v100 offset:16384
    ds_read_b64_tr_b16 a[66:67], v100 offset:17408
    ds_read_b64_tr_b16 a[68:69], v100 offset:20480
    ds_read_b64_tr_b16 a[70:71], v100 offset:21504
    ds_read_b64_tr_b16 a[72:73], v101 offset:16384
    ds_read_b64_tr_b16 a[74:75], v101 offset:17408
    ds_read_b64_tr_b16 a[76:77], v101 offset:20480
    ds_read_b64_tr_b16 a[78:79], v101 offset:21504
    s_waitcnt lgkmcnt(0)
    s_waitcnt vmcnt(19)
    ds_write_b128 v98, v[16:19] offset:32768
    s_waitcnt vmcnt(18)
    ds_write_b128 v98, v[20:23] offset:33792
    s_waitcnt vmcnt(17)
    ds_write_b128 v98, v[24:27] offset:34816
    s_waitcnt vmcnt(16)
    ds_write_b128 v98, v[28:31] offset:35840
    s_waitcnt lgkmcnt(0)
    s_add_u32 s30, s69, 0
    buffer_load_dwordx4 v[16:19], v97, s[64:67], s30 offen
    s_add_u32 s30, s69, 5120
    buffer_load_dwordx4 v[20:23], v97, s[64:67], s30 offen
    s_add_u32 s30, s69, 10240
    buffer_load_dwordx4 v[24:27], v97, s[64:67], s30 offen
    s_add_u32 s30, s69, 15360
    buffer_load_dwordx4 v[28:31], v97, s[64:67], s30 offen
    s_barrier
    ds_read_b64_tr_b16 a[80:81], v100 offset:32768
    ds_read_b64_tr_b16 a[82:83], v100 offset:33792
    ds_read_b64_tr_b16 a[84:85], v100 offset:36864
    ds_read_b64_tr_b16 a[86:87], v100 offset:37888
    ds_read_b64_tr_b16 a[88:89], v101 offset:32768
    ds_read_b64_tr_b16 a[90:91], v101 offset:33792
    ds_read_b64_tr_b16 a[92:93], v101 offset:36864
    ds_read_b64_tr_b16 a[94:95], v101 offset:37888
    s_waitcnt lgkmcnt(0)
    s_waitcnt vmcnt(19)
    ds_write_b128 v98, v[32:35] offset:16384
    s_waitcnt vmcnt(18)
    ds_write_b128 v98, v[36:39] offset:17408
    s_waitcnt vmcnt(17)
    ds_write_b128 v98, v[40:43] offset:18432
    s_waitcnt vmcnt(16)
    ds_write_b128 v98, v[44:47] offset:19456
    s_waitcnt lgkmcnt(0)
    s_add_u32 s30, s69, 81920
    buffer_load_dwordx4 v[32:35], v97, s[64:67], s30 offen
    s_add_u32 s30, s69, 87040
    buffer_load_dwordx4 v[36:39], v97, s[64:67], s30 offen
    s_add_u32 s30, s69, 92160
    buffer_load_dwordx4 v[40:43], v97, s[64:67], s30 offen
    s_add_u32 s30, s69, 97280
    buffer_load_dwordx4 v[44:47], v97, s[64:67], s30 offen
    s_barrier
    ds_read_b64_tr_b16 a[96:97], v100 offset:16384
    ds_read_b64_tr_b16 a[98:99], v100 offset:17408
    ds_read_b64_tr_b16 a[100:101], v100 offset:20480
    ds_read_b64_tr_b16 a[102:103], v100 offset:21504
    ds_read_b64_tr_b16 a[104:105], v101 offset:16384
    ds_read_b64_tr_b16 a[106:107], v101 offset:17408
    ds_read_b64_tr_b16 a[108:109], v101 offset:20480
    ds_read_b64_tr_b16 a[110:111], v101 offset:21504
    s_waitcnt lgkmcnt(0)
    s_waitcnt vmcnt(19)
    ds_write_b128 v98, v[48:51] offset:32768
    s_waitcnt vmcnt(18)
    ds_write_b128 v98, v[52:55] offset:33792
    s_waitcnt vmcnt(17)
    ds_write_b128 v98, v[56:59] offset:34816
    s_waitcnt vmcnt(16)
    ds_write_b128 v98, v[60:63] offset:35840
    s_waitcnt lgkmcnt(0)
    s_add_u32 s30, s69, 256
    buffer_load_dwordx4 v[48:51], v97, s[64:67], s30 offen
    s_add_u32 s30, s69, 5376
    buffer_load_dwordx4 v[52:55], v97, s[64:67], s30 offen
    s_add_u32 s30, s69, 10496
    buffer_load_dwordx4 v[56:59], v97, s[64:67], s30 offen
    s_add_u32 s30, s69, 15616
    buffer_load_dwordx4 v[60:63], v97, s[64:67], s30 offen
    s_barrier
    ds_read_b64_tr_b16 a[112:113], v100 offset:32768
    ds_read_b64_tr_b16 a[114:115], v100 offset:33792
    ds_read_b64_tr_b16 a[116:117], v100 offset:36864
    ds_read_b64_tr_b16 a[118:119], v100 offset:37888
    ds_read_b64_tr_b16 a[120:121], v101 offset:32768
    ds_read_b64_tr_b16 a[122:123], v101 offset:33792
    ds_read_b64_tr_b16 a[124:125], v101 offset:36864
    ds_read_b64_tr_b16 a[126:127], v101 offset:37888
    s_waitcnt lgkmcnt(0)
    s_waitcnt vmcnt(19)
    ds_write_b128 v98, v[64:67] offset:16384
    s_waitcnt vmcnt(18)
    ds_write_b128 v98, v[68:71] offset:17408
    s_waitcnt vmcnt(17)
    ds_write_b128 v98, v[72:75] offset:18432
    s_waitcnt vmcnt(16)
    ds_write_b128 v98, v[76:79] offset:19456
    s_waitcnt lgkmcnt(0)
    s_add_u32 s30, s69, 82176
    buffer_load_dwordx4 v[64:67], v97, s[64:67], s30 offen
    s_add_u32 s30, s69, 87296
    buffer_load_dwordx4 v[68:71], v97, s[64:67], s30 offen
    s_add_u32 s30, s69, 92416
    buffer_load_dwordx4 v[72:75], v97, s[64:67], s30 offen
    s_add_u32 s30, s69, 97536
    buffer_load_dwordx4 v[76:79], v97, s[64:67], s30 offen
    s_barrier
    ds_read_b64_tr_b16 a[128:129], v100 offset:16384
    ds_read_b64_tr_b16 a[130:131], v100 offset:17408
    ds_read_b64_tr_b16 a[132:133], v100 offset:20480
    ds_read_b64_tr_b16 a[134:135], v100 offset:21504
    ds_read_b64_tr_b16 a[136:137], v101 offset:16384
    ds_read_b64_tr_b16 a[138:139], v101 offset:17408
    ds_read_b64_tr_b16 a[140:141], v101 offset:20480
    ds_read_b64_tr_b16 a[142:143], v101 offset:21504
    s_waitcnt lgkmcnt(0)
    s_waitcnt vmcnt(19)
    ds_write_b128 v98, v[80:83] offset:32768
    s_waitcnt vmcnt(18)
    ds_write_b128 v98, v[84:87] offset:33792
    s_waitcnt vmcnt(17)
    ds_write_b128 v98, v[88:91] offset:34816
    s_waitcnt vmcnt(16)
    ds_write_b128 v98, v[92:95] offset:35840
    s_waitcnt lgkmcnt(0)
    s_add_u32 s30, s69, 512
    buffer_load_dwordx4 v[80:83], v97, s[64:67], s30 offen
    s_add_u32 s30, s69, 5632
    buffer_load_dwordx4 v[84:87], v97, s[64:67], s30 offen
    s_add_u32 s30, s69, 10752
    buffer_load_dwordx4 v[88:91], v97, s[64:67], s30 offen
    s_add_u32 s30, s69, 15872
    buffer_load_dwordx4 v[92:95], v97, s[64:67], s30 offen
    s_barrier
    ds_read_b64_tr_b16 a[144:145], v100 offset:32768
    ds_read_b64_tr_b16 a[146:147], v100 offset:33792
    ds_read_b64_tr_b16 a[148:149], v100 offset:36864
    ds_read_b64_tr_b16 a[150:151], v100 offset:37888
    ds_read_b64_tr_b16 a[152:153], v101 offset:32768
    ds_read_b64_tr_b16 a[154:155], v101 offset:33792
    ds_read_b64_tr_b16 a[156:157], v101 offset:36864
    ds_read_b64_tr_b16 a[158:159], v101 offset:37888
    s_waitcnt lgkmcnt(0)
    s_waitcnt vmcnt(19)
    ds_write_b128 v98, v[16:19] offset:16384
    s_waitcnt vmcnt(18)
    ds_write_b128 v98, v[20:23] offset:17408
    s_waitcnt vmcnt(17)
    ds_write_b128 v98, v[24:27] offset:18432
    s_waitcnt vmcnt(16)
    ds_write_b128 v98, v[28:31] offset:19456
    s_waitcnt lgkmcnt(0)
    s_add_u32 s30, s69, 82432
    buffer_load_dwordx4 v[16:19], v97, s[64:67], s30 offen
    s_add_u32 s30, s69, 87552
    buffer_load_dwordx4 v[20:23], v97, s[64:67], s30 offen
    s_add_u32 s30, s69, 92672
    buffer_load_dwordx4 v[24:27], v97, s[64:67], s30 offen
    s_add_u32 s30, s69, 97792
    buffer_load_dwordx4 v[28:31], v97, s[64:67], s30 offen
    s_barrier
    ds_read_b64_tr_b16 a[160:161], v102 offset:16384
    ds_read_b64_tr_b16 a[162:163], v102 offset:20480
    ds_read_b64_tr_b16 a[164:165], v102 offset:18432
    ds_read_b64_tr_b16 a[166:167], v102 offset:22528
    ds_read_b64_tr_b16 a[168:169], v103 offset:16384
    ds_read_b64_tr_b16 a[170:171], v103 offset:20480
    ds_read_b64_tr_b16 a[172:173], v103 offset:18432
    ds_read_b64_tr_b16 a[174:175], v103 offset:22528
    s_waitcnt lgkmcnt(0)
    s_waitcnt vmcnt(19)
    ds_write_b128 v98, v[32:35] offset:32768
    s_waitcnt vmcnt(18)
    ds_write_b128 v98, v[36:39] offset:33792
    s_waitcnt vmcnt(17)
    ds_write_b128 v98, v[40:43] offset:34816
    s_waitcnt vmcnt(16)
    ds_write_b128 v98, v[44:47] offset:35840
    s_waitcnt lgkmcnt(0)
    s_add_u32 s30, s69, 768
    buffer_load_dwordx4 v[32:35], v97, s[64:67], s30 offen
    s_add_u32 s30, s69, 5888
    buffer_load_dwordx4 v[36:39], v97, s[64:67], s30 offen
    s_add_u32 s30, s69, 11008
    buffer_load_dwordx4 v[40:43], v97, s[64:67], s30 offen
    s_add_u32 s30, s69, 16128
    buffer_load_dwordx4 v[44:47], v97, s[64:67], s30 offen
    s_barrier
    ds_read_b64_tr_b16 a[176:177], v102 offset:32768
    ds_read_b64_tr_b16 a[178:179], v102 offset:36864
    ds_read_b64_tr_b16 a[180:181], v102 offset:34816
    ds_read_b64_tr_b16 a[182:183], v102 offset:38912
    ds_read_b64_tr_b16 a[184:185], v103 offset:32768
    ds_read_b64_tr_b16 a[186:187], v103 offset:36864
    ds_read_b64_tr_b16 a[188:189], v103 offset:34816
    ds_read_b64_tr_b16 a[190:191], v103 offset:38912
    s_waitcnt lgkmcnt(0)
    s_waitcnt vmcnt(19)
    ds_write_b128 v98, v[48:51] offset:16384
    s_waitcnt vmcnt(18)
    ds_write_b128 v98, v[52:55] offset:17408
    s_waitcnt vmcnt(17)
    ds_write_b128 v98, v[56:59] offset:18432
    s_waitcnt vmcnt(16)
    ds_write_b128 v98, v[60:63] offset:19456
    s_waitcnt lgkmcnt(0)
    s_add_u32 s30, s69, 82688
    buffer_load_dwordx4 v[48:51], v97, s[64:67], s30 offen
    s_add_u32 s30, s69, 87808
    buffer_load_dwordx4 v[52:55], v97, s[64:67], s30 offen
    s_add_u32 s30, s69, 92928
    buffer_load_dwordx4 v[56:59], v97, s[64:67], s30 offen
    s_add_u32 s30, s69, 98048
    buffer_load_dwordx4 v[60:63], v97, s[64:67], s30 offen
    s_barrier
    ds_read_b64_tr_b16 a[192:193], v102 offset:16384
    ds_read_b64_tr_b16 a[194:195], v102 offset:20480
    ds_read_b64_tr_b16 a[196:197], v102 offset:18432
    ds_read_b64_tr_b16 a[198:199], v102 offset:22528
    ds_read_b64_tr_b16 a[200:201], v103 offset:16384
    ds_read_b64_tr_b16 a[202:203], v103 offset:20480
    ds_read_b64_tr_b16 a[204:205], v103 offset:18432
    ds_read_b64_tr_b16 a[206:207], v103 offset:22528
    s_waitcnt lgkmcnt(0)
    s_waitcnt vmcnt(19)
    ds_write_b128 v98, v[64:67] offset:32768
    s_waitcnt vmcnt(18)
    ds_write_b128 v98, v[68:71] offset:33792
    s_waitcnt vmcnt(17)
    ds_write_b128 v98, v[72:75] offset:34816
    s_waitcnt vmcnt(16)
    ds_write_b128 v98, v[76:79] offset:35840
    s_waitcnt lgkmcnt(0)
    s_add_u32 s30, s69, 1024
    buffer_load_dwordx4 v[64:67], v97, s[64:67], s30 offen
    s_add_u32 s30, s69, 6144
    buffer_load_dwordx4 v[68:71], v97, s[64:67], s30 offen
    s_add_u32 s30, s69, 11264
    buffer_load_dwordx4 v[72:75], v97, s[64:67], s30 offen
    s_add_u32 s30, s69, 16384
    buffer_load_dwordx4 v[76:79], v97, s[64:67], s30 offen
    s_barrier
    ds_read_b64_tr_b16 a[208:209], v102 offset:32768
    ds_read_b64_tr_b16 a[210:211], v102 offset:36864
    ds_read_b64_tr_b16 a[212:213], v102 offset:34816
    ds_read_b64_tr_b16 a[214:215], v102 offset:38912
    ds_read_b64_tr_b16 a[216:217], v103 offset:32768
    ds_read_b64_tr_b16 a[218:219], v103 offset:36864
    ds_read_b64_tr_b16 a[220:221], v103 offset:34816
    ds_read_b64_tr_b16 a[222:223], v103 offset:38912
    s_waitcnt lgkmcnt(0)
    s_waitcnt vmcnt(19)
    ds_write_b128 v98, v[80:83] offset:16384
    s_waitcnt vmcnt(18)
    ds_write_b128 v98, v[84:87] offset:17408
    s_waitcnt vmcnt(17)
    ds_write_b128 v98, v[88:91] offset:18432
    s_waitcnt vmcnt(16)
    ds_write_b128 v98, v[92:95] offset:19456
    s_waitcnt lgkmcnt(0)
    s_add_u32 s30, s69, 82944
    buffer_load_dwordx4 v[80:83], v97, s[64:67], s30 offen
    s_add_u32 s30, s69, 88064
    buffer_load_dwordx4 v[84:87], v97, s[64:67], s30 offen
    s_add_u32 s30, s69, 93184
    buffer_load_dwordx4 v[88:91], v97, s[64:67], s30 offen
    s_add_u32 s30, s69, 98304
    buffer_load_dwordx4 v[92:95], v97, s[64:67], s30 offen
    s_barrier
    ds_read_b64_tr_b16 a[224:225], v102 offset:16384
    ds_read_b64_tr_b16 a[226:227], v102 offset:20480
    ds_read_b64_tr_b16 a[228:229], v102 offset:18432
    ds_read_b64_tr_b16 a[230:231], v102 offset:22528
    ds_read_b64_tr_b16 a[232:233], v103 offset:16384
    ds_read_b64_tr_b16 a[234:235], v103 offset:20480
    ds_read_b64_tr_b16 a[236:237], v103 offset:18432
    ds_read_b64_tr_b16 a[238:239], v103 offset:22528
    s_waitcnt lgkmcnt(0)
    s_waitcnt vmcnt(19)
    ds_write_b128 v98, v[16:19] offset:32768
    s_waitcnt vmcnt(18)
    ds_write_b128 v98, v[20:23] offset:33792
    s_waitcnt vmcnt(17)
    ds_write_b128 v98, v[24:27] offset:34816
    s_waitcnt vmcnt(16)
    ds_write_b128 v98, v[28:31] offset:35840
    s_waitcnt lgkmcnt(0)
    s_barrier
    ds_read_b64_tr_b16 a[240:241], v102 offset:32768
    ds_read_b64_tr_b16 a[242:243], v102 offset:36864
    ds_read_b64_tr_b16 a[244:245], v102 offset:34816
    ds_read_b64_tr_b16 a[246:247], v102 offset:38912
    ds_read_b64_tr_b16 a[248:249], v103 offset:32768
    ds_read_b64_tr_b16 a[250:251], v103 offset:36864
    ds_read_b64_tr_b16 a[252:253], v103 offset:34816
    ds_read_b64_tr_b16 a[254:255], v103 offset:38912
    s_waitcnt lgkmcnt(0)
    s_waitcnt vmcnt(15)
    ds_write_b128 v98, v[32:35] offset:16384
    s_waitcnt vmcnt(14)
    ds_write_b128 v98, v[36:39] offset:17408
    s_waitcnt vmcnt(13)
    ds_write_b128 v98, v[40:43] offset:18432
    s_waitcnt vmcnt(12)
    ds_write_b128 v98, v[44:47] offset:19456
    s_waitcnt lgkmcnt(0)
    s_barrier
    ds_read_b64_tr_b16 v[192:193], v102 offset:16384
    ds_read_b64_tr_b16 v[194:195], v102 offset:20480
    ds_read_b64_tr_b16 v[196:197], v102 offset:18432
    ds_read_b64_tr_b16 v[198:199], v102 offset:22528
    ds_read_b64_tr_b16 v[200:201], v103 offset:16384
    ds_read_b64_tr_b16 v[202:203], v103 offset:20480
    ds_read_b64_tr_b16 v[204:205], v103 offset:18432
    ds_read_b64_tr_b16 v[206:207], v103 offset:22528
    s_waitcnt lgkmcnt(0)
    s_waitcnt vmcnt(11)
    ds_write_b128 v98, v[48:51] offset:32768
    s_waitcnt vmcnt(10)
    ds_write_b128 v98, v[52:55] offset:33792
    s_waitcnt vmcnt(9)
    ds_write_b128 v98, v[56:59] offset:34816
    s_waitcnt vmcnt(8)
    ds_write_b128 v98, v[60:63] offset:35840
    s_waitcnt lgkmcnt(0)
    s_barrier
    ds_read_b64_tr_b16 v[208:209], v102 offset:32768
    ds_read_b64_tr_b16 v[210:211], v102 offset:36864
    ds_read_b64_tr_b16 v[212:213], v102 offset:34816
    ds_read_b64_tr_b16 v[214:215], v102 offset:38912
    ds_read_b64_tr_b16 v[216:217], v103 offset:32768
    ds_read_b64_tr_b16 v[218:219], v103 offset:36864
    ds_read_b64_tr_b16 v[220:221], v103 offset:34816
    ds_read_b64_tr_b16 v[222:223], v103 offset:38912
    s_waitcnt lgkmcnt(0)
    s_waitcnt vmcnt(7)
    ds_write_b128 v98, v[64:67] offset:16384
    s_waitcnt vmcnt(6)
    ds_write_b128 v98, v[68:71] offset:17408
    s_waitcnt vmcnt(5)
    ds_write_b128 v98, v[72:75] offset:18432
    s_waitcnt vmcnt(4)
    ds_write_b128 v98, v[76:79] offset:19456
    s_waitcnt lgkmcnt(0)
    s_barrier
    ds_read_b64_tr_b16 v[224:225], v102 offset:16384
    ds_read_b64_tr_b16 v[226:227], v102 offset:20480
    ds_read_b64_tr_b16 v[228:229], v102 offset:18432
    ds_read_b64_tr_b16 v[230:231], v102 offset:22528
    ds_read_b64_tr_b16 v[232:233], v103 offset:16384
    ds_read_b64_tr_b16 v[234:235], v103 offset:20480
    ds_read_b64_tr_b16 v[236:237], v103 offset:18432
    ds_read_b64_tr_b16 v[238:239], v103 offset:22528
    s_waitcnt lgkmcnt(0)
    s_waitcnt vmcnt(3)
    ds_write_b128 v98, v[80:83] offset:32768
    s_waitcnt vmcnt(2)
    ds_write_b128 v98, v[84:87] offset:33792
    s_waitcnt vmcnt(1)
    ds_write_b128 v98, v[88:91] offset:34816
    s_waitcnt vmcnt(0)
    ds_write_b128 v98, v[92:95] offset:35840
    s_waitcnt lgkmcnt(0)
    s_barrier
    ds_read_b64_tr_b16 v[240:241], v102 offset:32768
    ds_read_b64_tr_b16 v[242:243], v102 offset:36864
    ds_read_b64_tr_b16 v[244:245], v102 offset:34816
    ds_read_b64_tr_b16 v[246:247], v102 offset:38912
    ds_read_b64_tr_b16 v[248:249], v103 offset:32768
    ds_read_b64_tr_b16 v[250:251], v103 offset:36864
    ds_read_b64_tr_b16 v[252:253], v103 offset:34816
    ds_read_b64_tr_b16 v[254:255], v103 offset:38912
    s_waitcnt lgkmcnt(0)
    s_branch prodone_6
prob_5:
    s_load_dwordx2 s[16:17], s[0:1], 48
    s_waitcnt lgkmcnt(0)
    s_mov_b32 s84, s16
    s_and_b32 s85, s17, 0xffff
    s_mov_b32 s86, 5242880
    s_mov_b32 s87, 0x00020000
    s_load_dwordx2 s[16:17], s[0:1], 56
    s_waitcnt lgkmcnt(0)
    s_mov_b32 s64, s16
    s_and_b32 s65, s17, 0xffff
    s_mov_b32 s66, 5242880
    s_mov_b32 s67, 0x00020000
    s_add_u32 s30, s68, 0
    buffer_load_dwordx4 v[16:19], v96, s[84:87], s30 offen
    s_add_u32 s30, s68, 32768
    buffer_load_dwordx4 v[20:23], v96, s[84:87], s30 offen
    s_add_u32 s30, s68, 65536
    buffer_load_dwordx4 v[24:27], v96, s[84:87], s30 offen
    s_add_u32 s30, s68, 98304
    buffer_load_dwordx4 v[28:31], v96, s[84:87], s30 offen
    s_add_u32 s30, s68, 524288
    buffer_load_dwordx4 v[32:35], v96, s[84:87], s30 offen
    s_add_u32 s30, s68, 557056
    buffer_load_dwordx4 v[36:39], v96, s[84:87], s30 offen
    s_add_u32 s30, s68, 589824
    buffer_load_dwordx4 v[40:43], v96, s[84:87], s30 offen
    s_add_u32 s30, s68, 622592
    buffer_load_dwordx4 v[44:47], v96, s[84:87], s30 offen
    s_add_u32 s30, s68, 1048576
    buffer_load_dwordx4 v[48:51], v96, s[84:87], s30 offen
    s_add_u32 s30, s68, 1081344
    buffer_load_dwordx4 v[52:55], v96, s[84:87], s30 offen
    s_add_u32 s30, s68, 1114112
    buffer_load_dwordx4 v[56:59], v96, s[84:87], s30 offen
    s_add_u32 s30, s68, 1146880
    buffer_load_dwordx4 v[60:63], v96, s[84:87], s30 offen
    s_add_u32 s30, s68, 1572864
    buffer_load_dwordx4 v[64:67], v96, s[84:87], s30 offen
    s_add_u32 s30, s68, 1605632
    buffer_load_dwordx4 v[68:71], v96, s[84:87], s30 offen
    s_add_u32 s30, s68, 1638400
    buffer_load_dwordx4 v[72:75], v96, s[84:87], s30 offen
    s_add_u32 s30, s68, 1671168
    buffer_load_dwordx4 v[76:79], v96, s[84:87], s30 offen
    s_add_u32 s30, s68, 2097152
    buffer_load_dwordx4 v[80:83], v96, s[84:87], s30 offen
    s_add_u32 s30, s68, 2129920
    buffer_load_dwordx4 v[84:87], v96, s[84:87], s30 offen
    s_add_u32 s30, s68, 2162688
    buffer_load_dwordx4 v[88:91], v96, s[84:87], s30 offen
    s_add_u32 s30, s68, 2195456
    buffer_load_dwordx4 v[92:95], v96, s[84:87], s30 offen
    s_waitcnt vmcnt(19)
    ds_write_b128 v98, v[16:19] offset:16384
    s_waitcnt vmcnt(18)
    ds_write_b128 v98, v[20:23] offset:17408
    s_waitcnt vmcnt(17)
    ds_write_b128 v98, v[24:27] offset:18432
    s_waitcnt vmcnt(16)
    ds_write_b128 v98, v[28:31] offset:19456
    s_waitcnt lgkmcnt(0)
    s_add_u32 s30, s68, 2621440
    buffer_load_dwordx4 v[16:19], v96, s[84:87], s30 offen
    s_add_u32 s30, s68, 2654208
    buffer_load_dwordx4 v[20:23], v96, s[84:87], s30 offen
    s_add_u32 s30, s68, 2686976
    buffer_load_dwordx4 v[24:27], v96, s[84:87], s30 offen
    s_add_u32 s30, s68, 2719744
    buffer_load_dwordx4 v[28:31], v96, s[84:87], s30 offen
    s_barrier
    ds_read_b64_tr_b16 a[0:1], v100 offset:16384
    ds_read_b64_tr_b16 a[2:3], v100 offset:17408
    ds_read_b64_tr_b16 a[4:5], v100 offset:20480
    ds_read_b64_tr_b16 a[6:7], v100 offset:21504
    ds_read_b64_tr_b16 a[8:9], v101 offset:16384
    ds_read_b64_tr_b16 a[10:11], v101 offset:17408
    ds_read_b64_tr_b16 a[12:13], v101 offset:20480
    ds_read_b64_tr_b16 a[14:15], v101 offset:21504
    s_waitcnt lgkmcnt(0)
    s_waitcnt vmcnt(19)
    ds_write_b128 v98, v[32:35] offset:32768
    s_waitcnt vmcnt(18)
    ds_write_b128 v98, v[36:39] offset:33792
    s_waitcnt vmcnt(17)
    ds_write_b128 v98, v[40:43] offset:34816
    s_waitcnt vmcnt(16)
    ds_write_b128 v98, v[44:47] offset:35840
    s_waitcnt lgkmcnt(0)
    s_add_u32 s30, s68, 3145728
    buffer_load_dwordx4 v[32:35], v96, s[84:87], s30 offen
    s_add_u32 s30, s68, 3178496
    buffer_load_dwordx4 v[36:39], v96, s[84:87], s30 offen
    s_add_u32 s30, s68, 3211264
    buffer_load_dwordx4 v[40:43], v96, s[84:87], s30 offen
    s_add_u32 s30, s68, 3244032
    buffer_load_dwordx4 v[44:47], v96, s[84:87], s30 offen
    s_barrier
    ds_read_b64_tr_b16 a[16:17], v100 offset:32768
    ds_read_b64_tr_b16 a[18:19], v100 offset:33792
    ds_read_b64_tr_b16 a[20:21], v100 offset:36864
    ds_read_b64_tr_b16 a[22:23], v100 offset:37888
    ds_read_b64_tr_b16 a[24:25], v101 offset:32768
    ds_read_b64_tr_b16 a[26:27], v101 offset:33792
    ds_read_b64_tr_b16 a[28:29], v101 offset:36864
    ds_read_b64_tr_b16 a[30:31], v101 offset:37888
    s_waitcnt lgkmcnt(0)
    s_waitcnt vmcnt(19)
    ds_write_b128 v98, v[48:51] offset:16384
    s_waitcnt vmcnt(18)
    ds_write_b128 v98, v[52:55] offset:17408
    s_waitcnt vmcnt(17)
    ds_write_b128 v98, v[56:59] offset:18432
    s_waitcnt vmcnt(16)
    ds_write_b128 v98, v[60:63] offset:19456
    s_waitcnt lgkmcnt(0)
    s_add_u32 s30, s68, 3670016
    buffer_load_dwordx4 v[48:51], v96, s[84:87], s30 offen
    s_add_u32 s30, s68, 3702784
    buffer_load_dwordx4 v[52:55], v96, s[84:87], s30 offen
    s_add_u32 s30, s68, 3735552
    buffer_load_dwordx4 v[56:59], v96, s[84:87], s30 offen
    s_add_u32 s30, s68, 3768320
    buffer_load_dwordx4 v[60:63], v96, s[84:87], s30 offen
    s_barrier
    ds_read_b64_tr_b16 a[32:33], v100 offset:16384
    ds_read_b64_tr_b16 a[34:35], v100 offset:17408
    ds_read_b64_tr_b16 a[36:37], v100 offset:20480
    ds_read_b64_tr_b16 a[38:39], v100 offset:21504
    ds_read_b64_tr_b16 a[40:41], v101 offset:16384
    ds_read_b64_tr_b16 a[42:43], v101 offset:17408
    ds_read_b64_tr_b16 a[44:45], v101 offset:20480
    ds_read_b64_tr_b16 a[46:47], v101 offset:21504
    s_waitcnt lgkmcnt(0)
    s_waitcnt vmcnt(19)
    ds_write_b128 v98, v[64:67] offset:32768
    s_waitcnt vmcnt(18)
    ds_write_b128 v98, v[68:71] offset:33792
    s_waitcnt vmcnt(17)
    ds_write_b128 v98, v[72:75] offset:34816
    s_waitcnt vmcnt(16)
    ds_write_b128 v98, v[76:79] offset:35840
    s_waitcnt lgkmcnt(0)
    s_add_u32 s30, s68, 4194304
    buffer_load_dwordx4 v[64:67], v96, s[84:87], s30 offen
    s_add_u32 s30, s68, 4227072
    buffer_load_dwordx4 v[68:71], v96, s[84:87], s30 offen
    s_add_u32 s30, s68, 4259840
    buffer_load_dwordx4 v[72:75], v96, s[84:87], s30 offen
    s_add_u32 s30, s68, 4292608
    buffer_load_dwordx4 v[76:79], v96, s[84:87], s30 offen
    s_barrier
    ds_read_b64_tr_b16 a[48:49], v100 offset:32768
    ds_read_b64_tr_b16 a[50:51], v100 offset:33792
    ds_read_b64_tr_b16 a[52:53], v100 offset:36864
    ds_read_b64_tr_b16 a[54:55], v100 offset:37888
    ds_read_b64_tr_b16 a[56:57], v101 offset:32768
    ds_read_b64_tr_b16 a[58:59], v101 offset:33792
    ds_read_b64_tr_b16 a[60:61], v101 offset:36864
    ds_read_b64_tr_b16 a[62:63], v101 offset:37888
    s_waitcnt lgkmcnt(0)
    s_waitcnt vmcnt(19)
    ds_write_b128 v98, v[80:83] offset:16384
    s_waitcnt vmcnt(18)
    ds_write_b128 v98, v[84:87] offset:17408
    s_waitcnt vmcnt(17)
    ds_write_b128 v98, v[88:91] offset:18432
    s_waitcnt vmcnt(16)
    ds_write_b128 v98, v[92:95] offset:19456
    s_waitcnt lgkmcnt(0)
    s_add_u32 s30, s68, 4718592
    buffer_load_dwordx4 v[80:83], v96, s[84:87], s30 offen
    s_add_u32 s30, s68, 4751360
    buffer_load_dwordx4 v[84:87], v96, s[84:87], s30 offen
    s_add_u32 s30, s68, 4784128
    buffer_load_dwordx4 v[88:91], v96, s[84:87], s30 offen
    s_add_u32 s30, s68, 4816896
    buffer_load_dwordx4 v[92:95], v96, s[84:87], s30 offen
    s_barrier
    ds_read_b64_tr_b16 a[64:65], v100 offset:16384
    ds_read_b64_tr_b16 a[66:67], v100 offset:17408
    ds_read_b64_tr_b16 a[68:69], v100 offset:20480
    ds_read_b64_tr_b16 a[70:71], v100 offset:21504
    ds_read_b64_tr_b16 a[72:73], v101 offset:16384
    ds_read_b64_tr_b16 a[74:75], v101 offset:17408
    ds_read_b64_tr_b16 a[76:77], v101 offset:20480
    ds_read_b64_tr_b16 a[78:79], v101 offset:21504
    s_waitcnt lgkmcnt(0)
    s_waitcnt vmcnt(19)
    ds_write_b128 v98, v[16:19] offset:32768
    s_waitcnt vmcnt(18)
    ds_write_b128 v98, v[20:23] offset:33792
    s_waitcnt vmcnt(17)
    ds_write_b128 v98, v[24:27] offset:34816
    s_waitcnt vmcnt(16)
    ds_write_b128 v98, v[28:31] offset:35840
    s_waitcnt lgkmcnt(0)
    s_add_u32 s30, s68, 0
    buffer_load_dwordx4 v[16:19], v96, s[64:67], s30 offen
    s_add_u32 s30, s68, 32768
    buffer_load_dwordx4 v[20:23], v96, s[64:67], s30 offen
    s_add_u32 s30, s68, 65536
    buffer_load_dwordx4 v[24:27], v96, s[64:67], s30 offen
    s_add_u32 s30, s68, 98304
    buffer_load_dwordx4 v[28:31], v96, s[64:67], s30 offen
    s_barrier
    ds_read_b64_tr_b16 a[80:81], v100 offset:32768
    ds_read_b64_tr_b16 a[82:83], v100 offset:33792
    ds_read_b64_tr_b16 a[84:85], v100 offset:36864
    ds_read_b64_tr_b16 a[86:87], v100 offset:37888
    ds_read_b64_tr_b16 a[88:89], v101 offset:32768
    ds_read_b64_tr_b16 a[90:91], v101 offset:33792
    ds_read_b64_tr_b16 a[92:93], v101 offset:36864
    ds_read_b64_tr_b16 a[94:95], v101 offset:37888
    s_waitcnt lgkmcnt(0)
    s_waitcnt vmcnt(19)
    ds_write_b128 v98, v[32:35] offset:16384
    s_waitcnt vmcnt(18)
    ds_write_b128 v98, v[36:39] offset:17408
    s_waitcnt vmcnt(17)
    ds_write_b128 v98, v[40:43] offset:18432
    s_waitcnt vmcnt(16)
    ds_write_b128 v98, v[44:47] offset:19456
    s_waitcnt lgkmcnt(0)
    s_add_u32 s30, s68, 524288
    buffer_load_dwordx4 v[32:35], v96, s[64:67], s30 offen
    s_add_u32 s30, s68, 557056
    buffer_load_dwordx4 v[36:39], v96, s[64:67], s30 offen
    s_add_u32 s30, s68, 589824
    buffer_load_dwordx4 v[40:43], v96, s[64:67], s30 offen
    s_add_u32 s30, s68, 622592
    buffer_load_dwordx4 v[44:47], v96, s[64:67], s30 offen
    s_barrier
    ds_read_b64_tr_b16 a[96:97], v100 offset:16384
    ds_read_b64_tr_b16 a[98:99], v100 offset:17408
    ds_read_b64_tr_b16 a[100:101], v100 offset:20480
    ds_read_b64_tr_b16 a[102:103], v100 offset:21504
    ds_read_b64_tr_b16 a[104:105], v101 offset:16384
    ds_read_b64_tr_b16 a[106:107], v101 offset:17408
    ds_read_b64_tr_b16 a[108:109], v101 offset:20480
    ds_read_b64_tr_b16 a[110:111], v101 offset:21504
    s_waitcnt lgkmcnt(0)
    s_waitcnt vmcnt(19)
    ds_write_b128 v98, v[48:51] offset:32768
    s_waitcnt vmcnt(18)
    ds_write_b128 v98, v[52:55] offset:33792
    s_waitcnt vmcnt(17)
    ds_write_b128 v98, v[56:59] offset:34816
    s_waitcnt vmcnt(16)
    ds_write_b128 v98, v[60:63] offset:35840
    s_waitcnt lgkmcnt(0)
    s_add_u32 s30, s68, 1048576
    buffer_load_dwordx4 v[48:51], v96, s[64:67], s30 offen
    s_add_u32 s30, s68, 1081344
    buffer_load_dwordx4 v[52:55], v96, s[64:67], s30 offen
    s_add_u32 s30, s68, 1114112
    buffer_load_dwordx4 v[56:59], v96, s[64:67], s30 offen
    s_add_u32 s30, s68, 1146880
    buffer_load_dwordx4 v[60:63], v96, s[64:67], s30 offen
    s_barrier
    ds_read_b64_tr_b16 a[112:113], v100 offset:32768
    ds_read_b64_tr_b16 a[114:115], v100 offset:33792
    ds_read_b64_tr_b16 a[116:117], v100 offset:36864
    ds_read_b64_tr_b16 a[118:119], v100 offset:37888
    ds_read_b64_tr_b16 a[120:121], v101 offset:32768
    ds_read_b64_tr_b16 a[122:123], v101 offset:33792
    ds_read_b64_tr_b16 a[124:125], v101 offset:36864
    ds_read_b64_tr_b16 a[126:127], v101 offset:37888
    s_waitcnt lgkmcnt(0)
    s_waitcnt vmcnt(19)
    ds_write_b128 v98, v[64:67] offset:16384
    s_waitcnt vmcnt(18)
    ds_write_b128 v98, v[68:71] offset:17408
    s_waitcnt vmcnt(17)
    ds_write_b128 v98, v[72:75] offset:18432
    s_waitcnt vmcnt(16)
    ds_write_b128 v98, v[76:79] offset:19456
    s_waitcnt lgkmcnt(0)
    s_add_u32 s30, s68, 1572864
    buffer_load_dwordx4 v[64:67], v96, s[64:67], s30 offen
    s_add_u32 s30, s68, 1605632
    buffer_load_dwordx4 v[68:71], v96, s[64:67], s30 offen
    s_add_u32 s30, s68, 1638400
    buffer_load_dwordx4 v[72:75], v96, s[64:67], s30 offen
    s_add_u32 s30, s68, 1671168
    buffer_load_dwordx4 v[76:79], v96, s[64:67], s30 offen
    s_barrier
    ds_read_b64_tr_b16 a[128:129], v100 offset:16384
    ds_read_b64_tr_b16 a[130:131], v100 offset:17408
    ds_read_b64_tr_b16 a[132:133], v100 offset:20480
    ds_read_b64_tr_b16 a[134:135], v100 offset:21504
    ds_read_b64_tr_b16 a[136:137], v101 offset:16384
    ds_read_b64_tr_b16 a[138:139], v101 offset:17408
    ds_read_b64_tr_b16 a[140:141], v101 offset:20480
    ds_read_b64_tr_b16 a[142:143], v101 offset:21504
    s_waitcnt lgkmcnt(0)
    s_waitcnt vmcnt(19)
    ds_write_b128 v98, v[80:83] offset:32768
    s_waitcnt vmcnt(18)
    ds_write_b128 v98, v[84:87] offset:33792
    s_waitcnt vmcnt(17)
    ds_write_b128 v98, v[88:91] offset:34816
    s_waitcnt vmcnt(16)
    ds_write_b128 v98, v[92:95] offset:35840
    s_waitcnt lgkmcnt(0)
    s_add_u32 s30, s68, 2097152
    buffer_load_dwordx4 v[80:83], v96, s[64:67], s30 offen
    s_add_u32 s30, s68, 2129920
    buffer_load_dwordx4 v[84:87], v96, s[64:67], s30 offen
    s_add_u32 s30, s68, 2162688
    buffer_load_dwordx4 v[88:91], v96, s[64:67], s30 offen
    s_add_u32 s30, s68, 2195456
    buffer_load_dwordx4 v[92:95], v96, s[64:67], s30 offen
    s_barrier
    ds_read_b64_tr_b16 a[144:145], v100 offset:32768
    ds_read_b64_tr_b16 a[146:147], v100 offset:33792
    ds_read_b64_tr_b16 a[148:149], v100 offset:36864
    ds_read_b64_tr_b16 a[150:151], v100 offset:37888
    ds_read_b64_tr_b16 a[152:153], v101 offset:32768
    ds_read_b64_tr_b16 a[154:155], v101 offset:33792
    ds_read_b64_tr_b16 a[156:157], v101 offset:36864
    ds_read_b64_tr_b16 a[158:159], v101 offset:37888
    s_waitcnt lgkmcnt(0)
    s_waitcnt vmcnt(19)
    ds_write_b128 v98, v[16:19] offset:16384
    s_waitcnt vmcnt(18)
    ds_write_b128 v98, v[20:23] offset:17408
    s_waitcnt vmcnt(17)
    ds_write_b128 v98, v[24:27] offset:18432
    s_waitcnt vmcnt(16)
    ds_write_b128 v98, v[28:31] offset:19456
    s_waitcnt lgkmcnt(0)
    s_add_u32 s30, s68, 2621440
    buffer_load_dwordx4 v[16:19], v96, s[64:67], s30 offen
    s_add_u32 s30, s68, 2654208
    buffer_load_dwordx4 v[20:23], v96, s[64:67], s30 offen
    s_add_u32 s30, s68, 2686976
    buffer_load_dwordx4 v[24:27], v96, s[64:67], s30 offen
    s_add_u32 s30, s68, 2719744
    buffer_load_dwordx4 v[28:31], v96, s[64:67], s30 offen
    s_barrier
    ds_read_b64_tr_b16 a[160:161], v100 offset:16384
    ds_read_b64_tr_b16 a[162:163], v100 offset:17408
    ds_read_b64_tr_b16 a[164:165], v100 offset:20480
    ds_read_b64_tr_b16 a[166:167], v100 offset:21504
    ds_read_b64_tr_b16 a[168:169], v101 offset:16384
    ds_read_b64_tr_b16 a[170:171], v101 offset:17408
    ds_read_b64_tr_b16 a[172:173], v101 offset:20480
    ds_read_b64_tr_b16 a[174:175], v101 offset:21504
    s_waitcnt lgkmcnt(0)
    s_waitcnt vmcnt(19)
    ds_write_b128 v98, v[32:35] offset:32768
    s_waitcnt vmcnt(18)
    ds_write_b128 v98, v[36:39] offset:33792
    s_waitcnt vmcnt(17)
    ds_write_b128 v98, v[40:43] offset:34816
    s_waitcnt vmcnt(16)
    ds_write_b128 v98, v[44:47] offset:35840
    s_waitcnt lgkmcnt(0)
    s_add_u32 s30, s68, 3145728
    buffer_load_dwordx4 v[32:35], v96, s[64:67], s30 offen
    s_add_u32 s30, s68, 3178496
    buffer_load_dwordx4 v[36:39], v96, s[64:67], s30 offen
    s_add_u32 s30, s68, 3211264
    buffer_load_dwordx4 v[40:43], v96, s[64:67], s30 offen
    s_add_u32 s30, s68, 3244032
    buffer_load_dwordx4 v[44:47], v96, s[64:67], s30 offen
    s_barrier
    ds_read_b64_tr_b16 a[176:177], v100 offset:32768
    ds_read_b64_tr_b16 a[178:179], v100 offset:33792
    ds_read_b64_tr_b16 a[180:181], v100 offset:36864
    ds_read_b64_tr_b16 a[182:183], v100 offset:37888
    ds_read_b64_tr_b16 a[184:185], v101 offset:32768
    ds_read_b64_tr_b16 a[186:187], v101 offset:33792
    ds_read_b64_tr_b16 a[188:189], v101 offset:36864
    ds_read_b64_tr_b16 a[190:191], v101 offset:37888
    s_waitcnt lgkmcnt(0)
    s_waitcnt vmcnt(19)
    ds_write_b128 v98, v[48:51] offset:16384
    s_waitcnt vmcnt(18)
    ds_write_b128 v98, v[52:55] offset:17408
    s_waitcnt vmcnt(17)
    ds_write_b128 v98, v[56:59] offset:18432
    s_waitcnt vmcnt(16)
    ds_write_b128 v98, v[60:63] offset:19456
    s_waitcnt lgkmcnt(0)
    s_add_u32 s30, s68, 3670016
    buffer_load_dwordx4 v[48:51], v96, s[64:67], s30 offen
    s_add_u32 s30, s68, 3702784
    buffer_load_dwordx4 v[52:55], v96, s[64:67], s30 offen
    s_add_u32 s30, s68, 3735552
    buffer_load_dwordx4 v[56:59], v96, s[64:67], s30 offen
    s_add_u32 s30, s68, 3768320
    buffer_load_dwordx4 v[60:63], v96, s[64:67], s30 offen
    s_barrier
    ds_read_b64_tr_b16 a[192:193], v100 offset:16384
    ds_read_b64_tr_b16 a[194:195], v100 offset:17408
    ds_read_b64_tr_b16 a[196:197], v100 offset:20480
    ds_read_b64_tr_b16 a[198:199], v100 offset:21504
    ds_read_b64_tr_b16 a[200:201], v101 offset:16384
    ds_read_b64_tr_b16 a[202:203], v101 offset:17408
    ds_read_b64_tr_b16 a[204:205], v101 offset:20480
    ds_read_b64_tr_b16 a[206:207], v101 offset:21504
    s_waitcnt lgkmcnt(0)
    s_waitcnt vmcnt(19)
    ds_write_b128 v98, v[64:67] offset:32768
    s_waitcnt vmcnt(18)
    ds_write_b128 v98, v[68:71] offset:33792
    s_waitcnt vmcnt(17)
    ds_write_b128 v98, v[72:75] offset:34816
    s_waitcnt vmcnt(16)
    ds_write_b128 v98, v[76:79] offset:35840
    s_waitcnt lgkmcnt(0)
    s_add_u32 s30, s68, 4194304
    buffer_load_dwordx4 v[64:67], v96, s[64:67], s30 offen
    s_add_u32 s30, s68, 4227072
    buffer_load_dwordx4 v[68:71], v96, s[64:67], s30 offen
    s_add_u32 s30, s68, 4259840
    buffer_load_dwordx4 v[72:75], v96, s[64:67], s30 offen
    s_add_u32 s30, s68, 4292608
    buffer_load_dwordx4 v[76:79], v96, s[64:67], s30 offen
    s_barrier
    ds_read_b64_tr_b16 a[208:209], v100 offset:32768
    ds_read_b64_tr_b16 a[210:211], v100 offset:33792
    ds_read_b64_tr_b16 a[212:213], v100 offset:36864
    ds_read_b64_tr_b16 a[214:215], v100 offset:37888
    ds_read_b64_tr_b16 a[216:217], v101 offset:32768
    ds_read_b64_tr_b16 a[218:219], v101 offset:33792
    ds_read_b64_tr_b16 a[220:221], v101 offset:36864
    ds_read_b64_tr_b16 a[222:223], v101 offset:37888
    s_waitcnt lgkmcnt(0)
    s_waitcnt vmcnt(19)
    ds_write_b128 v98, v[80:83] offset:16384
    s_waitcnt vmcnt(18)
    ds_write_b128 v98, v[84:87] offset:17408
    s_waitcnt vmcnt(17)
    ds_write_b128 v98, v[88:91] offset:18432
    s_waitcnt vmcnt(16)
    ds_write_b128 v98, v[92:95] offset:19456
    s_waitcnt lgkmcnt(0)
    s_add_u32 s30, s68, 4718592
    buffer_load_dwordx4 v[80:83], v96, s[64:67], s30 offen
    s_add_u32 s30, s68, 4751360
    buffer_load_dwordx4 v[84:87], v96, s[64:67], s30 offen
    s_add_u32 s30, s68, 4784128
    buffer_load_dwordx4 v[88:91], v96, s[64:67], s30 offen
    s_add_u32 s30, s68, 4816896
    buffer_load_dwordx4 v[92:95], v96, s[64:67], s30 offen
    s_barrier
    ds_read_b64_tr_b16 a[224:225], v100 offset:16384
    ds_read_b64_tr_b16 a[226:227], v100 offset:17408
    ds_read_b64_tr_b16 a[228:229], v100 offset:20480
    ds_read_b64_tr_b16 a[230:231], v100 offset:21504
    ds_read_b64_tr_b16 a[232:233], v101 offset:16384
    ds_read_b64_tr_b16 a[234:235], v101 offset:17408
    ds_read_b64_tr_b16 a[236:237], v101 offset:20480
    ds_read_b64_tr_b16 a[238:239], v101 offset:21504
    s_waitcnt lgkmcnt(0)
    s_waitcnt vmcnt(19)
    ds_write_b128 v98, v[16:19] offset:32768
    s_waitcnt vmcnt(18)
    ds_write_b128 v98, v[20:23] offset:33792
    s_waitcnt vmcnt(17)
    ds_write_b128 v98, v[24:27] offset:34816
    s_waitcnt vmcnt(16)
    ds_write_b128 v98, v[28:31] offset:35840
    s_waitcnt lgkmcnt(0)
    s_barrier
    ds_read_b64_tr_b16 a[240:241], v100 offset:32768
    ds_read_b64_tr_b16 a[242:243], v100 offset:33792
    ds_read_b64_tr_b16 a[244:245], v100 offset:36864
    ds_read_b64_tr_b16 a[246:247], v100 offset:37888
    ds_read_b64_tr_b16 a[248:249], v101 offset:32768
    ds_read_b64_tr_b16 a[250:251], v101 offset:33792
    ds_read_b64_tr_b16 a[252:253], v101 offset:36864
    ds_read_b64_tr_b16 a[254:255], v101 offset:37888
    s_waitcnt lgkmcnt(0)
    s_waitcnt vmcnt(15)
    ds_write_b128 v98, v[32:35] offset:16384
    s_waitcnt vmcnt(14)
    ds_write_b128 v98, v[36:39] offset:17408
    s_waitcnt vmcnt(13)
    ds_write_b128 v98, v[40:43] offset:18432
    s_waitcnt vmcnt(12)
    ds_write_b128 v98, v[44:47] offset:19456
    s_waitcnt lgkmcnt(0)
    s_barrier
    ds_read_b64_tr_b16 v[192:193], v100 offset:16384
    ds_read_b64_tr_b16 v[194:195], v100 offset:17408
    ds_read_b64_tr_b16 v[196:197], v100 offset:20480
    ds_read_b64_tr_b16 v[198:199], v100 offset:21504
    ds_read_b64_tr_b16 v[200:201], v101 offset:16384
    ds_read_b64_tr_b16 v[202:203], v101 offset:17408
    ds_read_b64_tr_b16 v[204:205], v101 offset:20480
    ds_read_b64_tr_b16 v[206:207], v101 offset:21504
    s_waitcnt lgkmcnt(0)
    s_waitcnt vmcnt(11)
    ds_write_b128 v98, v[48:51] offset:32768
    s_waitcnt vmcnt(10)
    ds_write_b128 v98, v[52:55] offset:33792
    s_waitcnt vmcnt(9)
    ds_write_b128 v98, v[56:59] offset:34816
    s_waitcnt vmcnt(8)
    ds_write_b128 v98, v[60:63] offset:35840
    s_waitcnt lgkmcnt(0)
    s_barrier
    ds_read_b64_tr_b16 v[208:209], v100 offset:32768
    ds_read_b64_tr_b16 v[210:211], v100 offset:33792
    ds_read_b64_tr_b16 v[212:213], v100 offset:36864
    ds_read_b64_tr_b16 v[214:215], v100 offset:37888
    ds_read_b64_tr_b16 v[216:217], v101 offset:32768
    ds_read_b64_tr_b16 v[218:219], v101 offset:33792
    ds_read_b64_tr_b16 v[220:221], v101 offset:36864
    ds_read_b64_tr_b16 v[222:223], v101 offset:37888
    s_waitcnt lgkmcnt(0)
    s_waitcnt vmcnt(7)
    ds_write_b128 v98, v[64:67] offset:16384
    s_waitcnt vmcnt(6)
    ds_write_b128 v98, v[68:71] offset:17408
    s_waitcnt vmcnt(5)
    ds_write_b128 v98, v[72:75] offset:18432
    s_waitcnt vmcnt(4)
    ds_write_b128 v98, v[76:79] offset:19456
    s_waitcnt lgkmcnt(0)
    s_barrier
    ds_read_b64_tr_b16 v[224:225], v100 offset:16384
    ds_read_b64_tr_b16 v[226:227], v100 offset:17408
    ds_read_b64_tr_b16 v[228:229], v100 offset:20480
    ds_read_b64_tr_b16 v[230:231], v100 offset:21504
    ds_read_b64_tr_b16 v[232:233], v101 offset:16384
    ds_read_b64_tr_b16 v[234:235], v101 offset:17408
    ds_read_b64_tr_b16 v[236:237], v101 offset:20480
    ds_read_b64_tr_b16 v[238:239], v101 offset:21504
    s_waitcnt lgkmcnt(0)
    s_waitcnt vmcnt(3)
    ds_write_b128 v98, v[80:83] offset:32768
    s_waitcnt vmcnt(2)
    ds_write_b128 v98, v[84:87] offset:33792
    s_waitcnt vmcnt(1)
    ds_write_b128 v98, v[88:91] offset:34816
    s_waitcnt vmcnt(0)
    ds_write_b128 v98, v[92:95] offset:35840
    s_waitcnt lgkmcnt(0)
    s_barrier
    ds_read_b64_tr_b16 v[240:241], v100 offset:32768
    ds_read_b64_tr_b16 v[242:243], v100 offset:33792
    ds_read_b64_tr_b16 v[244:245], v100 offset:36864
    ds_read_b64_tr_b16 v[246:247], v100 offset:37888
    ds_read_b64_tr_b16 v[248:249], v101 offset:32768
    ds_read_b64_tr_b16 v[250:251], v101 offset:33792
    ds_read_b64_tr_b16 v[252:253], v101 offset:36864
    ds_read_b64_tr_b16 v[254:255], v101 offset:37888
    s_waitcnt lgkmcnt(0)
prodone_6:
    s_waitcnt vmcnt(0) lgkmcnt(0)
    s_barrier
    v_lshl_or_b32 v16, v121, 16, v120
    v_lshl_or_b32 v17, v123, 16, v122
    v_lshl_or_b32 v18, v125, 16, v124
    v_lshl_or_b32 v19, v127, 16, v126
    v_lshlrev_b32 v10, 4, v0
    ds_write_b128 v10, v[16:19] offset:0
    s_waitcnt lgkmcnt(0)
    v_lshl_or_b32 v16, v129, 16, v128
    v_lshl_or_b32 v17, v131, 16, v130
    v_lshl_or_b32 v18, v133, 16, v132
    v_lshl_or_b32 v19, v135, 16, v134
    v_lshlrev_b32 v10, 4, v0
    ds_write_b128 v10, v[16:19] offset:4096
    s_waitcnt lgkmcnt(0)
    v_cmp_gt_u32 vcc, 128, v0
    s_nop 0
    s_and_saveexec_b64 s[16:17], vcc
    s_cbranch_execz m0skip_7
    v_lshl_or_b32 v16, v137, 16, v136
    v_lshl_or_b32 v17, v139, 16, v138
    v_lshl_or_b32 v18, v141, 16, v140
    v_lshl_or_b32 v19, v143, 16, v142
    v_lshlrev_b32 v10, 4, v0
    ds_write_b128 v10, v[16:19] offset:8192
    s_waitcnt lgkmcnt(0)
m0skip_7:
    s_mov_b64 exec, s[16:17]
    v_mov_b32 v190, v14
    s_waitcnt vmcnt(0) lgkmcnt(0)
    s_barrier
    s_load_dwordx2 s[96:97], s[0:1], 96
    s_waitcnt lgkmcnt(0)
    v_mov_b32 v10, 0
    v_mov_b32 v11, s91
    s_cmp_lg_u32 s4, 0
    s_cbranch_scc1 sb_8
    s_mov_b64 exec, 1
    global_atomic_add v10, v11, s[96:97] offset:4 sc1
sbp_9:
    s_sleep 2
    global_load_dword v16, v10, s[96:97] offset:4 sc1
    s_waitcnt vmcnt(0)
    s_waitcnt vmcnt(0)
    v_and_b32 v17, 0xffff, v16
    v_cmp_gt_u32 vcc, 64, v17
    s_cbranch_vccnz sbp_9
    v_lshrrev_b32 v16, 16, v16
    v_mov_b32 v11, 0
    ds_write_b32 v11, v16 offset:20480
    s_waitcnt lgkmcnt(0)
    s_mov_b64 exec, -1
sb_8:
    s_barrier
    v_mov_b32 v11, 0
    ds_read_b32 v16, v11 offset:20480
    s_waitcnt lgkmcnt(0)
    s_waitcnt lgkmcnt(0)
    v_readfirstlane_b32 s90, v16
    s_nop 0
    s_and_b32 s90, s90, 0xff
    s_mov_b32 s78, 0
    s_mov_b32 s5, 0
    s_cmp_lt_u32 s5, 8
    s_cbranch_scc0 ws1_10
    s_mov_b32 s30, 252
    s_lshr_b32 s31, s5, 1
    s_lshl_b32 s31, s31, 3
    v_mov_b32 v10, s30
kvp_12:
    global_load_dword v11, v10, s[96:97] sc1
    s_waitcnt vmcnt(0)
    s_waitcnt vmcnt(0)
    v_lshrrev_b32 v11, s31, v11
    v_and_b32 v11, 0xff, v11
    v_cmp_gt_u32 vcc, 64, v11
    s_cbranch_vccz kvp_12d
    s_sleep 4
    s_branch kvp_12
kvp_12d:
    s_branch ws2_11
ws1_10:
    s_lshr_b32 s30, s5, 4
    s_lshl_b32 s30, s30, 2
    s_add_u32 s30, s30, 16
    s_bfe_u32 s31, s5, 0x10003
    s_lshl_b32 s31, s31, 4
    v_mov_b32 v10, s30
kvp_13:
    global_load_dword v11, v10, s[96:97] sc1
    s_waitcnt vmcnt(0)
    s_waitcnt vmcnt(0)
    v_lshrrev_b32 v11, s31, v11
    v_and_b32 v11, 0xffff, v11
    v_cmp_gt_u32 vcc, 64, v11
    s_cbranch_vccz kvp_13d
    s_sleep 4
    s_branch kvp_13
kvp_13d:
ws2_11:
    v_mov_b32 v176, 0x3f803f80
    v_mov_b32 v177, 0x3f803f80
    v_mov_b32 v178, 0x3f803f80
    v_mov_b32 v179, 0x3f803f80
    v_mov_b32 v10, 0x3f803f80
    v_cmp_gt_u32 vcc, 32, v1
    s_nop 1
    v_cndmask_b32 v180, 0, v10, vcc
    v_cndmask_b32 v181, 0, v10, vcc
    s_lshl_b32 s24, s27, 13
    s_add_u32 s55, s57, s24
    s_add_u32 s56, s58, s24
    s_lshl_b32 s39, s39, 0
    v_add_u32 v11, 4096, v6
    s_cmp_lg_u32 s90, 0
    s_cbranch_scc1 slowmode_15
    s_and_b32 s31, s5, 3
    s_mul_i32 s21, s31, 10240
    s_add_u32 s21, s21, s39
    s_add_u32 s40, s21, 4096
    s_add_u32 s41, s21, s42
    s_and_b32 s20, s5, 1
    s_add_u32 s30, s5, 1
    s_and_b32 s31, s30, 3
    s_mul_i32 s22, s31, 10240
    s_add_u32 s22, s22, s38
    s_add_u32 s30, s5, 3
    s_and_b32 s31, s30, 3
    s_mul_i32 s23, s31, 10240
    s_add_u32 s23, s23, s38
    s_lshl_b32 s25, s5, 5
    s_add_u32 s25, s25, s27
    s_lshl_b32 s24, s25, 13
    s_add_u32 s24, s24, 262144
    s_add_u32 s55, s57, s24
    s_add_u32 s56, s58, s24
    s_lshl_b32 s25, s25, 12
    s_add_u32 s25, s25, 8388608
    s_lshl_b32 s30, s20, 12
    s_add_u32 s70, s45, s30
    s_add_u32 s71, s47, s30
    s_xor_b32 s30, s30, 4096
    s_add_u32 s46, s45, s30
    s_add_u32 s18, s47, s30
    s_lshl_b32 s30, s5, 12
    s_and_b32 s30, s30, 8192
    s_cmp_lt_u32 s5, 6
    s_cselect_b32 s30, s30, s78
    s_add_u32 s79, s43, s30
    s_add_u32 s80, s44, s30
    s_cmp_eq_u32 s36, 1
    s_cbranch_scc1 stepb_17s
    buffer_load_dwordx4 v[72:75], v6, s[8:11], s55 offen offset:0
    buffer_load_dwordx4 v[76:79], v6, s[8:11], s55 offen offset:1024
    buffer_load_dwordx4 v[80:83], v6, s[8:11], s56 offen
    buffer_load_dwordx4 v[84:87], v6, s[8:11], s56 offen offset:1024
    s_waitcnt vmcnt(0)
    ds_write_b128 v191, v[72:75] offset:24576
    ds_write_b128 v191, v[76:79] offset:25600
    s_waitcnt lgkmcnt(0)
    s_barrier
    s_branch stepa_16s
stepa_16:
    s_waitcnt vmcnt(0)
    ds_write_b128 v191, v[72:75] offset:24576
    ds_write_b128 v191, v[76:79] offset:25600
    s_barrier
    s_sleep 3
mpoll_18:
    buffer_load_dwordx4 v[128:131], v6, s[8:11], s21 offen sc1
    buffer_load_dwordx4 v[132:135], v6, s[8:11], s40 offen sc1
    buffer_load_dwordx4 v[136:139], v6, s[8:11], s41 offen sc1
    s_waitcnt vmcnt(0)
    v_max3_u32 v10, v128, v129, v130
    v_max3_u32 v11, v131, v132, v133
    v_max3_u32 v10, v10, v134, v135
    v_max3_u32 v11, v11, v136, v137
    v_max3_u32 v10, v10, v138, v139
    v_max_u32 v10, v10, v11
    v_cmp_eq_u32 vcc, -1, v10
    s_cbranch_vccnz mpoll_18
    v_add_u32 v11, s42, v12
    ds_write_b128 v12, v[128:131] offset:0
    ds_write_b128 v12, v[132:135] offset:4096
    ds_write_b128 v11, v[136:139] offset:0
    s_waitcnt lgkmcnt(0)
    s_barrier
stepa_16s:
    s_cmp_eq_u32 s5, 63
    s_cbranch_scc1 chend_14
    s_add_u32 s19, s5, 1
    s_cmp_ge_u32 s19, 64
    s_cbranch_scc1 nokv_19
    s_cmp_lt_u32 s19, 8
    s_cselect_b32 s30, 1, 7
    s_and_b32 s30, s19, s30
    s_cmp_lg_u32 s30, 0
    s_cbranch_scc1 nokv_19
    s_waitcnt vmcnt(0)
    s_cmp_lt_u32 s19, 8
    s_cbranch_scc0 ws1_21
    s_mov_b32 s30, 252
    s_lshr_b32 s31, s19, 1
    s_lshl_b32 s31, s31, 3
    v_mov_b32 v10, s30
kvp_23:
    global_load_dword v11, v10, s[96:97] sc1
    s_waitcnt vmcnt(0)
    s_waitcnt vmcnt(0)
    v_lshrrev_b32 v11, s31, v11
    v_and_b32 v11, 0xff, v11
    v_cmp_gt_u32 vcc, 64, v11
    s_cbranch_vccz kvp_23d
    s_sleep 4
    s_branch kvp_23
kvp_23d:
    s_branch ws2_22
ws1_21:
    s_lshr_b32 s30, s19, 4
    s_lshl_b32 s30, s30, 2
    s_add_u32 s30, s30, 16
    s_bfe_u32 s31, s19, 0x10003
    s_lshl_b32 s31, s31, 4
    v_mov_b32 v10, s30
kvp_24:
    global_load_dword v11, v10, s[96:97] sc1
    s_waitcnt vmcnt(0)
    s_waitcnt vmcnt(0)
    v_lshrrev_b32 v11, s31, v11
    v_and_b32 v11, 0xffff, v11
    v_cmp_gt_u32 vcc, 64, v11
    s_cbranch_vccz kvp_24d
    s_sleep 4
    s_branch kvp_24
kvp_24d:
ws2_22:
nokv_19:
    ds_read_b64_tr_b16 v[16:17], v3 offset:0
    ds_read_b64_tr_b16 v[18:19], v3 offset:512
    ds_read_b64_tr_b16 v[20:21], v3 offset:1024
    ds_read_b64_tr_b16 v[22:23], v3 offset:1536
    ds_read_b64_tr_b16 v[24:25], v3 offset:2048
    ds_read_b64_tr_b16 v[26:27], v3 offset:2560
    ds_read_b64_tr_b16 v[28:29], v3 offset:3072
    ds_read_b64_tr_b16 v[30:31], v3 offset:3584
    v_mov_b64 v[56:57], 0
    v_mov_b64 v[58:59], 0
    v_mov_b64 v[60:61], 0
    v_mov_b64 v[62:63], 0
    ds_read_b64_tr_b16 v[32:33], v3 offset:4096
    ds_read_b64_tr_b16 v[34:35], v3 offset:4608
    ds_read_b64_tr_b16 v[36:37], v3 offset:5120
    ds_read_b64_tr_b16 v[38:39], v3 offset:5632
    ds_read_b64_tr_b16 v[40:41], v3 offset:6144
    v_mov_b64 v[64:65], 0
    ds_read_b64_tr_b16 v[42:43], v3 offset:6656
    v_mov_b64 v[66:67], 0
    s_waitcnt lgkmcnt(12)
    v_smfmac_f32_16x16x64_bf16 v[56:59], v[16:19], a[0:7], v2
    ds_read_b64_tr_b16 v[44:45], v3 offset:7168
    ds_read_b64_tr_b16 v[46:47], v3 offset:7680
    ds_read_b64_tr_b16 v[48:49], v3 offset:8192
    v_smfmac_f32_16x16x64_bf16 v[60:63], v[16:19], a[8:15], v2
    ds_read_b64_tr_b16 v[50:51], v3 offset:8704
    ds_read_b64_tr_b16 v[52:53], v3 offset:9216
    s_waitcnt lgkmcnt(15)
    v_smfmac_f32_16x16x64_bf16 v[56:59], v[20:23], a[16:23], v2
    ds_read_b64_tr_b16 v[54:55], v3 offset:9728
    ds_read_b128 v[96:99], v6 offset:24576
    v_mov_b64 v[68:69], 0
    v_smfmac_f32_16x16x64_bf16 v[60:63], v[20:23], a[24:31], v2
    ds_read_b128 v[100:103], v6 offset:25600
    v_mov_b64 v[70:71], 0
    s_waitcnt lgkmcnt(15)
    v_smfmac_f32_16x16x64_bf16 v[56:59], v[24:27], a[32:39], v2
    ds_read_b128 v[104:107], v6 offset:26624
    v_smfmac_f32_16x16x64_bf16 v[60:63], v[24:27], a[40:47], v2
    ds_read_b128 v[108:111], v6 offset:27648
    v_mov_b64 v[24:25], 0
    s_waitcnt lgkmcnt(15)
    v_smfmac_f32_16x16x64_bf16 v[56:59], v[28:31], a[48:55], v2
    ds_read_b128 v[112:115], v6 offset:28672
    v_mov_b64 v[26:27], 0
    v_smfmac_f32_16x16x64_bf16 v[60:63], v[28:31], a[56:63], v2
    ds_read_b128 v[116:119], v6 offset:29696
    v_mov_b64 v[28:29], 0
    s_waitcnt lgkmcnt(15)
    v_smfmac_f32_16x16x64_bf16 v[56:59], v[32:35], a[64:71], v2
    ds_read_b128 v[120:123], v6 offset:30720
    ds_read_b128 v[124:127], v6 offset:31744
    v_smfmac_f32_16x16x64_bf16 v[60:63], v[32:35], a[72:79], v2
    v_mov_b64 v[30:31], 0
    s_waitcnt lgkmcnt(15)
    v_smfmac_f32_16x16x64_bf16 v[56:59], v[36:39], a[80:87], v2
    v_mov_b64 v[32:33], 0
    v_smfmac_f32_16x16x64_bf16 v[60:63], v[36:39], a[88:95], v2
    v_mov_b64 v[34:35], 0
    s_waitcnt lgkmcnt(14)
    v_smfmac_f32_16x16x64_bf16 v[56:59], v[40:43], a[96:103], v2
    v_mov_b64 v[36:37], 0
    v_smfmac_f32_16x16x64_bf16 v[60:63], v[40:43], a[104:111], v2
    v_mov_b64 v[38:39], 0
    s_waitcnt lgkmcnt(12)
    v_smfmac_f32_16x16x64_bf16 v[56:59], v[44:47], a[112:119], v2
    v_mov_b64 v[40:41], 0
    v_smfmac_f32_16x16x64_bf16 v[60:63], v[44:47], a[120:127], v2
    v_mov_b64 v[42:43], 0
    s_waitcnt lgkmcnt(10)
    v_smfmac_f32_16x16x64_bf16 v[56:59], v[48:51], a[128:135], v2
    v_mov_b64 v[44:45], 0
    v_smfmac_f32_16x16x64_bf16 v[60:63], v[48:51], a[136:143], v2
    v_mov_b64 v[46:47], 0
    s_waitcnt lgkmcnt(8)
    v_smfmac_f32_16x16x64_bf16 v[56:59], v[52:55], a[144:151], v2
    v_mov_b64 v[48:49], 0
    v_smfmac_f32_16x16x64_bf16 v[60:63], v[52:55], a[152:159], v2
    v_mov_b64 v[50:51], 0
    v_mov_b64 v[52:53], 0
    v_mov_b64 v[54:55], 0
    s_nop 4
    v_permlane32_swap_b32 v56, v60
    v_permlane32_swap_b32 v57, v61
    v_permlane32_swap_b32 v58, v62
    v_permlane32_swap_b32 v59, v63
    v_pk_add_f32 v[56:57], v[56:57], v[60:61]
    v_pk_add_f32 v[58:59], v[58:59], v[62:63]
    v_mul_f32 v56, s29, v56
    v_mul_f32 v57, s29, v57
    v_mul_f32 v58, s29, v58
    v_mul_f32 v59, s29, v59
    v_cvt_pk_bf16_f32 v60, v56, v57
    v_cvt_pk_bf16_f32 v61, v58, v59
    ds_write_b64 v4, v[60:61] offset:10240
    s_waitcnt lgkmcnt(0)
    s_barrier
    ds_read_b64_tr_b16 v[128:129], v5 offset:10240
    ds_read_b64_tr_b16 v[130:131], v5 offset:10496
    ds_read_b64_tr_b16 v[132:133], v5 offset:10752
    ds_read_b64_tr_b16 v[134:135], v5 offset:11008
    ds_read_b64_tr_b16 v[136:137], v5 offset:11264
    ds_read_b64_tr_b16 v[138:139], v5 offset:11520
    ds_read_b64_tr_b16 v[140:141], v5 offset:11776
    ds_read_b64_tr_b16 v[142:143], v5 offset:12032
    s_waitcnt lgkmcnt(6)
    v_mfma_f32_16x16x32_bf16 v[160:163], v[96:99], v[128:131], 0
    s_waitcnt lgkmcnt(4)
    v_mfma_f32_16x16x32_bf16 v[160:163], v[100:103], v[132:135], v[160:163]
    s_waitcnt lgkmcnt(2)
    v_mfma_f32_16x16x32_bf16 v[160:163], v[104:107], v[136:139], v[160:163]
    s_waitcnt lgkmcnt(0)
    v_mfma_f32_16x16x32_bf16 v[160:163], v[108:111], v[140:143], v[160:163]
    v_mfma_f32_16x16x32_bf16 v[164:167], v[112:115], v[128:131], 0
    v_mfma_f32_16x16x32_bf16 v[164:167], v[116:119], v[132:135], v[164:167]
    s_nop 1
    buffer_load_dwordx2 v[184:185], v4, s[8:11], s70 offen sc1
    v_exp_f32 v96, v160
    v_mfma_f32_16x16x32_bf16 v[164:167], v[120:123], v[136:139], v[164:167]
    v_exp_f32 v97, v161
    v_mfma_f32_16x16x32_bf16 v[164:167], v[124:127], v[140:143], v[164:167]
    v_exp_f32 v98, v162
    v_exp_f32 v99, v163
    s_waitcnt vmcnt(0)
    v_cmp_eq_u32 vcc, -1, v184
    s_cbranch_vccz kpd_26
kpoll_25:
    buffer_load_dwordx2 v[184:185], v4, s[8:11], s70 offen sc1
    s_waitcnt vmcnt(0)
    v_cmp_eq_u32 vcc, -1, v184
    s_cbranch_vccnz kpoll_25
kpd_26:
    ds_write_b64 v4, v[184:185] offset:12288
    v_exp_f32 v100, v164
    v_exp_f32 v101, v165
    v_exp_f32 v102, v166
    v_exp_f32 v103, v167
    v_cvt_pk_bf16_f32 v88, v96, v97
    v_cvt_pk_bf16_f32 v89, v98, v99
    v_cvt_pk_bf16_f32 v90, v100, v101
    s_waitcnt lgkmcnt(0)
    s_barrier
    v_cvt_pk_bf16_f32 v91, v102, v103
    ds_read_b64_tr_b16 v[144:145], v5 offset:12288
    ds_read_b64_tr_b16 v[146:147], v5 offset:12544
    ds_read_b64_tr_b16 v[148:149], v5 offset:12800
    ds_read_b64_tr_b16 v[150:151], v5 offset:13056
    ds_read_b64_tr_b16 v[152:153], v5 offset:13312
    ds_read_b64_tr_b16 v[154:155], v5 offset:13568
    ds_read_b64_tr_b16 v[156:157], v5 offset:13824
    ds_read_b64_tr_b16 v[158:159], v5 offset:14080
    v_mfma_f32_16x16x32_bf16 v[172:175], v[176:179], v[88:91], 0
    buffer_load_dwordx4 v[184:187], v12, s[8:11], s71 offen sc1
    v_mfma_f32_16x16x32_bf16 v[56:59], v[80:83], v[88:91], 0
    v_mfma_f32_16x16x32_bf16 v[60:63], v[84:87], v[88:91], 0
    s_waitcnt lgkmcnt(6)
    v_mfma_f32_16x16x32_bf16 v[168:171], v[144:147], v[128:131], 0
    s_waitcnt lgkmcnt(4)
    v_mfma_f32_16x16x32_bf16 v[168:171], v[148:151], v[132:135], v[168:171]
    s_waitcnt lgkmcnt(2)
    v_mfma_f32_16x16x32_bf16 v[168:171], v[152:155], v[136:139], v[168:171]
    s_waitcnt lgkmcnt(0)
    v_mfma_f32_16x16x32_bf16 v[168:171], v[156:159], v[140:143], v[168:171]
    s_nop 7
    v_exp_f32 v104, v168
    v_exp_f32 v105, v169
    v_exp_f32 v106, v170
    v_exp_f32 v107, v171
    v_cvt_pk_bf16_f32 v92, v104, v105
    v_cvt_pk_bf16_f32 v93, v106, v107
    s_nop 1
    v_mfma_f32_16x16x16_bf16 v[172:175], v[180:181], v[92:93], v[172:175]
    s_waitcnt vmcnt(0)
    v_cmp_eq_u32 vcc, -1, v184
    s_cbranch_vccz vpd_28
vpoll_27:
    buffer_load_dwordx4 v[184:187], v12, s[8:11], s71 offen sc1
    s_waitcnt vmcnt(0)
    v_cmp_eq_u32 vcc, -1, v184
    s_cbranch_vccnz vpoll_27
vpd_28:
    s_nop 4
    v_subrev_u32 v10, s94, v172
    v_cmp_le_u32 vcc, s95, v10
    s_cbranch_vccnz slow_29
slowd_30:
    v_mfma_f32_16x16x16_bf16 v[56:59], v[184:185], v[92:93], v[56:59]
    buffer_load_dwordx4 v[72:75], v6, s[8:11], s55 offen offset:0
    v_rcp_f32 v10, v172
    v_mfma_f32_16x16x16_bf16 v[60:63], v[186:187], v[92:93], v[60:63]
    buffer_load_dwordx4 v[76:79], v6, s[8:11], s55 offen offset:1024
    s_nop 1
    v_cndmask_b32 v56, v56, v58, s[48:49]
    v_cndmask_b32 v57, v57, v59, s[48:49]
    v_mul_f32 v56, v10, v56
    v_mul_f32 v57, v10, v57
    s_nop 0
    v_cndmask_b32 v60, v60, v62, s[48:49]
    v_cndmask_b32 v61, v61, v63, s[48:49]
    v_mul_f32 v60, v10, v60
    v_mul_f32 v61, v10, v61
    v_cvt_pk_bf16_f32 v170, v56, v57
    v_cvt_pk_bf16_f32 v171, v60, v61
    ds_write_b64 v13, v[170:171] offset:14336
    buffer_load_dwordx4 v[80:83], v6, s[8:11], s56 offen
    s_waitcnt lgkmcnt(0)
    s_barrier
    buffer_load_dwordx4 v[84:87], v6, s[8:11], s56 offen offset:1024
    ds_read_b128 v[16:19], v6 offset:14336
    ds_read_b128 v[20:23], v6 offset:15360
    s_waitcnt lgkmcnt(1)
    v_smfmac_f32_16x16x64_bf16 v[24:27], v[16:19], a[160:167], v2
    v_smfmac_f32_16x16x64_bf16 v[28:31], v[16:19], a[168:175], v2
    s_waitcnt lgkmcnt(0)
    v_smfmac_f32_16x16x64_bf16 v[24:27], v[20:23], a[176:183], v2
    v_smfmac_f32_16x16x64_bf16 v[28:31], v[20:23], a[184:191], v2
    v_smfmac_f32_16x16x64_bf16 v[32:35], v[16:19], a[192:199], v2
    v_smfmac_f32_16x16x64_bf16 v[36:39], v[16:19], a[200:207], v2
    s_nop 1
    v_permlane32_swap_b32 v24, v28
    v_permlane32_swap_b32 v25, v29
    v_smfmac_f32_16x16x64_bf16 v[32:35], v[20:23], a[208:215], v2
    v_permlane32_swap_b32 v26, v30
    v_smfmac_f32_16x16x64_bf16 v[36:39], v[20:23], a[216:223], v2
    v_permlane32_swap_b32 v27, v31
    v_pk_add_f32 v[24:25], v[24:25], v[28:29]
    v_smfmac_f32_16x16x64_bf16 v[40:43], v[16:19], a[224:231], v2
    v_pk_add_f32 v[26:27], v[26:27], v[30:31]
    s_nop 1
    v_permlane32_swap_b32 v32, v36
    v_permlane32_swap_b32 v33, v37
    v_smfmac_f32_16x16x64_bf16 v[44:47], v[16:19], a[232:239], v2
    v_and_or_b32 v24, v24, -2, s20
    v_smfmac_f32_16x16x64_bf16 v[40:43], v[20:23], a[240:247], v2
    buffer_store_dwordx4 v[24:27], v7, s[8:11], s50 offen
    v_permlane32_swap_b32 v34, v38
    v_smfmac_f32_16x16x64_bf16 v[44:47], v[20:23], a[248:255], v2
    v_permlane32_swap_b32 v35, v39
    v_pk_add_f32 v[32:33], v[32:33], v[36:37]
    v_pk_add_f32 v[34:35], v[34:35], v[38:39]
    v_and_or_b32 v32, v32, -2, s20
    v_smfmac_f32_16x16x64_bf16 v[48:51], v[16:19], v[192:199], v2
    buffer_store_dwordx4 v[32:35], v7, s[8:11], s51 offen
    v_permlane32_swap_b32 v40, v44
    v_permlane32_swap_b32 v41, v45
    v_smfmac_f32_16x16x64_bf16 v[52:55], v[16:19], v[200:207], v2
    v_permlane32_swap_b32 v42, v46
    v_permlane32_swap_b32 v43, v47
    v_pk_add_f32 v[40:41], v[40:41], v[44:45]
    v_smfmac_f32_16x16x64_bf16 v[48:51], v[20:23], v[208:215], v2
    v_pk_add_f32 v[42:43], v[42:43], v[46:47]
    v_smfmac_f32_16x16x64_bf16 v[52:55], v[20:23], v[216:223], v2
    v_and_or_b32 v40, v40, -2, s20
    v_smfmac_f32_16x16x64_bf16 v[64:67], v[16:19], v[224:231], v2
    buffer_store_dwordx4 v[40:43], v7, s[8:11], s52 offen
    v_smfmac_f32_16x16x64_bf16 v[68:71], v[16:19], v[232:239], v2
    v_permlane32_swap_b32 v48, v52
    v_permlane32_swap_b32 v49, v53
    v_permlane32_swap_b32 v50, v54
    v_permlane32_swap_b32 v51, v55
    v_pk_add_f32 v[48:49], v[48:49], v[52:53]
    v_smfmac_f32_16x16x64_bf16 v[64:67], v[20:23], v[240:247], v2
    v_pk_add_f32 v[50:51], v[50:51], v[54:55]
    v_smfmac_f32_16x16x64_bf16 v[68:71], v[20:23], v[248:255], v2
    v_and_or_b32 v48, v48, -2, s20
    buffer_store_dwordx4 v[48:51], v7, s[8:11], s53 offen
    s_nop 5
    v_permlane32_swap_b32 v64, v68
    v_permlane32_swap_b32 v65, v69
    v_permlane32_swap_b32 v66, v70
    v_permlane32_swap_b32 v67, v71
    v_pk_add_f32 v[64:65], v[64:65], v[68:69]
    v_pk_add_f32 v[66:67], v[66:67], v[70:71]
    v_and_or_b32 v64, v64, -2, s20
    buffer_store_dwordx4 v[64:67], v7, s[8:11], s54 offen
    s_cmp_eq_u32 s37, 0
    s_cbranch_scc1 nored_31
    s_waitcnt vmcnt(0)
retry_32:
    buffer_load_dwordx4 v[144:147], v8, s[8:11], s32 offen sc1
    buffer_load_dwordx4 v[148:151], v8, s[8:11], s33 offen sc1
    buffer_load_dwordx4 v[152:155], v8, s[8:11], s34 offen sc1
    buffer_load_dwordx4 v[156:159], v8, s[8:11], s35 offen sc1
    s_waitcnt vmcnt(3)
    v_xor_b32 v10, s20, v144
    s_waitcnt vmcnt(2)
    v_bitop3_b32 v10, v10, v148, s20 bitop3:0xf6
    v_pk_add_f32 v[144:145], v[144:145], v[148:149]
    v_pk_add_f32 v[146:147], v[146:147], v[150:151]
    s_waitcnt vmcnt(1)
    v_bitop3_b32 v10, v10, v152, s20 bitop3:0xf6
    v_pk_add_f32 v[144:145], v[144:145], v[152:153]
    v_pk_add_f32 v[146:147], v[146:147], v[154:155]
    s_waitcnt vmcnt(0)
    v_bitop3_b32 v10, v10, v156, s20 bitop3:0xf6
    v_pk_add_f32 v[144:145], v[144:145], v[156:157]
    v_pk_add_f32 v[146:147], v[146:147], v[158:159]
    v_and_b32 v10, 1, v10
    v_cmp_ne_u32 vcc, 0, v10
    s_cbranch_vccnz retry_32
    v_permlane32_swap_b32 v144, v145
    v_permlane32_swap_b32 v146, v147
    v_add_f32 v144, v144, v145
    v_add_f32 v146, v146, v147
    s_nop 1
    v_permlane16_swap_b32 v144, v146
    v_add_f32 v144, v144, v146
    v_and_or_b32 v148, v144, -2, s20
    s_andn2_b32 s30, s5, 2
    s_cmp_lg_u32 s30, 1
    s_cbranch_scc1 m1_35
    s_memtime s[84:85]
    s_waitcnt lgkmcnt(0)
m1_35:
    buffer_store_dword v148, v14, s[8:11], s79 offen sc1
    s_sleep 8
    buffer_load_dword v149, v14, s[8:11], s80 offen sc1
    s_sleep 2
xpoll_34:
    buffer_load_dword v150, v14, s[8:11], s80 offen sc1
    s_waitcnt vmcnt(1)
    v_xor_b32 v10, s20, v149
    v_and_b32 v10, 1, v10
    v_cmp_ne_u32 vcc, 0, v10
    s_cbranch_vccz xd_38
    buffer_load_dword v149, v14, s[8:11], s80 offen sc1
    s_waitcnt vmcnt(1)
    v_xor_b32 v10, s20, v150
    v_and_b32 v10, 1, v10
    v_cmp_ne_u32 vcc, 0, v10
    s_cbranch_vccnz xpoll_34
    s_waitcnt vmcnt(0)
xd_38:
    s_cmp_gt_u32 s5, 5
    s_cbranch_scc1 m2_36
    s_andn2_b32 s30, s5, 2
    s_cmp_lg_u32 s30, 1
    s_cbranch_scc1 m3_37
    s_memtime s[86:87]
    s_waitcnt lgkmcnt(0)
    s_waitcnt lgkmcnt(0)
    s_sub_u32 s86, s86, s84
    s_mov_b32 s81, s82
    s_mov_b32 s82, s86
    s_cmp_lg_u32 s5, 3
    s_cbranch_scc1 m2_36
    s_lshr_b32 s81, s81, 4
    s_lshr_b32 s82, s82, 4
    s_min_u32 s81, s81, 0x7fff
    s_min_u32 s82, s82, 0x7fff
    s_add_u32 s81, s81, 0x1000000
    s_mov_b64 exec, 1
    v_mov_b32 v10, 8
    v_mov_b32 v11, s82
    global_atomic_add v10, v11, s[96:97] sc1
    s_waitcnt vmcnt(0)
    v_mov_b32 v10, 136
    v_mov_b32 v11, s81
    global_atomic_add v10, v11, s[96:97] sc1
    s_mov_b64 exec, -1
    s_branch m2_36
m3_37:
    s_cmp_lg_u32 s5, 5
    s_cbranch_scc1 m2_36
    v_mov_b32 v10, 136
vl_39:
    global_load_dword v11, v10, s[96:97] sc1
    s_waitcnt vmcnt(0)
    s_waitcnt vmcnt(0)
    v_readfirstlane_b32 s30, v11
    s_nop 0
    s_lshr_b32 s31, s30, 24
    s_cmp_lt_u32 s31, 160
    s_cbranch_scc1 vl_39
    v_mov_b32 v10, 8
    global_load_dword v11, v10, s[96:97] sc1
    s_waitcnt vmcnt(0)
    s_waitcnt vmcnt(0)
    v_readfirstlane_b32 s31, v11
    s_and_b32 s30, s30, 0xffffff
    s_cmp_lt_u32 s31, s30
    s_cselect_b32 s78, 8192, 0
m2_36:
    v_add_f32 v144, v148, v149
    v_mov_b32 v145, v144
    s_nop 1
    v_permlane32_swap_b32 v145, v144
    v_cvt_pk_bf16_f32 v144, v145, v144
    v_min_u32 v144, -2, v144
    v_mov_b32 v146, -1
    buffer_store_dword v144, v9, s[8:11], s22 offen
    buffer_store_dword v146, v9, s[8:11], s23 offen
nored_31:
    s_add_u32 s5, s5, 1
    s_and_b32 s31, s5, 3
    s_mul_i32 s21, s31, 10240
    s_add_u32 s21, s21, s39
    s_add_u32 s40, s21, 4096
    s_add_u32 s41, s21, s42
    s_and_b32 s20, s5, 1
    s_add_u32 s30, s5, 1
    s_and_b32 s31, s30, 3
    s_mul_i32 s22, s31, 10240
    s_add_u32 s22, s22, s38
    s_add_u32 s30, s5, 3
    s_and_b32 s31, s30, 3
    s_mul_i32 s23, s31, 10240
    s_add_u32 s23, s23, s38
    s_lshl_b32 s25, s5, 5
    s_add_u32 s25, s25, s27
    s_lshl_b32 s24, s25, 13
    s_add_u32 s24, s24, 262144
    s_add_u32 s55, s57, s24
    s_add_u32 s56, s58, s24
    s_lshl_b32 s25, s25, 12
    s_add_u32 s25, s25, 8388608
    s_lshl_b32 s30, s20, 12
    s_add_u32 s70, s45, s30
    s_add_u32 s71, s47, s30
    s_xor_b32 s30, s30, 4096
    s_add_u32 s46, s45, s30
    s_add_u32 s18, s47, s30
    s_lshl_b32 s30, s5, 12
    s_and_b32 s30, s30, 8192
    s_cmp_lt_u32 s5, 6
    s_cselect_b32 s30, s30, s78
    s_add_u32 s79, s43, s30
    s_add_u32 s80, s44, s30
    s_cmp_lt_u32 s5, 64
    s_nop 3
    s_cbranch_scc1 stepa_16
    s_branch chend_14
slow_29:
    s_nop 7
    v_max3_f32 v10, v160, v161, v162
    v_max3_f32 v10, v163, v164, v10
    v_max3_f32 v10, v165, v166, v10
    v_max3_f32 v10, v168, v169, v10
    v_max3_f32 v10, v170, v171, v10
    v_max_f32 v10, v167, v10
    v_mov_b32 v11, v10
    s_nop 1
    v_permlane16_swap_b32 v11, v10
    v_max_f32 v10, v10, v11
    v_mov_b32 v11, v10
    s_nop 1
    v_permlane32_swap_b32 v11, v10
    v_max_f32 v10, v10, v11
    v_sub_f32 v96, v160, v10
    v_exp_f32 v96, v96
    v_sub_f32 v97, v161, v10
    v_exp_f32 v97, v97
    v_sub_f32 v98, v162, v10
    v_exp_f32 v98, v98
    v_sub_f32 v99, v163, v10
    v_exp_f32 v99, v99
    v_sub_f32 v100, v164, v10
    v_exp_f32 v100, v100
    v_sub_f32 v101, v165, v10
    v_exp_f32 v101, v101
    v_sub_f32 v102, v166, v10
    v_exp_f32 v102, v102
    v_sub_f32 v103, v167, v10
    v_exp_f32 v103, v103
    v_sub_f32 v104, v168, v10
    v_exp_f32 v104, v104
    v_sub_f32 v105, v169, v10
    v_exp_f32 v105, v105
    v_sub_f32 v106, v170, v10
    v_exp_f32 v106, v106
    v_sub_f32 v107, v171, v10
    v_exp_f32 v107, v107
    v_cvt_pk_bf16_f32 v88, v96, v97
    v_cvt_pk_bf16_f32 v89, v98, v99
    v_cvt_pk_bf16_f32 v90, v100, v101
    v_cvt_pk_bf16_f32 v91, v102, v103
    s_nop 1
    v_mfma_f32_16x16x32_bf16 v[56:59], v[80:83], v[88:91], 0
    v_mfma_f32_16x16x32_bf16 v[60:63], v[84:87], v[88:91], 0
    v_mfma_f32_16x16x32_bf16 v[172:175], v[176:179], v[88:91], 0
    s_nop 1
    v_cvt_pk_bf16_f32 v92, v104, v105
    v_cvt_pk_bf16_f32 v93, v106, v107
    s_nop 1
    v_mfma_f32_16x16x16_bf16 v[172:175], v[180:181], v[92:93], v[172:175]
    s_nop 9
    s_branch slowd_30
stepb_17:
    s_waitcnt vmcnt(0)
    s_barrier
    s_sleep 3
mpoll_40:
    buffer_load_dwordx4 v[128:131], v6, s[8:11], s21 offen sc1
    buffer_load_dwordx4 v[132:135], v6, s[8:11], s40 offen sc1
    buffer_load_dwordx4 v[136:139], v6, s[8:11], s41 offen sc1
    s_waitcnt vmcnt(0)
    v_max3_u32 v10, v128, v129, v130
    v_max3_u32 v11, v131, v132, v133
    v_max3_u32 v10, v10, v134, v135
    v_max3_u32 v11, v11, v136, v137
    v_max3_u32 v10, v10, v138, v139
    v_max_u32 v10, v10, v11
    v_cmp_eq_u32 vcc, -1, v10
    s_cbranch_vccnz mpoll_40
    v_add_u32 v11, s42, v12
    ds_write_b128 v12, v[128:131] offset:0
    ds_write_b128 v12, v[132:135] offset:4096
    ds_write_b128 v11, v[136:139] offset:0
    s_waitcnt lgkmcnt(0)
    s_barrier
    s_cmp_lg_u32 s4, 3
    s_cbranch_scc1 nopub_41
    s_add_u32 s30, s5, -1
    s_lshl_b32 s30, s30, 5
    s_add_u32 s30, s30, s27
    s_lshl_b32 s30, s30, 2
    s_add_u32 s30, s30, 1048576
    v_mov_b32 v10, 0
    v_mov_b32 v11, 1
    buffer_store_dword v11, v10, s[8:11], s30 offen sc1
nopub_41:
stepb_17s:
    ds_read_b64_tr_b16 v[16:17], v3 offset:0
    ds_read_b64_tr_b16 v[18:19], v3 offset:512
    v_mov_b64 v[56:57], 0
    v_mov_b64 v[58:59], 0
    v_mov_b64 v[60:61], 0
    v_mov_b64 v[62:63], 0
    ds_read_b64_tr_b16 v[20:21], v3 offset:1024
    ds_read_b64_tr_b16 v[22:23], v3 offset:1536
    ds_read_b64_tr_b16 v[24:25], v3 offset:2048
    ds_read_b64_tr_b16 v[26:27], v3 offset:2560
    ds_read_b64_tr_b16 v[28:29], v3 offset:3072
    ds_read_b64_tr_b16 v[30:31], v3 offset:3584
    ds_read_b64_tr_b16 v[32:33], v3 offset:4096
    ds_read_b64_tr_b16 v[34:35], v3 offset:4608
    ds_read_b64_tr_b16 v[36:37], v3 offset:5120
    v_mov_b64 v[64:65], 0
    ds_read_b64_tr_b16 v[38:39], v3 offset:5632
    v_mov_b64 v[66:67], 0
    ds_read_b64_tr_b16 v[40:41], v3 offset:6144
    v_mov_b64 v[68:69], 0
    s_waitcnt lgkmcnt(11)
    v_smfmac_f32_16x16x64_bf16 v[56:59], v[16:19], a[0:7], v2
    ds_read_b64_tr_b16 v[42:43], v3 offset:6656
    ds_read_b64_tr_b16 v[44:45], v3 offset:7168
    ds_read_b64_tr_b16 v[46:47], v3 offset:7680
    v_smfmac_f32_16x16x64_bf16 v[60:63], v[16:19], a[8:15], v2
    ds_read_b64_tr_b16 v[48:49], v3 offset:8192
    ds_read_b64_tr_b16 v[50:51], v3 offset:8704
    s_waitcnt lgkmcnt(14)
    v_smfmac_f32_16x16x64_bf16 v[56:59], v[20:23], a[16:23], v2
    ds_read_b64_tr_b16 v[52:53], v3 offset:9216
    ds_read_b64_tr_b16 v[54:55], v3 offset:9728
    v_mov_b64 v[70:71], 0
    v_smfmac_f32_16x16x64_bf16 v[60:63], v[20:23], a[24:31], v2
    v_mov_b32 v144, -1
    s_waitcnt lgkmcnt(14)
    v_smfmac_f32_16x16x64_bf16 v[56:59], v[24:27], a[32:39], v2
    v_mov_b32 v145, -1
    v_smfmac_f32_16x16x64_bf16 v[60:63], v[24:27], a[40:47], v2
    v_mov_b32 v146, -1
    s_waitcnt lgkmcnt(12)
    v_smfmac_f32_16x16x64_bf16 v[56:59], v[28:31], a[48:55], v2
    v_mov_b32 v147, -1
    v_smfmac_f32_16x16x64_bf16 v[60:63], v[28:31], a[56:63], v2
    s_waitcnt lgkmcnt(10)
    v_smfmac_f32_16x16x64_bf16 v[56:59], v[32:35], a[64:71], v2
    v_smfmac_f32_16x16x64_bf16 v[60:63], v[32:35], a[72:79], v2
    s_waitcnt lgkmcnt(8)
    v_smfmac_f32_16x16x64_bf16 v[56:59], v[36:39], a[80:87], v2
    v_smfmac_f32_16x16x64_bf16 v[60:63], v[36:39], a[88:95], v2
    s_waitcnt lgkmcnt(6)
    v_smfmac_f32_16x16x64_bf16 v[56:59], v[40:43], a[96:103], v2
    v_smfmac_f32_16x16x64_bf16 v[60:63], v[40:43], a[104:111], v2
    s_waitcnt lgkmcnt(4)
    v_smfmac_f32_16x16x64_bf16 v[56:59], v[44:47], a[112:119], v2
    v_smfmac_f32_16x16x64_bf16 v[60:63], v[44:47], a[120:127], v2
    s_waitcnt lgkmcnt(2)
    v_smfmac_f32_16x16x64_bf16 v[56:59], v[48:51], a[128:135], v2
    v_smfmac_f32_16x16x64_bf16 v[60:63], v[48:51], a[136:143], v2
    s_waitcnt lgkmcnt(0)
    v_smfmac_f32_16x16x64_bf16 v[56:59], v[52:55], a[144:151], v2
    v_smfmac_f32_16x16x64_bf16 v[60:63], v[52:55], a[152:159], v2
    s_nop 7
    v_permlane32_swap_b32 v56, v60
    v_permlane32_swap_b32 v57, v61
    v_permlane32_swap_b32 v58, v62
    v_permlane32_swap_b32 v59, v63
    v_pk_add_f32 v[56:57], v[56:57], v[60:61]
    v_pk_add_f32 v[58:59], v[58:59], v[62:63]
    v_cvt_pk_bf16_f32 v60, v56, v57
    v_cvt_pk_bf16_f32 v61, v58, v59
    v_min_u32 v60, -2, v60
    buffer_store_dwordx2 v[60:61], v4, s[8:11], s70 offen
    s_waitcnt vmcnt(0)
    v_smfmac_f32_16x16x64_bf16 v[64:67], v[16:19], a[160:167], v2
    buffer_store_dwordx2 v[60:61], v4, s[8:11], s25 offen sc1
    v_smfmac_f32_16x16x64_bf16 v[68:71], v[16:19], a[168:175], v2
    v_smfmac_f32_16x16x64_bf16 v[64:67], v[20:23], a[176:183], v2
    v_smfmac_f32_16x16x64_bf16 v[68:71], v[20:23], a[184:191], v2
    v_smfmac_f32_16x16x64_bf16 v[64:67], v[24:27], a[192:199], v2
    v_smfmac_f32_16x16x64_bf16 v[68:71], v[24:27], a[200:207], v2
    v_smfmac_f32_16x16x64_bf16 v[64:67], v[28:31], a[208:215], v2
    v_smfmac_f32_16x16x64_bf16 v[68:71], v[28:31], a[216:223], v2
    v_smfmac_f32_16x16x64_bf16 v[64:67], v[32:35], a[224:231], v2
    v_smfmac_f32_16x16x64_bf16 v[68:71], v[32:35], a[232:239], v2
    v_smfmac_f32_16x16x64_bf16 v[64:67], v[36:39], a[240:247], v2
    v_smfmac_f32_16x16x64_bf16 v[68:71], v[36:39], a[248:255], v2
    v_smfmac_f32_16x16x64_bf16 v[64:67], v[40:43], v[192:199], v2
    v_smfmac_f32_16x16x64_bf16 v[68:71], v[40:43], v[200:207], v2
    v_smfmac_f32_16x16x64_bf16 v[64:67], v[44:47], v[208:215], v2
    v_smfmac_f32_16x16x64_bf16 v[68:71], v[44:47], v[216:223], v2
    v_smfmac_f32_16x16x64_bf16 v[64:67], v[48:51], v[224:231], v2
    v_smfmac_f32_16x16x64_bf16 v[68:71], v[48:51], v[232:239], v2
    v_smfmac_f32_16x16x64_bf16 v[64:67], v[52:55], v[240:247], v2
    v_smfmac_f32_16x16x64_bf16 v[68:71], v[52:55], v[248:255], v2
    s_nop 4
    v_cvt_pk_bf16_f32 v184, v64, v65
    v_cvt_pk_bf16_f32 v185, v66, v67
    v_min_u32 v184, -2, v184
    v_cvt_pk_bf16_f32 v186, v68, v69
    v_cvt_pk_bf16_f32 v187, v70, v71
    buffer_store_dwordx4 v[184:187], v12, s[8:11], s71 offen
    v_permlane32_swap_b32 v64, v68
    v_permlane32_swap_b32 v65, v69
    v_permlane32_swap_b32 v66, v70
    v_permlane32_swap_b32 v67, v71
    v_pk_add_f32 v[64:65], v[64:65], v[68:69]
    v_pk_add_f32 v[66:67], v[66:67], v[70:71]
    v_cvt_pk_bf16_f32 v68, v64, v65
    v_cvt_pk_bf16_f32 v69, v66, v67
    buffer_store_dwordx2 v[68:69], v4, s[8:11], s25 offen offset:2048 sc1
    buffer_store_dwordx2 v[144:145], v4, s[8:11], s46 offen
    buffer_store_dwordx4 v[144:147], v12, s[8:11], s18 offen
    s_cmp_eq_u32 s5, 63
    s_cbranch_scc1 lastb_42
    s_cmp_eq_u32 s37, 0
    s_cbranch_scc1 nored_43
retry_44:
    buffer_load_dwordx4 v[144:147], v8, s[8:11], s32 offen sc1
    buffer_load_dwordx4 v[148:151], v8, s[8:11], s33 offen sc1
    buffer_load_dwordx4 v[152:155], v8, s[8:11], s34 offen sc1
    buffer_load_dwordx4 v[156:159], v8, s[8:11], s35 offen sc1
    s_waitcnt vmcnt(3)
    v_xor_b32 v10, s20, v144
    s_waitcnt vmcnt(2)
    v_bitop3_b32 v10, v10, v148, s20 bitop3:0xf6
    v_pk_add_f32 v[144:145], v[144:145], v[148:149]
    v_pk_add_f32 v[146:147], v[146:147], v[150:151]
    s_waitcnt vmcnt(1)
    v_bitop3_b32 v10, v10, v152, s20 bitop3:0xf6
    v_pk_add_f32 v[144:145], v[144:145], v[152:153]
    v_pk_add_f32 v[146:147], v[146:147], v[154:155]
    s_waitcnt vmcnt(0)
    v_bitop3_b32 v10, v10, v156, s20 bitop3:0xf6
    v_pk_add_f32 v[144:145], v[144:145], v[156:157]
    v_pk_add_f32 v[146:147], v[146:147], v[158:159]
    v_and_b32 v10, 1, v10
    v_cmp_ne_u32 vcc, 0, v10
    s_cbranch_vccnz retry_44
    v_permlane32_swap_b32 v144, v145
    v_permlane32_swap_b32 v146, v147
    v_add_f32 v144, v144, v145
    v_add_f32 v146, v146, v147
    s_nop 1
    v_permlane16_swap_b32 v144, v146
    v_add_f32 v144, v144, v146
    v_and_or_b32 v148, v144, -2, s20
    s_andn2_b32 s30, s5, 2
    s_cmp_lg_u32 s30, 1
    s_cbranch_scc1 m1_47
    s_memtime s[84:85]
    s_waitcnt lgkmcnt(0)
m1_47:
    buffer_store_dword v148, v14, s[8:11], s79 offen sc1
    s_sleep 8
    buffer_load_dword v149, v14, s[8:11], s80 offen sc1
    s_sleep 2
xpoll_46:
    buffer_load_dword v150, v14, s[8:11], s80 offen sc1
    s_waitcnt vmcnt(1)
    v_xor_b32 v10, s20, v149
    v_and_b32 v10, 1, v10
    v_cmp_ne_u32 vcc, 0, v10
    s_cbranch_vccz xd_50
    buffer_load_dword v149, v14, s[8:11], s80 offen sc1
    s_waitcnt vmcnt(1)
    v_xor_b32 v10, s20, v150
    v_and_b32 v10, 1, v10
    v_cmp_ne_u32 vcc, 0, v10
    s_cbranch_vccnz xpoll_46
    s_waitcnt vmcnt(0)
xd_50:
    s_cmp_gt_u32 s5, 5
    s_cbranch_scc1 m2_48
    s_andn2_b32 s30, s5, 2
    s_cmp_lg_u32 s30, 1
    s_cbranch_scc1 m3_49
    s_memtime s[86:87]
    s_waitcnt lgkmcnt(0)
    s_waitcnt lgkmcnt(0)
    s_sub_u32 s86, s86, s84
    s_mov_b32 s81, s82
    s_mov_b32 s82, s86
    s_cmp_lg_u32 s5, 3
    s_cbranch_scc1 m2_48
    s_lshr_b32 s81, s81, 4
    s_lshr_b32 s82, s82, 4
    s_min_u32 s81, s81, 0x7fff
    s_min_u32 s82, s82, 0x7fff
    s_add_u32 s81, s81, 0x1000000
    s_mov_b64 exec, 1
    v_mov_b32 v10, 8
    v_mov_b32 v11, s82
    global_atomic_add v10, v11, s[96:97] sc1
    s_waitcnt vmcnt(0)
    v_mov_b32 v10, 136
    v_mov_b32 v11, s81
    global_atomic_add v10, v11, s[96:97] sc1
    s_mov_b64 exec, -1
    s_branch m2_48
m3_49:
    s_cmp_lg_u32 s5, 5
    s_cbranch_scc1 m2_48
    v_mov_b32 v10, 136
vl_51:
    global_load_dword v11, v10, s[96:97] sc1
    s_waitcnt vmcnt(0)
    s_waitcnt vmcnt(0)
    v_readfirstlane_b32 s30, v11
    s_nop 0
    s_lshr_b32 s31, s30, 24
    s_cmp_lt_u32 s31, 160
    s_cbranch_scc1 vl_51
    v_mov_b32 v10, 8
    global_load_dword v11, v10, s[96:97] sc1
    s_waitcnt vmcnt(0)
    s_waitcnt vmcnt(0)
    v_readfirstlane_b32 s31, v11
    s_and_b32 s30, s30, 0xffffff
    s_cmp_lt_u32 s31, s30
    s_cselect_b32 s78, 8192, 0
m2_48:
    v_add_f32 v144, v148, v149
    v_mov_b32 v145, v144
    s_nop 1
    v_permlane32_swap_b32 v145, v144
    v_cvt_pk_bf16_f32 v144, v145, v144
    v_min_u32 v144, -2, v144
    v_mov_b32 v146, -1
    buffer_store_dword v144, v9, s[8:11], s22 offen
    buffer_store_dword v146, v9, s[8:11], s23 offen
nored_43:
    s_add_u32 s5, s5, 1
    s_and_b32 s31, s5, 3
    s_mul_i32 s21, s31, 10240
    s_add_u32 s21, s21, s39
    s_add_u32 s40, s21, 4096
    s_add_u32 s41, s21, s42
    s_and_b32 s20, s5, 1
    s_add_u32 s30, s5, 1
    s_and_b32 s31, s30, 3
    s_mul_i32 s22, s31, 10240
    s_add_u32 s22, s22, s38
    s_add_u32 s30, s5, 3
    s_and_b32 s31, s30, 3
    s_mul_i32 s23, s31, 10240
    s_add_u32 s23, s23, s38
    s_lshl_b32 s25, s5, 5
    s_add_u32 s25, s25, s27
    s_lshl_b32 s24, s25, 13
    s_add_u32 s24, s24, 262144
    s_add_u32 s55, s57, s24
    s_add_u32 s56, s58, s24
    s_lshl_b32 s25, s25, 12
    s_add_u32 s25, s25, 8388608
    s_lshl_b32 s30, s20, 12
    s_add_u32 s70, s45, s30
    s_add_u32 s71, s47, s30
    s_xor_b32 s30, s30, 4096
    s_add_u32 s46, s45, s30
    s_add_u32 s18, s47, s30
    s_lshl_b32 s30, s5, 12
    s_and_b32 s30, s30, 8192
    s_cmp_lt_u32 s5, 6
    s_cselect_b32 s30, s30, s78
    s_add_u32 s79, s43, s30
    s_add_u32 s80, s44, s30
    s_cmp_lt_u32 s5, 64
    s_nop 3
    s_cbranch_scc1 stepb_17
lastb_42:
    s_waitcnt vmcnt(0) lgkmcnt(0)
    s_barrier
    s_cmp_lg_u32 s4, 3
    s_cbranch_scc1 nopub_52
    s_add_u32 s30, s5, 0
    s_lshl_b32 s30, s30, 5
    s_add_u32 s30, s30, s27
    s_lshl_b32 s30, s30, 2
    s_add_u32 s30, s30, 1048576
    v_mov_b32 v10, 0
    v_mov_b32 v11, 1
    buffer_store_dword v11, v10, s[8:11], s30 offen sc1
nopub_52:
    s_branch chend_14
slowmode_15:
    s_and_b32 s31, s5, 3
    s_mul_i32 s21, s31, 10240
    s_add_u32 s21, s21, s39
    s_add_u32 s40, s21, 4096
    s_add_u32 s41, s21, s42
    s_and_b32 s20, s5, 1
    s_add_u32 s30, s5, 1
    s_and_b32 s31, s30, 3
    s_mul_i32 s22, s31, 10240
    s_add_u32 s22, s22, s38
    s_add_u32 s30, s5, 3
    s_and_b32 s31, s30, 3
    s_mul_i32 s23, s31, 10240
    s_add_u32 s23, s23, s38
    s_lshl_b32 s25, s5, 5
    s_add_u32 s25, s25, s27
    s_lshl_b32 s24, s25, 13
    s_add_u32 s24, s24, 262144
    s_add_u32 s55, s57, s24
    s_add_u32 s56, s58, s24
    s_lshl_b32 s25, s25, 12
    s_add_u32 s25, s25, 8388608
    s_lshl_b32 s30, s20, 12
    s_add_u32 s70, s45, s30
    s_add_u32 s71, s47, s30
    s_xor_b32 s30, s30, 4096
    s_add_u32 s46, s45, s30
    s_add_u32 s18, s47, s30
    s_lshl_b32 s30, s5, 12
    s_and_b32 s30, s30, 8192
    s_cmp_lt_u32 s5, 6
    s_cselect_b32 s30, s30, s78
    s_add_u32 s79, s43, s30
    s_add_u32 s80, s44, s30
    s_cmp_eq_u32 s36, 1
    s_cbranch_scc1 stepb_54s
    buffer_load_dwordx4 v[72:75], v6, s[8:11], s55 offen offset:0
    buffer_load_dwordx4 v[76:79], v6, s[8:11], s55 offen offset:1024
    buffer_load_dwordx4 v[80:83], v6, s[8:11], s56 offen
    buffer_load_dwordx4 v[84:87], v6, s[8:11], s56 offen offset:1024
    s_waitcnt vmcnt(0)
    ds_write_b128 v191, v[72:75] offset:24576
    ds_write_b128 v191, v[76:79] offset:25600
    s_waitcnt lgkmcnt(0)
    s_barrier
    s_branch stepa_53s
stepa_53:
    s_waitcnt vmcnt(0)
    ds_write_b128 v191, v[72:75] offset:24576
    ds_write_b128 v191, v[76:79] offset:25600
    s_barrier
    s_sleep 3
mpoll_55:
    buffer_load_dwordx4 v[128:131], v6, s[8:11], s21 offen sc1
    buffer_load_dwordx4 v[132:135], v6, s[8:11], s40 offen sc1
    buffer_load_dwordx4 v[136:139], v6, s[8:11], s41 offen sc1
    s_waitcnt vmcnt(0)
    v_max3_u32 v10, v128, v129, v130
    v_max3_u32 v11, v131, v132, v133
    v_max3_u32 v10, v10, v134, v135
    v_max3_u32 v11, v11, v136, v137
    v_max3_u32 v10, v10, v138, v139
    v_max_u32 v10, v10, v11
    v_cmp_eq_u32 vcc, -1, v10
    s_cbranch_vccnz mpoll_55
    v_add_u32 v11, s42, v12
    ds_write_b128 v12, v[128:131] offset:0
    ds_write_b128 v12, v[132:135] offset:4096
    ds_write_b128 v11, v[136:139] offset:0
    s_waitcnt lgkmcnt(0)
    s_barrier
stepa_53s:
    s_cmp_eq_u32 s5, 63
    s_cbranch_scc1 chend_14
    s_add_u32 s19, s5, 1
    s_cmp_ge_u32 s19, 64
    s_cbranch_scc1 nokv_56
    s_cmp_lt_u32 s19, 8
    s_cselect_b32 s30, 1, 7
    s_and_b32 s30, s19, s30
    s_cmp_lg_u32 s30, 0
    s_cbranch_scc1 nokv_56
    s_waitcnt vmcnt(0)
    s_cmp_lt_u32 s19, 8
    s_cbranch_scc0 ws1_58
    s_mov_b32 s30, 252
    s_lshr_b32 s31, s19, 1
    s_lshl_b32 s31, s31, 3
    v_mov_b32 v10, s30
kvp_60:
    global_load_dword v11, v10, s[96:97] sc1
    s_waitcnt vmcnt(0)
    s_waitcnt vmcnt(0)
    v_lshrrev_b32 v11, s31, v11
    v_and_b32 v11, 0xff, v11
    v_cmp_gt_u32 vcc, 64, v11
    s_cbranch_vccz kvp_60d
    s_sleep 4
    s_branch kvp_60
kvp_60d:
    s_branch ws2_59
ws1_58:
    s_lshr_b32 s30, s19, 4
    s_lshl_b32 s30, s30, 2
    s_add_u32 s30, s30, 16
    s_bfe_u32 s31, s19, 0x10003
    s_lshl_b32 s31, s31, 4
    v_mov_b32 v10, s30
kvp_61:
    global_load_dword v11, v10, s[96:97] sc1
    s_waitcnt vmcnt(0)
    s_waitcnt vmcnt(0)
    v_lshrrev_b32 v11, s31, v11
    v_and_b32 v11, 0xffff, v11
    v_cmp_gt_u32 vcc, 64, v11
    s_cbranch_vccz kvp_61d
    s_sleep 4
    s_branch kvp_61
kvp_61d:
ws2_59:
nokv_56:
    ds_read_b64_tr_b16 v[16:17], v3 offset:0
    ds_read_b64_tr_b16 v[18:19], v3 offset:512
    ds_read_b64_tr_b16 v[20:21], v3 offset:1024
    ds_read_b64_tr_b16 v[22:23], v3 offset:1536
    ds_read_b64_tr_b16 v[24:25], v3 offset:2048
    ds_read_b64_tr_b16 v[26:27], v3 offset:2560
    ds_read_b64_tr_b16 v[28:29], v3 offset:3072
    ds_read_b64_tr_b16 v[30:31], v3 offset:3584
    v_mov_b64 v[56:57], 0
    v_mov_b64 v[58:59], 0
    v_mov_b64 v[60:61], 0
    v_mov_b64 v[62:63], 0
    ds_read_b64_tr_b16 v[32:33], v3 offset:4096
    ds_read_b64_tr_b16 v[34:35], v3 offset:4608
    ds_read_b64_tr_b16 v[36:37], v3 offset:5120
    ds_read_b64_tr_b16 v[38:39], v3 offset:5632
    ds_read_b64_tr_b16 v[40:41], v3 offset:6144
    v_mov_b64 v[64:65], 0
    ds_read_b64_tr_b16 v[42:43], v3 offset:6656
    v_mov_b64 v[66:67], 0
    s_waitcnt lgkmcnt(12)
    v_smfmac_f32_16x16x64_bf16 v[56:59], v[16:19], a[0:7], v2
    ds_read_b64_tr_b16 v[44:45], v3 offset:7168
    ds_read_b64_tr_b16 v[46:47], v3 offset:7680
    ds_read_b64_tr_b16 v[48:49], v3 offset:8192
    v_smfmac_f32_16x16x64_bf16 v[60:63], v[16:19], a[8:15], v2
    ds_read_b64_tr_b16 v[50:51], v3 offset:8704
    ds_read_b64_tr_b16 v[52:53], v3 offset:9216
    s_waitcnt lgkmcnt(15)
    v_smfmac_f32_16x16x64_bf16 v[56:59], v[20:23], a[16:23], v2
    ds_read_b64_tr_b16 v[54:55], v3 offset:9728
    ds_read_b128 v[96:99], v6 offset:24576
    v_mov_b64 v[68:69], 0
    v_smfmac_f32_16x16x64_bf16 v[60:63], v[20:23], a[24:31], v2
    ds_read_b128 v[100:103], v6 offset:25600
    v_mov_b64 v[70:71], 0
    s_waitcnt lgkmcnt(15)
    v_smfmac_f32_16x16x64_bf16 v[56:59], v[24:27], a[32:39], v2
    ds_read_b128 v[104:107], v6 offset:26624
    v_smfmac_f32_16x16x64_bf16 v[60:63], v[24:27], a[40:47], v2
    ds_read_b128 v[108:111], v6 offset:27648
    v_mov_b64 v[24:25], 0
    s_waitcnt lgkmcnt(15)
    v_smfmac_f32_16x16x64_bf16 v[56:59], v[28:31], a[48:55], v2
    ds_read_b128 v[112:115], v6 offset:28672
    v_mov_b64 v[26:27], 0
    v_smfmac_f32_16x16x64_bf16 v[60:63], v[28:31], a[56:63], v2
    ds_read_b128 v[116:119], v6 offset:29696
    v_mov_b64 v[28:29], 0
    s_waitcnt lgkmcnt(15)
    v_smfmac_f32_16x16x64_bf16 v[56:59], v[32:35], a[64:71], v2
    ds_read_b128 v[120:123], v6 offset:30720
    ds_read_b128 v[124:127], v6 offset:31744
    v_smfmac_f32_16x16x64_bf16 v[60:63], v[32:35], a[72:79], v2
    v_mov_b64 v[30:31], 0
    s_waitcnt lgkmcnt(15)
    v_smfmac_f32_16x16x64_bf16 v[56:59], v[36:39], a[80:87], v2
    v_mov_b64 v[32:33], 0
    v_smfmac_f32_16x16x64_bf16 v[60:63], v[36:39], a[88:95], v2
    v_mov_b64 v[34:35], 0
    s_waitcnt lgkmcnt(14)
    v_smfmac_f32_16x16x64_bf16 v[56:59], v[40:43], a[96:103], v2
    v_mov_b64 v[36:37], 0
    v_smfmac_f32_16x16x64_bf16 v[60:63], v[40:43], a[104:111], v2
    v_mov_b64 v[38:39], 0
    s_waitcnt lgkmcnt(12)
    v_smfmac_f32_16x16x64_bf16 v[56:59], v[44:47], a[112:119], v2
    v_mov_b64 v[40:41], 0
    v_smfmac_f32_16x16x64_bf16 v[60:63], v[44:47], a[120:127], v2
    v_mov_b64 v[42:43], 0
    s_waitcnt lgkmcnt(10)
    v_smfmac_f32_16x16x64_bf16 v[56:59], v[48:51], a[128:135], v2
    v_mov_b64 v[44:45], 0
    v_smfmac_f32_16x16x64_bf16 v[60:63], v[48:51], a[136:143], v2
    v_mov_b64 v[46:47], 0
    s_waitcnt lgkmcnt(8)
    v_smfmac_f32_16x16x64_bf16 v[56:59], v[52:55], a[144:151], v2
    v_mov_b64 v[48:49], 0
    v_smfmac_f32_16x16x64_bf16 v[60:63], v[52:55], a[152:159], v2
    v_mov_b64 v[50:51], 0
    v_mov_b64 v[52:53], 0
    v_mov_b64 v[54:55], 0
    s_nop 4
    v_permlane32_swap_b32 v56, v60
    v_permlane32_swap_b32 v57, v61
    v_permlane32_swap_b32 v58, v62
    v_permlane32_swap_b32 v59, v63
    v_pk_add_f32 v[56:57], v[56:57], v[60:61]
    v_pk_add_f32 v[58:59], v[58:59], v[62:63]
    v_mul_f32 v56, s29, v56
    v_mul_f32 v57, s29, v57
    v_mul_f32 v58, s29, v58
    v_mul_f32 v59, s29, v59
    v_cvt_pk_bf16_f32 v60, v56, v57
    v_cvt_pk_bf16_f32 v61, v58, v59
    ds_write_b64 v4, v[60:61] offset:10240
    s_waitcnt lgkmcnt(0)
    s_barrier
    ds_read_b64_tr_b16 v[128:129], v5 offset:10240
    ds_read_b64_tr_b16 v[130:131], v5 offset:10496
    ds_read_b64_tr_b16 v[132:133], v5 offset:10752
    ds_read_b64_tr_b16 v[134:135], v5 offset:11008
    ds_read_b64_tr_b16 v[136:137], v5 offset:11264
    ds_read_b64_tr_b16 v[138:139], v5 offset:11520
    ds_read_b64_tr_b16 v[140:141], v5 offset:11776
    ds_read_b64_tr_b16 v[142:143], v5 offset:12032
    s_waitcnt lgkmcnt(6)
    v_mfma_f32_16x16x32_bf16 v[160:163], v[96:99], v[128:131], 0
    s_waitcnt lgkmcnt(4)
    v_mfma_f32_16x16x32_bf16 v[160:163], v[100:103], v[132:135], v[160:163]
    s_waitcnt lgkmcnt(2)
    v_mfma_f32_16x16x32_bf16 v[160:163], v[104:107], v[136:139], v[160:163]
    s_waitcnt lgkmcnt(0)
    v_mfma_f32_16x16x32_bf16 v[160:163], v[108:111], v[140:143], v[160:163]
    v_mfma_f32_16x16x32_bf16 v[164:167], v[112:115], v[128:131], 0
    v_mfma_f32_16x16x32_bf16 v[164:167], v[116:119], v[132:135], v[164:167]
    s_nop 1
    buffer_load_dwordx2 v[184:185], v4, s[8:11], s70 offen sc1
    v_exp_f32 v96, v160
    v_mfma_f32_16x16x32_bf16 v[164:167], v[120:123], v[136:139], v[164:167]
    v_exp_f32 v97, v161
    v_mfma_f32_16x16x32_bf16 v[164:167], v[124:127], v[140:143], v[164:167]
    v_exp_f32 v98, v162
    v_exp_f32 v99, v163
    s_waitcnt vmcnt(0)
    v_cmp_eq_u32 vcc, -1, v184
    s_cbranch_vccz kpd_63
kpoll_62:
    buffer_load_dwordx2 v[184:185], v4, s[8:11], s70 offen sc1
    s_waitcnt vmcnt(0)
    v_cmp_eq_u32 vcc, -1, v184
    s_cbranch_vccnz kpoll_62
kpd_63:
    ds_write_b64 v4, v[184:185] offset:12288
    v_exp_f32 v100, v164
    v_exp_f32 v101, v165
    v_exp_f32 v102, v166
    v_exp_f32 v103, v167
    v_cvt_pk_bf16_f32 v88, v96, v97
    v_cvt_pk_bf16_f32 v89, v98, v99
    v_cvt_pk_bf16_f32 v90, v100, v101
    s_waitcnt lgkmcnt(0)
    s_barrier
    v_cvt_pk_bf16_f32 v91, v102, v103
    ds_read_b64_tr_b16 v[144:145], v5 offset:12288
    ds_read_b64_tr_b16 v[146:147], v5 offset:12544
    ds_read_b64_tr_b16 v[148:149], v5 offset:12800
    ds_read_b64_tr_b16 v[150:151], v5 offset:13056
    ds_read_b64_tr_b16 v[152:153], v5 offset:13312
    ds_read_b64_tr_b16 v[154:155], v5 offset:13568
    ds_read_b64_tr_b16 v[156:157], v5 offset:13824
    ds_read_b64_tr_b16 v[158:159], v5 offset:14080
    v_mfma_f32_16x16x32_bf16 v[172:175], v[176:179], v[88:91], 0
    buffer_load_dwordx4 v[184:187], v12, s[8:11], s71 offen sc1
    v_mfma_f32_16x16x32_bf16 v[56:59], v[80:83], v[88:91], 0
    v_mfma_f32_16x16x32_bf16 v[60:63], v[84:87], v[88:91], 0
    s_waitcnt lgkmcnt(6)
    v_mfma_f32_16x16x32_bf16 v[168:171], v[144:147], v[128:131], 0
    s_waitcnt lgkmcnt(4)
    v_mfma_f32_16x16x32_bf16 v[168:171], v[148:151], v[132:135], v[168:171]
    s_waitcnt lgkmcnt(2)
    v_mfma_f32_16x16x32_bf16 v[168:171], v[152:155], v[136:139], v[168:171]
    s_waitcnt lgkmcnt(0)
    v_mfma_f32_16x16x32_bf16 v[168:171], v[156:159], v[140:143], v[168:171]
    s_nop 7
    v_exp_f32 v104, v168
    v_exp_f32 v105, v169
    v_exp_f32 v106, v170
    v_exp_f32 v107, v171
    v_cvt_pk_bf16_f32 v92, v104, v105
    v_cvt_pk_bf16_f32 v93, v106, v107
    s_nop 1
    v_mfma_f32_16x16x16_bf16 v[172:175], v[180:181], v[92:93], v[172:175]
    s_waitcnt vmcnt(0)
    v_cmp_eq_u32 vcc, -1, v184
    s_cbranch_vccz vpd_65
vpoll_64:
    buffer_load_dwordx4 v[184:187], v12, s[8:11], s71 offen sc1
    s_waitcnt vmcnt(0)
    v_cmp_eq_u32 vcc, -1, v184
    s_cbranch_vccnz vpoll_64
vpd_65:
    s_nop 4
    v_subrev_u32 v10, s94, v172
    v_cmp_le_u32 vcc, s95, v10
    s_cbranch_vccnz slow_66
slowd_67:
    v_mfma_f32_16x16x16_bf16 v[56:59], v[184:185], v[92:93], v[56:59]
    buffer_load_dwordx4 v[72:75], v6, s[8:11], s55 offen offset:0
    v_rcp_f32 v10, v172
    v_mfma_f32_16x16x16_bf16 v[60:63], v[186:187], v[92:93], v[60:63]
    buffer_load_dwordx4 v[76:79], v6, s[8:11], s55 offen offset:1024
    s_nop 1
    v_cndmask_b32 v56, v56, v58, s[48:49]
    v_cndmask_b32 v57, v57, v59, s[48:49]
    v_mul_f32 v56, v10, v56
    v_mul_f32 v57, v10, v57
    s_nop 0
    v_cndmask_b32 v60, v60, v62, s[48:49]
    v_cndmask_b32 v61, v61, v63, s[48:49]
    v_mul_f32 v60, v10, v60
    v_mul_f32 v61, v10, v61
    v_cvt_pk_bf16_f32 v170, v56, v57
    v_cvt_pk_bf16_f32 v171, v60, v61
    ds_write_b64 v13, v[170:171] offset:14336
    buffer_load_dwordx4 v[80:83], v6, s[8:11], s56 offen
    s_waitcnt lgkmcnt(0)
    s_barrier
    buffer_load_dwordx4 v[84:87], v6, s[8:11], s56 offen offset:1024
    ds_read_b128 v[16:19], v6 offset:14336
    ds_read_b128 v[20:23], v6 offset:15360
    s_waitcnt lgkmcnt(1)
    v_smfmac_f32_16x16x64_bf16 v[24:27], v[16:19], a[160:167], v2
    v_smfmac_f32_16x16x64_bf16 v[28:31], v[16:19], a[168:175], v2
    s_waitcnt lgkmcnt(0)
    v_smfmac_f32_16x16x64_bf16 v[24:27], v[20:23], a[176:183], v2
    v_smfmac_f32_16x16x64_bf16 v[28:31], v[20:23], a[184:191], v2
    v_smfmac_f32_16x16x64_bf16 v[32:35], v[16:19], a[192:199], v2
    v_smfmac_f32_16x16x64_bf16 v[36:39], v[16:19], a[200:207], v2
    s_nop 1
    v_permlane32_swap_b32 v24, v28
    v_permlane32_swap_b32 v25, v29
    v_smfmac_f32_16x16x64_bf16 v[32:35], v[20:23], a[208:215], v2
    v_permlane32_swap_b32 v26, v30
    v_smfmac_f32_16x16x64_bf16 v[36:39], v[20:23], a[216:223], v2
    v_permlane32_swap_b32 v27, v31
    v_pk_add_f32 v[24:25], v[24:25], v[28:29]
    v_smfmac_f32_16x16x64_bf16 v[40:43], v[16:19], a[224:231], v2
    v_pk_add_f32 v[26:27], v[26:27], v[30:31]
    s_nop 1
    v_permlane32_swap_b32 v32, v36
    v_permlane32_swap_b32 v33, v37
    v_smfmac_f32_16x16x64_bf16 v[44:47], v[16:19], a[232:239], v2
    v_and_or_b32 v24, v24, -2, s20
    v_smfmac_f32_16x16x64_bf16 v[40:43], v[20:23], a[240:247], v2
    buffer_store_dwordx4 v[24:27], v7, s[8:11], s50 offen sc1
    v_permlane32_swap_b32 v34, v38
    v_smfmac_f32_16x16x64_bf16 v[44:47], v[20:23], a[248:255], v2
    v_permlane32_swap_b32 v35, v39
    v_pk_add_f32 v[32:33], v[32:33], v[36:37]
    v_pk_add_f32 v[34:35], v[34:35], v[38:39]
    v_and_or_b32 v32, v32, -2, s20
    v_smfmac_f32_16x16x64_bf16 v[48:51], v[16:19], v[192:199], v2
    buffer_store_dwordx4 v[32:35], v7, s[8:11], s51 offen sc1
    v_permlane32_swap_b32 v40, v44
    v_permlane32_swap_b32 v41, v45
    v_smfmac_f32_16x16x64_bf16 v[52:55], v[16:19], v[200:207], v2
    v_permlane32_swap_b32 v42, v46
    v_permlane32_swap_b32 v43, v47
    v_pk_add_f32 v[40:41], v[40:41], v[44:45]
    v_smfmac_f32_16x16x64_bf16 v[48:51], v[20:23], v[208:215], v2
    v_pk_add_f32 v[42:43], v[42:43], v[46:47]
    v_smfmac_f32_16x16x64_bf16 v[52:55], v[20:23], v[216:223], v2
    v_and_or_b32 v40, v40, -2, s20
    v_smfmac_f32_16x16x64_bf16 v[64:67], v[16:19], v[224:231], v2
    buffer_store_dwordx4 v[40:43], v7, s[8:11], s52 offen sc1
    v_smfmac_f32_16x16x64_bf16 v[68:71], v[16:19], v[232:239], v2
    v_permlane32_swap_b32 v48, v52
    v_permlane32_swap_b32 v49, v53
    v_permlane32_swap_b32 v50, v54
    v_permlane32_swap_b32 v51, v55
    v_pk_add_f32 v[48:49], v[48:49], v[52:53]
    v_smfmac_f32_16x16x64_bf16 v[64:67], v[20:23], v[240:247], v2
    v_pk_add_f32 v[50:51], v[50:51], v[54:55]
    v_smfmac_f32_16x16x64_bf16 v[68:71], v[20:23], v[248:255], v2
    v_and_or_b32 v48, v48, -2, s20
    buffer_store_dwordx4 v[48:51], v7, s[8:11], s53 offen sc1
    s_nop 5
    v_permlane32_swap_b32 v64, v68
    v_permlane32_swap_b32 v65, v69
    v_permlane32_swap_b32 v66, v70
    v_permlane32_swap_b32 v67, v71
    v_pk_add_f32 v[64:65], v[64:65], v[68:69]
    v_pk_add_f32 v[66:67], v[66:67], v[70:71]
    v_and_or_b32 v64, v64, -2, s20
    buffer_store_dwordx4 v[64:67], v7, s[8:11], s54 offen sc1
    s_cmp_eq_u32 s37, 0
    s_cbranch_scc1 nored_68
    s_waitcnt vmcnt(0)
retry_69:
    buffer_load_dwordx4 v[144:147], v8, s[8:11], s32 offen sc1
    buffer_load_dwordx4 v[148:151], v8, s[8:11], s33 offen sc1
    buffer_load_dwordx4 v[152:155], v8, s[8:11], s34 offen sc1
    buffer_load_dwordx4 v[156:159], v8, s[8:11], s35 offen sc1
    s_waitcnt vmcnt(3)
    v_xor_b32 v10, s20, v144
    s_waitcnt vmcnt(2)
    v_bitop3_b32 v10, v10, v148, s20 bitop3:0xf6
    v_pk_add_f32 v[144:145], v[144:145], v[148:149]
    v_pk_add_f32 v[146:147], v[146:147], v[150:151]
    s_waitcnt vmcnt(1)
    v_bitop3_b32 v10, v10, v152, s20 bitop3:0xf6
    v_pk_add_f32 v[144:145], v[144:145], v[152:153]
    v_pk_add_f32 v[146:147], v[146:147], v[154:155]
    s_waitcnt vmcnt(0)
    v_bitop3_b32 v10, v10, v156, s20 bitop3:0xf6
    v_pk_add_f32 v[144:145], v[144:145], v[156:157]
    v_pk_add_f32 v[146:147], v[146:147], v[158:159]
    v_and_b32 v10, 1, v10
    v_cmp_ne_u32 vcc, 0, v10
    s_cbranch_vccnz retry_69
    v_permlane32_swap_b32 v144, v145
    v_permlane32_swap_b32 v146, v147
    v_add_f32 v144, v144, v145
    v_add_f32 v146, v146, v147
    s_nop 1
    v_permlane16_swap_b32 v144, v146
    v_add_f32 v144, v144, v146
    v_and_or_b32 v148, v144, -2, s20
    s_andn2_b32 s30, s5, 2
    s_cmp_lg_u32 s30, 1
    s_cbranch_scc1 m1_72
    s_memtime s[84:85]
    s_waitcnt lgkmcnt(0)
m1_72:
    buffer_store_dword v148, v14, s[8:11], s79 offen sc1
    s_sleep 8
    buffer_load_dword v149, v14, s[8:11], s80 offen sc1
    s_sleep 2
xpoll_71:
    buffer_load_dword v150, v14, s[8:11], s80 offen sc1
    s_waitcnt vmcnt(1)
    v_xor_b32 v10, s20, v149
    v_and_b32 v10, 1, v10
    v_cmp_ne_u32 vcc, 0, v10
    s_cbranch_vccz xd_75
    buffer_load_dword v149, v14, s[8:11], s80 offen sc1
    s_waitcnt vmcnt(1)
    v_xor_b32 v10, s20, v150
    v_and_b32 v10, 1, v10
    v_cmp_ne_u32 vcc, 0, v10
    s_cbranch_vccnz xpoll_71
    s_waitcnt vmcnt(0)
xd_75:
    s_cmp_gt_u32 s5, 5
    s_cbranch_scc1 m2_73
    s_andn2_b32 s30, s5, 2
    s_cmp_lg_u32 s30, 1
    s_cbranch_scc1 m3_74
    s_memtime s[86:87]
    s_waitcnt lgkmcnt(0)
    s_waitcnt lgkmcnt(0)
    s_sub_u32 s86, s86, s84
    s_mov_b32 s81, s82
    s_mov_b32 s82, s86
    s_cmp_lg_u32 s5, 3
    s_cbranch_scc1 m2_73
    s_lshr_b32 s81, s81, 4
    s_lshr_b32 s82, s82, 4
    s_min_u32 s81, s81, 0x7fff
    s_min_u32 s82, s82, 0x7fff
    s_add_u32 s81, s81, 0x1000000
    s_mov_b64 exec, 1
    v_mov_b32 v10, 8
    v_mov_b32 v11, s82
    global_atomic_add v10, v11, s[96:97] sc1
    s_waitcnt vmcnt(0)
    v_mov_b32 v10, 136
    v_mov_b32 v11, s81
    global_atomic_add v10, v11, s[96:97] sc1
    s_mov_b64 exec, -1
    s_branch m2_73
m3_74:
    s_cmp_lg_u32 s5, 5
    s_cbranch_scc1 m2_73
    v_mov_b32 v10, 136
vl_76:
    global_load_dword v11, v10, s[96:97] sc1
    s_waitcnt vmcnt(0)
    s_waitcnt vmcnt(0)
    v_readfirstlane_b32 s30, v11
    s_nop 0
    s_lshr_b32 s31, s30, 24
    s_cmp_lt_u32 s31, 160
    s_cbranch_scc1 vl_76
    v_mov_b32 v10, 8
    global_load_dword v11, v10, s[96:97] sc1
    s_waitcnt vmcnt(0)
    s_waitcnt vmcnt(0)
    v_readfirstlane_b32 s31, v11
    s_and_b32 s30, s30, 0xffffff
    s_cmp_lt_u32 s31, s30
    s_cselect_b32 s78, 8192, 0
m2_73:
    v_add_f32 v144, v148, v149
    v_mov_b32 v145, v144
    s_nop 1
    v_permlane32_swap_b32 v145, v144
    v_cvt_pk_bf16_f32 v144, v145, v144
    v_min_u32 v144, -2, v144
    v_mov_b32 v146, -1
    buffer_store_dword v144, v9, s[8:11], s22 offen sc1
    buffer_store_dword v146, v9, s[8:11], s23 offen sc1
nored_68:
    s_add_u32 s5, s5, 1
    s_and_b32 s31, s5, 3
    s_mul_i32 s21, s31, 10240
    s_add_u32 s21, s21, s39
    s_add_u32 s40, s21, 4096
    s_add_u32 s41, s21, s42
    s_and_b32 s20, s5, 1
    s_add_u32 s30, s5, 1
    s_and_b32 s31, s30, 3
    s_mul_i32 s22, s31, 10240
    s_add_u32 s22, s22, s38
    s_add_u32 s30, s5, 3
    s_and_b32 s31, s30, 3
    s_mul_i32 s23, s31, 10240
    s_add_u32 s23, s23, s38
    s_lshl_b32 s25, s5, 5
    s_add_u32 s25, s25, s27
    s_lshl_b32 s24, s25, 13
    s_add_u32 s24, s24, 262144
    s_add_u32 s55, s57, s24
    s_add_u32 s56, s58, s24
    s_lshl_b32 s25, s25, 12
    s_add_u32 s25, s25, 8388608
    s_lshl_b32 s30, s20, 12
    s_add_u32 s70, s45, s30
    s_add_u32 s71, s47, s30
    s_xor_b32 s30, s30, 4096
    s_add_u32 s46, s45, s30
    s_add_u32 s18, s47, s30
    s_lshl_b32 s30, s5, 12
    s_and_b32 s30, s30, 8192
    s_cmp_lt_u32 s5, 6
    s_cselect_b32 s30, s30, s78
    s_add_u32 s79, s43, s30
    s_add_u32 s80, s44, s30
    s_cmp_lt_u32 s5, 64
    s_nop 3
    s_cbranch_scc1 stepa_53
    s_branch chend_14
slow_66:
    s_nop 7
    v_max3_f32 v10, v160, v161, v162
    v_max3_f32 v10, v163, v164, v10
    v_max3_f32 v10, v165, v166, v10
    v_max3_f32 v10, v168, v169, v10
    v_max3_f32 v10, v170, v171, v10
    v_max_f32 v10, v167, v10
    v_mov_b32 v11, v10
    s_nop 1
    v_permlane16_swap_b32 v11, v10
    v_max_f32 v10, v10, v11
    v_mov_b32 v11, v10
    s_nop 1
    v_permlane32_swap_b32 v11, v10
    v_max_f32 v10, v10, v11
    v_sub_f32 v96, v160, v10
    v_exp_f32 v96, v96
    v_sub_f32 v97, v161, v10
    v_exp_f32 v97, v97
    v_sub_f32 v98, v162, v10
    v_exp_f32 v98, v98
    v_sub_f32 v99, v163, v10
    v_exp_f32 v99, v99
    v_sub_f32 v100, v164, v10
    v_exp_f32 v100, v100
    v_sub_f32 v101, v165, v10
    v_exp_f32 v101, v101
    v_sub_f32 v102, v166, v10
    v_exp_f32 v102, v102
    v_sub_f32 v103, v167, v10
    v_exp_f32 v103, v103
    v_sub_f32 v104, v168, v10
    v_exp_f32 v104, v104
    v_sub_f32 v105, v169, v10
    v_exp_f32 v105, v105
    v_sub_f32 v106, v170, v10
    v_exp_f32 v106, v106
    v_sub_f32 v107, v171, v10
    v_exp_f32 v107, v107
    v_cvt_pk_bf16_f32 v88, v96, v97
    v_cvt_pk_bf16_f32 v89, v98, v99
    v_cvt_pk_bf16_f32 v90, v100, v101
    v_cvt_pk_bf16_f32 v91, v102, v103
    s_nop 1
    v_mfma_f32_16x16x32_bf16 v[56:59], v[80:83], v[88:91], 0
    v_mfma_f32_16x16x32_bf16 v[60:63], v[84:87], v[88:91], 0
    v_mfma_f32_16x16x32_bf16 v[172:175], v[176:179], v[88:91], 0
    s_nop 1
    v_cvt_pk_bf16_f32 v92, v104, v105
    v_cvt_pk_bf16_f32 v93, v106, v107
    s_nop 1
    v_mfma_f32_16x16x16_bf16 v[172:175], v[180:181], v[92:93], v[172:175]
    s_nop 9
    s_branch slowd_67
stepb_54:
    s_waitcnt vmcnt(0)
    s_barrier
    s_sleep 3
mpoll_77:
    buffer_load_dwordx4 v[128:131], v6, s[8:11], s21 offen sc1
    buffer_load_dwordx4 v[132:135], v6, s[8:11], s40 offen sc1
    buffer_load_dwordx4 v[136:139], v6, s[8:11], s41 offen sc1
    s_waitcnt vmcnt(0)
    v_max3_u32 v10, v128, v129, v130
    v_max3_u32 v11, v131, v132, v133
    v_max3_u32 v10, v10, v134, v135
    v_max3_u32 v11, v11, v136, v137
    v_max3_u32 v10, v10, v138, v139
    v_max_u32 v10, v10, v11
    v_cmp_eq_u32 vcc, -1, v10
    s_cbranch_vccnz mpoll_77
    v_add_u32 v11, s42, v12
    ds_write_b128 v12, v[128:131] offset:0
    ds_write_b128 v12, v[132:135] offset:4096
    ds_write_b128 v11, v[136:139] offset:0
    s_waitcnt lgkmcnt(0)
    s_barrier
    s_cmp_lg_u32 s4, 3
    s_cbranch_scc1 nopub_78
    s_add_u32 s30, s5, -1
    s_lshl_b32 s30, s30, 5
    s_add_u32 s30, s30, s27
    s_lshl_b32 s30, s30, 2
    s_add_u32 s30, s30, 1048576
    v_mov_b32 v10, 0
    v_mov_b32 v11, 1
    buffer_store_dword v11, v10, s[8:11], s30 offen sc1
nopub_78:
stepb_54s:
    ds_read_b64_tr_b16 v[16:17], v3 offset:0
    ds_read_b64_tr_b16 v[18:19], v3 offset:512
    v_mov_b64 v[56:57], 0
    v_mov_b64 v[58:59], 0
    v_mov_b64 v[60:61], 0
    v_mov_b64 v[62:63], 0
    ds_read_b64_tr_b16 v[20:21], v3 offset:1024
    ds_read_b64_tr_b16 v[22:23], v3 offset:1536
    ds_read_b64_tr_b16 v[24:25], v3 offset:2048
    ds_read_b64_tr_b16 v[26:27], v3 offset:2560
    ds_read_b64_tr_b16 v[28:29], v3 offset:3072
    ds_read_b64_tr_b16 v[30:31], v3 offset:3584
    ds_read_b64_tr_b16 v[32:33], v3 offset:4096
    ds_read_b64_tr_b16 v[34:35], v3 offset:4608
    ds_read_b64_tr_b16 v[36:37], v3 offset:5120
    v_mov_b64 v[64:65], 0
    ds_read_b64_tr_b16 v[38:39], v3 offset:5632
    v_mov_b64 v[66:67], 0
    ds_read_b64_tr_b16 v[40:41], v3 offset:6144
    v_mov_b64 v[68:69], 0
    s_waitcnt lgkmcnt(11)
    v_smfmac_f32_16x16x64_bf16 v[56:59], v[16:19], a[0:7], v2
    ds_read_b64_tr_b16 v[42:43], v3 offset:6656
    ds_read_b64_tr_b16 v[44:45], v3 offset:7168
    ds_read_b64_tr_b16 v[46:47], v3 offset:7680
    v_smfmac_f32_16x16x64_bf16 v[60:63], v[16:19], a[8:15], v2
    ds_read_b64_tr_b16 v[48:49], v3 offset:8192
    ds_read_b64_tr_b16 v[50:51], v3 offset:8704
    s_waitcnt lgkmcnt(14)
    v_smfmac_f32_16x16x64_bf16 v[56:59], v[20:23], a[16:23], v2
    ds_read_b64_tr_b16 v[52:53], v3 offset:9216
    ds_read_b64_tr_b16 v[54:55], v3 offset:9728
    v_mov_b64 v[70:71], 0
    v_smfmac_f32_16x16x64_bf16 v[60:63], v[20:23], a[24:31], v2
    v_mov_b32 v144, -1
    s_waitcnt lgkmcnt(14)
    v_smfmac_f32_16x16x64_bf16 v[56:59], v[24:27], a[32:39], v2
    v_mov_b32 v145, -1
    v_smfmac_f32_16x16x64_bf16 v[60:63], v[24:27], a[40:47], v2
    v_mov_b32 v146, -1
    s_waitcnt lgkmcnt(12)
    v_smfmac_f32_16x16x64_bf16 v[56:59], v[28:31], a[48:55], v2
    v_mov_b32 v147, -1
    v_smfmac_f32_16x16x64_bf16 v[60:63], v[28:31], a[56:63], v2
    s_waitcnt lgkmcnt(10)
    v_smfmac_f32_16x16x64_bf16 v[56:59], v[32:35], a[64:71], v2
    v_smfmac_f32_16x16x64_bf16 v[60:63], v[32:35], a[72:79], v2
    s_waitcnt lgkmcnt(8)
    v_smfmac_f32_16x16x64_bf16 v[56:59], v[36:39], a[80:87], v2
    v_smfmac_f32_16x16x64_bf16 v[60:63], v[36:39], a[88:95], v2
    s_waitcnt lgkmcnt(6)
    v_smfmac_f32_16x16x64_bf16 v[56:59], v[40:43], a[96:103], v2
    v_smfmac_f32_16x16x64_bf16 v[60:63], v[40:43], a[104:111], v2
    s_waitcnt lgkmcnt(4)
    v_smfmac_f32_16x16x64_bf16 v[56:59], v[44:47], a[112:119], v2
    v_smfmac_f32_16x16x64_bf16 v[60:63], v[44:47], a[120:127], v2
    s_waitcnt lgkmcnt(2)
    v_smfmac_f32_16x16x64_bf16 v[56:59], v[48:51], a[128:135], v2
    v_smfmac_f32_16x16x64_bf16 v[60:63], v[48:51], a[136:143], v2
    s_waitcnt lgkmcnt(0)
    v_smfmac_f32_16x16x64_bf16 v[56:59], v[52:55], a[144:151], v2
    v_smfmac_f32_16x16x64_bf16 v[60:63], v[52:55], a[152:159], v2
    s_nop 7
    v_permlane32_swap_b32 v56, v60
    v_permlane32_swap_b32 v57, v61
    v_permlane32_swap_b32 v58, v62
    v_permlane32_swap_b32 v59, v63
    v_pk_add_f32 v[56:57], v[56:57], v[60:61]
    v_pk_add_f32 v[58:59], v[58:59], v[62:63]
    v_cvt_pk_bf16_f32 v60, v56, v57
    v_cvt_pk_bf16_f32 v61, v58, v59
    v_min_u32 v60, -2, v60
    buffer_store_dwordx2 v[60:61], v4, s[8:11], s70 offen sc1
    s_waitcnt vmcnt(0)
    v_smfmac_f32_16x16x64_bf16 v[64:67], v[16:19], a[160:167], v2
    buffer_store_dwordx2 v[60:61], v4, s[8:11], s25 offen sc1
    v_smfmac_f32_16x16x64_bf16 v[68:71], v[16:19], a[168:175], v2
    v_smfmac_f32_16x16x64_bf16 v[64:67], v[20:23], a[176:183], v2
    v_smfmac_f32_16x16x64_bf16 v[68:71], v[20:23], a[184:191], v2
    v_smfmac_f32_16x16x64_bf16 v[64:67], v[24:27], a[192:199], v2
    v_smfmac_f32_16x16x64_bf16 v[68:71], v[24:27], a[200:207], v2
    v_smfmac_f32_16x16x64_bf16 v[64:67], v[28:31], a[208:215], v2
    v_smfmac_f32_16x16x64_bf16 v[68:71], v[28:31], a[216:223], v2
    v_smfmac_f32_16x16x64_bf16 v[64:67], v[32:35], a[224:231], v2
    v_smfmac_f32_16x16x64_bf16 v[68:71], v[32:35], a[232:239], v2
    v_smfmac_f32_16x16x64_bf16 v[64:67], v[36:39], a[240:247], v2
    v_smfmac_f32_16x16x64_bf16 v[68:71], v[36:39], a[248:255], v2
    v_smfmac_f32_16x16x64_bf16 v[64:67], v[40:43], v[192:199], v2
    v_smfmac_f32_16x16x64_bf16 v[68:71], v[40:43], v[200:207], v2
    v_smfmac_f32_16x16x64_bf16 v[64:67], v[44:47], v[208:215], v2
    v_smfmac_f32_16x16x64_bf16 v[68:71], v[44:47], v[216:223], v2
    v_smfmac_f32_16x16x64_bf16 v[64:67], v[48:51], v[224:231], v2
    v_smfmac_f32_16x16x64_bf16 v[68:71], v[48:51], v[232:239], v2
    v_smfmac_f32_16x16x64_bf16 v[64:67], v[52:55], v[240:247], v2
    v_smfmac_f32_16x16x64_bf16 v[68:71], v[52:55], v[248:255], v2
    s_nop 4
    v_cvt_pk_bf16_f32 v184, v64, v65
    v_cvt_pk_bf16_f32 v185, v66, v67
    v_min_u32 v184, -2, v184
    v_cvt_pk_bf16_f32 v186, v68, v69
    v_cvt_pk_bf16_f32 v187, v70, v71
    buffer_store_dwordx4 v[184:187], v12, s[8:11], s71 offen sc1
    v_permlane32_swap_b32 v64, v68
    v_permlane32_swap_b32 v65, v69
    v_permlane32_swap_b32 v66, v70
    v_permlane32_swap_b32 v67, v71
    v_pk_add_f32 v[64:65], v[64:65], v[68:69]
    v_pk_add_f32 v[66:67], v[66:67], v[70:71]
    v_cvt_pk_bf16_f32 v68, v64, v65
    v_cvt_pk_bf16_f32 v69, v66, v67
    buffer_store_dwordx2 v[68:69], v4, s[8:11], s25 offen offset:2048 sc1
    buffer_store_dwordx2 v[144:145], v4, s[8:11], s46 offen sc1
    buffer_store_dwordx4 v[144:147], v12, s[8:11], s18 offen sc1
    s_cmp_eq_u32 s5, 63
    s_cbranch_scc1 lastb_79
    s_cmp_eq_u32 s37, 0
    s_cbranch_scc1 nored_80
retry_81:
    buffer_load_dwordx4 v[144:147], v8, s[8:11], s32 offen sc1
    buffer_load_dwordx4 v[148:151], v8, s[8:11], s33 offen sc1
    buffer_load_dwordx4 v[152:155], v8, s[8:11], s34 offen sc1
    buffer_load_dwordx4 v[156:159], v8, s[8:11], s35 offen sc1
    s_waitcnt vmcnt(3)
    v_xor_b32 v10, s20, v144
    s_waitcnt vmcnt(2)
    v_bitop3_b32 v10, v10, v148, s20 bitop3:0xf6
    v_pk_add_f32 v[144:145], v[144:145], v[148:149]
    v_pk_add_f32 v[146:147], v[146:147], v[150:151]
    s_waitcnt vmcnt(1)
    v_bitop3_b32 v10, v10, v152, s20 bitop3:0xf6
    v_pk_add_f32 v[144:145], v[144:145], v[152:153]
    v_pk_add_f32 v[146:147], v[146:147], v[154:155]
    s_waitcnt vmcnt(0)
    v_bitop3_b32 v10, v10, v156, s20 bitop3:0xf6
    v_pk_add_f32 v[144:145], v[144:145], v[156:157]
    v_pk_add_f32 v[146:147], v[146:147], v[158:159]
    v_and_b32 v10, 1, v10
    v_cmp_ne_u32 vcc, 0, v10
    s_cbranch_vccnz retry_81
    v_permlane32_swap_b32 v144, v145
    v_permlane32_swap_b32 v146, v147
    v_add_f32 v144, v144, v145
    v_add_f32 v146, v146, v147
    s_nop 1
    v_permlane16_swap_b32 v144, v146
    v_add_f32 v144, v144, v146
    v_and_or_b32 v148, v144, -2, s20
    s_andn2_b32 s30, s5, 2
    s_cmp_lg_u32 s30, 1
    s_cbranch_scc1 m1_84
    s_memtime s[84:85]
    s_waitcnt lgkmcnt(0)
m1_84:
    buffer_store_dword v148, v14, s[8:11], s79 offen sc1
    s_sleep 8
    buffer_load_dword v149, v14, s[8:11], s80 offen sc1
    s_sleep 2
xpoll_83:
    buffer_load_dword v150, v14, s[8:11], s80 offen sc1
    s_waitcnt vmcnt(1)
    v_xor_b32 v10, s20, v149
    v_and_b32 v10, 1, v10
    v_cmp_ne_u32 vcc, 0, v10
    s_cbranch_vccz xd_87
    buffer_load_dword v149, v14, s[8:11], s80 offen sc1
    s_waitcnt vmcnt(1)
    v_xor_b32 v10, s20, v150
    v_and_b32 v10, 1, v10
    v_cmp_ne_u32 vcc, 0, v10
    s_cbranch_vccnz xpoll_83
    s_waitcnt vmcnt(0)
xd_87:
    s_cmp_gt_u32 s5, 5
    s_cbranch_scc1 m2_85
    s_andn2_b32 s30, s5, 2
    s_cmp_lg_u32 s30, 1
    s_cbranch_scc1 m3_86
    s_memtime s[86:87]
    s_waitcnt lgkmcnt(0)
    s_waitcnt lgkmcnt(0)
    s_sub_u32 s86, s86, s84
    s_mov_b32 s81, s82
    s_mov_b32 s82, s86
    s_cmp_lg_u32 s5, 3
    s_cbranch_scc1 m2_85
    s_lshr_b32 s81, s81, 4
    s_lshr_b32 s82, s82, 4
    s_min_u32 s81, s81, 0x7fff
    s_min_u32 s82, s82, 0x7fff
    s_add_u32 s81, s81, 0x1000000
    s_mov_b64 exec, 1
    v_mov_b32 v10, 8
    v_mov_b32 v11, s82
    global_atomic_add v10, v11, s[96:97] sc1
    s_waitcnt vmcnt(0)
    v_mov_b32 v10, 136
    v_mov_b32 v11, s81
    global_atomic_add v10, v11, s[96:97] sc1
    s_mov_b64 exec, -1
    s_branch m2_85
m3_86:
    s_cmp_lg_u32 s5, 5
    s_cbranch_scc1 m2_85
    v_mov_b32 v10, 136
vl_88:
    global_load_dword v11, v10, s[96:97] sc1
    s_waitcnt vmcnt(0)
    s_waitcnt vmcnt(0)
    v_readfirstlane_b32 s30, v11
    s_nop 0
    s_lshr_b32 s31, s30, 24
    s_cmp_lt_u32 s31, 160
    s_cbranch_scc1 vl_88
    v_mov_b32 v10, 8
    global_load_dword v11, v10, s[96:97] sc1
    s_waitcnt vmcnt(0)
    s_waitcnt vmcnt(0)
    v_readfirstlane_b32 s31, v11
    s_and_b32 s30, s30, 0xffffff
    s_cmp_lt_u32 s31, s30
    s_cselect_b32 s78, 8192, 0
m2_85:
    v_add_f32 v144, v148, v149
    v_mov_b32 v145, v144
    s_nop 1
    v_permlane32_swap_b32 v145, v144
    v_cvt_pk_bf16_f32 v144, v145, v144
    v_min_u32 v144, -2, v144
    v_mov_b32 v146, -1
    buffer_store_dword v144, v9, s[8:11], s22 offen sc1
    buffer_store_dword v146, v9, s[8:11], s23 offen sc1
nored_80:
    s_add_u32 s5, s5, 1
    s_and_b32 s31, s5, 3
    s_mul_i32 s21, s31, 10240
    s_add_u32 s21, s21, s39
    s_add_u32 s40, s21, 4096
    s_add_u32 s41, s21, s42
    s_and_b32 s20, s5, 1
    s_add_u32 s30, s5, 1
    s_and_b32 s31, s30, 3
    s_mul_i32 s22, s31, 10240
    s_add_u32 s22, s22, s38
    s_add_u32 s30, s5, 3
    s_and_b32 s31, s30, 3
    s_mul_i32 s23, s31, 10240
    s_add_u32 s23, s23, s38
    s_lshl_b32 s25, s5, 5
    s_add_u32 s25, s25, s27
    s_lshl_b32 s24, s25, 13
    s_add_u32 s24, s24, 262144
    s_add_u32 s55, s57, s24
    s_add_u32 s56, s58, s24
    s_lshl_b32 s25, s25, 12
    s_add_u32 s25, s25, 8388608
    s_lshl_b32 s30, s20, 12
    s_add_u32 s70, s45, s30
    s_add_u32 s71, s47, s30
    s_xor_b32 s30, s30, 4096
    s_add_u32 s46, s45, s30
    s_add_u32 s18, s47, s30
    s_lshl_b32 s30, s5, 12
    s_and_b32 s30, s30, 8192
    s_cmp_lt_u32 s5, 6
    s_cselect_b32 s30, s30, s78
    s_add_u32 s79, s43, s30
    s_add_u32 s80, s44, s30
    s_cmp_lt_u32 s5, 64
    s_nop 3
    s_cbranch_scc1 stepb_54
lastb_79:
    s_waitcnt vmcnt(0) lgkmcnt(0)
    s_barrier
    s_cmp_lg_u32 s4, 3
    s_cbranch_scc1 nopub_89
    s_add_u32 s30, s5, 0
    s_lshl_b32 s30, s30, 5
    s_add_u32 s30, s30, s27
    s_lshl_b32 s30, s30, 2
    s_add_u32 s30, s30, 1048576
    v_mov_b32 v10, 0
    v_mov_b32 v11, 1
    buffer_store_dword v11, v10, s[8:11], s30 offen sc1
nopub_89:
    s_branch chend_14
chend_14:
    s_waitcnt vmcnt(0) lgkmcnt(0)
    s_cmp_eq_u32 s88, 0
    s_cbranch_scc1 L_end
    s_branch L_resume
L_chain_far:
    s_lshl_b32 s7, s4, 6
    v_add_u32 v0, s7, v1
    s_branch L_chain
L_resume:
    v_and_b32 v1, 63, v0
    v_lshrrev_b32 v2, 6, v0
    s_nop 0
    v_readfirstlane_b32 s4, v2
    v_lshlrev_b32 v2, 4, v1
    v_and_b32 v3, 15, v1
    v_lshrrev_b32 v4, 4, v1
    s_load_dwordx2 s[16:17], s[0:1], 104
    s_waitcnt lgkmcnt(0)
    s_mov_b32 s8, s16
    s_and_b32 s9, s17, 0xffff
    s_mov_b32 s10, 268435456
    s_mov_b32 s11, 0x00020000
    s_load_dwordx2 s[98:99], s[0:1], 96
    s_waitcnt lgkmcnt(0)
    s_mov_b32 s92, 0
    s_mov_b32 s83, 0
    s_mov_b32 s89, 5
    s_bfe_u32 s5, s88, 0x80008
    s_and_b32 s7, s88, 0xff
    s_mov_b32 s84, 32
    s_mov_b32 s86, 16
    s_mov_b32 s88, 8
    s_mov_b32 s85, 134217728
    s_mov_b32 s87, 268435456
    s_branch L_T34x
L_worker:
    v_and_b32 v1, 63, v0
    v_lshrrev_b32 v2, 6, v0
    s_nop 0
    v_readfirstlane_b32 s4, v2
    v_lshlrev_b32 v2, 4, v1
    v_and_b32 v3, 15, v1
    v_lshrrev_b32 v4, 4, v1
    s_load_dwordx2 s[16:17], s[0:1], 104
    s_waitcnt lgkmcnt(0)
    s_mov_b32 s8, s16
    s_and_b32 s9, s17, 0xffff
    s_mov_b32 s10, 268435456
    s_mov_b32 s11, 0x00020000
    s_load_dwordx2 s[98:99], s[0:1], 96
    s_waitcnt lgkmcnt(0)
    s_mov_b32 s92, 0
    s_mov_b32 s83, 0
    s_mov_b32 s89, 5
    s_mov_b32 s84, 32
    s_mov_b32 s86, 16
    s_mov_b32 s88, 8
    s_mov_b32 s85, 134217728
    s_mov_b32 s87, 268435456
    s_cmp_lg_u32 s4, 0
    s_cbranch_scc1 tki_90
    s_lshl_b32 s93, s83, 2
    s_add_u32 s93, s93, 176
    v_mov_b32 v250, s93
    v_mov_b32 v251, 1
    s_mov_b64 exec, 1
    global_atomic_add v249, v250, v251, s[98:99] sc0 sc1
    s_mov_b64 exec, -1
tki_90:
L_next:
    s_cmp_lg_u32 s4, 0
    s_cbranch_scc1 tk_91
    s_waitcnt vmcnt(0)
    v_mov_b32 v250, 163836
    s_mov_b64 exec, 1
    ds_write_b32 v250, v249
    s_waitcnt lgkmcnt(0)
    s_mov_b64 exec, -1
tk_91:
    s_barrier
    v_mov_b32 v250, 163836
    ds_read_b32 v252, v250
    s_waitcnt lgkmcnt(0)
    s_waitcnt lgkmcnt(0)
    v_readfirstlane_b32 s6, v252
    s_barrier
    s_mul_i32 s20, s84, 4
    s_cmp_ge_u32 s6, s20
    s_cbranch_scc1 dn_107
    s_mul_hi_u32 s5, s6, s85
    s_mul_i32 s21, s5, s84
    s_sub_u32 s7, s6, s21
    s_add_u32 s5, s5, 0
    s_and_b32 s21, s5, 1
    s_lshr_b32 s5, s5, 1
    s_cmp_eq_u32 s21, 0
    s_cbranch_scc1 LKDK_103
    s_branch LKDV_104
dn_107:
    s_sub_u32 s6, s6, s20
    s_mul_i32 s20, s84, 2
    s_cmp_ge_u32 s6, s20
    s_cbranch_scc1 dn_108
    s_mul_hi_u32 s5, s6, s85
    s_mul_i32 s21, s5, s84
    s_sub_u32 s7, s6, s21
    s_add_u32 s5, s5, 4
    s_and_b32 s21, s5, 1
    s_lshr_b32 s5, s5, 1
    s_cmp_eq_u32 s21, 0
    s_cbranch_scc1 LKDK_103
    s_branch LKDV_104
dn_108:
    s_sub_u32 s6, s6, s20
    s_mov_b32 s20, 192
    s_cmp_ge_u32 s6, s20
    s_cbranch_scc1 dn_109
    s_mov_b32 s6, s6
    s_branch LT0_92
dn_109:
    s_sub_u32 s6, s6, s20
    s_mul_i32 s20, s84, 2
    s_cmp_ge_u32 s6, s20
    s_cbranch_scc1 dn_110
    s_mul_hi_u32 s5, s6, s85
    s_mul_i32 s21, s5, s84
    s_sub_u32 s7, s6, s21
    s_add_u32 s5, s5, 6
    s_and_b32 s21, s5, 1
    s_lshr_b32 s5, s5, 1
    s_cmp_eq_u32 s21, 0
    s_cbranch_scc1 LKDK_103
    s_branch LKDV_104
dn_110:
    s_sub_u32 s6, s6, s20
    s_lshl_b32 s20, s84, 1
    s_cmp_ge_u32 s6, s20
    s_cbranch_scc1 dn_111
    s_mul_hi_u32 s5, s6, s85
    s_mul_i32 s21, s5, s84
    s_sub_u32 s7, s6, s21
    s_cmp_eq_u32 s5, 0
    s_mov_b32 s5, 1
    s_cbranch_scc1 LBK_93
    s_branch LBV_94
dn_111:
    s_sub_u32 s6, s6, s20
    s_lshl_b32 s20, s84, 1
    s_cmp_ge_u32 s6, s20
    s_cbranch_scc1 dn_112
    s_mul_hi_u32 s5, s6, s85
    s_mul_i32 s21, s5, s84
    s_sub_u32 s7, s6, s21
    s_cmp_eq_u32 s5, 0
    s_mov_b32 s5, 2
    s_cbranch_scc1 LBK_93
    s_branch LBV_94
dn_112:
    s_sub_u32 s6, s6, s20
    s_mov_b32 s20, 228
    s_cmp_ge_u32 s6, s20
    s_cbranch_scc1 dn_113
    s_mov_b32 s6, s6
    s_add_u32 s6, s6, 192
    s_branch LT0_92
dn_113:
    s_sub_u32 s6, s6, s20
    s_lshl_b32 s20, s84, 1
    s_cmp_ge_u32 s6, s20
    s_cbranch_scc1 dn_114
    s_mul_hi_u32 s5, s6, s85
    s_mul_i32 s21, s5, s84
    s_sub_u32 s7, s6, s21
    s_cmp_eq_u32 s5, 0
    s_mov_b32 s5, 3
    s_cbranch_scc1 LBK_93
    s_branch LBV_94
dn_114:
    s_sub_u32 s6, s6, s20
    s_mov_b32 s20, s84
    s_cmp_ge_u32 s6, s20
    s_cbranch_scc1 dn_115
    s_mov_b32 s7, s6
    s_mov_b32 s5, 0
    s_branch LBQ_95
dn_115:
    s_sub_u32 s6, s6, s20
    s_mov_b32 s20, s84
    s_cmp_ge_u32 s6, s20
    s_cbranch_scc1 dn_116
    s_mov_b32 s7, s6
    s_mov_b32 s5, 1
    s_branch LBQ_95
dn_116:
    s_sub_u32 s6, s6, s20
    s_lshl_b32 s20, s86, 3
    s_cmp_ge_u32 s6, s20
    s_cbranch_scc1 dn_117
    s_mul_hi_u32 s5, s6, s87
    s_mul_i32 s21, s5, s86
    s_sub_u32 s7, s6, s21
    s_branch LAQK_96
dn_117:
    s_sub_u32 s6, s6, s20
    s_lshl_b32 s20, s88, 3
    s_cmp_ge_u32 s6, s20
    s_cbranch_scc1 dn_118
    s_lshr_b32 s5, s6, 3
    s_mul_i32 s21, s5, s88
    s_sub_u32 s7, s6, s21
    s_branch LAV_97
dn_118:
    s_sub_u32 s6, s6, s20
    s_lshl_b32 s20, s84, 1
    s_cmp_ge_u32 s6, s20
    s_cbranch_scc1 dn_119
    s_mul_hi_u32 s5, s6, s85
    s_mul_i32 s21, s5, s84
    s_sub_u32 s7, s6, s21
    s_cmp_eq_u32 s5, 0
    s_mov_b32 s5, 4
    s_cbranch_scc1 LBK_93
    s_branch LBV_94
dn_119:
    s_sub_u32 s6, s6, s20
    s_mov_b32 s20, s84
    s_cmp_ge_u32 s6, s20
    s_cbranch_scc1 dn_120
    s_mov_b32 s7, s6
    s_mov_b32 s5, 2
    s_branch LBQ_95
dn_120:
    s_sub_u32 s6, s6, s20
    s_mov_b32 s20, s84
    s_cmp_ge_u32 s6, s20
    s_cbranch_scc1 dn_121
    s_mov_b32 s7, s6
    s_mov_b32 s5, 3
    s_branch LBQ_95
dn_121:
    s_sub_u32 s6, s6, s20
    s_lshl_b32 s20, s88, 2
    s_cmp_ge_u32 s6, s20
    s_cbranch_scc1 dn_122
    s_lshr_b32 s5, s6, 3
    s_mul_i32 s21, s5, s88
    s_sub_u32 s7, s6, s21
    s_add_u32 s5, s5, 0
    s_branch LT34_100
dn_122:
    s_sub_u32 s6, s6, s20
    s_mov_b32 s20, s84
    s_cmp_ge_u32 s6, s20
    s_cbranch_scc1 dn_123
    s_mov_b32 s5, s6
    s_mov_b32 s7, 0
    s_branch LT2_98
dn_123:
    s_sub_u32 s6, s6, s20
    s_mov_b32 s20, s84
    s_cmp_ge_u32 s6, s20
    s_cbranch_scc1 dn_124
    s_mov_b32 s5, s6
    s_mov_b32 s7, 1
    s_branch LT2_98
dn_124:
    s_sub_u32 s6, s6, s20
    s_lshl_b32 s20, s84, 1
    s_cmp_ge_u32 s6, s20
    s_cbranch_scc1 dn_125
    s_mul_hi_u32 s5, s6, s85
    s_mul_i32 s21, s5, s84
    s_sub_u32 s7, s6, s21
    s_cmp_eq_u32 s5, 0
    s_mov_b32 s5, 5
    s_cbranch_scc1 LBK_93
    s_branch LBV_94
dn_125:
    s_sub_u32 s6, s6, s20
    s_mov_b32 s20, s84
    s_cmp_ge_u32 s6, s20
    s_cbranch_scc1 dn_126
    s_mov_b32 s7, s6
    s_mov_b32 s5, 4
    s_branch LBQ_95
dn_126:
    s_sub_u32 s6, s6, s20
    s_lshl_b32 s20, s88, 2
    s_cmp_ge_u32 s6, s20
    s_cbranch_scc1 dn_127
    s_lshr_b32 s5, s6, 3
    s_mul_i32 s21, s5, s88
    s_sub_u32 s7, s6, s21
    s_add_u32 s5, s5, 4
    s_branch LT34_100
dn_127:
    s_sub_u32 s6, s6, s20
    s_mov_b32 s20, s84
    s_cmp_ge_u32 s6, s20
    s_cbranch_scc1 dn_128
    s_mov_b32 s5, s6
    s_mov_b32 s7, 2
    s_branch LT2_98
dn_128:
    s_sub_u32 s6, s6, s20
    s_mov_b32 s20, s84
    s_cmp_ge_u32 s6, s20
    s_cbranch_scc1 dn_129
    s_mov_b32 s5, s6
    s_mov_b32 s7, 3
    s_branch LT2_98
dn_129:
    s_sub_u32 s6, s6, s20
    s_lshl_b32 s20, s84, 1
    s_cmp_ge_u32 s6, s20
    s_cbranch_scc1 dn_130
    s_mul_hi_u32 s5, s6, s85
    s_mul_i32 s21, s5, s84
    s_sub_u32 s7, s6, s21
    s_cmp_eq_u32 s5, 0
    s_mov_b32 s5, 6
    s_cbranch_scc1 LBK_93
    s_branch LBV_94
dn_130:
    s_sub_u32 s6, s6, s20
    s_mov_b32 s20, s84
    s_cmp_ge_u32 s6, s20
    s_cbranch_scc1 dn_131
    s_mov_b32 s7, s6
    s_mov_b32 s5, 5
    s_branch LBQ_95
dn_131:
    s_sub_u32 s6, s6, s20
    s_mov_b32 s20, 5
    s_cmp_ge_u32 s6, s20
    s_cbranch_scc1 dn_132
    s_mov_b32 s7, s6
    s_mov_b32 s5, 0
    s_branch LT4A_99
dn_132:
    s_sub_u32 s6, s6, s20
    s_mov_b32 s20, 5
    s_cmp_ge_u32 s6, s20
    s_cbranch_scc1 dn_133
    s_mov_b32 s7, s6
    s_mov_b32 s5, 1
    s_branch LT4A_99
dn_133:
    s_sub_u32 s6, s6, s20
    s_lshl_b32 s20, s88, 2
    s_cmp_ge_u32 s6, s20
    s_cbranch_scc1 dn_134
    s_lshr_b32 s5, s6, 3
    s_mul_i32 s21, s5, s88
    s_sub_u32 s7, s6, s21
    s_add_u32 s5, s5, 8
    s_branch LT34_100
dn_134:
    s_sub_u32 s6, s6, s20
    s_mov_b32 s20, s84
    s_cmp_ge_u32 s6, s20
    s_cbranch_scc1 dn_135
    s_mov_b32 s5, s6
    s_mov_b32 s7, 4
    s_branch LT2_98
dn_135:
    s_sub_u32 s6, s6, s20
    s_mov_b32 s20, s84
    s_cmp_ge_u32 s6, s20
    s_cbranch_scc1 dn_136
    s_mov_b32 s5, s6
    s_mov_b32 s7, 5
    s_branch LT2_98
dn_136:
    s_sub_u32 s6, s6, s20
    s_lshl_b32 s20, s84, 1
    s_cmp_ge_u32 s6, s20
    s_cbranch_scc1 dn_137
    s_mul_hi_u32 s5, s6, s85
    s_mul_i32 s21, s5, s84
    s_sub_u32 s7, s6, s21
    s_cmp_eq_u32 s5, 0
    s_mov_b32 s5, 7
    s_cbranch_scc1 LBK_93
    s_branch LBV_94
dn_137:
    s_sub_u32 s6, s6, s20
    s_mov_b32 s20, s84
    s_cmp_ge_u32 s6, s20
    s_cbranch_scc1 dn_138
    s_mov_b32 s7, s6
    s_mov_b32 s5, 6
    s_branch LBQ_95
dn_138:
    s_sub_u32 s6, s6, s20
    s_mov_b32 s20, 5
    s_cmp_ge_u32 s6, s20
    s_cbranch_scc1 dn_139
    s_mov_b32 s7, s6
    s_mov_b32 s5, 2
    s_branch LT4A_99
dn_139:
    s_sub_u32 s6, s6, s20
    s_mov_b32 s20, 5
    s_cmp_ge_u32 s6, s20
    s_cbranch_scc1 dn_140
    s_mov_b32 s7, s6
    s_mov_b32 s5, 3
    s_branch LT4A_99
dn_140:
    s_sub_u32 s6, s6, s20
    s_lshl_b32 s20, s88, 2
    s_cmp_ge_u32 s6, s20
    s_cbranch_scc1 dn_141
    s_lshr_b32 s5, s6, 3
    s_mul_i32 s21, s5, s88
    s_sub_u32 s7, s6, s21
    s_add_u32 s5, s5, 12
    s_branch LT34_100
dn_141:
    s_sub_u32 s6, s6, s20
    s_mov_b32 s20, s84
    s_cmp_ge_u32 s6, s20
    s_cbranch_scc1 dn_142
    s_mov_b32 s5, s6
    s_mov_b32 s7, 6
    s_branch LT2_98
dn_142:
    s_sub_u32 s6, s6, s20
    s_mov_b32 s20, s84
    s_cmp_ge_u32 s6, s20
    s_cbranch_scc1 dn_143
    s_mov_b32 s5, s6
    s_mov_b32 s7, 7
    s_branch LT2_98
dn_143:
    s_sub_u32 s6, s6, s20
    s_mov_b32 s20, s84
    s_cmp_ge_u32 s6, s20
    s_cbranch_scc1 dn_144
    s_mov_b32 s7, s6
    s_mov_b32 s5, 7
    s_branch LBQ_95
dn_144:
    s_sub_u32 s6, s6, s20
    s_mov_b32 s20, 5
    s_cmp_ge_u32 s6, s20
    s_cbranch_scc1 dn_145
    s_mov_b32 s7, s6
    s_mov_b32 s5, 4
    s_branch LT4A_99
dn_145:
    s_sub_u32 s6, s6, s20
    s_mov_b32 s20, 5
    s_cmp_ge_u32 s6, s20
    s_cbranch_scc1 dn_146
    s_mov_b32 s7, s6
    s_mov_b32 s5, 5
    s_branch LT4A_99
dn_146:
    s_sub_u32 s6, s6, s20
    s_mov_b32 s20, s84
    s_cmp_ge_u32 s6, s20
    s_cbranch_scc1 dn_147
    s_mov_b32 s7, s6
    s_lshr_b32 s5, s7, 2
    s_add_u32 s5, s5, 0
    s_and_b32 s7, s7, 3
    s_branch LT5_105
dn_147:
    s_sub_u32 s6, s6, s20
    s_mov_b32 s20, s84
    s_cmp_ge_u32 s6, s20
    s_cbranch_scc1 dn_148
    s_mov_b32 s7, s6
    s_lshr_b32 s5, s7, 2
    s_add_u32 s5, s5, 8
    s_and_b32 s7, s7, 3
    s_branch LT5_105
dn_148:
    s_sub_u32 s6, s6, s20
    s_lshl_b32 s20, s88, 2
    s_cmp_ge_u32 s6, s20
    s_cbranch_scc1 dn_149
    s_lshr_b32 s5, s6, 3
    s_mul_i32 s21, s5, s88
    s_sub_u32 s7, s6, s21
    s_add_u32 s5, s5, 16
    s_branch LT34_100
dn_149:
    s_sub_u32 s6, s6, s20
    s_mov_b32 s20, 5
    s_cmp_ge_u32 s6, s20
    s_cbranch_scc1 dn_150
    s_mov_b32 s7, s6
    s_mov_b32 s5, 6
    s_branch LT4A_99
dn_150:
    s_sub_u32 s6, s6, s20
    s_mov_b32 s20, 5
    s_cmp_ge_u32 s6, s20
    s_cbranch_scc1 dn_151
    s_mov_b32 s7, s6
    s_mov_b32 s5, 7
    s_branch LT4A_99
dn_151:
    s_sub_u32 s6, s6, s20
    s_mov_b32 s20, s84
    s_cmp_ge_u32 s6, s20
    s_cbranch_scc1 dn_152
    s_mov_b32 s7, s6
    s_lshr_b32 s5, s7, 2
    s_add_u32 s5, s5, 16
    s_and_b32 s7, s7, 3
    s_branch LT5_105
dn_152:
    s_sub_u32 s6, s6, s20
    s_mov_b32 s20, s84
    s_cmp_ge_u32 s6, s20
    s_cbranch_scc1 dn_153
    s_mov_b32 s7, s6
    s_lshr_b32 s5, s7, 2
    s_add_u32 s5, s5, 24
    s_and_b32 s7, s7, 3
    s_branch LT5_105
dn_153:
    s_sub_u32 s6, s6, s20
    s_lshl_b32 s20, s88, 2
    s_cmp_ge_u32 s6, s20
    s_cbranch_scc1 dn_154
    s_lshr_b32 s5, s6, 3
    s_mul_i32 s21, s5, s88
    s_sub_u32 s7, s6, s21
    s_add_u32 s5, s5, 20
    s_branch LT34_100
dn_154:
    s_sub_u32 s6, s6, s20
    s_mov_b32 s20, s84
    s_cmp_ge_u32 s6, s20
    s_cbranch_scc1 dn_155
    s_mov_b32 s7, s6
    s_lshr_b32 s5, s7, 2
    s_add_u32 s5, s5, 32
    s_and_b32 s7, s7, 3
    s_branch LT5_105
dn_155:
    s_sub_u32 s6, s6, s20
    s_lshl_b32 s20, s88, 2
    s_cmp_ge_u32 s6, s20
    s_cbranch_scc1 dn_156
    s_lshr_b32 s5, s6, 3
    s_mul_i32 s21, s5, s88
    s_sub_u32 s7, s6, s21
    s_add_u32 s5, s5, 24
    s_branch LT34_100
dn_156:
    s_sub_u32 s6, s6, s20
    s_mov_b32 s20, s84
    s_cmp_ge_u32 s6, s20
    s_cbranch_scc1 dn_157
    s_mov_b32 s7, s6
    s_lshr_b32 s5, s7, 2
    s_add_u32 s5, s5, 40
    s_and_b32 s7, s7, 3
    s_branch LT5_105
dn_157:
    s_sub_u32 s6, s6, s20
    s_mov_b32 s20, s88
    s_cmp_ge_u32 s6, s20
    s_cbranch_scc1 dn_158
    s_mov_b32 s7, s6
    s_mov_b32 s5, 28
    s_branch LT34_100
dn_158:
    s_sub_u32 s6, s6, s20
    s_mov_b32 s20, 4
    s_cmp_ge_u32 s6, s20
    s_cbranch_scc1 dn_159
    s_mov_b32 s7, s6
    s_mov_b32 s5, 48
    s_branch LT5_105
dn_159:
    s_sub_u32 s6, s6, s20
    s_mov_b32 s20, 4
    s_cmp_ge_u32 s6, s20
    s_cbranch_scc1 dn_160
    s_mov_b32 s7, s6
    s_mov_b32 s5, 49
    s_branch LT5_105
dn_160:
    s_sub_u32 s6, s6, s20
    s_mov_b32 s20, s88
    s_cmp_ge_u32 s6, s20
    s_cbranch_scc1 dn_161
    s_mov_b32 s7, s6
    s_mov_b32 s5, 29
    s_branch LT34_100
dn_161:
    s_sub_u32 s6, s6, s20
    s_mov_b32 s20, 4
    s_cmp_ge_u32 s6, s20
    s_cbranch_scc1 dn_162
    s_mov_b32 s7, s6
    s_mov_b32 s5, 50
    s_branch LT5_105
dn_162:
    s_sub_u32 s6, s6, s20
    s_mov_b32 s20, 4
    s_cmp_ge_u32 s6, s20
    s_cbranch_scc1 dn_163
    s_mov_b32 s7, s6
    s_mov_b32 s5, 51
    s_branch LT5_105
dn_163:
    s_sub_u32 s6, s6, s20
    s_mov_b32 s20, 16
    s_cmp_ge_u32 s6, s20
    s_cbranch_scc1 dn_164
    s_and_b32 s7, s6, 7
    s_lshr_b32 s59, s6, 3
    s_mov_b32 s5, 60
    s_branch LT34O_106
dn_164:
    s_sub_u32 s6, s6, s20
    s_mov_b32 s20, 4
    s_cmp_ge_u32 s6, s20
    s_cbranch_scc1 dn_165
    s_mov_b32 s7, s6
    s_mov_b32 s5, 52
    s_branch LT5_105
dn_165:
    s_sub_u32 s6, s6, s20
    s_mov_b32 s20, 16
    s_cmp_ge_u32 s6, s20
    s_cbranch_scc1 dn_166
    s_and_b32 s7, s6, 7
    s_lshr_b32 s59, s6, 3
    s_mov_b32 s5, 61
    s_branch LT34O_106
dn_166:
    s_sub_u32 s6, s6, s20
    s_mov_b32 s20, 4
    s_cmp_ge_u32 s6, s20
    s_cbranch_scc1 dn_167
    s_mov_b32 s7, s6
    s_mov_b32 s5, 53
    s_branch LT5_105
dn_167:
    s_sub_u32 s6, s6, s20
    s_mov_b32 s20, 16
    s_cmp_ge_u32 s6, s20
    s_cbranch_scc1 dn_168
    s_and_b32 s7, s6, 7
    s_lshr_b32 s59, s6, 3
    s_mov_b32 s5, 62
    s_branch LT34O_106
dn_168:
    s_sub_u32 s6, s6, s20
    s_mov_b32 s20, 4
    s_cmp_ge_u32 s6, s20
    s_cbranch_scc1 dn_169
    s_mov_b32 s7, s6
    s_mov_b32 s5, 54
    s_branch LT5_105
dn_169:
    s_sub_u32 s6, s6, s20
    s_mov_b32 s20, 16
    s_cmp_ge_u32 s6, s20
    s_cbranch_scc1 dn_170
    s_and_b32 s7, s6, 7
    s_lshr_b32 s59, s6, 3
    s_mov_b32 s5, 63
    s_branch LT34O_106
dn_170:
    s_sub_u32 s6, s6, s20
    s_mov_b32 s20, 4
    s_cmp_ge_u32 s6, s20
    s_cbranch_scc1 dn_171
    s_mov_b32 s7, s6
    s_mov_b32 s5, 55
    s_branch LT5_105
dn_171:
    s_sub_u32 s6, s6, s20
    s_mov_b32 s20, s84
    s_cmp_ge_u32 s6, s20
    s_cbranch_scc1 dn_172
    s_mov_b32 s7, s6
    s_lshr_b32 s5, s7, 2
    s_add_u32 s5, s5, 56
    s_and_b32 s7, s7, 3
    s_branch LT5_105
dn_172:
    s_sub_u32 s6, s6, s20
    s_add_u32 s89, s89, 1
    s_cmp_ge_u32 s89, 6
    s_cbranch_scc1 L_fin
    s_add_u32 s83, s83, 1
    s_cmp_eq_u32 s83, 6
    s_cselect_b32 s83, 0, s83
    s_mov_b32 s84, 32
    s_mov_b32 s86, 16
    s_mov_b32 s88, 8
    s_mov_b32 s85, 134217728
    s_mov_b32 s87, 268435456
    s_cmp_lg_u32 s4, 0
    s_cbranch_scc1 tki_173
    s_lshl_b32 s93, s83, 2
    s_add_u32 s93, s93, 176
    v_mov_b32 v250, s93
    v_mov_b32 v251, 1
    s_mov_b64 exec, 1
    global_atomic_add v249, v250, v251, s[98:99] sc0 sc1
    s_mov_b64 exec, -1
tki_173:
    s_branch L_next
L_fin:
    s_branch L_end
LT0_92:
    s_cmp_ge_u32 s6, 32
    s_cbranch_scc1 t0n_175
    s_sub_u32 s20, s6, 0
    s_lshl_b32 s20, s20, 2
    s_add_u32 s20, s20, s4
    s_load_dwordx2 s[16:17], s[0:1], 0
    s_waitcnt lgkmcnt(0)
    s_mov_b32 s12, s16
    s_and_b32 s13, s17, 0xffff
    s_mov_b32 s14, 2621440
    s_mov_b32 s15, 0x00020000
    s_load_dwordx2 s[16:17], s[0:1], 80
    s_waitcnt lgkmcnt(0)
    s_mov_b32 s28, s16
    s_and_b32 s29, s17, 0xffff
    s_mov_b32 s30, 1280
    s_mov_b32 s31, 0x00020000
    v_mul_u32_u24 v5, 1280, v3
    v_lshl_add_u32 v5, v4, 4, v5
    v_lshlrev_b32 v6, 4, v4
    s_mul_i32 s22, s20, 20480
    s_lshl_b32 s23, s20, 10
    s_add_u32 s23, s23, 125829120
    buffer_load_dwordx4 v[16:19], v5, s[12:15], s22 offen offset:0
    buffer_load_dwordx4 v[20:23], v5, s[12:15], s22 offen offset:64
    buffer_load_dwordx4 v[24:27], v5, s[12:15], s22 offen offset:128
    buffer_load_dwordx4 v[28:31], v5, s[12:15], s22 offen offset:192
    buffer_load_dwordx4 v[32:35], v5, s[12:15], s22 offen offset:256
    buffer_load_dwordx4 v[36:39], v5, s[12:15], s22 offen offset:320
    buffer_load_dwordx4 v[40:43], v5, s[12:15], s22 offen offset:384
    buffer_load_dwordx4 v[44:47], v5, s[12:15], s22 offen offset:448
    buffer_load_dwordx4 v[48:51], v5, s[12:15], s22 offen offset:512
    buffer_load_dwordx4 v[52:55], v5, s[12:15], s22 offen offset:576
    buffer_load_dwordx4 v[56:59], v5, s[12:15], s22 offen offset:640
    buffer_load_dwordx4 v[60:63], v5, s[12:15], s22 offen offset:704
    buffer_load_dwordx4 v[64:67], v5, s[12:15], s22 offen offset:768
    buffer_load_dwordx4 v[68:71], v5, s[12:15], s22 offen offset:832
    buffer_load_dwordx4 v[72:75], v5, s[12:15], s22 offen offset:896
    buffer_load_dwordx4 v[76:79], v5, s[12:15], s22 offen offset:960
    buffer_load_dwordx4 v[80:83], v5, s[12:15], s22 offen offset:1024
    buffer_load_dwordx4 v[84:87], v5, s[12:15], s22 offen offset:1088
    buffer_load_dwordx4 v[88:91], v5, s[12:15], s22 offen offset:1152
    buffer_load_dwordx4 v[92:95], v5, s[12:15], s22 offen offset:1216
    buffer_load_dwordx4 v[96:99], v6, s[28:31], 0 offen offset:0
    buffer_load_dwordx4 v[100:103], v6, s[28:31], 0 offen offset:64
    buffer_load_dwordx4 v[104:107], v6, s[28:31], 0 offen offset:128
    buffer_load_dwordx4 v[108:111], v6, s[28:31], 0 offen offset:192
    buffer_load_dwordx4 v[112:115], v6, s[28:31], 0 offen offset:256
    buffer_load_dwordx4 v[116:119], v6, s[28:31], 0 offen offset:320
    buffer_load_dwordx4 v[120:123], v6, s[28:31], 0 offen offset:384
    buffer_load_dwordx4 v[124:127], v6, s[28:31], 0 offen offset:448
    buffer_load_dwordx4 v[128:131], v6, s[28:31], 0 offen offset:512
    buffer_load_dwordx4 v[132:135], v6, s[28:31], 0 offen offset:576
    buffer_load_dwordx4 v[136:139], v6, s[28:31], 0 offen offset:640
    buffer_load_dwordx4 v[140:143], v6, s[28:31], 0 offen offset:704
    buffer_load_dwordx4 v[144:147], v6, s[28:31], 0 offen offset:768
    buffer_load_dwordx4 v[148:151], v6, s[28:31], 0 offen offset:832
    buffer_load_dwordx4 v[152:155], v6, s[28:31], 0 offen offset:896
    buffer_load_dwordx4 v[156:159], v6, s[28:31], 0 offen offset:960
    buffer_load_dwordx4 v[160:163], v6, s[28:31], 0 offen offset:1024
    buffer_load_dwordx4 v[164:167], v6, s[28:31], 0 offen offset:1088
    buffer_load_dwordx4 v[168:171], v6, s[28:31], 0 offen offset:1152
    buffer_load_dwordx4 v[172:175], v6, s[28:31], 0 offen offset:1216
    s_add_u32 s24, s23, 0
    s_waitcnt vmcnt(39)
    buffer_store_dwordx4 v[16:19], v2, s[8:11], s24 offen sc1
    s_add_u32 s24, s23, 131072
    s_waitcnt vmcnt(39)
    buffer_store_dwordx4 v[20:23], v2, s[8:11], s24 offen sc1
    s_add_u32 s24, s23, 262144
    s_waitcnt vmcnt(39)
    buffer_store_dwordx4 v[24:27], v2, s[8:11], s24 offen sc1
    s_add_u32 s24, s23, 393216
    s_waitcnt vmcnt(39)
    buffer_store_dwordx4 v[28:31], v2, s[8:11], s24 offen sc1
    s_add_u32 s24, s23, 524288
    s_waitcnt vmcnt(39)
    buffer_store_dwordx4 v[32:35], v2, s[8:11], s24 offen sc1
    s_add_u32 s24, s23, 655360
    s_waitcnt vmcnt(39)
    buffer_store_dwordx4 v[36:39], v2, s[8:11], s24 offen sc1
    s_add_u32 s24, s23, 786432
    s_waitcnt vmcnt(39)
    buffer_store_dwordx4 v[40:43], v2, s[8:11], s24 offen sc1
    s_add_u32 s24, s23, 917504
    s_waitcnt vmcnt(39)
    buffer_store_dwordx4 v[44:47], v2, s[8:11], s24 offen sc1
    s_add_u32 s24, s23, 1048576
    s_waitcnt vmcnt(39)
    buffer_store_dwordx4 v[48:51], v2, s[8:11], s24 offen sc1
    s_add_u32 s24, s23, 1179648
    s_waitcnt vmcnt(39)
    buffer_store_dwordx4 v[52:55], v2, s[8:11], s24 offen sc1
    s_add_u32 s24, s23, 1310720
    s_waitcnt vmcnt(39)
    buffer_store_dwordx4 v[56:59], v2, s[8:11], s24 offen sc1
    s_add_u32 s24, s23, 1441792
    s_waitcnt vmcnt(39)
    buffer_store_dwordx4 v[60:63], v2, s[8:11], s24 offen sc1
    s_add_u32 s24, s23, 1572864
    s_waitcnt vmcnt(39)
    buffer_store_dwordx4 v[64:67], v2, s[8:11], s24 offen sc1
    s_add_u32 s24, s23, 1703936
    s_waitcnt vmcnt(39)
    buffer_store_dwordx4 v[68:71], v2, s[8:11], s24 offen sc1
    s_add_u32 s24, s23, 1835008
    s_waitcnt vmcnt(39)
    buffer_store_dwordx4 v[72:75], v2, s[8:11], s24 offen sc1
    s_add_u32 s24, s23, 1966080
    s_waitcnt vmcnt(39)
    buffer_store_dwordx4 v[76:79], v2, s[8:11], s24 offen sc1
    s_add_u32 s24, s23, 2097152
    s_waitcnt vmcnt(39)
    buffer_store_dwordx4 v[80:83], v2, s[8:11], s24 offen sc1
    s_add_u32 s24, s23, 2228224
    s_waitcnt vmcnt(39)
    buffer_store_dwordx4 v[84:87], v2, s[8:11], s24 offen sc1
    s_add_u32 s24, s23, 2359296
    s_waitcnt vmcnt(39)
    buffer_store_dwordx4 v[88:91], v2, s[8:11], s24 offen sc1
    s_add_u32 s24, s23, 2490368
    s_waitcnt vmcnt(39)
    buffer_store_dwordx4 v[92:95], v2, s[8:11], s24 offen sc1
    v_mov_b32 v7, 0
    v_mov_b32 v12, 0
    v_lshlrev_b32 v8, 16, v16
    v_and_b32 v9, 0xffff0000, v16
    s_waitcnt vmcnt(39)
    v_lshlrev_b32 v10, 16, v96
    v_and_b32 v11, 0xffff0000, v96
    v_fmac_f32 v7, v8, v10
    v_fmac_f32 v12, v9, v11
    v_lshlrev_b32 v8, 16, v17
    v_and_b32 v9, 0xffff0000, v17
    v_lshlrev_b32 v10, 16, v97
    v_and_b32 v11, 0xffff0000, v97
    v_fmac_f32 v7, v8, v10
    v_fmac_f32 v12, v9, v11
    v_lshlrev_b32 v8, 16, v18
    v_and_b32 v9, 0xffff0000, v18
    v_lshlrev_b32 v10, 16, v98
    v_and_b32 v11, 0xffff0000, v98
    v_fmac_f32 v7, v8, v10
    v_fmac_f32 v12, v9, v11
    v_lshlrev_b32 v8, 16, v19
    v_and_b32 v9, 0xffff0000, v19
    v_lshlrev_b32 v10, 16, v99
    v_and_b32 v11, 0xffff0000, v99
    v_fmac_f32 v7, v8, v10
    v_fmac_f32 v12, v9, v11
    v_lshlrev_b32 v8, 16, v20
    v_and_b32 v9, 0xffff0000, v20
    s_waitcnt vmcnt(38)
    v_lshlrev_b32 v10, 16, v100
    v_and_b32 v11, 0xffff0000, v100
    v_fmac_f32 v7, v8, v10
    v_fmac_f32 v12, v9, v11
    v_lshlrev_b32 v8, 16, v21
    v_and_b32 v9, 0xffff0000, v21
    v_lshlrev_b32 v10, 16, v101
    v_and_b32 v11, 0xffff0000, v101
    v_fmac_f32 v7, v8, v10
    v_fmac_f32 v12, v9, v11
    v_lshlrev_b32 v8, 16, v22
    v_and_b32 v9, 0xffff0000, v22
    v_lshlrev_b32 v10, 16, v102
    v_and_b32 v11, 0xffff0000, v102
    v_fmac_f32 v7, v8, v10
    v_fmac_f32 v12, v9, v11
    v_lshlrev_b32 v8, 16, v23
    v_and_b32 v9, 0xffff0000, v23
    v_lshlrev_b32 v10, 16, v103
    v_and_b32 v11, 0xffff0000, v103
    v_fmac_f32 v7, v8, v10
    v_fmac_f32 v12, v9, v11
    v_lshlrev_b32 v8, 16, v24
    v_and_b32 v9, 0xffff0000, v24
    s_waitcnt vmcnt(37)
    v_lshlrev_b32 v10, 16, v104
    v_and_b32 v11, 0xffff0000, v104
    v_fmac_f32 v7, v8, v10
    v_fmac_f32 v12, v9, v11
    v_lshlrev_b32 v8, 16, v25
    v_and_b32 v9, 0xffff0000, v25
    v_lshlrev_b32 v10, 16, v105
    v_and_b32 v11, 0xffff0000, v105
    v_fmac_f32 v7, v8, v10
    v_fmac_f32 v12, v9, v11
    v_lshlrev_b32 v8, 16, v26
    v_and_b32 v9, 0xffff0000, v26
    v_lshlrev_b32 v10, 16, v106
    v_and_b32 v11, 0xffff0000, v106
    v_fmac_f32 v7, v8, v10
    v_fmac_f32 v12, v9, v11
    v_lshlrev_b32 v8, 16, v27
    v_and_b32 v9, 0xffff0000, v27
    v_lshlrev_b32 v10, 16, v107
    v_and_b32 v11, 0xffff0000, v107
    v_fmac_f32 v7, v8, v10
    v_fmac_f32 v12, v9, v11
    v_lshlrev_b32 v8, 16, v28
    v_and_b32 v9, 0xffff0000, v28
    s_waitcnt vmcnt(36)
    v_lshlrev_b32 v10, 16, v108
    v_and_b32 v11, 0xffff0000, v108
    v_fmac_f32 v7, v8, v10
    v_fmac_f32 v12, v9, v11
    v_lshlrev_b32 v8, 16, v29
    v_and_b32 v9, 0xffff0000, v29
    v_lshlrev_b32 v10, 16, v109
    v_and_b32 v11, 0xffff0000, v109
    v_fmac_f32 v7, v8, v10
    v_fmac_f32 v12, v9, v11
    v_lshlrev_b32 v8, 16, v30
    v_and_b32 v9, 0xffff0000, v30
    v_lshlrev_b32 v10, 16, v110
    v_and_b32 v11, 0xffff0000, v110
    v_fmac_f32 v7, v8, v10
    v_fmac_f32 v12, v9, v11
    v_lshlrev_b32 v8, 16, v31
    v_and_b32 v9, 0xffff0000, v31
    v_lshlrev_b32 v10, 16, v111
    v_and_b32 v11, 0xffff0000, v111
    v_fmac_f32 v7, v8, v10
    v_fmac_f32 v12, v9, v11
    v_lshlrev_b32 v8, 16, v32
    v_and_b32 v9, 0xffff0000, v32
    s_waitcnt vmcnt(35)
    v_lshlrev_b32 v10, 16, v112
    v_and_b32 v11, 0xffff0000, v112
    v_fmac_f32 v7, v8, v10
    v_fmac_f32 v12, v9, v11
    v_lshlrev_b32 v8, 16, v33
    v_and_b32 v9, 0xffff0000, v33
    v_lshlrev_b32 v10, 16, v113
    v_and_b32 v11, 0xffff0000, v113
    v_fmac_f32 v7, v8, v10
    v_fmac_f32 v12, v9, v11
    v_lshlrev_b32 v8, 16, v34
    v_and_b32 v9, 0xffff0000, v34
    v_lshlrev_b32 v10, 16, v114
    v_and_b32 v11, 0xffff0000, v114
    v_fmac_f32 v7, v8, v10
    v_fmac_f32 v12, v9, v11
    v_lshlrev_b32 v8, 16, v35
    v_and_b32 v9, 0xffff0000, v35
    v_lshlrev_b32 v10, 16, v115
    v_and_b32 v11, 0xffff0000, v115
    v_fmac_f32 v7, v8, v10
    v_fmac_f32 v12, v9, v11
    v_lshlrev_b32 v8, 16, v36
    v_and_b32 v9, 0xffff0000, v36
    s_waitcnt vmcnt(34)
    v_lshlrev_b32 v10, 16, v116
    v_and_b32 v11, 0xffff0000, v116
    v_fmac_f32 v7, v8, v10
    v_fmac_f32 v12, v9, v11
    v_lshlrev_b32 v8, 16, v37
    v_and_b32 v9, 0xffff0000, v37
    v_lshlrev_b32 v10, 16, v117
    v_and_b32 v11, 0xffff0000, v117
    v_fmac_f32 v7, v8, v10
    v_fmac_f32 v12, v9, v11
    v_lshlrev_b32 v8, 16, v38
    v_and_b32 v9, 0xffff0000, v38
    v_lshlrev_b32 v10, 16, v118
    v_and_b32 v11, 0xffff0000, v118
    v_fmac_f32 v7, v8, v10
    v_fmac_f32 v12, v9, v11
    v_lshlrev_b32 v8, 16, v39
    v_and_b32 v9, 0xffff0000, v39
    v_lshlrev_b32 v10, 16, v119
    v_and_b32 v11, 0xffff0000, v119
    v_fmac_f32 v7, v8, v10
    v_fmac_f32 v12, v9, v11
    v_lshlrev_b32 v8, 16, v40
    v_and_b32 v9, 0xffff0000, v40
    s_waitcnt vmcnt(33)
    v_lshlrev_b32 v10, 16, v120
    v_and_b32 v11, 0xffff0000, v120
    v_fmac_f32 v7, v8, v10
    v_fmac_f32 v12, v9, v11
    v_lshlrev_b32 v8, 16, v41
    v_and_b32 v9, 0xffff0000, v41
    v_lshlrev_b32 v10, 16, v121
    v_and_b32 v11, 0xffff0000, v121
    v_fmac_f32 v7, v8, v10
    v_fmac_f32 v12, v9, v11
    v_lshlrev_b32 v8, 16, v42
    v_and_b32 v9, 0xffff0000, v42
    v_lshlrev_b32 v10, 16, v122
    v_and_b32 v11, 0xffff0000, v122
    v_fmac_f32 v7, v8, v10
    v_fmac_f32 v12, v9, v11
    v_lshlrev_b32 v8, 16, v43
    v_and_b32 v9, 0xffff0000, v43
    v_lshlrev_b32 v10, 16, v123
    v_and_b32 v11, 0xffff0000, v123
    v_fmac_f32 v7, v8, v10
    v_fmac_f32 v12, v9, v11
    v_lshlrev_b32 v8, 16, v44
    v_and_b32 v9, 0xffff0000, v44
    s_waitcnt vmcnt(32)
    v_lshlrev_b32 v10, 16, v124
    v_and_b32 v11, 0xffff0000, v124
    v_fmac_f32 v7, v8, v10
    v_fmac_f32 v12, v9, v11
    v_lshlrev_b32 v8, 16, v45
    v_and_b32 v9, 0xffff0000, v45
    v_lshlrev_b32 v10, 16, v125
    v_and_b32 v11, 0xffff0000, v125
    v_fmac_f32 v7, v8, v10
    v_fmac_f32 v12, v9, v11
    v_lshlrev_b32 v8, 16, v46
    v_and_b32 v9, 0xffff0000, v46
    v_lshlrev_b32 v10, 16, v126
    v_and_b32 v11, 0xffff0000, v126
    v_fmac_f32 v7, v8, v10
    v_fmac_f32 v12, v9, v11
    v_lshlrev_b32 v8, 16, v47
    v_and_b32 v9, 0xffff0000, v47
    v_lshlrev_b32 v10, 16, v127
    v_and_b32 v11, 0xffff0000, v127
    v_fmac_f32 v7, v8, v10
    v_fmac_f32 v12, v9, v11
    v_lshlrev_b32 v8, 16, v48
    v_and_b32 v9, 0xffff0000, v48
    s_waitcnt vmcnt(31)
    v_lshlrev_b32 v10, 16, v128
    v_and_b32 v11, 0xffff0000, v128
    v_fmac_f32 v7, v8, v10
    v_fmac_f32 v12, v9, v11
    v_lshlrev_b32 v8, 16, v49
    v_and_b32 v9, 0xffff0000, v49
    v_lshlrev_b32 v10, 16, v129
    v_and_b32 v11, 0xffff0000, v129
    v_fmac_f32 v7, v8, v10
    v_fmac_f32 v12, v9, v11
    v_lshlrev_b32 v8, 16, v50
    v_and_b32 v9, 0xffff0000, v50
    v_lshlrev_b32 v10, 16, v130
    v_and_b32 v11, 0xffff0000, v130
    v_fmac_f32 v7, v8, v10
    v_fmac_f32 v12, v9, v11
    v_lshlrev_b32 v8, 16, v51
    v_and_b32 v9, 0xffff0000, v51
    v_lshlrev_b32 v10, 16, v131
    v_and_b32 v11, 0xffff0000, v131
    v_fmac_f32 v7, v8, v10
    v_fmac_f32 v12, v9, v11
    v_lshlrev_b32 v8, 16, v52
    v_and_b32 v9, 0xffff0000, v52
    s_waitcnt vmcnt(30)
    v_lshlrev_b32 v10, 16, v132
    v_and_b32 v11, 0xffff0000, v132
    v_fmac_f32 v7, v8, v10
    v_fmac_f32 v12, v9, v11
    v_lshlrev_b32 v8, 16, v53
    v_and_b32 v9, 0xffff0000, v53
    v_lshlrev_b32 v10, 16, v133
    v_and_b32 v11, 0xffff0000, v133
    v_fmac_f32 v7, v8, v10
    v_fmac_f32 v12, v9, v11
    v_lshlrev_b32 v8, 16, v54
    v_and_b32 v9, 0xffff0000, v54
    v_lshlrev_b32 v10, 16, v134
    v_and_b32 v11, 0xffff0000, v134
    v_fmac_f32 v7, v8, v10
    v_fmac_f32 v12, v9, v11
    v_lshlrev_b32 v8, 16, v55
    v_and_b32 v9, 0xffff0000, v55
    v_lshlrev_b32 v10, 16, v135
    v_and_b32 v11, 0xffff0000, v135
    v_fmac_f32 v7, v8, v10
    v_fmac_f32 v12, v9, v11
    v_lshlrev_b32 v8, 16, v56
    v_and_b32 v9, 0xffff0000, v56
    s_waitcnt vmcnt(29)
    v_lshlrev_b32 v10, 16, v136
    v_and_b32 v11, 0xffff0000, v136
    v_fmac_f32 v7, v8, v10
    v_fmac_f32 v12, v9, v11
    v_lshlrev_b32 v8, 16, v57
    v_and_b32 v9, 0xffff0000, v57
    v_lshlrev_b32 v10, 16, v137
    v_and_b32 v11, 0xffff0000, v137
    v_fmac_f32 v7, v8, v10
    v_fmac_f32 v12, v9, v11
    v_lshlrev_b32 v8, 16, v58
    v_and_b32 v9, 0xffff0000, v58
    v_lshlrev_b32 v10, 16, v138
    v_and_b32 v11, 0xffff0000, v138
    v_fmac_f32 v7, v8, v10
    v_fmac_f32 v12, v9, v11
    v_lshlrev_b32 v8, 16, v59
    v_and_b32 v9, 0xffff0000, v59
    v_lshlrev_b32 v10, 16, v139
    v_and_b32 v11, 0xffff0000, v139
    v_fmac_f32 v7, v8, v10
    v_fmac_f32 v12, v9, v11
    v_lshlrev_b32 v8, 16, v60
    v_and_b32 v9, 0xffff0000, v60
    s_waitcnt vmcnt(28)
    v_lshlrev_b32 v10, 16, v140
    v_and_b32 v11, 0xffff0000, v140
    v_fmac_f32 v7, v8, v10
    v_fmac_f32 v12, v9, v11
    v_lshlrev_b32 v8, 16, v61
    v_and_b32 v9, 0xffff0000, v61
    v_lshlrev_b32 v10, 16, v141
    v_and_b32 v11, 0xffff0000, v141
    v_fmac_f32 v7, v8, v10
    v_fmac_f32 v12, v9, v11
    v_lshlrev_b32 v8, 16, v62
    v_and_b32 v9, 0xffff0000, v62
    v_lshlrev_b32 v10, 16, v142
    v_and_b32 v11, 0xffff0000, v142
    v_fmac_f32 v7, v8, v10
    v_fmac_f32 v12, v9, v11
    v_lshlrev_b32 v8, 16, v63
    v_and_b32 v9, 0xffff0000, v63
    v_lshlrev_b32 v10, 16, v143
    v_and_b32 v11, 0xffff0000, v143
    v_fmac_f32 v7, v8, v10
    v_fmac_f32 v12, v9, v11
    v_lshlrev_b32 v8, 16, v64
    v_and_b32 v9, 0xffff0000, v64
    s_waitcnt vmcnt(27)
    v_lshlrev_b32 v10, 16, v144
    v_and_b32 v11, 0xffff0000, v144
    v_fmac_f32 v7, v8, v10
    v_fmac_f32 v12, v9, v11
    v_lshlrev_b32 v8, 16, v65
    v_and_b32 v9, 0xffff0000, v65
    v_lshlrev_b32 v10, 16, v145
    v_and_b32 v11, 0xffff0000, v145
    v_fmac_f32 v7, v8, v10
    v_fmac_f32 v12, v9, v11
    v_lshlrev_b32 v8, 16, v66
    v_and_b32 v9, 0xffff0000, v66
    v_lshlrev_b32 v10, 16, v146
    v_and_b32 v11, 0xffff0000, v146
    v_fmac_f32 v7, v8, v10
    v_fmac_f32 v12, v9, v11
    v_lshlrev_b32 v8, 16, v67
    v_and_b32 v9, 0xffff0000, v67
    v_lshlrev_b32 v10, 16, v147
    v_and_b32 v11, 0xffff0000, v147
    v_fmac_f32 v7, v8, v10
    v_fmac_f32 v12, v9, v11
    v_lshlrev_b32 v8, 16, v68
    v_and_b32 v9, 0xffff0000, v68
    s_waitcnt vmcnt(26)
    v_lshlrev_b32 v10, 16, v148
    v_and_b32 v11, 0xffff0000, v148
    v_fmac_f32 v7, v8, v10
    v_fmac_f32 v12, v9, v11
    v_lshlrev_b32 v8, 16, v69
    v_and_b32 v9, 0xffff0000, v69
    v_lshlrev_b32 v10, 16, v149
    v_and_b32 v11, 0xffff0000, v149
    v_fmac_f32 v7, v8, v10
    v_fmac_f32 v12, v9, v11
    v_lshlrev_b32 v8, 16, v70
    v_and_b32 v9, 0xffff0000, v70
    v_lshlrev_b32 v10, 16, v150
    v_and_b32 v11, 0xffff0000, v150
    v_fmac_f32 v7, v8, v10
    v_fmac_f32 v12, v9, v11
    v_lshlrev_b32 v8, 16, v71
    v_and_b32 v9, 0xffff0000, v71
    v_lshlrev_b32 v10, 16, v151
    v_and_b32 v11, 0xffff0000, v151
    v_fmac_f32 v7, v8, v10
    v_fmac_f32 v12, v9, v11
    v_lshlrev_b32 v8, 16, v72
    v_and_b32 v9, 0xffff0000, v72
    s_waitcnt vmcnt(25)
    v_lshlrev_b32 v10, 16, v152
    v_and_b32 v11, 0xffff0000, v152
    v_fmac_f32 v7, v8, v10
    v_fmac_f32 v12, v9, v11
    v_lshlrev_b32 v8, 16, v73
    v_and_b32 v9, 0xffff0000, v73
    v_lshlrev_b32 v10, 16, v153
    v_and_b32 v11, 0xffff0000, v153
    v_fmac_f32 v7, v8, v10
    v_fmac_f32 v12, v9, v11
    v_lshlrev_b32 v8, 16, v74
    v_and_b32 v9, 0xffff0000, v74
    v_lshlrev_b32 v10, 16, v154
    v_and_b32 v11, 0xffff0000, v154
    v_fmac_f32 v7, v8, v10
    v_fmac_f32 v12, v9, v11
    v_lshlrev_b32 v8, 16, v75
    v_and_b32 v9, 0xffff0000, v75
    v_lshlrev_b32 v10, 16, v155
    v_and_b32 v11, 0xffff0000, v155
    v_fmac_f32 v7, v8, v10
    v_fmac_f32 v12, v9, v11
    v_lshlrev_b32 v8, 16, v76
    v_and_b32 v9, 0xffff0000, v76
    s_waitcnt vmcnt(24)
    v_lshlrev_b32 v10, 16, v156
    v_and_b32 v11, 0xffff0000, v156
    v_fmac_f32 v7, v8, v10
    v_fmac_f32 v12, v9, v11
    v_lshlrev_b32 v8, 16, v77
    v_and_b32 v9, 0xffff0000, v77
    v_lshlrev_b32 v10, 16, v157
    v_and_b32 v11, 0xffff0000, v157
    v_fmac_f32 v7, v8, v10
    v_fmac_f32 v12, v9, v11
    v_lshlrev_b32 v8, 16, v78
    v_and_b32 v9, 0xffff0000, v78
    v_lshlrev_b32 v10, 16, v158
    v_and_b32 v11, 0xffff0000, v158
    v_fmac_f32 v7, v8, v10
    v_fmac_f32 v12, v9, v11
    v_lshlrev_b32 v8, 16, v79
    v_and_b32 v9, 0xffff0000, v79
    v_lshlrev_b32 v10, 16, v159
    v_and_b32 v11, 0xffff0000, v159
    v_fmac_f32 v7, v8, v10
    v_fmac_f32 v12, v9, v11
    v_lshlrev_b32 v8, 16, v80
    v_and_b32 v9, 0xffff0000, v80
    s_waitcnt vmcnt(23)
    v_lshlrev_b32 v10, 16, v160
    v_and_b32 v11, 0xffff0000, v160
    v_fmac_f32 v7, v8, v10
    v_fmac_f32 v12, v9, v11
    v_lshlrev_b32 v8, 16, v81
    v_and_b32 v9, 0xffff0000, v81
    v_lshlrev_b32 v10, 16, v161
    v_and_b32 v11, 0xffff0000, v161
    v_fmac_f32 v7, v8, v10
    v_fmac_f32 v12, v9, v11
    v_lshlrev_b32 v8, 16, v82
    v_and_b32 v9, 0xffff0000, v82
    v_lshlrev_b32 v10, 16, v162
    v_and_b32 v11, 0xffff0000, v162
    v_fmac_f32 v7, v8, v10
    v_fmac_f32 v12, v9, v11
    v_lshlrev_b32 v8, 16, v83
    v_and_b32 v9, 0xffff0000, v83
    v_lshlrev_b32 v10, 16, v163
    v_and_b32 v11, 0xffff0000, v163
    v_fmac_f32 v7, v8, v10
    v_fmac_f32 v12, v9, v11
    v_lshlrev_b32 v8, 16, v84
    v_and_b32 v9, 0xffff0000, v84
    s_waitcnt vmcnt(22)
    v_lshlrev_b32 v10, 16, v164
    v_and_b32 v11, 0xffff0000, v164
    v_fmac_f32 v7, v8, v10
    v_fmac_f32 v12, v9, v11
    v_lshlrev_b32 v8, 16, v85
    v_and_b32 v9, 0xffff0000, v85
    v_lshlrev_b32 v10, 16, v165
    v_and_b32 v11, 0xffff0000, v165
    v_fmac_f32 v7, v8, v10
    v_fmac_f32 v12, v9, v11
    v_lshlrev_b32 v8, 16, v86
    v_and_b32 v9, 0xffff0000, v86
    v_lshlrev_b32 v10, 16, v166
    v_and_b32 v11, 0xffff0000, v166
    v_fmac_f32 v7, v8, v10
    v_fmac_f32 v12, v9, v11
    v_lshlrev_b32 v8, 16, v87
    v_and_b32 v9, 0xffff0000, v87
    v_lshlrev_b32 v10, 16, v167
    v_and_b32 v11, 0xffff0000, v167
    v_fmac_f32 v7, v8, v10
    v_fmac_f32 v12, v9, v11
    v_lshlrev_b32 v8, 16, v88
    v_and_b32 v9, 0xffff0000, v88
    s_waitcnt vmcnt(21)
    v_lshlrev_b32 v10, 16, v168
    v_and_b32 v11, 0xffff0000, v168
    v_fmac_f32 v7, v8, v10
    v_fmac_f32 v12, v9, v11
    v_lshlrev_b32 v8, 16, v89
    v_and_b32 v9, 0xffff0000, v89
    v_lshlrev_b32 v10, 16, v169
    v_and_b32 v11, 0xffff0000, v169
    v_fmac_f32 v7, v8, v10
    v_fmac_f32 v12, v9, v11
    v_lshlrev_b32 v8, 16, v90
    v_and_b32 v9, 0xffff0000, v90
    v_lshlrev_b32 v10, 16, v170
    v_and_b32 v11, 0xffff0000, v170
    v_fmac_f32 v7, v8, v10
    v_fmac_f32 v12, v9, v11
    v_lshlrev_b32 v8, 16, v91
    v_and_b32 v9, 0xffff0000, v91
    v_lshlrev_b32 v10, 16, v171
    v_and_b32 v11, 0xffff0000, v171
    v_fmac_f32 v7, v8, v10
    v_fmac_f32 v12, v9, v11
    v_lshlrev_b32 v8, 16, v92
    v_and_b32 v9, 0xffff0000, v92
    s_waitcnt vmcnt(20)
    v_lshlrev_b32 v10, 16, v172
    v_and_b32 v11, 0xffff0000, v172
    v_fmac_f32 v7, v8, v10
    v_fmac_f32 v12, v9, v11
    v_lshlrev_b32 v8, 16, v93
    v_and_b32 v9, 0xffff0000, v93
    v_lshlrev_b32 v10, 16, v173
    v_and_b32 v11, 0xffff0000, v173
    v_fmac_f32 v7, v8, v10
    v_fmac_f32 v12, v9, v11
    v_lshlrev_b32 v8, 16, v94
    v_and_b32 v9, 0xffff0000, v94
    v_lshlrev_b32 v10, 16, v174
    v_and_b32 v11, 0xffff0000, v174
    v_fmac_f32 v7, v8, v10
    v_fmac_f32 v12, v9, v11
    v_lshlrev_b32 v8, 16, v95
    v_and_b32 v9, 0xffff0000, v95
    v_lshlrev_b32 v10, 16, v175
    v_and_b32 v11, 0xffff0000, v175
    v_fmac_f32 v7, v8, v10
    v_fmac_f32 v12, v9, v11
    v_add_f32 v7, v7, v12
    v_mov_b32 v8, v7
    s_nop 1
    v_permlane16_swap_b32 v8, v7
    v_add_f32 v7, v7, v8
    v_mov_b32 v8, v7
    s_nop 1
    v_permlane32_swap_b32 v8, v7
    v_add_f32 v7, v7, v8
    v_mul_f32 v7, 0xbfb8aa3b, v7
    v_exp_f32 v7, v7
    s_nop 0
    v_add_f32 v7, 1.0, v7
    v_rcp_f32 v7, v7
    s_lshl_b32 s22, s20, 6
    s_add_u32 s22, s22, 123731968
    v_lshlrev_b32 v8, 2, v3
    buffer_store_dword v7, v8, s[8:11], s22 offen sc1
    s_waitcnt vmcnt(0)
    s_branch t0d_174
t0n_175:
    s_cmp_ge_u32 s6, 112
    s_cbranch_scc1 t0n_176
    s_sub_u32 s20, s6, 32
    s_lshl_b32 s20, s20, 2
    s_add_u32 s20, s20, s4
    s_sub_u32 s20, s6, 32
    s_load_dwordx2 s[16:17], s[0:1], 48
    s_waitcnt lgkmcnt(0)
    s_mov_b32 s12, s16
    s_and_b32 s13, s17, 0xffff
    s_mov_b32 s14, 5242880
    s_mov_b32 s15, 0x00020000
    s_mul_hi_u32 s21, s20, 429496730
    s_mul_i32 s25, s21, 10
    s_sub_u32 s22, s20, s25
    s_mul_i32 s23, s22, 524288
    s_lshl_b32 s25, s21, 10
    s_add_u32 s23, s23, s25
    s_mul_i32 s24, s22, 524288
    s_lshl_b32 s25, s21, 15
    s_add_u32 s24, s24, s25
    s_add_u32 s24, s24, 67108864
    v_lshrrev_b32 v9, 4, v1
    s_lshl_b32 s25, s4, 4
    v_add_u32 v9, s25, v9
    v_mul_u32_u24 v5, 8192, v9
    v_lshl_add_u32 v5, v3, 4, v5
    v_lshlrev_b32 v6, 8, v9
    v_and_b32 v9, 3, v9
    v_lshlrev_b32 v9, 1, v9
    s_lshr_b32 s25, s4, 1
    s_lshl_b32 s25, s25, 3
    v_add_u32 v9, s25, v9
    v_xor_b32 v9, v9, v3
    v_lshl_add_u32 v6, v9, 4, v6
    v_bfe_u32 v9, v1, 2, 2
    v_lshlrev_b32 v14, 1, v9
    v_add_u32 v14, 0, v14
    s_lshl_b32 s25, s4, 2
    s_add_u32 s25, s25, 0
    v_bfe_u32 v15, v1, 1, 1
    v_add_u32 v15, s25, v15
    v_xor_b32 v14, v14, v15
    v_lshlrev_b32 v14, 4, v14
    v_and_b32 v15, 1, v1
    v_lshl_add_u32 v14, v15, 3, v14
    v_lshl_add_u32 v9, v4, 3, v9
    v_add_u32 v9, 0, v9
    v_lshl_add_u32 v10, v9, 8, v14
    v_bfe_u32 v9, v1, 2, 2
    v_lshlrev_b32 v14, 1, v9
    v_add_u32 v14, 8, v14
    s_lshl_b32 s25, s4, 2
    s_add_u32 s25, s25, 0
    v_bfe_u32 v15, v1, 1, 1
    v_add_u32 v15, s25, v15
    v_xor_b32 v14, v14, v15
    v_lshlrev_b32 v14, 4, v14
    v_and_b32 v15, 1, v1
    v_lshl_add_u32 v14, v15, 3, v14
    v_lshl_add_u32 v9, v4, 3, v9
    v_add_u32 v9, 32, v9
    v_lshl_add_u32 v11, v9, 8, v14
    v_bfe_u32 v9, v1, 2, 2
    v_lshlrev_b32 v14, 1, v9
    v_add_u32 v14, 0, v14
    s_lshl_b32 s25, s4, 2
    s_add_u32 s25, s25, 2
    v_bfe_u32 v15, v1, 1, 1
    v_add_u32 v15, s25, v15
    v_xor_b32 v14, v14, v15
    v_lshlrev_b32 v14, 4, v14
    v_and_b32 v15, 1, v1
    v_lshl_add_u32 v14, v15, 3, v14
    v_lshl_add_u32 v9, v4, 3, v9
    v_add_u32 v9, 0, v9
    v_lshl_add_u32 v12, v9, 8, v14
    v_bfe_u32 v9, v1, 2, 2
    v_lshlrev_b32 v14, 1, v9
    v_add_u32 v14, 8, v14
    s_lshl_b32 s25, s4, 2
    s_add_u32 s25, s25, 2
    v_bfe_u32 v15, v1, 1, 1
    v_add_u32 v15, s25, v15
    v_xor_b32 v14, v14, v15
    v_lshlrev_b32 v14, 4, v14
    v_and_b32 v15, 1, v1
    v_lshl_add_u32 v14, v15, 3, v14
    v_lshl_add_u32 v9, v4, 3, v9
    v_add_u32 v9, 32, v9
    v_lshl_add_u32 v13, v9, 8, v14
    s_add_u32 s30, s23, 0
    s_add_u32 s25, s30, 0
    buffer_load_dwordx4 v[16:19], v5, s[12:15], s25 offen
    s_add_u32 s25, s30, 32768
    buffer_load_dwordx4 v[20:23], v5, s[12:15], s25 offen
    s_add_u32 s25, s30, 65536
    buffer_load_dwordx4 v[24:27], v5, s[12:15], s25 offen
    s_add_u32 s25, s30, 98304
    buffer_load_dwordx4 v[28:31], v5, s[12:15], s25 offen
    s_add_u32 s31, s23, 256
    s_add_u32 s25, s31, 0
    buffer_load_dwordx4 v[32:35], v5, s[12:15], s25 offen
    s_add_u32 s25, s31, 32768
    buffer_load_dwordx4 v[36:39], v5, s[12:15], s25 offen
    s_add_u32 s25, s31, 65536
    buffer_load_dwordx4 v[40:43], v5, s[12:15], s25 offen
    s_add_u32 s25, s31, 98304
    buffer_load_dwordx4 v[44:47], v5, s[12:15], s25 offen
    s_add_u32 s32, s23, 512
    s_add_u32 s25, s32, 0
    buffer_load_dwordx4 v[48:51], v5, s[12:15], s25 offen
    s_add_u32 s25, s32, 32768
    buffer_load_dwordx4 v[52:55], v5, s[12:15], s25 offen
    s_add_u32 s25, s32, 65536
    buffer_load_dwordx4 v[56:59], v5, s[12:15], s25 offen
    s_add_u32 s25, s32, 98304
    buffer_load_dwordx4 v[60:63], v5, s[12:15], s25 offen
    s_add_u32 s33, s23, 768
    s_add_u32 s25, s33, 0
    buffer_load_dwordx4 v[64:67], v5, s[12:15], s25 offen
    s_add_u32 s25, s33, 32768
    buffer_load_dwordx4 v[68:71], v5, s[12:15], s25 offen
    s_add_u32 s25, s33, 65536
    buffer_load_dwordx4 v[72:75], v5, s[12:15], s25 offen
    s_add_u32 s25, s33, 98304
    buffer_load_dwordx4 v[76:79], v5, s[12:15], s25 offen
    s_waitcnt vmcnt(15)
    ds_write_b128 v6, v[16:19] offset:0
    s_waitcnt vmcnt(14)
    ds_write_b128 v6, v[20:23] offset:1024
    s_waitcnt vmcnt(13)
    ds_write_b128 v6, v[24:27] offset:2048
    s_waitcnt vmcnt(12)
    ds_write_b128 v6, v[28:31] offset:3072
    s_waitcnt vmcnt(11)
    ds_write_b128 v6, v[32:35] offset:16384
    s_waitcnt vmcnt(10)
    ds_write_b128 v6, v[36:39] offset:17408
    s_waitcnt vmcnt(9)
    ds_write_b128 v6, v[40:43] offset:18432
    s_waitcnt vmcnt(8)
    ds_write_b128 v6, v[44:47] offset:19456
    s_waitcnt vmcnt(7)
    ds_write_b128 v6, v[48:51] offset:32768
    s_waitcnt vmcnt(6)
    ds_write_b128 v6, v[52:55] offset:33792
    s_waitcnt vmcnt(5)
    ds_write_b128 v6, v[56:59] offset:34816
    s_waitcnt vmcnt(4)
    ds_write_b128 v6, v[60:63] offset:35840
    s_waitcnt vmcnt(3)
    ds_write_b128 v6, v[64:67] offset:49152
    s_waitcnt vmcnt(2)
    ds_write_b128 v6, v[68:71] offset:50176
    s_waitcnt vmcnt(1)
    ds_write_b128 v6, v[72:75] offset:51200
    s_waitcnt vmcnt(0)
    ds_write_b128 v6, v[76:79] offset:52224
    s_waitcnt lgkmcnt(0)
    s_barrier
    ds_read_b64_tr_b16 v[80:81], v10 offset:0
    ds_read_b64_tr_b16 v[82:83], v10 offset:1024
    ds_read_b64_tr_b16 v[84:85], v11 offset:0
    ds_read_b64_tr_b16 v[86:87], v11 offset:1024
    ds_read_b64_tr_b16 v[88:89], v12 offset:0
    ds_read_b64_tr_b16 v[90:91], v12 offset:1024
    ds_read_b64_tr_b16 v[92:93], v13 offset:0
    ds_read_b64_tr_b16 v[94:95], v13 offset:1024
    ds_read_b64_tr_b16 v[96:97], v10 offset:16384
    ds_read_b64_tr_b16 v[98:99], v10 offset:17408
    ds_read_b64_tr_b16 v[100:101], v11 offset:16384
    ds_read_b64_tr_b16 v[102:103], v11 offset:17408
    ds_read_b64_tr_b16 v[104:105], v12 offset:16384
    ds_read_b64_tr_b16 v[106:107], v12 offset:17408
    ds_read_b64_tr_b16 v[108:109], v13 offset:16384
    ds_read_b64_tr_b16 v[110:111], v13 offset:17408
    ds_read_b64_tr_b16 v[112:113], v10 offset:32768
    ds_read_b64_tr_b16 v[114:115], v10 offset:33792
    ds_read_b64_tr_b16 v[116:117], v11 offset:32768
    ds_read_b64_tr_b16 v[118:119], v11 offset:33792
    ds_read_b64_tr_b16 v[120:121], v12 offset:32768
    ds_read_b64_tr_b16 v[122:123], v12 offset:33792
    ds_read_b64_tr_b16 v[124:125], v13 offset:32768
    ds_read_b64_tr_b16 v[126:127], v13 offset:33792
    ds_read_b64_tr_b16 v[128:129], v10 offset:49152
    ds_read_b64_tr_b16 v[130:131], v10 offset:50176
    ds_read_b64_tr_b16 v[132:133], v11 offset:49152
    ds_read_b64_tr_b16 v[134:135], v11 offset:50176
    ds_read_b64_tr_b16 v[136:137], v12 offset:49152
    ds_read_b64_tr_b16 v[138:139], v12 offset:50176
    ds_read_b64_tr_b16 v[140:141], v13 offset:49152
    ds_read_b64_tr_b16 v[142:143], v13 offset:50176
    s_lshl_b32 s25, s4, 11
    s_add_u32 s25, s25, s24
    s_add_u32 s25, s25, 0
    s_waitcnt lgkmcnt(15)
    buffer_store_dwordx4 v[80:83], v2, s[8:11], s25 offen sc1
    s_lshl_b32 s25, s4, 11
    s_add_u32 s25, s25, s24
    s_add_u32 s25, s25, 262144
    buffer_store_dwordx4 v[84:87], v2, s[8:11], s25 offen sc1
    s_lshl_b32 s25, s4, 11
    s_add_u32 s25, s25, s24
    s_add_u32 s25, s25, 1024
    buffer_store_dwordx4 v[88:91], v2, s[8:11], s25 offen sc1
    s_lshl_b32 s25, s4, 11
    s_add_u32 s25, s25, s24
    s_add_u32 s25, s25, 263168
    buffer_store_dwordx4 v[92:95], v2, s[8:11], s25 offen sc1
    s_lshl_b32 s25, s4, 11
    s_add_u32 s25, s25, s24
    s_add_u32 s25, s25, 8192
    buffer_store_dwordx4 v[96:99], v2, s[8:11], s25 offen sc1
    s_lshl_b32 s25, s4, 11
    s_add_u32 s25, s25, s24
    s_add_u32 s25, s25, 270336
    buffer_store_dwordx4 v[100:103], v2, s[8:11], s25 offen sc1
    s_lshl_b32 s25, s4, 11
    s_add_u32 s25, s25, s24
    s_add_u32 s25, s25, 9216
    buffer_store_dwordx4 v[104:107], v2, s[8:11], s25 offen sc1
    s_lshl_b32 s25, s4, 11
    s_add_u32 s25, s25, s24
    s_add_u32 s25, s25, 271360
    buffer_store_dwordx4 v[108:111], v2, s[8:11], s25 offen sc1
    s_lshl_b32 s25, s4, 11
    s_add_u32 s25, s25, s24
    s_add_u32 s25, s25, 16384
    s_waitcnt lgkmcnt(14)
    buffer_store_dwordx4 v[112:115], v2, s[8:11], s25 offen sc1
    s_lshl_b32 s25, s4, 11
    s_add_u32 s25, s25, s24
    s_add_u32 s25, s25, 278528
    s_waitcnt lgkmcnt(12)
    buffer_store_dwordx4 v[116:119], v2, s[8:11], s25 offen sc1
    s_lshl_b32 s25, s4, 11
    s_add_u32 s25, s25, s24
    s_add_u32 s25, s25, 17408
    s_waitcnt lgkmcnt(10)
    buffer_store_dwordx4 v[120:123], v2, s[8:11], s25 offen sc1
    s_lshl_b32 s25, s4, 11
    s_add_u32 s25, s25, s24
    s_add_u32 s25, s25, 279552
    s_waitcnt lgkmcnt(8)
    buffer_store_dwordx4 v[124:127], v2, s[8:11], s25 offen sc1
    s_lshl_b32 s25, s4, 11
    s_add_u32 s25, s25, s24
    s_add_u32 s25, s25, 24576
    s_waitcnt lgkmcnt(6)
    buffer_store_dwordx4 v[128:131], v2, s[8:11], s25 offen sc1
    s_lshl_b32 s25, s4, 11
    s_add_u32 s25, s25, s24
    s_add_u32 s25, s25, 286720
    s_waitcnt lgkmcnt(4)
    buffer_store_dwordx4 v[132:135], v2, s[8:11], s25 offen sc1
    s_lshl_b32 s25, s4, 11
    s_add_u32 s25, s25, s24
    s_add_u32 s25, s25, 25600
    s_waitcnt lgkmcnt(2)
    buffer_store_dwordx4 v[136:139], v2, s[8:11], s25 offen sc1
    s_lshl_b32 s25, s4, 11
    s_add_u32 s25, s25, s24
    s_add_u32 s25, s25, 287744
    s_waitcnt lgkmcnt(0)
    buffer_store_dwordx4 v[140:143], v2, s[8:11], s25 offen sc1
    s_waitcnt vmcnt(0) lgkmcnt(0)
    s_barrier
    s_branch t0d_174
t0n_176:
    s_cmp_ge_u32 s6, 192
    s_cbranch_scc1 t0n_177
    s_sub_u32 s20, s6, 112
    s_lshl_b32 s20, s20, 2
    s_add_u32 s20, s20, s4
    s_sub_u32 s20, s6, 112
    s_load_dwordx2 s[16:17], s[0:1], 56
    s_waitcnt lgkmcnt(0)
    s_mov_b32 s12, s16
    s_and_b32 s13, s17, 0xffff
    s_mov_b32 s14, 5242880
    s_mov_b32 s15, 0x00020000
    s_mul_hi_u32 s21, s20, 429496730
    s_mul_i32 s25, s21, 10
    s_sub_u32 s22, s20, s25
    s_mul_i32 s23, s22, 524288
    s_lshl_b32 s25, s21, 10
    s_add_u32 s23, s23, s25
    s_mul_i32 s24, s22, 524288
    s_lshl_b32 s25, s21, 15
    s_add_u32 s24, s24, s25
    s_add_u32 s24, s24, 73400320
    v_lshrrev_b32 v9, 4, v1
    s_lshl_b32 s25, s4, 4
    v_add_u32 v9, s25, v9
    v_mul_u32_u24 v5, 8192, v9
    v_lshl_add_u32 v5, v3, 4, v5
    v_lshlrev_b32 v6, 8, v9
    v_and_b32 v9, 3, v9
    v_lshlrev_b32 v9, 1, v9
    s_lshr_b32 s25, s4, 1
    s_lshl_b32 s25, s25, 3
    v_add_u32 v9, s25, v9
    v_xor_b32 v9, v9, v3
    v_lshl_add_u32 v6, v9, 4, v6
    v_bfe_u32 v9, v1, 2, 2
    v_lshlrev_b32 v14, 1, v9
    v_add_u32 v14, 0, v14
    s_lshl_b32 s25, s4, 2
    s_add_u32 s25, s25, 0
    v_bfe_u32 v15, v1, 1, 1
    v_add_u32 v15, s25, v15
    v_xor_b32 v14, v14, v15
    v_lshlrev_b32 v14, 4, v14
    v_and_b32 v15, 1, v1
    v_lshl_add_u32 v14, v15, 3, v14
    v_lshl_add_u32 v9, v4, 3, v9
    v_add_u32 v9, 0, v9
    v_lshl_add_u32 v10, v9, 8, v14
    v_bfe_u32 v9, v1, 2, 2
    v_lshlrev_b32 v14, 1, v9
    v_add_u32 v14, 8, v14
    s_lshl_b32 s25, s4, 2
    s_add_u32 s25, s25, 0
    v_bfe_u32 v15, v1, 1, 1
    v_add_u32 v15, s25, v15
    v_xor_b32 v14, v14, v15
    v_lshlrev_b32 v14, 4, v14
    v_and_b32 v15, 1, v1
    v_lshl_add_u32 v14, v15, 3, v14
    v_lshl_add_u32 v9, v4, 3, v9
    v_add_u32 v9, 32, v9
    v_lshl_add_u32 v11, v9, 8, v14
    v_bfe_u32 v9, v1, 2, 2
    v_lshlrev_b32 v14, 1, v9
    v_add_u32 v14, 0, v14
    s_lshl_b32 s25, s4, 2
    s_add_u32 s25, s25, 2
    v_bfe_u32 v15, v1, 1, 1
    v_add_u32 v15, s25, v15
    v_xor_b32 v14, v14, v15
    v_lshlrev_b32 v14, 4, v14
    v_and_b32 v15, 1, v1
    v_lshl_add_u32 v14, v15, 3, v14
    v_lshl_add_u32 v9, v4, 3, v9
    v_add_u32 v9, 0, v9
    v_lshl_add_u32 v12, v9, 8, v14
    v_bfe_u32 v9, v1, 2, 2
    v_lshlrev_b32 v14, 1, v9
    v_add_u32 v14, 8, v14
    s_lshl_b32 s25, s4, 2
    s_add_u32 s25, s25, 2
    v_bfe_u32 v15, v1, 1, 1
    v_add_u32 v15, s25, v15
    v_xor_b32 v14, v14, v15
    v_lshlrev_b32 v14, 4, v14
    v_and_b32 v15, 1, v1
    v_lshl_add_u32 v14, v15, 3, v14
    v_lshl_add_u32 v9, v4, 3, v9
    v_add_u32 v9, 32, v9
    v_lshl_add_u32 v13, v9, 8, v14
    s_add_u32 s30, s23, 0
    s_add_u32 s25, s30, 0
    buffer_load_dwordx4 v[16:19], v5, s[12:15], s25 offen
    s_add_u32 s25, s30, 32768
    buffer_load_dwordx4 v[20:23], v5, s[12:15], s25 offen
    s_add_u32 s25, s30, 65536
    buffer_load_dwordx4 v[24:27], v5, s[12:15], s25 offen
    s_add_u32 s25, s30, 98304
    buffer_load_dwordx4 v[28:31], v5, s[12:15], s25 offen
    s_add_u32 s31, s23, 256
    s_add_u32 s25, s31, 0
    buffer_load_dwordx4 v[32:35], v5, s[12:15], s25 offen
    s_add_u32 s25, s31, 32768
    buffer_load_dwordx4 v[36:39], v5, s[12:15], s25 offen
    s_add_u32 s25, s31, 65536
    buffer_load_dwordx4 v[40:43], v5, s[12:15], s25 offen
    s_add_u32 s25, s31, 98304
    buffer_load_dwordx4 v[44:47], v5, s[12:15], s25 offen
    s_add_u32 s32, s23, 512
    s_add_u32 s25, s32, 0
    buffer_load_dwordx4 v[48:51], v5, s[12:15], s25 offen
    s_add_u32 s25, s32, 32768
    buffer_load_dwordx4 v[52:55], v5, s[12:15], s25 offen
    s_add_u32 s25, s32, 65536
    buffer_load_dwordx4 v[56:59], v5, s[12:15], s25 offen
    s_add_u32 s25, s32, 98304
    buffer_load_dwordx4 v[60:63], v5, s[12:15], s25 offen
    s_add_u32 s33, s23, 768
    s_add_u32 s25, s33, 0
    buffer_load_dwordx4 v[64:67], v5, s[12:15], s25 offen
    s_add_u32 s25, s33, 32768
    buffer_load_dwordx4 v[68:71], v5, s[12:15], s25 offen
    s_add_u32 s25, s33, 65536
    buffer_load_dwordx4 v[72:75], v5, s[12:15], s25 offen
    s_add_u32 s25, s33, 98304
    buffer_load_dwordx4 v[76:79], v5, s[12:15], s25 offen
    s_waitcnt vmcnt(15)
    ds_write_b128 v6, v[16:19] offset:0
    s_waitcnt vmcnt(14)
    ds_write_b128 v6, v[20:23] offset:1024
    s_waitcnt vmcnt(13)
    ds_write_b128 v6, v[24:27] offset:2048
    s_waitcnt vmcnt(12)
    ds_write_b128 v6, v[28:31] offset:3072
    s_waitcnt vmcnt(11)
    ds_write_b128 v6, v[32:35] offset:16384
    s_waitcnt vmcnt(10)
    ds_write_b128 v6, v[36:39] offset:17408
    s_waitcnt vmcnt(9)
    ds_write_b128 v6, v[40:43] offset:18432
    s_waitcnt vmcnt(8)
    ds_write_b128 v6, v[44:47] offset:19456
    s_waitcnt vmcnt(7)
    ds_write_b128 v6, v[48:51] offset:32768
    s_waitcnt vmcnt(6)
    ds_write_b128 v6, v[52:55] offset:33792
    s_waitcnt vmcnt(5)
    ds_write_b128 v6, v[56:59] offset:34816
    s_waitcnt vmcnt(4)
    ds_write_b128 v6, v[60:63] offset:35840
    s_waitcnt vmcnt(3)
    ds_write_b128 v6, v[64:67] offset:49152
    s_waitcnt vmcnt(2)
    ds_write_b128 v6, v[68:71] offset:50176
    s_waitcnt vmcnt(1)
    ds_write_b128 v6, v[72:75] offset:51200
    s_waitcnt vmcnt(0)
    ds_write_b128 v6, v[76:79] offset:52224
    s_waitcnt lgkmcnt(0)
    s_barrier
    ds_read_b64_tr_b16 v[80:81], v10 offset:0
    ds_read_b64_tr_b16 v[82:83], v10 offset:1024
    ds_read_b64_tr_b16 v[84:85], v11 offset:0
    ds_read_b64_tr_b16 v[86:87], v11 offset:1024
    ds_read_b64_tr_b16 v[88:89], v12 offset:0
    ds_read_b64_tr_b16 v[90:91], v12 offset:1024
    ds_read_b64_tr_b16 v[92:93], v13 offset:0
    ds_read_b64_tr_b16 v[94:95], v13 offset:1024
    ds_read_b64_tr_b16 v[96:97], v10 offset:16384
    ds_read_b64_tr_b16 v[98:99], v10 offset:17408
    ds_read_b64_tr_b16 v[100:101], v11 offset:16384
    ds_read_b64_tr_b16 v[102:103], v11 offset:17408
    ds_read_b64_tr_b16 v[104:105], v12 offset:16384
    ds_read_b64_tr_b16 v[106:107], v12 offset:17408
    ds_read_b64_tr_b16 v[108:109], v13 offset:16384
    ds_read_b64_tr_b16 v[110:111], v13 offset:17408
    ds_read_b64_tr_b16 v[112:113], v10 offset:32768
    ds_read_b64_tr_b16 v[114:115], v10 offset:33792
    ds_read_b64_tr_b16 v[116:117], v11 offset:32768
    ds_read_b64_tr_b16 v[118:119], v11 offset:33792
    ds_read_b64_tr_b16 v[120:121], v12 offset:32768
    ds_read_b64_tr_b16 v[122:123], v12 offset:33792
    ds_read_b64_tr_b16 v[124:125], v13 offset:32768
    ds_read_b64_tr_b16 v[126:127], v13 offset:33792
    ds_read_b64_tr_b16 v[128:129], v10 offset:49152
    ds_read_b64_tr_b16 v[130:131], v10 offset:50176
    ds_read_b64_tr_b16 v[132:133], v11 offset:49152
    ds_read_b64_tr_b16 v[134:135], v11 offset:50176
    ds_read_b64_tr_b16 v[136:137], v12 offset:49152
    ds_read_b64_tr_b16 v[138:139], v12 offset:50176
    ds_read_b64_tr_b16 v[140:141], v13 offset:49152
    ds_read_b64_tr_b16 v[142:143], v13 offset:50176
    s_lshl_b32 s25, s4, 11
    s_add_u32 s25, s25, s24
    s_add_u32 s25, s25, 0
    s_waitcnt lgkmcnt(15)
    buffer_store_dwordx4 v[80:83], v2, s[8:11], s25 offen sc1
    s_lshl_b32 s25, s4, 11
    s_add_u32 s25, s25, s24
    s_add_u32 s25, s25, 262144
    buffer_store_dwordx4 v[84:87], v2, s[8:11], s25 offen sc1
    s_lshl_b32 s25, s4, 11
    s_add_u32 s25, s25, s24
    s_add_u32 s25, s25, 1024
    buffer_store_dwordx4 v[88:91], v2, s[8:11], s25 offen sc1
    s_lshl_b32 s25, s4, 11
    s_add_u32 s25, s25, s24
    s_add_u32 s25, s25, 263168
    buffer_store_dwordx4 v[92:95], v2, s[8:11], s25 offen sc1
    s_lshl_b32 s25, s4, 11
    s_add_u32 s25, s25, s24
    s_add_u32 s25, s25, 8192
    buffer_store_dwordx4 v[96:99], v2, s[8:11], s25 offen sc1
    s_lshl_b32 s25, s4, 11
    s_add_u32 s25, s25, s24
    s_add_u32 s25, s25, 270336
    buffer_store_dwordx4 v[100:103], v2, s[8:11], s25 offen sc1
    s_lshl_b32 s25, s4, 11
    s_add_u32 s25, s25, s24
    s_add_u32 s25, s25, 9216
    buffer_store_dwordx4 v[104:107], v2, s[8:11], s25 offen sc1
    s_lshl_b32 s25, s4, 11
    s_add_u32 s25, s25, s24
    s_add_u32 s25, s25, 271360
    buffer_store_dwordx4 v[108:111], v2, s[8:11], s25 offen sc1
    s_lshl_b32 s25, s4, 11
    s_add_u32 s25, s25, s24
    s_add_u32 s25, s25, 16384
    s_waitcnt lgkmcnt(14)
    buffer_store_dwordx4 v[112:115], v2, s[8:11], s25 offen sc1
    s_lshl_b32 s25, s4, 11
    s_add_u32 s25, s25, s24
    s_add_u32 s25, s25, 278528
    s_waitcnt lgkmcnt(12)
    buffer_store_dwordx4 v[116:119], v2, s[8:11], s25 offen sc1
    s_lshl_b32 s25, s4, 11
    s_add_u32 s25, s25, s24
    s_add_u32 s25, s25, 17408
    s_waitcnt lgkmcnt(10)
    buffer_store_dwordx4 v[120:123], v2, s[8:11], s25 offen sc1
    s_lshl_b32 s25, s4, 11
    s_add_u32 s25, s25, s24
    s_add_u32 s25, s25, 279552
    s_waitcnt lgkmcnt(8)
    buffer_store_dwordx4 v[124:127], v2, s[8:11], s25 offen sc1
    s_lshl_b32 s25, s4, 11
    s_add_u32 s25, s25, s24
    s_add_u32 s25, s25, 24576
    s_waitcnt lgkmcnt(6)
    buffer_store_dwordx4 v[128:131], v2, s[8:11], s25 offen sc1
    s_lshl_b32 s25, s4, 11
    s_add_u32 s25, s25, s24
    s_add_u32 s25, s25, 286720
    s_waitcnt lgkmcnt(4)
    buffer_store_dwordx4 v[132:135], v2, s[8:11], s25 offen sc1
    s_lshl_b32 s25, s4, 11
    s_add_u32 s25, s25, s24
    s_add_u32 s25, s25, 25600
    s_waitcnt lgkmcnt(2)
    buffer_store_dwordx4 v[136:139], v2, s[8:11], s25 offen sc1
    s_lshl_b32 s25, s4, 11
    s_add_u32 s25, s25, s24
    s_add_u32 s25, s25, 287744
    s_waitcnt lgkmcnt(0)
    buffer_store_dwordx4 v[140:143], v2, s[8:11], s25 offen sc1
    s_waitcnt vmcnt(0) lgkmcnt(0)
    s_barrier
    s_branch t0d_174
t0n_177:
    s_cmp_ge_u32 s6, 224
    s_cbranch_scc1 t0n_178
    s_sub_u32 s20, s6, 192
    s_lshl_b32 s20, s20, 2
    s_add_u32 s20, s20, s4
    s_load_dwordx2 s[16:17], s[0:1], 8
    s_waitcnt lgkmcnt(0)
    s_mov_b32 s12, s16
    s_and_b32 s13, s17, 0xffff
    s_mov_b32 s14, 2457600
    s_mov_b32 s15, 0x00020000
    s_lshr_b32 s21, s20, 2
    s_mul_i32 s21, s21, 20
    s_bfe_u32 s22, s20, 0x10001
    s_mul_i32 s22, s22, 640
    s_add_u32 s21, s21, s22
    s_and_b32 s25, s20, 1
    s_lshl_b32 s22, s25, 4
    s_add_u32 s21, s21, s22
    s_lshl_b32 s21, s21, 1
    v_mul_u32_u24 v5, 30720, v4
    v_lshl_add_u32 v5, v3, 1, v5
    v_add_u32 v5, s21, v5
    s_cmp_eq_u32 s25, 0
    s_cselect_b32 s22, 16, 4
    v_cmp_gt_u32 vcc, s22, v3
    v_mov_b32 v6, 0x7ff00000
    s_nop 0
    v_cndmask_b32 v5, v6, v5, vcc
    v_add_u32 v8, 0, v5
    v_add_u32 v9, 3840, v5
    v_add_u32 v10, 7680, v5
    v_add_u32 v11, 11520, v5
    v_add_u32 v12, 15360, v5
    v_add_u32 v13, 19200, v5
    v_add_u32 v14, 23040, v5
    v_add_u32 v15, 26880, v5
    s_lshl_b32 s23, s20, 10
    s_add_u32 s23, s23, 85983232
    s_mov_b32 s30, 0
    buffer_load_ushort v32, v8, s[12:15], s30 offen
    buffer_load_ushort v33, v9, s[12:15], s30 offen
    buffer_load_ushort v34, v10, s[12:15], s30 offen
    buffer_load_ushort v35, v11, s[12:15], s30 offen
    buffer_load_ushort v36, v12, s[12:15], s30 offen
    buffer_load_ushort v37, v13, s[12:15], s30 offen
    buffer_load_ushort v38, v14, s[12:15], s30 offen
    buffer_load_ushort v39, v15, s[12:15], s30 offen
    s_mov_b32 s31, 122880
    buffer_load_ushort v40, v8, s[12:15], s31 offen
    buffer_load_ushort v41, v9, s[12:15], s31 offen
    buffer_load_ushort v42, v10, s[12:15], s31 offen
    buffer_load_ushort v43, v11, s[12:15], s31 offen
    buffer_load_ushort v44, v12, s[12:15], s31 offen
    buffer_load_ushort v45, v13, s[12:15], s31 offen
    buffer_load_ushort v46, v14, s[12:15], s31 offen
    buffer_load_ushort v47, v15, s[12:15], s31 offen
    s_mov_b32 s32, 245760
    buffer_load_ushort v48, v8, s[12:15], s32 offen
    buffer_load_ushort v49, v9, s[12:15], s32 offen
    buffer_load_ushort v50, v10, s[12:15], s32 offen
    buffer_load_ushort v51, v11, s[12:15], s32 offen
    buffer_load_ushort v52, v12, s[12:15], s32 offen
    buffer_load_ushort v53, v13, s[12:15], s32 offen
    buffer_load_ushort v54, v14, s[12:15], s32 offen
    buffer_load_ushort v55, v15, s[12:15], s32 offen
    s_mov_b32 s33, 368640
    buffer_load_ushort v56, v8, s[12:15], s33 offen
    buffer_load_ushort v57, v9, s[12:15], s33 offen
    buffer_load_ushort v58, v10, s[12:15], s33 offen
    buffer_load_ushort v59, v11, s[12:15], s33 offen
    buffer_load_ushort v60, v12, s[12:15], s33 offen
    buffer_load_ushort v61, v13, s[12:15], s33 offen
    buffer_load_ushort v62, v14, s[12:15], s33 offen
    buffer_load_ushort v63, v15, s[12:15], s33 offen
    s_mov_b32 s34, 491520
    buffer_load_ushort v64, v8, s[12:15], s34 offen
    buffer_load_ushort v65, v9, s[12:15], s34 offen
    buffer_load_ushort v66, v10, s[12:15], s34 offen
    buffer_load_ushort v67, v11, s[12:15], s34 offen
    buffer_load_ushort v68, v12, s[12:15], s34 offen
    buffer_load_ushort v69, v13, s[12:15], s34 offen
    buffer_load_ushort v70, v14, s[12:15], s34 offen
    buffer_load_ushort v71, v15, s[12:15], s34 offen
    s_mov_b32 s35, 614400
    buffer_load_ushort v72, v8, s[12:15], s35 offen
    buffer_load_ushort v73, v9, s[12:15], s35 offen
    buffer_load_ushort v74, v10, s[12:15], s35 offen
    buffer_load_ushort v75, v11, s[12:15], s35 offen
    buffer_load_ushort v76, v12, s[12:15], s35 offen
    buffer_load_ushort v77, v13, s[12:15], s35 offen
    buffer_load_ushort v78, v14, s[12:15], s35 offen
    buffer_load_ushort v79, v15, s[12:15], s35 offen
    s_mov_b32 s36, 737280
    buffer_load_ushort v80, v8, s[12:15], s36 offen
    buffer_load_ushort v81, v9, s[12:15], s36 offen
    buffer_load_ushort v82, v10, s[12:15], s36 offen
    buffer_load_ushort v83, v11, s[12:15], s36 offen
    buffer_load_ushort v84, v12, s[12:15], s36 offen
    buffer_load_ushort v85, v13, s[12:15], s36 offen
    buffer_load_ushort v86, v14, s[12:15], s36 offen
    buffer_load_ushort v87, v15, s[12:15], s36 offen
    s_mov_b32 s37, 860160
    buffer_load_ushort v88, v8, s[12:15], s37 offen
    buffer_load_ushort v89, v9, s[12:15], s37 offen
    buffer_load_ushort v90, v10, s[12:15], s37 offen
    buffer_load_ushort v91, v11, s[12:15], s37 offen
    buffer_load_ushort v92, v12, s[12:15], s37 offen
    buffer_load_ushort v93, v13, s[12:15], s37 offen
    buffer_load_ushort v94, v14, s[12:15], s37 offen
    buffer_load_ushort v95, v15, s[12:15], s37 offen
    s_mov_b32 s38, 983040
    buffer_load_ushort v96, v8, s[12:15], s38 offen
    buffer_load_ushort v97, v9, s[12:15], s38 offen
    buffer_load_ushort v98, v10, s[12:15], s38 offen
    buffer_load_ushort v99, v11, s[12:15], s38 offen
    buffer_load_ushort v100, v12, s[12:15], s38 offen
    buffer_load_ushort v101, v13, s[12:15], s38 offen
    buffer_load_ushort v102, v14, s[12:15], s38 offen
    buffer_load_ushort v103, v15, s[12:15], s38 offen
    s_mov_b32 s39, 1105920
    buffer_load_ushort v104, v8, s[12:15], s39 offen
    buffer_load_ushort v105, v9, s[12:15], s39 offen
    buffer_load_ushort v106, v10, s[12:15], s39 offen
    buffer_load_ushort v107, v11, s[12:15], s39 offen
    buffer_load_ushort v108, v12, s[12:15], s39 offen
    buffer_load_ushort v109, v13, s[12:15], s39 offen
    buffer_load_ushort v110, v14, s[12:15], s39 offen
    buffer_load_ushort v111, v15, s[12:15], s39 offen
    s_mov_b32 s40, 1228800
    buffer_load_ushort v112, v8, s[12:15], s40 offen
    buffer_load_ushort v113, v9, s[12:15], s40 offen
    buffer_load_ushort v114, v10, s[12:15], s40 offen
    buffer_load_ushort v115, v11, s[12:15], s40 offen
    buffer_load_ushort v116, v12, s[12:15], s40 offen
    buffer_load_ushort v117, v13, s[12:15], s40 offen
    buffer_load_ushort v118, v14, s[12:15], s40 offen
    buffer_load_ushort v119, v15, s[12:15], s40 offen
    s_mov_b32 s41, 1351680
    buffer_load_ushort v120, v8, s[12:15], s41 offen
    buffer_load_ushort v121, v9, s[12:15], s41 offen
    buffer_load_ushort v122, v10, s[12:15], s41 offen
    buffer_load_ushort v123, v11, s[12:15], s41 offen
    buffer_load_ushort v124, v12, s[12:15], s41 offen
    buffer_load_ushort v125, v13, s[12:15], s41 offen
    buffer_load_ushort v126, v14, s[12:15], s41 offen
    buffer_load_ushort v127, v15, s[12:15], s41 offen
    s_mov_b32 s42, 1474560
    buffer_load_ushort v128, v8, s[12:15], s42 offen
    buffer_load_ushort v129, v9, s[12:15], s42 offen
    buffer_load_ushort v130, v10, s[12:15], s42 offen
    buffer_load_ushort v131, v11, s[12:15], s42 offen
    buffer_load_ushort v132, v12, s[12:15], s42 offen
    buffer_load_ushort v133, v13, s[12:15], s42 offen
    buffer_load_ushort v134, v14, s[12:15], s42 offen
    buffer_load_ushort v135, v15, s[12:15], s42 offen
    s_mov_b32 s43, 1597440
    buffer_load_ushort v136, v8, s[12:15], s43 offen
    buffer_load_ushort v137, v9, s[12:15], s43 offen
    buffer_load_ushort v138, v10, s[12:15], s43 offen
    buffer_load_ushort v139, v11, s[12:15], s43 offen
    buffer_load_ushort v140, v12, s[12:15], s43 offen
    buffer_load_ushort v141, v13, s[12:15], s43 offen
    buffer_load_ushort v142, v14, s[12:15], s43 offen
    buffer_load_ushort v143, v15, s[12:15], s43 offen
    s_mov_b32 s44, 1720320
    buffer_load_ushort v144, v8, s[12:15], s44 offen
    buffer_load_ushort v145, v9, s[12:15], s44 offen
    buffer_load_ushort v146, v10, s[12:15], s44 offen
    buffer_load_ushort v147, v11, s[12:15], s44 offen
    buffer_load_ushort v148, v12, s[12:15], s44 offen
    buffer_load_ushort v149, v13, s[12:15], s44 offen
    buffer_load_ushort v150, v14, s[12:15], s44 offen
    buffer_load_ushort v151, v15, s[12:15], s44 offen
    s_mov_b32 s45, 1843200
    buffer_load_ushort v152, v8, s[12:15], s45 offen
    buffer_load_ushort v153, v9, s[12:15], s45 offen
    buffer_load_ushort v154, v10, s[12:15], s45 offen
    buffer_load_ushort v155, v11, s[12:15], s45 offen
    buffer_load_ushort v156, v12, s[12:15], s45 offen
    buffer_load_ushort v157, v13, s[12:15], s45 offen
    buffer_load_ushort v158, v14, s[12:15], s45 offen
    buffer_load_ushort v159, v15, s[12:15], s45 offen
    s_mov_b32 s46, 1966080
    buffer_load_ushort v160, v8, s[12:15], s46 offen
    buffer_load_ushort v161, v9, s[12:15], s46 offen
    buffer_load_ushort v162, v10, s[12:15], s46 offen
    buffer_load_ushort v163, v11, s[12:15], s46 offen
    buffer_load_ushort v164, v12, s[12:15], s46 offen
    buffer_load_ushort v165, v13, s[12:15], s46 offen
    buffer_load_ushort v166, v14, s[12:15], s46 offen
    buffer_load_ushort v167, v15, s[12:15], s46 offen
    s_mov_b32 s47, 2088960
    buffer_load_ushort v168, v8, s[12:15], s47 offen
    buffer_load_ushort v169, v9, s[12:15], s47 offen
    buffer_load_ushort v170, v10, s[12:15], s47 offen
    buffer_load_ushort v171, v11, s[12:15], s47 offen
    buffer_load_ushort v172, v12, s[12:15], s47 offen
    buffer_load_ushort v173, v13, s[12:15], s47 offen
    buffer_load_ushort v174, v14, s[12:15], s47 offen
    buffer_load_ushort v175, v15, s[12:15], s47 offen
    s_mov_b32 s48, 2211840
    buffer_load_ushort v176, v8, s[12:15], s48 offen
    buffer_load_ushort v177, v9, s[12:15], s48 offen
    buffer_load_ushort v178, v10, s[12:15], s48 offen
    buffer_load_ushort v179, v11, s[12:15], s48 offen
    buffer_load_ushort v180, v12, s[12:15], s48 offen
    buffer_load_ushort v181, v13, s[12:15], s48 offen
    buffer_load_ushort v182, v14, s[12:15], s48 offen
    buffer_load_ushort v183, v15, s[12:15], s48 offen
    s_mov_b32 s49, 2334720
    buffer_load_ushort v184, v8, s[12:15], s49 offen
    buffer_load_ushort v185, v9, s[12:15], s49 offen
    buffer_load_ushort v186, v10, s[12:15], s49 offen
    buffer_load_ushort v187, v11, s[12:15], s49 offen
    buffer_load_ushort v188, v12, s[12:15], s49 offen
    buffer_load_ushort v189, v13, s[12:15], s49 offen
    buffer_load_ushort v190, v14, s[12:15], s49 offen
    buffer_load_ushort v191, v15, s[12:15], s49 offen
    s_waitcnt vmcnt(63)
    v_lshl_or_b32 v16, v33, 16, v32
    v_lshl_or_b32 v17, v35, 16, v34
    v_lshl_or_b32 v18, v37, 16, v36
    v_lshl_or_b32 v19, v39, 16, v38
    s_add_u32 s25, s23, 0
    buffer_store_dwordx4 v[16:19], v2, s[8:11], s25 offen sc1
    v_lshl_or_b32 v20, v41, 16, v40
    v_lshl_or_b32 v21, v43, 16, v42
    v_lshl_or_b32 v22, v45, 16, v44
    v_lshl_or_b32 v23, v47, 16, v46
    s_add_u32 s25, s23, 131072
    buffer_store_dwordx4 v[20:23], v2, s[8:11], s25 offen sc1
    v_lshl_or_b32 v24, v49, 16, v48
    v_lshl_or_b32 v25, v51, 16, v50
    v_lshl_or_b32 v26, v53, 16, v52
    v_lshl_or_b32 v27, v55, 16, v54
    s_add_u32 s25, s23, 262144
    buffer_store_dwordx4 v[24:27], v2, s[8:11], s25 offen sc1
    v_lshl_or_b32 v28, v57, 16, v56
    v_lshl_or_b32 v29, v59, 16, v58
    v_lshl_or_b32 v30, v61, 16, v60
    v_lshl_or_b32 v31, v63, 16, v62
    s_add_u32 s25, s23, 393216
    buffer_store_dwordx4 v[28:31], v2, s[8:11], s25 offen sc1
    v_lshl_or_b32 v16, v65, 16, v64
    v_lshl_or_b32 v17, v67, 16, v66
    v_lshl_or_b32 v18, v69, 16, v68
    v_lshl_or_b32 v19, v71, 16, v70
    s_add_u32 s25, s23, 524288
    buffer_store_dwordx4 v[16:19], v2, s[8:11], s25 offen sc1
    v_lshl_or_b32 v20, v73, 16, v72
    v_lshl_or_b32 v21, v75, 16, v74
    v_lshl_or_b32 v22, v77, 16, v76
    v_lshl_or_b32 v23, v79, 16, v78
    s_add_u32 s25, s23, 655360
    buffer_store_dwordx4 v[20:23], v2, s[8:11], s25 offen sc1
    v_lshl_or_b32 v24, v81, 16, v80
    v_lshl_or_b32 v25, v83, 16, v82
    v_lshl_or_b32 v26, v85, 16, v84
    v_lshl_or_b32 v27, v87, 16, v86
    s_add_u32 s25, s23, 786432
    buffer_store_dwordx4 v[24:27], v2, s[8:11], s25 offen sc1
    v_lshl_or_b32 v28, v89, 16, v88
    v_lshl_or_b32 v29, v91, 16, v90
    v_lshl_or_b32 v30, v93, 16, v92
    v_lshl_or_b32 v31, v95, 16, v94
    s_add_u32 s25, s23, 917504
    buffer_store_dwordx4 v[28:31], v2, s[8:11], s25 offen sc1
    v_lshl_or_b32 v16, v97, 16, v96
    v_lshl_or_b32 v17, v99, 16, v98
    v_lshl_or_b32 v18, v101, 16, v100
    v_lshl_or_b32 v19, v103, 16, v102
    s_add_u32 s25, s23, 1048576
    buffer_store_dwordx4 v[16:19], v2, s[8:11], s25 offen sc1
    v_lshl_or_b32 v20, v105, 16, v104
    v_lshl_or_b32 v21, v107, 16, v106
    v_lshl_or_b32 v22, v109, 16, v108
    v_lshl_or_b32 v23, v111, 16, v110
    s_add_u32 s25, s23, 1179648
    buffer_store_dwordx4 v[20:23], v2, s[8:11], s25 offen sc1
    v_lshl_or_b32 v24, v113, 16, v112
    v_lshl_or_b32 v25, v115, 16, v114
    v_lshl_or_b32 v26, v117, 16, v116
    v_lshl_or_b32 v27, v119, 16, v118
    s_add_u32 s25, s23, 1310720
    buffer_store_dwordx4 v[24:27], v2, s[8:11], s25 offen sc1
    v_lshl_or_b32 v28, v121, 16, v120
    v_lshl_or_b32 v29, v123, 16, v122
    v_lshl_or_b32 v30, v125, 16, v124
    v_lshl_or_b32 v31, v127, 16, v126
    s_add_u32 s25, s23, 1441792
    buffer_store_dwordx4 v[28:31], v2, s[8:11], s25 offen sc1
    s_waitcnt vmcnt(63)
    v_lshl_or_b32 v16, v129, 16, v128
    v_lshl_or_b32 v17, v131, 16, v130
    v_lshl_or_b32 v18, v133, 16, v132
    v_lshl_or_b32 v19, v135, 16, v134
    s_add_u32 s25, s23, 1572864
    buffer_store_dwordx4 v[16:19], v2, s[8:11], s25 offen sc1
    v_lshl_or_b32 v20, v137, 16, v136
    v_lshl_or_b32 v21, v139, 16, v138
    s_waitcnt vmcnt(63)
    v_lshl_or_b32 v22, v141, 16, v140
    s_waitcnt vmcnt(61)
    v_lshl_or_b32 v23, v143, 16, v142
    s_add_u32 s25, s23, 1703936
    buffer_store_dwordx4 v[20:23], v2, s[8:11], s25 offen sc1
    s_waitcnt vmcnt(60)
    v_lshl_or_b32 v24, v145, 16, v144
    s_waitcnt vmcnt(58)
    v_lshl_or_b32 v25, v147, 16, v146
    s_waitcnt vmcnt(56)
    v_lshl_or_b32 v26, v149, 16, v148
    s_waitcnt vmcnt(54)
    v_lshl_or_b32 v27, v151, 16, v150
    s_add_u32 s25, s23, 1835008
    buffer_store_dwordx4 v[24:27], v2, s[8:11], s25 offen sc1
    s_waitcnt vmcnt(53)
    v_lshl_or_b32 v28, v153, 16, v152
    s_waitcnt vmcnt(51)
    v_lshl_or_b32 v29, v155, 16, v154
    s_waitcnt vmcnt(49)
    v_lshl_or_b32 v30, v157, 16, v156
    s_waitcnt vmcnt(47)
    v_lshl_or_b32 v31, v159, 16, v158
    s_add_u32 s25, s23, 1966080
    buffer_store_dwordx4 v[28:31], v2, s[8:11], s25 offen sc1
    s_waitcnt vmcnt(46)
    v_lshl_or_b32 v16, v161, 16, v160
    s_waitcnt vmcnt(44)
    v_lshl_or_b32 v17, v163, 16, v162
    s_waitcnt vmcnt(42)
    v_lshl_or_b32 v18, v165, 16, v164
    s_waitcnt vmcnt(40)
    v_lshl_or_b32 v19, v167, 16, v166
    s_add_u32 s25, s23, 2097152
    buffer_store_dwordx4 v[16:19], v2, s[8:11], s25 offen sc1
    s_waitcnt vmcnt(39)
    v_lshl_or_b32 v20, v169, 16, v168
    s_waitcnt vmcnt(37)
    v_lshl_or_b32 v21, v171, 16, v170
    s_waitcnt vmcnt(35)
    v_lshl_or_b32 v22, v173, 16, v172
    s_waitcnt vmcnt(33)
    v_lshl_or_b32 v23, v175, 16, v174
    s_add_u32 s25, s23, 2228224
    buffer_store_dwordx4 v[20:23], v2, s[8:11], s25 offen sc1
    s_waitcnt vmcnt(32)
    v_lshl_or_b32 v24, v177, 16, v176
    s_waitcnt vmcnt(30)
    v_lshl_or_b32 v25, v179, 16, v178
    s_waitcnt vmcnt(28)
    v_lshl_or_b32 v26, v181, 16, v180
    s_waitcnt vmcnt(26)
    v_lshl_or_b32 v27, v183, 16, v182
    s_add_u32 s25, s23, 2359296
    buffer_store_dwordx4 v[24:27], v2, s[8:11], s25 offen sc1
    s_waitcnt vmcnt(25)
    v_lshl_or_b32 v28, v185, 16, v184
    s_waitcnt vmcnt(23)
    v_lshl_or_b32 v29, v187, 16, v186
    s_waitcnt vmcnt(21)
    v_lshl_or_b32 v30, v189, 16, v188
    s_waitcnt vmcnt(19)
    v_lshl_or_b32 v31, v191, 16, v190
    s_add_u32 s25, s23, 2490368
    buffer_store_dwordx4 v[28:31], v2, s[8:11], s25 offen sc1
    s_waitcnt vmcnt(0)
    s_branch t0d_174
t0n_178:
    s_cmp_ge_u32 s6, 240
    s_cbranch_scc1 t0n_179
    s_sub_u32 s20, s6, 224
    s_lshl_b32 s20, s20, 2
    s_add_u32 s20, s20, s4
    s_load_dwordx2 s[16:17], s[0:1], 8
    s_waitcnt lgkmcnt(0)
    s_mov_b32 s12, s16
    s_and_b32 s13, s17, 0xffff
    s_mov_b32 s14, 2457600
    s_mov_b32 s15, 0x00020000
    s_lshr_b32 s21, s20, 1
    s_mul_i32 s21, s21, 20
    s_add_u32 s21, s21, 1280
    s_and_b32 s25, s20, 1
    s_lshl_b32 s22, s25, 4
    s_add_u32 s21, s21, s22
    s_lshl_b32 s21, s21, 1
    v_mul_u32_u24 v5, 30720, v4
    v_lshl_add_u32 v5, v3, 1, v5
    v_add_u32 v5, s21, v5
    s_cmp_eq_u32 s25, 0
    s_cselect_b32 s22, 16, 4
    v_cmp_gt_u32 vcc, s22, v3
    v_mov_b32 v6, 0x7ff00000
    s_nop 0
    v_cndmask_b32 v5, v6, v5, vcc
    v_add_u32 v8, 0, v5
    v_add_u32 v9, 3840, v5
    v_add_u32 v10, 7680, v5
    v_add_u32 v11, 11520, v5
    v_add_u32 v12, 15360, v5
    v_add_u32 v13, 19200, v5
    v_add_u32 v14, 23040, v5
    v_add_u32 v15, 26880, v5
    s_lshl_b32 s23, s20, 10
    s_add_u32 s23, s23, 89128960
    s_mov_b32 s30, 0
    buffer_load_ushort v32, v8, s[12:15], s30 offen
    buffer_load_ushort v33, v9, s[12:15], s30 offen
    buffer_load_ushort v34, v10, s[12:15], s30 offen
    buffer_load_ushort v35, v11, s[12:15], s30 offen
    buffer_load_ushort v36, v12, s[12:15], s30 offen
    buffer_load_ushort v37, v13, s[12:15], s30 offen
    buffer_load_ushort v38, v14, s[12:15], s30 offen
    buffer_load_ushort v39, v15, s[12:15], s30 offen
    s_mov_b32 s31, 122880
    buffer_load_ushort v40, v8, s[12:15], s31 offen
    buffer_load_ushort v41, v9, s[12:15], s31 offen
    buffer_load_ushort v42, v10, s[12:15], s31 offen
    buffer_load_ushort v43, v11, s[12:15], s31 offen
    buffer_load_ushort v44, v12, s[12:15], s31 offen
    buffer_load_ushort v45, v13, s[12:15], s31 offen
    buffer_load_ushort v46, v14, s[12:15], s31 offen
    buffer_load_ushort v47, v15, s[12:15], s31 offen
    s_mov_b32 s32, 245760
    buffer_load_ushort v48, v8, s[12:15], s32 offen
    buffer_load_ushort v49, v9, s[12:15], s32 offen
    buffer_load_ushort v50, v10, s[12:15], s32 offen
    buffer_load_ushort v51, v11, s[12:15], s32 offen
    buffer_load_ushort v52, v12, s[12:15], s32 offen
    buffer_load_ushort v53, v13, s[12:15], s32 offen
    buffer_load_ushort v54, v14, s[12:15], s32 offen
    buffer_load_ushort v55, v15, s[12:15], s32 offen
    s_mov_b32 s33, 368640
    buffer_load_ushort v56, v8, s[12:15], s33 offen
    buffer_load_ushort v57, v9, s[12:15], s33 offen
    buffer_load_ushort v58, v10, s[12:15], s33 offen
    buffer_load_ushort v59, v11, s[12:15], s33 offen
    buffer_load_ushort v60, v12, s[12:15], s33 offen
    buffer_load_ushort v61, v13, s[12:15], s33 offen
    buffer_load_ushort v62, v14, s[12:15], s33 offen
    buffer_load_ushort v63, v15, s[12:15], s33 offen
    s_mov_b32 s34, 491520
    buffer_load_ushort v64, v8, s[12:15], s34 offen
    buffer_load_ushort v65, v9, s[12:15], s34 offen
    buffer_load_ushort v66, v10, s[12:15], s34 offen
    buffer_load_ushort v67, v11, s[12:15], s34 offen
    buffer_load_ushort v68, v12, s[12:15], s34 offen
    buffer_load_ushort v69, v13, s[12:15], s34 offen
    buffer_load_ushort v70, v14, s[12:15], s34 offen
    buffer_load_ushort v71, v15, s[12:15], s34 offen
    s_mov_b32 s35, 614400
    buffer_load_ushort v72, v8, s[12:15], s35 offen
    buffer_load_ushort v73, v9, s[12:15], s35 offen
    buffer_load_ushort v74, v10, s[12:15], s35 offen
    buffer_load_ushort v75, v11, s[12:15], s35 offen
    buffer_load_ushort v76, v12, s[12:15], s35 offen
    buffer_load_ushort v77, v13, s[12:15], s35 offen
    buffer_load_ushort v78, v14, s[12:15], s35 offen
    buffer_load_ushort v79, v15, s[12:15], s35 offen
    s_mov_b32 s36, 737280
    buffer_load_ushort v80, v8, s[12:15], s36 offen
    buffer_load_ushort v81, v9, s[12:15], s36 offen
    buffer_load_ushort v82, v10, s[12:15], s36 offen
    buffer_load_ushort v83, v11, s[12:15], s36 offen
    buffer_load_ushort v84, v12, s[12:15], s36 offen
    buffer_load_ushort v85, v13, s[12:15], s36 offen
    buffer_load_ushort v86, v14, s[12:15], s36 offen
    buffer_load_ushort v87, v15, s[12:15], s36 offen
    s_mov_b32 s37, 860160
    buffer_load_ushort v88, v8, s[12:15], s37 offen
    buffer_load_ushort v89, v9, s[12:15], s37 offen
    buffer_load_ushort v90, v10, s[12:15], s37 offen
    buffer_load_ushort v91, v11, s[12:15], s37 offen
    buffer_load_ushort v92, v12, s[12:15], s37 offen
    buffer_load_ushort v93, v13, s[12:15], s37 offen
    buffer_load_ushort v94, v14, s[12:15], s37 offen
    buffer_load_ushort v95, v15, s[12:15], s37 offen
    s_mov_b32 s38, 983040
    buffer_load_ushort v96, v8, s[12:15], s38 offen
    buffer_load_ushort v97, v9, s[12:15], s38 offen
    buffer_load_ushort v98, v10, s[12:15], s38 offen
    buffer_load_ushort v99, v11, s[12:15], s38 offen
    buffer_load_ushort v100, v12, s[12:15], s38 offen
    buffer_load_ushort v101, v13, s[12:15], s38 offen
    buffer_load_ushort v102, v14, s[12:15], s38 offen
    buffer_load_ushort v103, v15, s[12:15], s38 offen
    s_mov_b32 s39, 1105920
    buffer_load_ushort v104, v8, s[12:15], s39 offen
    buffer_load_ushort v105, v9, s[12:15], s39 offen
    buffer_load_ushort v106, v10, s[12:15], s39 offen
    buffer_load_ushort v107, v11, s[12:15], s39 offen
    buffer_load_ushort v108, v12, s[12:15], s39 offen
    buffer_load_ushort v109, v13, s[12:15], s39 offen
    buffer_load_ushort v110, v14, s[12:15], s39 offen
    buffer_load_ushort v111, v15, s[12:15], s39 offen
    s_mov_b32 s40, 1228800
    buffer_load_ushort v112, v8, s[12:15], s40 offen
    buffer_load_ushort v113, v9, s[12:15], s40 offen
    buffer_load_ushort v114, v10, s[12:15], s40 offen
    buffer_load_ushort v115, v11, s[12:15], s40 offen
    buffer_load_ushort v116, v12, s[12:15], s40 offen
    buffer_load_ushort v117, v13, s[12:15], s40 offen
    buffer_load_ushort v118, v14, s[12:15], s40 offen
    buffer_load_ushort v119, v15, s[12:15], s40 offen
    s_mov_b32 s41, 1351680
    buffer_load_ushort v120, v8, s[12:15], s41 offen
    buffer_load_ushort v121, v9, s[12:15], s41 offen
    buffer_load_ushort v122, v10, s[12:15], s41 offen
    buffer_load_ushort v123, v11, s[12:15], s41 offen
    buffer_load_ushort v124, v12, s[12:15], s41 offen
    buffer_load_ushort v125, v13, s[12:15], s41 offen
    buffer_load_ushort v126, v14, s[12:15], s41 offen
    buffer_load_ushort v127, v15, s[12:15], s41 offen
    s_mov_b32 s42, 1474560
    buffer_load_ushort v128, v8, s[12:15], s42 offen
    buffer_load_ushort v129, v9, s[12:15], s42 offen
    buffer_load_ushort v130, v10, s[12:15], s42 offen
    buffer_load_ushort v131, v11, s[12:15], s42 offen
    buffer_load_ushort v132, v12, s[12:15], s42 offen
    buffer_load_ushort v133, v13, s[12:15], s42 offen
    buffer_load_ushort v134, v14, s[12:15], s42 offen
    buffer_load_ushort v135, v15, s[12:15], s42 offen
    s_mov_b32 s43, 1597440
    buffer_load_ushort v136, v8, s[12:15], s43 offen
    buffer_load_ushort v137, v9, s[12:15], s43 offen
    buffer_load_ushort v138, v10, s[12:15], s43 offen
    buffer_load_ushort v139, v11, s[12:15], s43 offen
    buffer_load_ushort v140, v12, s[12:15], s43 offen
    buffer_load_ushort v141, v13, s[12:15], s43 offen
    buffer_load_ushort v142, v14, s[12:15], s43 offen
    buffer_load_ushort v143, v15, s[12:15], s43 offen
    s_mov_b32 s44, 1720320
    buffer_load_ushort v144, v8, s[12:15], s44 offen
    buffer_load_ushort v145, v9, s[12:15], s44 offen
    buffer_load_ushort v146, v10, s[12:15], s44 offen
    buffer_load_ushort v147, v11, s[12:15], s44 offen
    buffer_load_ushort v148, v12, s[12:15], s44 offen
    buffer_load_ushort v149, v13, s[12:15], s44 offen
    buffer_load_ushort v150, v14, s[12:15], s44 offen
    buffer_load_ushort v151, v15, s[12:15], s44 offen
    s_mov_b32 s45, 1843200
    buffer_load_ushort v152, v8, s[12:15], s45 offen
    buffer_load_ushort v153, v9, s[12:15], s45 offen
    buffer_load_ushort v154, v10, s[12:15], s45 offen
    buffer_load_ushort v155, v11, s[12:15], s45 offen
    buffer_load_ushort v156, v12, s[12:15], s45 offen
    buffer_load_ushort v157, v13, s[12:15], s45 offen
    buffer_load_ushort v158, v14, s[12:15], s45 offen
    buffer_load_ushort v159, v15, s[12:15], s45 offen
    s_mov_b32 s46, 1966080
    buffer_load_ushort v160, v8, s[12:15], s46 offen
    buffer_load_ushort v161, v9, s[12:15], s46 offen
    buffer_load_ushort v162, v10, s[12:15], s46 offen
    buffer_load_ushort v163, v11, s[12:15], s46 offen
    buffer_load_ushort v164, v12, s[12:15], s46 offen
    buffer_load_ushort v165, v13, s[12:15], s46 offen
    buffer_load_ushort v166, v14, s[12:15], s46 offen
    buffer_load_ushort v167, v15, s[12:15], s46 offen
    s_mov_b32 s47, 2088960
    buffer_load_ushort v168, v8, s[12:15], s47 offen
    buffer_load_ushort v169, v9, s[12:15], s47 offen
    buffer_load_ushort v170, v10, s[12:15], s47 offen
    buffer_load_ushort v171, v11, s[12:15], s47 offen
    buffer_load_ushort v172, v12, s[12:15], s47 offen
    buffer_load_ushort v173, v13, s[12:15], s47 offen
    buffer_load_ushort v174, v14, s[12:15], s47 offen
    buffer_load_ushort v175, v15, s[12:15], s47 offen
    s_mov_b32 s48, 2211840
    buffer_load_ushort v176, v8, s[12:15], s48 offen
    buffer_load_ushort v177, v9, s[12:15], s48 offen
    buffer_load_ushort v178, v10, s[12:15], s48 offen
    buffer_load_ushort v179, v11, s[12:15], s48 offen
    buffer_load_ushort v180, v12, s[12:15], s48 offen
    buffer_load_ushort v181, v13, s[12:15], s48 offen
    buffer_load_ushort v182, v14, s[12:15], s48 offen
    buffer_load_ushort v183, v15, s[12:15], s48 offen
    s_mov_b32 s49, 2334720
    buffer_load_ushort v184, v8, s[12:15], s49 offen
    buffer_load_ushort v185, v9, s[12:15], s49 offen
    buffer_load_ushort v186, v10, s[12:15], s49 offen
    buffer_load_ushort v187, v11, s[12:15], s49 offen
    buffer_load_ushort v188, v12, s[12:15], s49 offen
    buffer_load_ushort v189, v13, s[12:15], s49 offen
    buffer_load_ushort v190, v14, s[12:15], s49 offen
    buffer_load_ushort v191, v15, s[12:15], s49 offen
    s_waitcnt vmcnt(63)
    v_lshl_or_b32 v16, v33, 16, v32
    v_lshl_or_b32 v17, v35, 16, v34
    v_lshl_or_b32 v18, v37, 16, v36
    v_lshl_or_b32 v19, v39, 16, v38
    s_add_u32 s25, s23, 0
    buffer_store_dwordx4 v[16:19], v2, s[8:11], s25 offen sc1
    v_lshl_or_b32 v20, v41, 16, v40
    v_lshl_or_b32 v21, v43, 16, v42
    v_lshl_or_b32 v22, v45, 16, v44
    v_lshl_or_b32 v23, v47, 16, v46
    s_add_u32 s25, s23, 65536
    buffer_store_dwordx4 v[20:23], v2, s[8:11], s25 offen sc1
    v_lshl_or_b32 v24, v49, 16, v48
    v_lshl_or_b32 v25, v51, 16, v50
    v_lshl_or_b32 v26, v53, 16, v52
    v_lshl_or_b32 v27, v55, 16, v54
    s_add_u32 s25, s23, 131072
    buffer_store_dwordx4 v[24:27], v2, s[8:11], s25 offen sc1
    v_lshl_or_b32 v28, v57, 16, v56
    v_lshl_or_b32 v29, v59, 16, v58
    v_lshl_or_b32 v30, v61, 16, v60
    v_lshl_or_b32 v31, v63, 16, v62
    s_add_u32 s25, s23, 196608
    buffer_store_dwordx4 v[28:31], v2, s[8:11], s25 offen sc1
    v_lshl_or_b32 v16, v65, 16, v64
    v_lshl_or_b32 v17, v67, 16, v66
    v_lshl_or_b32 v18, v69, 16, v68
    v_lshl_or_b32 v19, v71, 16, v70
    s_add_u32 s25, s23, 262144
    buffer_store_dwordx4 v[16:19], v2, s[8:11], s25 offen sc1
    v_lshl_or_b32 v20, v73, 16, v72
    v_lshl_or_b32 v21, v75, 16, v74
    v_lshl_or_b32 v22, v77, 16, v76
    v_lshl_or_b32 v23, v79, 16, v78
    s_add_u32 s25, s23, 327680
    buffer_store_dwordx4 v[20:23], v2, s[8:11], s25 offen sc1
    v_lshl_or_b32 v24, v81, 16, v80
    v_lshl_or_b32 v25, v83, 16, v82
    v_lshl_or_b32 v26, v85, 16, v84
    v_lshl_or_b32 v27, v87, 16, v86
    s_add_u32 s25, s23, 393216
    buffer_store_dwordx4 v[24:27], v2, s[8:11], s25 offen sc1
    v_lshl_or_b32 v28, v89, 16, v88
    v_lshl_or_b32 v29, v91, 16, v90
    v_lshl_or_b32 v30, v93, 16, v92
    v_lshl_or_b32 v31, v95, 16, v94
    s_add_u32 s25, s23, 458752
    buffer_store_dwordx4 v[28:31], v2, s[8:11], s25 offen sc1
    v_lshl_or_b32 v16, v97, 16, v96
    v_lshl_or_b32 v17, v99, 16, v98
    v_lshl_or_b32 v18, v101, 16, v100
    v_lshl_or_b32 v19, v103, 16, v102
    s_add_u32 s25, s23, 524288
    buffer_store_dwordx4 v[16:19], v2, s[8:11], s25 offen sc1
    v_lshl_or_b32 v20, v105, 16, v104
    v_lshl_or_b32 v21, v107, 16, v106
    v_lshl_or_b32 v22, v109, 16, v108
    v_lshl_or_b32 v23, v111, 16, v110
    s_add_u32 s25, s23, 589824
    buffer_store_dwordx4 v[20:23], v2, s[8:11], s25 offen sc1
    v_lshl_or_b32 v24, v113, 16, v112
    v_lshl_or_b32 v25, v115, 16, v114
    v_lshl_or_b32 v26, v117, 16, v116
    v_lshl_or_b32 v27, v119, 16, v118
    s_add_u32 s25, s23, 655360
    buffer_store_dwordx4 v[24:27], v2, s[8:11], s25 offen sc1
    v_lshl_or_b32 v28, v121, 16, v120
    v_lshl_or_b32 v29, v123, 16, v122
    v_lshl_or_b32 v30, v125, 16, v124
    v_lshl_or_b32 v31, v127, 16, v126
    s_add_u32 s25, s23, 720896
    buffer_store_dwordx4 v[28:31], v2, s[8:11], s25 offen sc1
    s_waitcnt vmcnt(63)
    v_lshl_or_b32 v16, v129, 16, v128
    v_lshl_or_b32 v17, v131, 16, v130
    v_lshl_or_b32 v18, v133, 16, v132
    v_lshl_or_b32 v19, v135, 16, v134
    s_add_u32 s25, s23, 786432
    buffer_store_dwordx4 v[16:19], v2, s[8:11], s25 offen sc1
    v_lshl_or_b32 v20, v137, 16, v136
    v_lshl_or_b32 v21, v139, 16, v138
    s_waitcnt vmcnt(63)
    v_lshl_or_b32 v22, v141, 16, v140
    s_waitcnt vmcnt(61)
    v_lshl_or_b32 v23, v143, 16, v142
    s_add_u32 s25, s23, 851968
    buffer_store_dwordx4 v[20:23], v2, s[8:11], s25 offen sc1
    s_waitcnt vmcnt(60)
    v_lshl_or_b32 v24, v145, 16, v144
    s_waitcnt vmcnt(58)
    v_lshl_or_b32 v25, v147, 16, v146
    s_waitcnt vmcnt(56)
    v_lshl_or_b32 v26, v149, 16, v148
    s_waitcnt vmcnt(54)
    v_lshl_or_b32 v27, v151, 16, v150
    s_add_u32 s25, s23, 917504
    buffer_store_dwordx4 v[24:27], v2, s[8:11], s25 offen sc1
    s_waitcnt vmcnt(53)
    v_lshl_or_b32 v28, v153, 16, v152
    s_waitcnt vmcnt(51)
    v_lshl_or_b32 v29, v155, 16, v154
    s_waitcnt vmcnt(49)
    v_lshl_or_b32 v30, v157, 16, v156
    s_waitcnt vmcnt(47)
    v_lshl_or_b32 v31, v159, 16, v158
    s_add_u32 s25, s23, 983040
    buffer_store_dwordx4 v[28:31], v2, s[8:11], s25 offen sc1
    s_waitcnt vmcnt(46)
    v_lshl_or_b32 v16, v161, 16, v160
    s_waitcnt vmcnt(44)
    v_lshl_or_b32 v17, v163, 16, v162
    s_waitcnt vmcnt(42)
    v_lshl_or_b32 v18, v165, 16, v164
    s_waitcnt vmcnt(40)
    v_lshl_or_b32 v19, v167, 16, v166
    s_add_u32 s25, s23, 1048576
    buffer_store_dwordx4 v[16:19], v2, s[8:11], s25 offen sc1
    s_waitcnt vmcnt(39)
    v_lshl_or_b32 v20, v169, 16, v168
    s_waitcnt vmcnt(37)
    v_lshl_or_b32 v21, v171, 16, v170
    s_waitcnt vmcnt(35)
    v_lshl_or_b32 v22, v173, 16, v172
    s_waitcnt vmcnt(33)
    v_lshl_or_b32 v23, v175, 16, v174
    s_add_u32 s25, s23, 1114112
    buffer_store_dwordx4 v[20:23], v2, s[8:11], s25 offen sc1
    s_waitcnt vmcnt(32)
    v_lshl_or_b32 v24, v177, 16, v176
    s_waitcnt vmcnt(30)
    v_lshl_or_b32 v25, v179, 16, v178
    s_waitcnt vmcnt(28)
    v_lshl_or_b32 v26, v181, 16, v180
    s_waitcnt vmcnt(26)
    v_lshl_or_b32 v27, v183, 16, v182
    s_add_u32 s25, s23, 1179648
    buffer_store_dwordx4 v[24:27], v2, s[8:11], s25 offen sc1
    s_waitcnt vmcnt(25)
    v_lshl_or_b32 v28, v185, 16, v184
    s_waitcnt vmcnt(23)
    v_lshl_or_b32 v29, v187, 16, v186
    s_waitcnt vmcnt(21)
    v_lshl_or_b32 v30, v189, 16, v188
    s_waitcnt vmcnt(19)
    v_lshl_or_b32 v31, v191, 16, v190
    s_add_u32 s25, s23, 1245184
    buffer_store_dwordx4 v[28:31], v2, s[8:11], s25 offen sc1
    s_waitcnt vmcnt(0)
    s_branch t0d_174
t0n_179:
    s_cmp_ge_u32 s6, 320
    s_cbranch_scc1 t0n_180
    s_sub_u32 s20, s6, 240
    s_lshl_b32 s20, s20, 2
    s_add_u32 s20, s20, s4
    s_sub_u32 s20, s6, 240
    s_load_dwordx2 s[16:17], s[0:1], 40
    s_waitcnt lgkmcnt(0)
    s_mov_b32 s12, s16
    s_and_b32 s13, s17, 0xffff
    s_mov_b32 s14, 5242880
    s_mov_b32 s15, 0x00020000
    s_mul_hi_u32 s21, s20, 429496730
    s_mul_i32 s25, s21, 10
    s_sub_u32 s22, s20, s25
    s_mul_i32 s23, s22, 524288
    s_lshl_b32 s25, s21, 10
    s_add_u32 s23, s23, s25
    s_mul_i32 s24, s22, 524288
    s_lshl_b32 s25, s21, 15
    s_add_u32 s24, s24, s25
    s_add_u32 s24, s24, 79691776
    v_lshrrev_b32 v9, 4, v1
    s_lshl_b32 s25, s4, 4
    v_add_u32 v9, s25, v9
    v_mul_u32_u24 v5, 8192, v9
    v_lshl_add_u32 v5, v3, 4, v5
    v_lshlrev_b32 v6, 8, v9
    v_and_b32 v9, 3, v9
    v_lshlrev_b32 v9, 1, v9
    s_lshr_b32 s25, s4, 1
    s_lshl_b32 s25, s25, 3
    v_add_u32 v9, s25, v9
    v_xor_b32 v9, v9, v3
    v_lshl_add_u32 v6, v9, 4, v6
    v_bfe_u32 v9, v1, 2, 2
    v_lshlrev_b32 v14, 1, v9
    v_add_u32 v14, 0, v14
    s_lshl_b32 s25, s4, 2
    s_add_u32 s25, s25, 0
    v_bfe_u32 v15, v1, 1, 1
    v_add_u32 v15, s25, v15
    v_xor_b32 v14, v14, v15
    v_lshlrev_b32 v14, 4, v14
    v_and_b32 v15, 1, v1
    v_lshl_add_u32 v14, v15, 3, v14
    v_lshl_add_u32 v9, v4, 3, v9
    v_add_u32 v9, 0, v9
    v_lshl_add_u32 v10, v9, 8, v14
    v_bfe_u32 v9, v1, 2, 2
    v_lshlrev_b32 v14, 1, v9
    v_add_u32 v14, 8, v14
    s_lshl_b32 s25, s4, 2
    s_add_u32 s25, s25, 0
    v_bfe_u32 v15, v1, 1, 1
    v_add_u32 v15, s25, v15
    v_xor_b32 v14, v14, v15
    v_lshlrev_b32 v14, 4, v14
    v_and_b32 v15, 1, v1
    v_lshl_add_u32 v14, v15, 3, v14
    v_lshl_add_u32 v9, v4, 3, v9
    v_add_u32 v9, 32, v9
    v_lshl_add_u32 v11, v9, 8, v14
    v_bfe_u32 v9, v1, 2, 2
    v_lshlrev_b32 v14, 1, v9
    v_add_u32 v14, 0, v14
    s_lshl_b32 s25, s4, 2
    s_add_u32 s25, s25, 2
    v_bfe_u32 v15, v1, 1, 1
    v_add_u32 v15, s25, v15
    v_xor_b32 v14, v14, v15
    v_lshlrev_b32 v14, 4, v14
    v_and_b32 v15, 1, v1
    v_lshl_add_u32 v14, v15, 3, v14
    v_lshl_add_u32 v9, v4, 3, v9
    v_add_u32 v9, 0, v9
    v_lshl_add_u32 v12, v9, 8, v14
    v_bfe_u32 v9, v1, 2, 2
    v_lshlrev_b32 v14, 1, v9
    v_add_u32 v14, 8, v14
    s_lshl_b32 s25, s4, 2
    s_add_u32 s25, s25, 2
    v_bfe_u32 v15, v1, 1, 1
    v_add_u32 v15, s25, v15
    v_xor_b32 v14, v14, v15
    v_lshlrev_b32 v14, 4, v14
    v_and_b32 v15, 1, v1
    v_lshl_add_u32 v14, v15, 3, v14
    v_lshl_add_u32 v9, v4, 3, v9
    v_add_u32 v9, 32, v9
    v_lshl_add_u32 v13, v9, 8, v14
    s_add_u32 s30, s23, 0
    s_add_u32 s25, s30, 0
    buffer_load_dwordx4 v[16:19], v5, s[12:15], s25 offen
    s_add_u32 s25, s30, 32768
    buffer_load_dwordx4 v[20:23], v5, s[12:15], s25 offen
    s_add_u32 s25, s30, 65536
    buffer_load_dwordx4 v[24:27], v5, s[12:15], s25 offen
    s_add_u32 s25, s30, 98304
    buffer_load_dwordx4 v[28:31], v5, s[12:15], s25 offen
    s_add_u32 s31, s23, 256
    s_add_u32 s25, s31, 0
    buffer_load_dwordx4 v[32:35], v5, s[12:15], s25 offen
    s_add_u32 s25, s31, 32768
    buffer_load_dwordx4 v[36:39], v5, s[12:15], s25 offen
    s_add_u32 s25, s31, 65536
    buffer_load_dwordx4 v[40:43], v5, s[12:15], s25 offen
    s_add_u32 s25, s31, 98304
    buffer_load_dwordx4 v[44:47], v5, s[12:15], s25 offen
    s_add_u32 s32, s23, 512
    s_add_u32 s25, s32, 0
    buffer_load_dwordx4 v[48:51], v5, s[12:15], s25 offen
    s_add_u32 s25, s32, 32768
    buffer_load_dwordx4 v[52:55], v5, s[12:15], s25 offen
    s_add_u32 s25, s32, 65536
    buffer_load_dwordx4 v[56:59], v5, s[12:15], s25 offen
    s_add_u32 s25, s32, 98304
    buffer_load_dwordx4 v[60:63], v5, s[12:15], s25 offen
    s_add_u32 s33, s23, 768
    s_add_u32 s25, s33, 0
    buffer_load_dwordx4 v[64:67], v5, s[12:15], s25 offen
    s_add_u32 s25, s33, 32768
    buffer_load_dwordx4 v[68:71], v5, s[12:15], s25 offen
    s_add_u32 s25, s33, 65536
    buffer_load_dwordx4 v[72:75], v5, s[12:15], s25 offen
    s_add_u32 s25, s33, 98304
    buffer_load_dwordx4 v[76:79], v5, s[12:15], s25 offen
    s_waitcnt vmcnt(15)
    ds_write_b128 v6, v[16:19] offset:0
    s_waitcnt vmcnt(14)
    ds_write_b128 v6, v[20:23] offset:1024
    s_waitcnt vmcnt(13)
    ds_write_b128 v6, v[24:27] offset:2048
    s_waitcnt vmcnt(12)
    ds_write_b128 v6, v[28:31] offset:3072
    s_waitcnt vmcnt(11)
    ds_write_b128 v6, v[32:35] offset:16384
    s_waitcnt vmcnt(10)
    ds_write_b128 v6, v[36:39] offset:17408
    s_waitcnt vmcnt(9)
    ds_write_b128 v6, v[40:43] offset:18432
    s_waitcnt vmcnt(8)
    ds_write_b128 v6, v[44:47] offset:19456
    s_waitcnt vmcnt(7)
    ds_write_b128 v6, v[48:51] offset:32768
    s_waitcnt vmcnt(6)
    ds_write_b128 v6, v[52:55] offset:33792
    s_waitcnt vmcnt(5)
    ds_write_b128 v6, v[56:59] offset:34816
    s_waitcnt vmcnt(4)
    ds_write_b128 v6, v[60:63] offset:35840
    s_waitcnt vmcnt(3)
    ds_write_b128 v6, v[64:67] offset:49152
    s_waitcnt vmcnt(2)
    ds_write_b128 v6, v[68:71] offset:50176
    s_waitcnt vmcnt(1)
    ds_write_b128 v6, v[72:75] offset:51200
    s_waitcnt vmcnt(0)
    ds_write_b128 v6, v[76:79] offset:52224
    s_waitcnt lgkmcnt(0)
    s_barrier
    ds_read_b64_tr_b16 v[80:81], v10 offset:0
    ds_read_b64_tr_b16 v[82:83], v10 offset:1024
    ds_read_b64_tr_b16 v[84:85], v11 offset:0
    ds_read_b64_tr_b16 v[86:87], v11 offset:1024
    ds_read_b64_tr_b16 v[88:89], v12 offset:0
    ds_read_b64_tr_b16 v[90:91], v12 offset:1024
    ds_read_b64_tr_b16 v[92:93], v13 offset:0
    ds_read_b64_tr_b16 v[94:95], v13 offset:1024
    ds_read_b64_tr_b16 v[96:97], v10 offset:16384
    ds_read_b64_tr_b16 v[98:99], v10 offset:17408
    ds_read_b64_tr_b16 v[100:101], v11 offset:16384
    ds_read_b64_tr_b16 v[102:103], v11 offset:17408
    ds_read_b64_tr_b16 v[104:105], v12 offset:16384
    ds_read_b64_tr_b16 v[106:107], v12 offset:17408
    ds_read_b64_tr_b16 v[108:109], v13 offset:16384
    ds_read_b64_tr_b16 v[110:111], v13 offset:17408
    ds_read_b64_tr_b16 v[112:113], v10 offset:32768
    ds_read_b64_tr_b16 v[114:115], v10 offset:33792
    ds_read_b64_tr_b16 v[116:117], v11 offset:32768
    ds_read_b64_tr_b16 v[118:119], v11 offset:33792
    ds_read_b64_tr_b16 v[120:121], v12 offset:32768
    ds_read_b64_tr_b16 v[122:123], v12 offset:33792
    ds_read_b64_tr_b16 v[124:125], v13 offset:32768
    ds_read_b64_tr_b16 v[126:127], v13 offset:33792
    ds_read_b64_tr_b16 v[128:129], v10 offset:49152
    ds_read_b64_tr_b16 v[130:131], v10 offset:50176
    ds_read_b64_tr_b16 v[132:133], v11 offset:49152
    ds_read_b64_tr_b16 v[134:135], v11 offset:50176
    ds_read_b64_tr_b16 v[136:137], v12 offset:49152
    ds_read_b64_tr_b16 v[138:139], v12 offset:50176
    ds_read_b64_tr_b16 v[140:141], v13 offset:49152
    ds_read_b64_tr_b16 v[142:143], v13 offset:50176
    s_lshl_b32 s25, s4, 11
    s_add_u32 s25, s25, s24
    s_add_u32 s25, s25, 0
    s_waitcnt lgkmcnt(15)
    buffer_store_dwordx4 v[80:83], v2, s[8:11], s25 offen sc1
    s_lshl_b32 s25, s4, 11
    s_add_u32 s25, s25, s24
    s_add_u32 s25, s25, 262144
    buffer_store_dwordx4 v[84:87], v2, s[8:11], s25 offen sc1
    s_lshl_b32 s25, s4, 11
    s_add_u32 s25, s25, s24
    s_add_u32 s25, s25, 1024
    buffer_store_dwordx4 v[88:91], v2, s[8:11], s25 offen sc1
    s_lshl_b32 s25, s4, 11
    s_add_u32 s25, s25, s24
    s_add_u32 s25, s25, 263168
    buffer_store_dwordx4 v[92:95], v2, s[8:11], s25 offen sc1
    s_lshl_b32 s25, s4, 11
    s_add_u32 s25, s25, s24
    s_add_u32 s25, s25, 8192
    buffer_store_dwordx4 v[96:99], v2, s[8:11], s25 offen sc1
    s_lshl_b32 s25, s4, 11
    s_add_u32 s25, s25, s24
    s_add_u32 s25, s25, 270336
    buffer_store_dwordx4 v[100:103], v2, s[8:11], s25 offen sc1
    s_lshl_b32 s25, s4, 11
    s_add_u32 s25, s25, s24
    s_add_u32 s25, s25, 9216
    buffer_store_dwordx4 v[104:107], v2, s[8:11], s25 offen sc1
    s_lshl_b32 s25, s4, 11
    s_add_u32 s25, s25, s24
    s_add_u32 s25, s25, 271360
    buffer_store_dwordx4 v[108:111], v2, s[8:11], s25 offen sc1
    s_lshl_b32 s25, s4, 11
    s_add_u32 s25, s25, s24
    s_add_u32 s25, s25, 16384
    s_waitcnt lgkmcnt(14)
    buffer_store_dwordx4 v[112:115], v2, s[8:11], s25 offen sc1
    s_lshl_b32 s25, s4, 11
    s_add_u32 s25, s25, s24
    s_add_u32 s25, s25, 278528
    s_waitcnt lgkmcnt(12)
    buffer_store_dwordx4 v[116:119], v2, s[8:11], s25 offen sc1
    s_lshl_b32 s25, s4, 11
    s_add_u32 s25, s25, s24
    s_add_u32 s25, s25, 17408
    s_waitcnt lgkmcnt(10)
    buffer_store_dwordx4 v[120:123], v2, s[8:11], s25 offen sc1
    s_lshl_b32 s25, s4, 11
    s_add_u32 s25, s25, s24
    s_add_u32 s25, s25, 279552
    s_waitcnt lgkmcnt(8)
    buffer_store_dwordx4 v[124:127], v2, s[8:11], s25 offen sc1
    s_lshl_b32 s25, s4, 11
    s_add_u32 s25, s25, s24
    s_add_u32 s25, s25, 24576
    s_waitcnt lgkmcnt(6)
    buffer_store_dwordx4 v[128:131], v2, s[8:11], s25 offen sc1
    s_lshl_b32 s25, s4, 11
    s_add_u32 s25, s25, s24
    s_add_u32 s25, s25, 286720
    s_waitcnt lgkmcnt(4)
    buffer_store_dwordx4 v[132:135], v2, s[8:11], s25 offen sc1
    s_lshl_b32 s25, s4, 11
    s_add_u32 s25, s25, s24
    s_add_u32 s25, s25, 25600
    s_waitcnt lgkmcnt(2)
    buffer_store_dwordx4 v[136:139], v2, s[8:11], s25 offen sc1
    s_lshl_b32 s25, s4, 11
    s_add_u32 s25, s25, s24
    s_add_u32 s25, s25, 287744
    s_waitcnt lgkmcnt(0)
    buffer_store_dwordx4 v[140:143], v2, s[8:11], s25 offen sc1
    s_waitcnt vmcnt(0) lgkmcnt(0)
    s_barrier
    s_branch t0d_174
t0n_180:
    s_cmp_ge_u32 s6, 400
    s_cbranch_scc1 t0n_181
    s_sub_u32 s20, s6, 320
    s_lshl_b32 s20, s20, 2
    s_add_u32 s20, s20, s4
    s_sub_u32 s20, s6, 320
    s_load_dwordx2 s[16:17], s[0:1], 64
    s_waitcnt lgkmcnt(0)
    s_mov_b32 s12, s16
    s_and_b32 s13, s17, 0xffff
    s_mov_b32 s14, 5242880
    s_mov_b32 s15, 0x00020000
    s_mul_hi_u32 s21, s20, 858993460
    s_mul_i32 s25, s21, 5
    s_sub_u32 s22, s20, s25
    s_mul_i32 s23, s21, 327680
    s_lshl_b32 s25, s22, 8
    s_add_u32 s23, s23, s25
    s_mul_i32 s24, s21, 327680
    s_lshl_b32 s25, s22, 13
    s_add_u32 s24, s24, s25
    s_add_u32 s24, s24, 91226112
    v_lshrrev_b32 v9, 4, v1
    s_lshl_b32 s25, s4, 4
    v_add_u32 v9, s25, v9
    v_mul_u32_u24 v5, 1280, v9
    v_lshl_add_u32 v5, v3, 4, v5
    v_lshlrev_b32 v6, 8, v9
    v_and_b32 v9, 3, v9
    v_lshlrev_b32 v9, 1, v9
    s_lshr_b32 s25, s4, 1
    s_lshl_b32 s25, s25, 3
    v_add_u32 v9, s25, v9
    v_xor_b32 v9, v9, v3
    v_lshl_add_u32 v6, v9, 4, v6
    v_bfe_u32 v9, v1, 2, 2
    v_lshlrev_b32 v14, 1, v9
    v_add_u32 v14, 0, v14
    s_lshl_b32 s25, s4, 2
    s_add_u32 s25, s25, 0
    v_bfe_u32 v15, v1, 1, 1
    v_add_u32 v15, s25, v15
    v_xor_b32 v14, v14, v15
    v_lshlrev_b32 v14, 4, v14
    v_and_b32 v15, 1, v1
    v_lshl_add_u32 v14, v15, 3, v14
    v_lshl_add_u32 v9, v4, 2, v9
    v_add_u32 v9, 0, v9
    v_lshl_add_u32 v10, v9, 8, v14
    v_bfe_u32 v9, v1, 2, 2
    v_lshlrev_b32 v14, 1, v9
    v_add_u32 v14, 8, v14
    s_lshl_b32 s25, s4, 2
    s_add_u32 s25, s25, 0
    v_bfe_u32 v15, v1, 1, 1
    v_add_u32 v15, s25, v15
    v_xor_b32 v14, v14, v15
    v_lshlrev_b32 v14, 4, v14
    v_and_b32 v15, 1, v1
    v_lshl_add_u32 v14, v15, 3, v14
    v_lshl_add_u32 v9, v4, 2, v9
    v_add_u32 v9, 32, v9
    v_lshl_add_u32 v11, v9, 8, v14
    v_bfe_u32 v9, v1, 2, 2
    v_lshlrev_b32 v14, 1, v9
    v_add_u32 v14, 0, v14
    s_lshl_b32 s25, s4, 2
    s_add_u32 s25, s25, 2
    v_bfe_u32 v15, v1, 1, 1
    v_add_u32 v15, s25, v15
    v_xor_b32 v14, v14, v15
    v_lshlrev_b32 v14, 4, v14
    v_and_b32 v15, 1, v1
    v_lshl_add_u32 v14, v15, 3, v14
    v_lshl_add_u32 v9, v4, 2, v9
    v_add_u32 v9, 0, v9
    v_lshl_add_u32 v12, v9, 8, v14
    v_bfe_u32 v9, v1, 2, 2
    v_lshlrev_b32 v14, 1, v9
    v_add_u32 v14, 8, v14
    s_lshl_b32 s25, s4, 2
    s_add_u32 s25, s25, 2
    v_bfe_u32 v15, v1, 1, 1
    v_add_u32 v15, s25, v15
    v_xor_b32 v14, v14, v15
    v_lshlrev_b32 v14, 4, v14
    v_and_b32 v15, 1, v1
    v_lshl_add_u32 v14, v15, 3, v14
    v_lshl_add_u32 v9, v4, 2, v9
    v_add_u32 v9, 32, v9
    v_lshl_add_u32 v13, v9, 8, v14
    s_add_u32 s30, s23, 0
    s_add_u32 s25, s30, 0
    buffer_load_dwordx4 v[16:19], v5, s[12:15], s25 offen
    s_add_u32 s25, s30, 5120
    buffer_load_dwordx4 v[20:23], v5, s[12:15], s25 offen
    s_add_u32 s25, s30, 10240
    buffer_load_dwordx4 v[24:27], v5, s[12:15], s25 offen
    s_add_u32 s25, s30, 15360
    buffer_load_dwordx4 v[28:31], v5, s[12:15], s25 offen
    s_add_u32 s31, s23, 81920
    s_add_u32 s25, s31, 0
    buffer_load_dwordx4 v[32:35], v5, s[12:15], s25 offen
    s_add_u32 s25, s31, 5120
    buffer_load_dwordx4 v[36:39], v5, s[12:15], s25 offen
    s_add_u32 s25, s31, 10240
    buffer_load_dwordx4 v[40:43], v5, s[12:15], s25 offen
    s_add_u32 s25, s31, 15360
    buffer_load_dwordx4 v[44:47], v5, s[12:15], s25 offen
    s_add_u32 s32, s23, 163840
    s_add_u32 s25, s32, 0
    buffer_load_dwordx4 v[48:51], v5, s[12:15], s25 offen
    s_add_u32 s25, s32, 5120
    buffer_load_dwordx4 v[52:55], v5, s[12:15], s25 offen
    s_add_u32 s25, s32, 10240
    buffer_load_dwordx4 v[56:59], v5, s[12:15], s25 offen
    s_add_u32 s25, s32, 15360
    buffer_load_dwordx4 v[60:63], v5, s[12:15], s25 offen
    s_add_u32 s33, s23, 245760
    s_add_u32 s25, s33, 0
    buffer_load_dwordx4 v[64:67], v5, s[12:15], s25 offen
    s_add_u32 s25, s33, 5120
    buffer_load_dwordx4 v[68:71], v5, s[12:15], s25 offen
    s_add_u32 s25, s33, 10240
    buffer_load_dwordx4 v[72:75], v5, s[12:15], s25 offen
    s_add_u32 s25, s33, 15360
    buffer_load_dwordx4 v[76:79], v5, s[12:15], s25 offen
    s_waitcnt vmcnt(15)
    ds_write_b128 v6, v[16:19] offset:0
    s_waitcnt vmcnt(14)
    ds_write_b128 v6, v[20:23] offset:1024
    s_waitcnt vmcnt(13)
    ds_write_b128 v6, v[24:27] offset:2048
    s_waitcnt vmcnt(12)
    ds_write_b128 v6, v[28:31] offset:3072
    s_waitcnt vmcnt(11)
    ds_write_b128 v6, v[32:35] offset:16384
    s_waitcnt vmcnt(10)
    ds_write_b128 v6, v[36:39] offset:17408
    s_waitcnt vmcnt(9)
    ds_write_b128 v6, v[40:43] offset:18432
    s_waitcnt vmcnt(8)
    ds_write_b128 v6, v[44:47] offset:19456
    s_waitcnt vmcnt(7)
    ds_write_b128 v6, v[48:51] offset:32768
    s_waitcnt vmcnt(6)
    ds_write_b128 v6, v[52:55] offset:33792
    s_waitcnt vmcnt(5)
    ds_write_b128 v6, v[56:59] offset:34816
    s_waitcnt vmcnt(4)
    ds_write_b128 v6, v[60:63] offset:35840
    s_waitcnt vmcnt(3)
    ds_write_b128 v6, v[64:67] offset:49152
    s_waitcnt vmcnt(2)
    ds_write_b128 v6, v[68:71] offset:50176
    s_waitcnt vmcnt(1)
    ds_write_b128 v6, v[72:75] offset:51200
    s_waitcnt vmcnt(0)
    ds_write_b128 v6, v[76:79] offset:52224
    s_waitcnt lgkmcnt(0)
    s_barrier
    ds_read_b64_tr_b16 v[80:81], v10 offset:0
    ds_read_b64_tr_b16 v[82:83], v10 offset:4096
    ds_read_b64_tr_b16 v[84:85], v11 offset:0
    ds_read_b64_tr_b16 v[86:87], v11 offset:4096
    ds_read_b64_tr_b16 v[88:89], v12 offset:0
    ds_read_b64_tr_b16 v[90:91], v12 offset:4096
    ds_read_b64_tr_b16 v[92:93], v13 offset:0
    ds_read_b64_tr_b16 v[94:95], v13 offset:4096
    ds_read_b64_tr_b16 v[96:97], v10 offset:16384
    ds_read_b64_tr_b16 v[98:99], v10 offset:20480
    ds_read_b64_tr_b16 v[100:101], v11 offset:16384
    ds_read_b64_tr_b16 v[102:103], v11 offset:20480
    ds_read_b64_tr_b16 v[104:105], v12 offset:16384
    ds_read_b64_tr_b16 v[106:107], v12 offset:20480
    ds_read_b64_tr_b16 v[108:109], v13 offset:16384
    ds_read_b64_tr_b16 v[110:111], v13 offset:20480
    ds_read_b64_tr_b16 v[112:113], v10 offset:32768
    ds_read_b64_tr_b16 v[114:115], v10 offset:36864
    ds_read_b64_tr_b16 v[116:117], v11 offset:32768
    ds_read_b64_tr_b16 v[118:119], v11 offset:36864
    ds_read_b64_tr_b16 v[120:121], v12 offset:32768
    ds_read_b64_tr_b16 v[122:123], v12 offset:36864
    ds_read_b64_tr_b16 v[124:125], v13 offset:32768
    ds_read_b64_tr_b16 v[126:127], v13 offset:36864
    ds_read_b64_tr_b16 v[128:129], v10 offset:49152
    ds_read_b64_tr_b16 v[130:131], v10 offset:53248
    ds_read_b64_tr_b16 v[132:133], v11 offset:49152
    ds_read_b64_tr_b16 v[134:135], v11 offset:53248
    ds_read_b64_tr_b16 v[136:137], v12 offset:49152
    ds_read_b64_tr_b16 v[138:139], v12 offset:53248
    ds_read_b64_tr_b16 v[140:141], v13 offset:49152
    ds_read_b64_tr_b16 v[142:143], v13 offset:53248
    s_lshl_b32 s25, s4, 11
    s_add_u32 s25, s25, s24
    s_add_u32 s25, s25, 0
    s_waitcnt lgkmcnt(15)
    buffer_store_dwordx4 v[80:83], v2, s[8:11], s25 offen sc1
    s_lshl_b32 s25, s4, 11
    s_add_u32 s25, s25, s24
    s_add_u32 s25, s25, 40960
    buffer_store_dwordx4 v[84:87], v2, s[8:11], s25 offen sc1
    s_lshl_b32 s25, s4, 11
    s_add_u32 s25, s25, s24
    s_add_u32 s25, s25, 1024
    buffer_store_dwordx4 v[88:91], v2, s[8:11], s25 offen sc1
    s_lshl_b32 s25, s4, 11
    s_add_u32 s25, s25, s24
    s_add_u32 s25, s25, 41984
    buffer_store_dwordx4 v[92:95], v2, s[8:11], s25 offen sc1
    s_lshl_b32 s25, s4, 11
    s_add_u32 s25, s25, s24
    s_add_u32 s25, s25, 81920
    buffer_store_dwordx4 v[96:99], v2, s[8:11], s25 offen sc1
    s_lshl_b32 s25, s4, 11
    s_add_u32 s25, s25, s24
    s_add_u32 s25, s25, 122880
    buffer_store_dwordx4 v[100:103], v2, s[8:11], s25 offen sc1
    s_lshl_b32 s25, s4, 11
    s_add_u32 s25, s25, s24
    s_add_u32 s25, s25, 82944
    buffer_store_dwordx4 v[104:107], v2, s[8:11], s25 offen sc1
    s_lshl_b32 s25, s4, 11
    s_add_u32 s25, s25, s24
    s_add_u32 s25, s25, 123904
    buffer_store_dwordx4 v[108:111], v2, s[8:11], s25 offen sc1
    s_lshl_b32 s25, s4, 11
    s_add_u32 s25, s25, s24
    s_add_u32 s25, s25, 163840
    s_waitcnt lgkmcnt(14)
    buffer_store_dwordx4 v[112:115], v2, s[8:11], s25 offen sc1
    s_lshl_b32 s25, s4, 11
    s_add_u32 s25, s25, s24
    s_add_u32 s25, s25, 204800
    s_waitcnt lgkmcnt(12)
    buffer_store_dwordx4 v[116:119], v2, s[8:11], s25 offen sc1
    s_lshl_b32 s25, s4, 11
    s_add_u32 s25, s25, s24
    s_add_u32 s25, s25, 164864
    s_waitcnt lgkmcnt(10)
    buffer_store_dwordx4 v[120:123], v2, s[8:11], s25 offen sc1
    s_lshl_b32 s25, s4, 11
    s_add_u32 s25, s25, s24
    s_add_u32 s25, s25, 205824
    s_waitcnt lgkmcnt(8)
    buffer_store_dwordx4 v[124:127], v2, s[8:11], s25 offen sc1
    s_lshl_b32 s25, s4, 11
    s_add_u32 s25, s25, s24
    s_add_u32 s25, s25, 245760
    s_waitcnt lgkmcnt(6)
    buffer_store_dwordx4 v[128:131], v2, s[8:11], s25 offen sc1
    s_lshl_b32 s25, s4, 11
    s_add_u32 s25, s25, s24
    s_add_u32 s25, s25, 286720
    s_waitcnt lgkmcnt(4)
    buffer_store_dwordx4 v[132:135], v2, s[8:11], s25 offen sc1
    s_lshl_b32 s25, s4, 11
    s_add_u32 s25, s25, s24
    s_add_u32 s25, s25, 246784
    s_waitcnt lgkmcnt(2)
    buffer_store_dwordx4 v[136:139], v2, s[8:11], s25 offen sc1
    s_lshl_b32 s25, s4, 11
    s_add_u32 s25, s25, s24
    s_add_u32 s25, s25, 287744
    s_waitcnt lgkmcnt(0)
    buffer_store_dwordx4 v[140:143], v2, s[8:11], s25 offen sc1
    s_waitcnt vmcnt(0) lgkmcnt(0)
    s_barrier
    s_branch t0d_174
t0n_181:
    s_cmp_ge_u32 s6, 420
    s_cbranch_scc1 t0n_182
    s_sub_u32 s20, s6, 400
    s_lshl_b32 s20, s20, 2
    s_add_u32 s20, s20, s4
    s_load_dwordx2 s[16:17], s[0:1], 16
    s_waitcnt lgkmcnt(0)
    s_mov_b32 s12, s16
    s_and_b32 s13, s17, 0xffff
    s_mov_b32 s14, 819200
    s_mov_b32 s15, 0x00020000
    s_cmp_ge_u32 s20, 40
    s_cselect_b32 s21, 1, 0
    s_mul_i32 s22, s21, 40
    s_sub_u32 s22, s20, s22
    v_mul_u32_u24 v5, 5120, v4
    v_lshl_add_u32 v5, v3, 1, v5
    s_lshl_b32 s25, s22, 5
    s_mul_i32 s24, s21, 409600
    s_add_u32 s25, s25, s24
    v_add_u32 v5, s25, v5
    v_mov_b32 v6, 0x7ff00000
    v_cmp_eq_u32 vcc, 0, v4
    s_nop 1
    v_cndmask_b32 v6, v6, v5, vcc
    v_add_u32 v8, 0, v5
    v_add_u32 v9, 1280, v5
    v_add_u32 v10, 2560, v5
    v_add_u32 v11, 3840, v5
    v_add_u32 v12, 20480, v6
    v_add_u32 v13, 21760, v6
    v_add_u32 v14, 23040, v6
    v_add_u32 v15, 24320, v6
    s_lshl_b32 s23, s22, 10
    s_mul_i32 s25, s21, 655360
    s_add_u32 s23, s23, s25
    s_add_u32 s23, s23, 97517568
    s_mov_b32 s30, 0
    buffer_load_ushort v32, v8, s[12:15], s30 offen
    buffer_load_ushort v33, v9, s[12:15], s30 offen
    buffer_load_ushort v34, v10, s[12:15], s30 offen
    buffer_load_ushort v35, v11, s[12:15], s30 offen
    buffer_load_ushort v36, v12, s[12:15], s30 offen
    buffer_load_ushort v37, v13, s[12:15], s30 offen
    buffer_load_ushort v38, v14, s[12:15], s30 offen
    buffer_load_ushort v39, v15, s[12:15], s30 offen
    s_mov_b32 s31, 25600
    buffer_load_ushort v40, v8, s[12:15], s31 offen
    buffer_load_ushort v41, v9, s[12:15], s31 offen
    buffer_load_ushort v42, v10, s[12:15], s31 offen
    buffer_load_ushort v43, v11, s[12:15], s31 offen
    buffer_load_ushort v44, v12, s[12:15], s31 offen
    buffer_load_ushort v45, v13, s[12:15], s31 offen
    buffer_load_ushort v46, v14, s[12:15], s31 offen
    buffer_load_ushort v47, v15, s[12:15], s31 offen
    s_mov_b32 s32, 51200
    buffer_load_ushort v48, v8, s[12:15], s32 offen
    buffer_load_ushort v49, v9, s[12:15], s32 offen
    buffer_load_ushort v50, v10, s[12:15], s32 offen
    buffer_load_ushort v51, v11, s[12:15], s32 offen
    buffer_load_ushort v52, v12, s[12:15], s32 offen
    buffer_load_ushort v53, v13, s[12:15], s32 offen
    buffer_load_ushort v54, v14, s[12:15], s32 offen
    buffer_load_ushort v55, v15, s[12:15], s32 offen
    s_mov_b32 s33, 76800
    buffer_load_ushort v56, v8, s[12:15], s33 offen
    buffer_load_ushort v57, v9, s[12:15], s33 offen
    buffer_load_ushort v58, v10, s[12:15], s33 offen
    buffer_load_ushort v59, v11, s[12:15], s33 offen
    buffer_load_ushort v60, v12, s[12:15], s33 offen
    buffer_load_ushort v61, v13, s[12:15], s33 offen
    buffer_load_ushort v62, v14, s[12:15], s33 offen
    buffer_load_ushort v63, v15, s[12:15], s33 offen
    s_mov_b32 s34, 102400
    buffer_load_ushort v64, v8, s[12:15], s34 offen
    buffer_load_ushort v65, v9, s[12:15], s34 offen
    buffer_load_ushort v66, v10, s[12:15], s34 offen
    buffer_load_ushort v67, v11, s[12:15], s34 offen
    buffer_load_ushort v68, v12, s[12:15], s34 offen
    buffer_load_ushort v69, v13, s[12:15], s34 offen
    buffer_load_ushort v70, v14, s[12:15], s34 offen
    buffer_load_ushort v71, v15, s[12:15], s34 offen
    s_mov_b32 s35, 128000
    buffer_load_ushort v72, v8, s[12:15], s35 offen
    buffer_load_ushort v73, v9, s[12:15], s35 offen
    buffer_load_ushort v74, v10, s[12:15], s35 offen
    buffer_load_ushort v75, v11, s[12:15], s35 offen
    buffer_load_ushort v76, v12, s[12:15], s35 offen
    buffer_load_ushort v77, v13, s[12:15], s35 offen
    buffer_load_ushort v78, v14, s[12:15], s35 offen
    buffer_load_ushort v79, v15, s[12:15], s35 offen
    s_mov_b32 s36, 153600
    buffer_load_ushort v80, v8, s[12:15], s36 offen
    buffer_load_ushort v81, v9, s[12:15], s36 offen
    buffer_load_ushort v82, v10, s[12:15], s36 offen
    buffer_load_ushort v83, v11, s[12:15], s36 offen
    buffer_load_ushort v84, v12, s[12:15], s36 offen
    buffer_load_ushort v85, v13, s[12:15], s36 offen
    buffer_load_ushort v86, v14, s[12:15], s36 offen
    buffer_load_ushort v87, v15, s[12:15], s36 offen
    s_mov_b32 s37, 179200
    buffer_load_ushort v88, v8, s[12:15], s37 offen
    buffer_load_ushort v89, v9, s[12:15], s37 offen
    buffer_load_ushort v90, v10, s[12:15], s37 offen
    buffer_load_ushort v91, v11, s[12:15], s37 offen
    buffer_load_ushort v92, v12, s[12:15], s37 offen
    buffer_load_ushort v93, v13, s[12:15], s37 offen
    buffer_load_ushort v94, v14, s[12:15], s37 offen
    buffer_load_ushort v95, v15, s[12:15], s37 offen
    s_mov_b32 s38, 204800
    buffer_load_ushort v96, v8, s[12:15], s38 offen
    buffer_load_ushort v97, v9, s[12:15], s38 offen
    buffer_load_ushort v98, v10, s[12:15], s38 offen
    buffer_load_ushort v99, v11, s[12:15], s38 offen
    buffer_load_ushort v100, v12, s[12:15], s38 offen
    buffer_load_ushort v101, v13, s[12:15], s38 offen
    buffer_load_ushort v102, v14, s[12:15], s38 offen
    buffer_load_ushort v103, v15, s[12:15], s38 offen
    s_mov_b32 s39, 230400
    buffer_load_ushort v104, v8, s[12:15], s39 offen
    buffer_load_ushort v105, v9, s[12:15], s39 offen
    buffer_load_ushort v106, v10, s[12:15], s39 offen
    buffer_load_ushort v107, v11, s[12:15], s39 offen
    buffer_load_ushort v108, v12, s[12:15], s39 offen
    buffer_load_ushort v109, v13, s[12:15], s39 offen
    buffer_load_ushort v110, v14, s[12:15], s39 offen
    buffer_load_ushort v111, v15, s[12:15], s39 offen
    s_mov_b32 s40, 256000
    buffer_load_ushort v112, v8, s[12:15], s40 offen
    buffer_load_ushort v113, v9, s[12:15], s40 offen
    buffer_load_ushort v114, v10, s[12:15], s40 offen
    buffer_load_ushort v115, v11, s[12:15], s40 offen
    buffer_load_ushort v116, v12, s[12:15], s40 offen
    buffer_load_ushort v117, v13, s[12:15], s40 offen
    buffer_load_ushort v118, v14, s[12:15], s40 offen
    buffer_load_ushort v119, v15, s[12:15], s40 offen
    s_mov_b32 s41, 281600
    buffer_load_ushort v120, v8, s[12:15], s41 offen
    buffer_load_ushort v121, v9, s[12:15], s41 offen
    buffer_load_ushort v122, v10, s[12:15], s41 offen
    buffer_load_ushort v123, v11, s[12:15], s41 offen
    buffer_load_ushort v124, v12, s[12:15], s41 offen
    buffer_load_ushort v125, v13, s[12:15], s41 offen
    buffer_load_ushort v126, v14, s[12:15], s41 offen
    buffer_load_ushort v127, v15, s[12:15], s41 offen
    s_mov_b32 s42, 307200
    buffer_load_ushort v128, v8, s[12:15], s42 offen
    buffer_load_ushort v129, v9, s[12:15], s42 offen
    buffer_load_ushort v130, v10, s[12:15], s42 offen
    buffer_load_ushort v131, v11, s[12:15], s42 offen
    buffer_load_ushort v132, v12, s[12:15], s42 offen
    buffer_load_ushort v133, v13, s[12:15], s42 offen
    buffer_load_ushort v134, v14, s[12:15], s42 offen
    buffer_load_ushort v135, v15, s[12:15], s42 offen
    s_mov_b32 s43, 332800
    buffer_load_ushort v136, v8, s[12:15], s43 offen
    buffer_load_ushort v137, v9, s[12:15], s43 offen
    buffer_load_ushort v138, v10, s[12:15], s43 offen
    buffer_load_ushort v139, v11, s[12:15], s43 offen
    buffer_load_ushort v140, v12, s[12:15], s43 offen
    buffer_load_ushort v141, v13, s[12:15], s43 offen
    buffer_load_ushort v142, v14, s[12:15], s43 offen
    buffer_load_ushort v143, v15, s[12:15], s43 offen
    s_mov_b32 s44, 358400
    buffer_load_ushort v144, v8, s[12:15], s44 offen
    buffer_load_ushort v145, v9, s[12:15], s44 offen
    buffer_load_ushort v146, v10, s[12:15], s44 offen
    buffer_load_ushort v147, v11, s[12:15], s44 offen
    buffer_load_ushort v148, v12, s[12:15], s44 offen
    buffer_load_ushort v149, v13, s[12:15], s44 offen
    buffer_load_ushort v150, v14, s[12:15], s44 offen
    buffer_load_ushort v151, v15, s[12:15], s44 offen
    s_mov_b32 s45, 384000
    buffer_load_ushort v152, v8, s[12:15], s45 offen
    buffer_load_ushort v153, v9, s[12:15], s45 offen
    buffer_load_ushort v154, v10, s[12:15], s45 offen
    buffer_load_ushort v155, v11, s[12:15], s45 offen
    buffer_load_ushort v156, v12, s[12:15], s45 offen
    buffer_load_ushort v157, v13, s[12:15], s45 offen
    buffer_load_ushort v158, v14, s[12:15], s45 offen
    buffer_load_ushort v159, v15, s[12:15], s45 offen
    s_waitcnt vmcnt(63)
    v_lshl_or_b32 v16, v33, 16, v32
    v_lshl_or_b32 v17, v35, 16, v34
    v_lshl_or_b32 v18, v37, 16, v36
    v_lshl_or_b32 v19, v39, 16, v38
    s_add_u32 s25, s23, 0
    buffer_store_dwordx4 v[16:19], v2, s[8:11], s25 offen sc1
    v_lshl_or_b32 v20, v41, 16, v40
    v_lshl_or_b32 v21, v43, 16, v42
    v_lshl_or_b32 v22, v45, 16, v44
    v_lshl_or_b32 v23, v47, 16, v46
    s_add_u32 s25, s23, 40960
    buffer_store_dwordx4 v[20:23], v2, s[8:11], s25 offen sc1
    v_lshl_or_b32 v24, v49, 16, v48
    v_lshl_or_b32 v25, v51, 16, v50
    v_lshl_or_b32 v26, v53, 16, v52
    v_lshl_or_b32 v27, v55, 16, v54
    s_add_u32 s25, s23, 81920
    buffer_store_dwordx4 v[24:27], v2, s[8:11], s25 offen sc1
    v_lshl_or_b32 v28, v57, 16, v56
    v_lshl_or_b32 v29, v59, 16, v58
    v_lshl_or_b32 v30, v61, 16, v60
    v_lshl_or_b32 v31, v63, 16, v62
    s_add_u32 s25, s23, 122880
    buffer_store_dwordx4 v[28:31], v2, s[8:11], s25 offen sc1
    v_lshl_or_b32 v16, v65, 16, v64
    v_lshl_or_b32 v17, v67, 16, v66
    v_lshl_or_b32 v18, v69, 16, v68
    v_lshl_or_b32 v19, v71, 16, v70
    s_add_u32 s25, s23, 163840
    buffer_store_dwordx4 v[16:19], v2, s[8:11], s25 offen sc1
    v_lshl_or_b32 v20, v73, 16, v72
    v_lshl_or_b32 v21, v75, 16, v74
    v_lshl_or_b32 v22, v77, 16, v76
    v_lshl_or_b32 v23, v79, 16, v78
    s_add_u32 s25, s23, 204800
    buffer_store_dwordx4 v[20:23], v2, s[8:11], s25 offen sc1
    v_lshl_or_b32 v24, v81, 16, v80
    v_lshl_or_b32 v25, v83, 16, v82
    v_lshl_or_b32 v26, v85, 16, v84
    v_lshl_or_b32 v27, v87, 16, v86
    s_add_u32 s25, s23, 245760
    buffer_store_dwordx4 v[24:27], v2, s[8:11], s25 offen sc1
    v_lshl_or_b32 v28, v89, 16, v88
    v_lshl_or_b32 v29, v91, 16, v90
    v_lshl_or_b32 v30, v93, 16, v92
    v_lshl_or_b32 v31, v95, 16, v94
    s_add_u32 s25, s23, 286720
    buffer_store_dwordx4 v[28:31], v2, s[8:11], s25 offen sc1
    s_waitcnt vmcnt(63)
    v_lshl_or_b32 v16, v97, 16, v96
    v_lshl_or_b32 v17, v99, 16, v98
    v_lshl_or_b32 v18, v101, 16, v100
    v_lshl_or_b32 v19, v103, 16, v102
    s_add_u32 s25, s23, 327680
    buffer_store_dwordx4 v[16:19], v2, s[8:11], s25 offen sc1
    s_waitcnt vmcnt(63)
    v_lshl_or_b32 v20, v105, 16, v104
    s_waitcnt vmcnt(61)
    v_lshl_or_b32 v21, v107, 16, v106
    s_waitcnt vmcnt(59)
    v_lshl_or_b32 v22, v109, 16, v108
    s_waitcnt vmcnt(57)
    v_lshl_or_b32 v23, v111, 16, v110
    s_add_u32 s25, s23, 368640
    buffer_store_dwordx4 v[20:23], v2, s[8:11], s25 offen sc1
    s_waitcnt vmcnt(56)
    v_lshl_or_b32 v24, v113, 16, v112
    s_waitcnt vmcnt(54)
    v_lshl_or_b32 v25, v115, 16, v114
    s_waitcnt vmcnt(52)
    v_lshl_or_b32 v26, v117, 16, v116
    s_waitcnt vmcnt(50)
    v_lshl_or_b32 v27, v119, 16, v118
    s_add_u32 s25, s23, 409600
    buffer_store_dwordx4 v[24:27], v2, s[8:11], s25 offen sc1
    s_waitcnt vmcnt(49)
    v_lshl_or_b32 v28, v121, 16, v120
    s_waitcnt vmcnt(47)
    v_lshl_or_b32 v29, v123, 16, v122
    s_waitcnt vmcnt(45)
    v_lshl_or_b32 v30, v125, 16, v124
    s_waitcnt vmcnt(43)
    v_lshl_or_b32 v31, v127, 16, v126
    s_add_u32 s25, s23, 450560
    buffer_store_dwordx4 v[28:31], v2, s[8:11], s25 offen sc1
    s_waitcnt vmcnt(42)
    v_lshl_or_b32 v16, v129, 16, v128
    s_waitcnt vmcnt(40)
    v_lshl_or_b32 v17, v131, 16, v130
    s_waitcnt vmcnt(38)
    v_lshl_or_b32 v18, v133, 16, v132
    s_waitcnt vmcnt(36)
    v_lshl_or_b32 v19, v135, 16, v134
    s_add_u32 s25, s23, 491520
    buffer_store_dwordx4 v[16:19], v2, s[8:11], s25 offen sc1
    s_waitcnt vmcnt(35)
    v_lshl_or_b32 v20, v137, 16, v136
    s_waitcnt vmcnt(33)
    v_lshl_or_b32 v21, v139, 16, v138
    s_waitcnt vmcnt(31)
    v_lshl_or_b32 v22, v141, 16, v140
    s_waitcnt vmcnt(29)
    v_lshl_or_b32 v23, v143, 16, v142
    s_add_u32 s25, s23, 532480
    buffer_store_dwordx4 v[20:23], v2, s[8:11], s25 offen sc1
    s_waitcnt vmcnt(28)
    v_lshl_or_b32 v24, v145, 16, v144
    s_waitcnt vmcnt(26)
    v_lshl_or_b32 v25, v147, 16, v146
    s_waitcnt vmcnt(24)
    v_lshl_or_b32 v26, v149, 16, v148
    s_waitcnt vmcnt(22)
    v_lshl_or_b32 v27, v151, 16, v150
    s_add_u32 s25, s23, 573440
    buffer_store_dwordx4 v[24:27], v2, s[8:11], s25 offen sc1
    s_waitcnt vmcnt(21)
    v_lshl_or_b32 v28, v153, 16, v152
    s_waitcnt vmcnt(19)
    v_lshl_or_b32 v29, v155, 16, v154
    s_waitcnt vmcnt(17)
    v_lshl_or_b32 v30, v157, 16, v156
    s_waitcnt vmcnt(15)
    v_lshl_or_b32 v31, v159, 16, v158
    s_add_u32 s25, s23, 614400
    buffer_store_dwordx4 v[28:31], v2, s[8:11], s25 offen sc1
    s_waitcnt vmcnt(0)
    s_branch t0d_174
t0n_182:
t0d_174:
    s_mov_b32 s21, 0x10000
    s_cmp_lt_u32 s6, 192
    s_cselect_b32 s20, 0x10001, s21
    s_cmp_lg_u32 s4, 0
    s_cbranch_scc1 tki_183
    s_lshl_b32 s93, s83, 2
    s_add_u32 s93, s93, 176
    v_mov_b32 v250, s93
    v_mov_b32 v251, 1
    s_mov_b64 exec, 1
    global_atomic_add v249, v250, v251, s[98:99] sc0 sc1
    s_mov_b64 exec, -1
tki_183:
    s_waitcnt vmcnt(0) lgkmcnt(0)
    s_barrier
    s_cmp_lg_u32 s4, 0
    s_cbranch_scc1 sig_184
    v_mov_b32 v250, 12
    v_mov_b32 v251, s20
    s_mov_b64 exec, 1
    global_atomic_add v250, v251, s[98:99] sc1
    s_mov_b64 exec, -1
sig_184:
    s_branch L_next
LKDK_103:
    s_load_dwordx2 s[16:17], s[0:1], 48
    s_waitcnt lgkmcnt(0)
    s_mov_b32 s12, s16
    s_and_b32 s13, s17, 0xffff
    s_mov_b32 s14, 5242880
    s_mov_b32 s15, 0x00020000
    s_load_dwordx2 s[16:17], s[0:1], 0
    s_waitcnt lgkmcnt(0)
    s_mov_b32 s28, s16
    s_and_b32 s29, s17, 0xffff
    s_mov_b32 s30, 2621440
    s_mov_b32 s31, 0x00020000
    s_and_b32 s20, s4, 1
    s_lshr_b32 s26, s4, 1
    s_lshl_b32 s21, s7, 8
    s_lshl_b32 s22, s5, 1
    s_add_u32 s22, s22, s26
    s_mul_i32 s22, s22, 40960
    v_lshrrev_b32 v9, 4, v1
    s_lshl_b32 s25, s4, 4
    v_add_u32 v9, s25, v9
    v_mul_u32_u24 v5, 8192, v9
    v_lshl_add_u32 v5, v3, 4, v5
    v_lshlrev_b32 v6, 8, v9
    v_and_b32 v9, 3, v9
    v_lshlrev_b32 v9, 1, v9
    s_lshr_b32 s25, s4, 1
    s_lshl_b32 s25, s25, 3
    v_add_u32 v9, s25, v9
    v_xor_b32 v9, v9, v3
    v_lshl_add_u32 v6, v9, 4, v6
    v_mul_u32_u24 v7, 1280, v3
    v_lshl_add_u32 v7, v4, 4, v7
    v_add_u32 v8, 20480, v7
    v_bfe_u32 v9, v1, 2, 2
    v_lshlrev_b32 v18, 1, v9
    v_add_u32 v18, 0, v18
    s_lshl_b32 s25, s20, 3
    s_add_u32 s25, s25, 0
    v_bfe_u32 v19, v1, 1, 1
    v_add_u32 v19, s25, v19
    v_xor_b32 v18, v18, v19
    v_lshlrev_b32 v18, 4, v18
    v_and_b32 v19, 1, v1
    v_lshl_add_u32 v18, v19, 3, v18
    v_lshl_add_u32 v9, v4, 3, v9
    v_add_u32 v9, 0, v9
    v_lshl_add_u32 v10, v9, 8, v18
    v_bfe_u32 v9, v1, 2, 2
    v_lshlrev_b32 v18, 1, v9
    v_add_u32 v18, 8, v18
    s_lshl_b32 s25, s20, 3
    s_add_u32 s25, s25, 0
    v_bfe_u32 v19, v1, 1, 1
    v_add_u32 v19, s25, v19
    v_xor_b32 v18, v18, v19
    v_lshlrev_b32 v18, 4, v18
    v_and_b32 v19, 1, v1
    v_lshl_add_u32 v18, v19, 3, v18
    v_lshl_add_u32 v9, v4, 3, v9
    v_add_u32 v9, 32, v9
    v_lshl_add_u32 v11, v9, 8, v18
    v_bfe_u32 v9, v1, 2, 2
    v_lshlrev_b32 v18, 1, v9
    v_add_u32 v18, 0, v18
    s_lshl_b32 s25, s20, 3
    s_add_u32 s25, s25, 2
    v_bfe_u32 v19, v1, 1, 1
    v_add_u32 v19, s25, v19
    v_xor_b32 v18, v18, v19
    v_lshlrev_b32 v18, 4, v18
    v_and_b32 v19, 1, v1
    v_lshl_add_u32 v18, v19, 3, v18
    v_lshl_add_u32 v9, v4, 3, v9
    v_add_u32 v9, 0, v9
    v_lshl_add_u32 v12, v9, 8, v18
    v_bfe_u32 v9, v1, 2, 2
    v_lshlrev_b32 v18, 1, v9
    v_add_u32 v18, 8, v18
    s_lshl_b32 s25, s20, 3
    s_add_u32 s25, s25, 2
    v_bfe_u32 v19, v1, 1, 1
    v_add_u32 v19, s25, v19
    v_xor_b32 v18, v18, v19
    v_lshlrev_b32 v18, 4, v18
    v_and_b32 v19, 1, v1
    v_lshl_add_u32 v18, v19, 3, v18
    v_lshl_add_u32 v9, v4, 3, v9
    v_add_u32 v9, 32, v9
    v_lshl_add_u32 v13, v9, 8, v18
    v_bfe_u32 v9, v1, 2, 2
    v_lshlrev_b32 v18, 1, v9
    v_add_u32 v18, 0, v18
    s_lshl_b32 s25, s20, 3
    s_add_u32 s25, s25, 4
    v_bfe_u32 v19, v1, 1, 1
    v_add_u32 v19, s25, v19
    v_xor_b32 v18, v18, v19
    v_lshlrev_b32 v18, 4, v18
    v_and_b32 v19, 1, v1
    v_lshl_add_u32 v18, v19, 3, v18
    v_lshl_add_u32 v9, v4, 3, v9
    v_add_u32 v9, 0, v9
    v_lshl_add_u32 v14, v9, 8, v18
    v_bfe_u32 v9, v1, 2, 2
    v_lshlrev_b32 v18, 1, v9
    v_add_u32 v18, 8, v18
    s_lshl_b32 s25, s20, 3
    s_add_u32 s25, s25, 4
    v_bfe_u32 v19, v1, 1, 1
    v_add_u32 v19, s25, v19
    v_xor_b32 v18, v18, v19
    v_lshlrev_b32 v18, 4, v18
    v_and_b32 v19, 1, v1
    v_lshl_add_u32 v18, v19, 3, v18
    v_lshl_add_u32 v9, v4, 3, v9
    v_add_u32 v9, 32, v9
    v_lshl_add_u32 v15, v9, 8, v18
    v_bfe_u32 v9, v1, 2, 2
    v_lshlrev_b32 v18, 1, v9
    v_add_u32 v18, 0, v18
    s_lshl_b32 s25, s20, 3
    s_add_u32 s25, s25, 6
    v_bfe_u32 v19, v1, 1, 1
    v_add_u32 v19, s25, v19
    v_xor_b32 v18, v18, v19
    v_lshlrev_b32 v18, 4, v18
    v_and_b32 v19, 1, v1
    v_lshl_add_u32 v18, v19, 3, v18
    v_lshl_add_u32 v9, v4, 3, v9
    v_add_u32 v9, 0, v9
    v_lshl_add_u32 v16, v9, 8, v18
    v_bfe_u32 v9, v1, 2, 2
    v_lshlrev_b32 v18, 1, v9
    v_add_u32 v18, 8, v18
    s_lshl_b32 s25, s20, 3
    s_add_u32 s25, s25, 6
    v_bfe_u32 v19, v1, 1, 1
    v_add_u32 v19, s25, v19
    v_xor_b32 v18, v18, v19
    v_lshlrev_b32 v18, 4, v18
    v_and_b32 v19, 1, v1
    v_lshl_add_u32 v18, v19, 3, v18
    v_lshl_add_u32 v9, v4, 3, v9
    v_add_u32 v9, 32, v9
    v_lshl_add_u32 v17, v9, 8, v18
    v_mov_b32 v116, 0
    v_mov_b32 v117, 0
    v_mov_b32 v118, 0
    v_mov_b32 v119, 0
    v_mov_b32 v120, 0
    v_mov_b32 v121, 0
    v_mov_b32 v122, 0
    v_mov_b32 v123, 0
    v_mov_b32 v124, 0
    v_mov_b32 v125, 0
    v_mov_b32 v126, 0
    v_mov_b32 v127, 0
    v_mov_b32 v128, 0
    v_mov_b32 v129, 0
    v_mov_b32 v130, 0
    v_mov_b32 v131, 0
    v_mov_b32 v132, 0
    v_mov_b32 v133, 0
    v_mov_b32 v134, 0
    v_mov_b32 v135, 0
    v_mov_b32 v136, 0
    v_mov_b32 v137, 0
    v_mov_b32 v138, 0
    v_mov_b32 v139, 0
    v_mov_b32 v140, 0
    v_mov_b32 v141, 0
    v_mov_b32 v142, 0
    v_mov_b32 v143, 0
    v_mov_b32 v144, 0
    v_mov_b32 v145, 0
    v_mov_b32 v146, 0
    v_mov_b32 v147, 0
    s_add_u32 s25, s21, 0
    buffer_load_dwordx4 v[20:23], v5, s[12:15], s25 offen
    s_add_u32 s25, s21, 32768
    buffer_load_dwordx4 v[24:27], v5, s[12:15], s25 offen
    s_add_u32 s25, s21, 65536
    buffer_load_dwordx4 v[28:31], v5, s[12:15], s25 offen
    s_add_u32 s25, s21, 98304
    buffer_load_dwordx4 v[32:35], v5, s[12:15], s25 offen
    buffer_load_dwordx4 v[52:55], v7, s[28:31], s22 offen offset:0
    buffer_load_dwordx4 v[56:59], v8, s[28:31], s22 offen offset:0
    buffer_load_dwordx4 v[60:63], v7, s[28:31], s22 offen offset:64
    buffer_load_dwordx4 v[64:67], v8, s[28:31], s22 offen offset:64
    s_add_u32 s21, s21, 524288
    s_add_u32 s22, s22, 128
    s_add_u32 s25, s21, 0
    buffer_load_dwordx4 v[36:39], v5, s[12:15], s25 offen
    s_add_u32 s25, s21, 32768
    buffer_load_dwordx4 v[40:43], v5, s[12:15], s25 offen
    s_add_u32 s25, s21, 65536
    buffer_load_dwordx4 v[44:47], v5, s[12:15], s25 offen
    s_add_u32 s25, s21, 98304
    buffer_load_dwordx4 v[48:51], v5, s[12:15], s25 offen
    buffer_load_dwordx4 v[68:71], v7, s[28:31], s22 offen offset:0
    buffer_load_dwordx4 v[72:75], v8, s[28:31], s22 offen offset:0
    buffer_load_dwordx4 v[76:79], v7, s[28:31], s22 offen offset:64
    buffer_load_dwordx4 v[80:83], v8, s[28:31], s22 offen offset:64
    s_add_u32 s21, s21, 524288
    s_add_u32 s22, s22, 128
    s_mov_b32 s23, 0
kdl_185:
    s_waitcnt vmcnt(15)
    ds_write_b128 v6, v[20:23] offset:0
    s_waitcnt vmcnt(14)
    ds_write_b128 v6, v[24:27] offset:1024
    s_waitcnt vmcnt(13)
    ds_write_b128 v6, v[28:31] offset:2048
    s_waitcnt vmcnt(12)
    ds_write_b128 v6, v[32:35] offset:3072
    s_waitcnt lgkmcnt(0)
    s_barrier
    ds_read_b64_tr_b16 v[84:85], v10 offset:0
    ds_read_b64_tr_b16 v[86:87], v10 offset:1024
    ds_read_b64_tr_b16 v[88:89], v11 offset:0
    ds_read_b64_tr_b16 v[90:91], v11 offset:1024
    ds_read_b64_tr_b16 v[92:93], v12 offset:0
    ds_read_b64_tr_b16 v[94:95], v12 offset:1024
    ds_read_b64_tr_b16 v[96:97], v13 offset:0
    ds_read_b64_tr_b16 v[98:99], v13 offset:1024
    ds_read_b64_tr_b16 v[100:101], v14 offset:0
    ds_read_b64_tr_b16 v[102:103], v14 offset:1024
    ds_read_b64_tr_b16 v[104:105], v15 offset:0
    ds_read_b64_tr_b16 v[106:107], v15 offset:1024
    ds_read_b64_tr_b16 v[108:109], v16 offset:0
    ds_read_b64_tr_b16 v[110:111], v16 offset:1024
    ds_read_b64_tr_b16 v[112:113], v17 offset:0
    ds_read_b64_tr_b16 v[114:115], v17 offset:1024
    s_waitcnt vmcnt(11) lgkmcnt(14)
    v_mfma_f32_16x16x32_bf16 v[116:119], v[84:87], v[52:55], v[116:119]
    s_waitcnt vmcnt(10)
    v_mfma_f32_16x16x32_bf16 v[120:123], v[84:87], v[56:59], v[120:123]
    s_waitcnt lgkmcnt(10)
    v_mfma_f32_16x16x32_bf16 v[124:127], v[92:95], v[52:55], v[124:127]
    v_mfma_f32_16x16x32_bf16 v[128:131], v[92:95], v[56:59], v[128:131]
    s_waitcnt lgkmcnt(6)
    v_mfma_f32_16x16x32_bf16 v[132:135], v[100:103], v[52:55], v[132:135]
    v_mfma_f32_16x16x32_bf16 v[136:139], v[100:103], v[56:59], v[136:139]
    s_waitcnt lgkmcnt(2)
    v_mfma_f32_16x16x32_bf16 v[140:143], v[108:111], v[52:55], v[140:143]
    v_mfma_f32_16x16x32_bf16 v[144:147], v[108:111], v[56:59], v[144:147]
    s_waitcnt vmcnt(9)
    v_mfma_f32_16x16x32_bf16 v[116:119], v[88:91], v[60:63], v[116:119]
    s_waitcnt vmcnt(8)
    v_mfma_f32_16x16x32_bf16 v[120:123], v[88:91], v[64:67], v[120:123]
    v_mfma_f32_16x16x32_bf16 v[124:127], v[96:99], v[60:63], v[124:127]
    v_mfma_f32_16x16x32_bf16 v[128:131], v[96:99], v[64:67], v[128:131]
    v_mfma_f32_16x16x32_bf16 v[132:135], v[104:107], v[60:63], v[132:135]
    v_mfma_f32_16x16x32_bf16 v[136:139], v[104:107], v[64:67], v[136:139]
    s_waitcnt lgkmcnt(0)
    v_mfma_f32_16x16x32_bf16 v[140:143], v[112:115], v[60:63], v[140:143]
    v_mfma_f32_16x16x32_bf16 v[144:147], v[112:115], v[64:67], v[144:147]
    s_add_u32 s25, s21, 0
    buffer_load_dwordx4 v[20:23], v5, s[12:15], s25 offen
    s_add_u32 s25, s21, 32768
    buffer_load_dwordx4 v[24:27], v5, s[12:15], s25 offen
    s_add_u32 s25, s21, 65536
    buffer_load_dwordx4 v[28:31], v5, s[12:15], s25 offen
    s_add_u32 s25, s21, 98304
    buffer_load_dwordx4 v[32:35], v5, s[12:15], s25 offen
    buffer_load_dwordx4 v[52:55], v7, s[28:31], s22 offen offset:0
    buffer_load_dwordx4 v[56:59], v8, s[28:31], s22 offen offset:0
    buffer_load_dwordx4 v[60:63], v7, s[28:31], s22 offen offset:64
    buffer_load_dwordx4 v[64:67], v8, s[28:31], s22 offen offset:64
    s_add_u32 s21, s21, 524288
    s_add_u32 s22, s22, 128
    s_waitcnt vmcnt(15)
    ds_write_b128 v6, v[36:39] offset:16384
    s_waitcnt vmcnt(14)
    ds_write_b128 v6, v[40:43] offset:17408
    s_waitcnt vmcnt(13)
    ds_write_b128 v6, v[44:47] offset:18432
    s_waitcnt vmcnt(12)
    ds_write_b128 v6, v[48:51] offset:19456
    s_waitcnt lgkmcnt(0)
    s_barrier
    ds_read_b64_tr_b16 v[84:85], v10 offset:16384
    ds_read_b64_tr_b16 v[86:87], v10 offset:17408
    ds_read_b64_tr_b16 v[88:89], v11 offset:16384
    ds_read_b64_tr_b16 v[90:91], v11 offset:17408
    ds_read_b64_tr_b16 v[92:93], v12 offset:16384
    ds_read_b64_tr_b16 v[94:95], v12 offset:17408
    ds_read_b64_tr_b16 v[96:97], v13 offset:16384
    ds_read_b64_tr_b16 v[98:99], v13 offset:17408
    ds_read_b64_tr_b16 v[100:101], v14 offset:16384
    ds_read_b64_tr_b16 v[102:103], v14 offset:17408
    ds_read_b64_tr_b16 v[104:105], v15 offset:16384
    ds_read_b64_tr_b16 v[106:107], v15 offset:17408
    ds_read_b64_tr_b16 v[108:109], v16 offset:16384
    ds_read_b64_tr_b16 v[110:111], v16 offset:17408
    ds_read_b64_tr_b16 v[112:113], v17 offset:16384
    ds_read_b64_tr_b16 v[114:115], v17 offset:17408
    s_waitcnt vmcnt(11) lgkmcnt(14)
    v_mfma_f32_16x16x32_bf16 v[116:119], v[84:87], v[68:71], v[116:119]
    s_waitcnt vmcnt(10)
    v_mfma_f32_16x16x32_bf16 v[120:123], v[84:87], v[72:75], v[120:123]
    s_waitcnt lgkmcnt(10)
    v_mfma_f32_16x16x32_bf16 v[124:127], v[92:95], v[68:71], v[124:127]
    v_mfma_f32_16x16x32_bf16 v[128:131], v[92:95], v[72:75], v[128:131]
    s_waitcnt lgkmcnt(6)
    v_mfma_f32_16x16x32_bf16 v[132:135], v[100:103], v[68:71], v[132:135]
    v_mfma_f32_16x16x32_bf16 v[136:139], v[100:103], v[72:75], v[136:139]
    s_waitcnt lgkmcnt(2)
    v_mfma_f32_16x16x32_bf16 v[140:143], v[108:111], v[68:71], v[140:143]
    v_mfma_f32_16x16x32_bf16 v[144:147], v[108:111], v[72:75], v[144:147]
    s_waitcnt vmcnt(9)
    v_mfma_f32_16x16x32_bf16 v[116:119], v[88:91], v[76:79], v[116:119]
    s_waitcnt vmcnt(8)
    v_mfma_f32_16x16x32_bf16 v[120:123], v[88:91], v[80:83], v[120:123]
    v_mfma_f32_16x16x32_bf16 v[124:127], v[96:99], v[76:79], v[124:127]
    v_mfma_f32_16x16x32_bf16 v[128:131], v[96:99], v[80:83], v[128:131]
    v_mfma_f32_16x16x32_bf16 v[132:135], v[104:107], v[76:79], v[132:135]
    v_mfma_f32_16x16x32_bf16 v[136:139], v[104:107], v[80:83], v[136:139]
    s_waitcnt lgkmcnt(0)
    v_mfma_f32_16x16x32_bf16 v[140:143], v[112:115], v[76:79], v[140:143]
    v_mfma_f32_16x16x32_bf16 v[144:147], v[112:115], v[80:83], v[144:147]
    s_add_u32 s25, s21, 0
    buffer_load_dwordx4 v[36:39], v5, s[12:15], s25 offen
    s_add_u32 s25, s21, 32768
    buffer_load_dwordx4 v[40:43], v5, s[12:15], s25 offen
    s_add_u32 s25, s21, 65536
    buffer_load_dwordx4 v[44:47], v5, s[12:15], s25 offen
    s_add_u32 s25, s21, 98304
    buffer_load_dwordx4 v[48:51], v5, s[12:15], s25 offen
    buffer_load_dwordx4 v[68:71], v7, s[28:31], s22 offen offset:0
    buffer_load_dwordx4 v[72:75], v8, s[28:31], s22 offen offset:0
    buffer_load_dwordx4 v[76:79], v7, s[28:31], s22 offen offset:64
    buffer_load_dwordx4 v[80:83], v8, s[28:31], s22 offen offset:64
    s_add_u32 s21, s21, 524288
    s_add_u32 s22, s22, 128
    s_add_u32 s23, s23, 2
    s_cmp_lt_u32 s23, 10
    s_nop 3
    s_cbranch_scc1 kdl_185
    s_waitcnt vmcnt(0)
    s_nop 9
    s_lshl_b32 s24, s5, 1
    s_add_u32 s24, s24, s26
    s_lshl_b32 s24, s24, 5
    s_add_u32 s24, s24, s7
    s_lshl_b32 s24, s24, 13
    s_lshl_b32 s25, s20, 11
    s_add_u32 s24, s24, s25
    s_add_u32 s24, s24, 16777216
    v_cvt_pk_bf16_f32 v84, v116, v117
    v_cvt_pk_bf16_f32 v85, v118, v119
    v_cvt_pk_bf16_f32 v86, v124, v125
    v_cvt_pk_bf16_f32 v87, v126, v127
    s_add_u32 s25, s24, 0
    buffer_store_dwordx4 v[84:87], v2, s[8:11], s25 offen sc1
    v_cvt_pk_bf16_f32 v88, v132, v133
    v_cvt_pk_bf16_f32 v89, v134, v135
    v_cvt_pk_bf16_f32 v90, v140, v141
    v_cvt_pk_bf16_f32 v91, v142, v143
    s_add_u32 s25, s24, 1024
    buffer_store_dwordx4 v[88:91], v2, s[8:11], s25 offen sc1
    v_cvt_pk_bf16_f32 v92, v120, v121
    v_cvt_pk_bf16_f32 v93, v122, v123
    v_cvt_pk_bf16_f32 v94, v128, v129
    v_cvt_pk_bf16_f32 v95, v130, v131
    s_add_u32 s25, s24, 4096
    buffer_store_dwordx4 v[92:95], v2, s[8:11], s25 offen sc1
    v_cvt_pk_bf16_f32 v96, v136, v137
    v_cvt_pk_bf16_f32 v97, v138, v139
    v_cvt_pk_bf16_f32 v98, v144, v145
    v_cvt_pk_bf16_f32 v99, v146, v147
    s_add_u32 s25, s24, 5120
    buffer_store_dwordx4 v[96:99], v2, s[8:11], s25 offen sc1
    s_waitcnt vmcnt(0) lgkmcnt(0)
    s_lshl_b32 s21, s5, 3
    s_lshl_b32 s21, 1, s21
    s_cmp_lg_u32 s4, 0
    s_cbranch_scc1 tki_186
    s_lshl_b32 s93, s83, 2
    s_add_u32 s93, s93, 176
    v_mov_b32 v250, s93
    v_mov_b32 v251, 1
    s_mov_b64 exec, 1
    global_atomic_add v249, v250, v251, s[98:99] sc0 sc1
    s_mov_b64 exec, -1
tki_186:
    s_waitcnt vmcnt(0) lgkmcnt(0)
    s_barrier
    s_cmp_lg_u32 s4, 0
    s_cbranch_scc1 sig_187
    v_mov_b32 v250, 252
    v_mov_b32 v251, s21
    s_mov_b64 exec, 1
    global_atomic_add v250, v251, s[98:99] sc1
    s_mov_b64 exec, -1
sig_187:
    s_branch L_next
LKDV_104:
    s_load_dwordx2 s[16:17], s[0:1], 56
    s_waitcnt lgkmcnt(0)
    s_mov_b32 s12, s16
    s_and_b32 s13, s17, 0xffff
    s_mov_b32 s14, 5242880
    s_mov_b32 s15, 0x00020000
    s_load_dwordx2 s[16:17], s[0:1], 0
    s_waitcnt lgkmcnt(0)
    s_mov_b32 s28, s16
    s_and_b32 s29, s17, 0xffff
    s_mov_b32 s30, 2621440
    s_mov_b32 s31, 0x00020000
    s_and_b32 s20, s4, 1
    s_lshr_b32 s26, s4, 1
    s_lshl_b32 s21, s7, 8
    s_lshl_b32 s22, s5, 1
    s_add_u32 s22, s22, s26
    s_mul_i32 s22, s22, 40960
    v_lshrrev_b32 v9, 4, v1
    s_lshl_b32 s25, s4, 4
    v_add_u32 v9, s25, v9
    v_mul_u32_u24 v5, 8192, v9
    v_lshl_add_u32 v5, v3, 4, v5
    v_lshlrev_b32 v6, 8, v9
    v_and_b32 v9, 3, v9
    v_lshlrev_b32 v9, 1, v9
    s_lshr_b32 s25, s4, 1
    s_lshl_b32 s25, s25, 3
    v_add_u32 v9, s25, v9
    v_xor_b32 v9, v9, v3
    v_lshl_add_u32 v6, v9, 4, v6
    v_mul_u32_u24 v7, 1280, v3
    v_lshl_add_u32 v7, v4, 4, v7
    v_add_u32 v8, 20480, v7
    v_bfe_u32 v9, v1, 2, 2
    v_lshlrev_b32 v18, 1, v9
    v_add_u32 v18, 0, v18
    s_lshl_b32 s25, s20, 3
    s_add_u32 s25, s25, 0
    v_bfe_u32 v19, v1, 1, 1
    v_add_u32 v19, s25, v19
    v_xor_b32 v18, v18, v19
    v_lshlrev_b32 v18, 4, v18
    v_and_b32 v19, 1, v1
    v_lshl_add_u32 v18, v19, 3, v18
    v_lshl_add_u32 v9, v4, 3, v9
    v_add_u32 v9, 0, v9
    v_lshl_add_u32 v10, v9, 8, v18
    v_bfe_u32 v9, v1, 2, 2
    v_lshlrev_b32 v18, 1, v9
    v_add_u32 v18, 8, v18
    s_lshl_b32 s25, s20, 3
    s_add_u32 s25, s25, 0
    v_bfe_u32 v19, v1, 1, 1
    v_add_u32 v19, s25, v19
    v_xor_b32 v18, v18, v19
    v_lshlrev_b32 v18, 4, v18
    v_and_b32 v19, 1, v1
    v_lshl_add_u32 v18, v19, 3, v18
    v_lshl_add_u32 v9, v4, 3, v9
    v_add_u32 v9, 32, v9
    v_lshl_add_u32 v11, v9, 8, v18
    v_bfe_u32 v9, v1, 2, 2
    v_lshlrev_b32 v18, 1, v9
    v_add_u32 v18, 0, v18
    s_lshl_b32 s25, s20, 3
    s_add_u32 s25, s25, 2
    v_bfe_u32 v19, v1, 1, 1
    v_add_u32 v19, s25, v19
    v_xor_b32 v18, v18, v19
    v_lshlrev_b32 v18, 4, v18
    v_and_b32 v19, 1, v1
    v_lshl_add_u32 v18, v19, 3, v18
    v_lshl_add_u32 v9, v4, 3, v9
    v_add_u32 v9, 0, v9
    v_lshl_add_u32 v12, v9, 8, v18
    v_bfe_u32 v9, v1, 2, 2
    v_lshlrev_b32 v18, 1, v9
    v_add_u32 v18, 8, v18
    s_lshl_b32 s25, s20, 3
    s_add_u32 s25, s25, 2
    v_bfe_u32 v19, v1, 1, 1
    v_add_u32 v19, s25, v19
    v_xor_b32 v18, v18, v19
    v_lshlrev_b32 v18, 4, v18
    v_and_b32 v19, 1, v1
    v_lshl_add_u32 v18, v19, 3, v18
    v_lshl_add_u32 v9, v4, 3, v9
    v_add_u32 v9, 32, v9
    v_lshl_add_u32 v13, v9, 8, v18
    v_bfe_u32 v9, v1, 2, 2
    v_lshlrev_b32 v18, 1, v9
    v_add_u32 v18, 0, v18
    s_lshl_b32 s25, s20, 3
    s_add_u32 s25, s25, 4
    v_bfe_u32 v19, v1, 1, 1
    v_add_u32 v19, s25, v19
    v_xor_b32 v18, v18, v19
    v_lshlrev_b32 v18, 4, v18
    v_and_b32 v19, 1, v1
    v_lshl_add_u32 v18, v19, 3, v18
    v_lshl_add_u32 v9, v4, 3, v9
    v_add_u32 v9, 0, v9
    v_lshl_add_u32 v14, v9, 8, v18
    v_bfe_u32 v9, v1, 2, 2
    v_lshlrev_b32 v18, 1, v9
    v_add_u32 v18, 8, v18
    s_lshl_b32 s25, s20, 3
    s_add_u32 s25, s25, 4
    v_bfe_u32 v19, v1, 1, 1
    v_add_u32 v19, s25, v19
    v_xor_b32 v18, v18, v19
    v_lshlrev_b32 v18, 4, v18
    v_and_b32 v19, 1, v1
    v_lshl_add_u32 v18, v19, 3, v18
    v_lshl_add_u32 v9, v4, 3, v9
    v_add_u32 v9, 32, v9
    v_lshl_add_u32 v15, v9, 8, v18
    v_bfe_u32 v9, v1, 2, 2
    v_lshlrev_b32 v18, 1, v9
    v_add_u32 v18, 0, v18
    s_lshl_b32 s25, s20, 3
    s_add_u32 s25, s25, 6
    v_bfe_u32 v19, v1, 1, 1
    v_add_u32 v19, s25, v19
    v_xor_b32 v18, v18, v19
    v_lshlrev_b32 v18, 4, v18
    v_and_b32 v19, 1, v1
    v_lshl_add_u32 v18, v19, 3, v18
    v_lshl_add_u32 v9, v4, 3, v9
    v_add_u32 v9, 0, v9
    v_lshl_add_u32 v16, v9, 8, v18
    v_bfe_u32 v9, v1, 2, 2
    v_lshlrev_b32 v18, 1, v9
    v_add_u32 v18, 8, v18
    s_lshl_b32 s25, s20, 3
    s_add_u32 s25, s25, 6
    v_bfe_u32 v19, v1, 1, 1
    v_add_u32 v19, s25, v19
    v_xor_b32 v18, v18, v19
    v_lshlrev_b32 v18, 4, v18
    v_and_b32 v19, 1, v1
    v_lshl_add_u32 v18, v19, 3, v18
    v_lshl_add_u32 v9, v4, 3, v9
    v_add_u32 v9, 32, v9
    v_lshl_add_u32 v17, v9, 8, v18
    v_mov_b32 v116, 0
    v_mov_b32 v117, 0
    v_mov_b32 v118, 0
    v_mov_b32 v119, 0
    v_mov_b32 v120, 0
    v_mov_b32 v121, 0
    v_mov_b32 v122, 0
    v_mov_b32 v123, 0
    v_mov_b32 v124, 0
    v_mov_b32 v125, 0
    v_mov_b32 v126, 0
    v_mov_b32 v127, 0
    v_mov_b32 v128, 0
    v_mov_b32 v129, 0
    v_mov_b32 v130, 0
    v_mov_b32 v131, 0
    v_mov_b32 v132, 0
    v_mov_b32 v133, 0
    v_mov_b32 v134, 0
    v_mov_b32 v135, 0
    v_mov_b32 v136, 0
    v_mov_b32 v137, 0
    v_mov_b32 v138, 0
    v_mov_b32 v139, 0
    v_mov_b32 v140, 0
    v_mov_b32 v141, 0
    v_mov_b32 v142, 0
    v_mov_b32 v143, 0
    v_mov_b32 v144, 0
    v_mov_b32 v145, 0
    v_mov_b32 v146, 0
    v_mov_b32 v147, 0
    s_add_u32 s25, s21, 0
    buffer_load_dwordx4 v[20:23], v5, s[12:15], s25 offen
    s_add_u32 s25, s21, 32768
    buffer_load_dwordx4 v[24:27], v5, s[12:15], s25 offen
    s_add_u32 s25, s21, 65536
    buffer_load_dwordx4 v[28:31], v5, s[12:15], s25 offen
    s_add_u32 s25, s21, 98304
    buffer_load_dwordx4 v[32:35], v5, s[12:15], s25 offen
    buffer_load_dwordx4 v[52:55], v7, s[28:31], s22 offen offset:0
    buffer_load_dwordx4 v[56:59], v8, s[28:31], s22 offen offset:0
    buffer_load_dwordx4 v[60:63], v7, s[28:31], s22 offen offset:64
    buffer_load_dwordx4 v[64:67], v8, s[28:31], s22 offen offset:64
    s_add_u32 s21, s21, 524288
    s_add_u32 s22, s22, 128
    s_add_u32 s25, s21, 0
    buffer_load_dwordx4 v[36:39], v5, s[12:15], s25 offen
    s_add_u32 s25, s21, 32768
    buffer_load_dwordx4 v[40:43], v5, s[12:15], s25 offen
    s_add_u32 s25, s21, 65536
    buffer_load_dwordx4 v[44:47], v5, s[12:15], s25 offen
    s_add_u32 s25, s21, 98304
    buffer_load_dwordx4 v[48:51], v5, s[12:15], s25 offen
    buffer_load_dwordx4 v[68:71], v7, s[28:31], s22 offen offset:0
    buffer_load_dwordx4 v[72:75], v8, s[28:31], s22 offen offset:0
    buffer_load_dwordx4 v[76:79], v7, s[28:31], s22 offen offset:64
    buffer_load_dwordx4 v[80:83], v8, s[28:31], s22 offen offset:64
    s_add_u32 s21, s21, 524288
    s_add_u32 s22, s22, 128
    s_mov_b32 s23, 0
kdl_188:
    s_waitcnt vmcnt(15)
    ds_write_b128 v6, v[20:23] offset:0
    s_waitcnt vmcnt(14)
    ds_write_b128 v6, v[24:27] offset:1024
    s_waitcnt vmcnt(13)
    ds_write_b128 v6, v[28:31] offset:2048
    s_waitcnt vmcnt(12)
    ds_write_b128 v6, v[32:35] offset:3072
    s_waitcnt lgkmcnt(0)
    s_barrier
    ds_read_b64_tr_b16 v[84:85], v10 offset:0
    ds_read_b64_tr_b16 v[86:87], v10 offset:1024
    ds_read_b64_tr_b16 v[88:89], v11 offset:0
    ds_read_b64_tr_b16 v[90:91], v11 offset:1024
    ds_read_b64_tr_b16 v[92:93], v12 offset:0
    ds_read_b64_tr_b16 v[94:95], v12 offset:1024
    ds_read_b64_tr_b16 v[96:97], v13 offset:0
    ds_read_b64_tr_b16 v[98:99], v13 offset:1024
    ds_read_b64_tr_b16 v[100:101], v14 offset:0
    ds_read_b64_tr_b16 v[102:103], v14 offset:1024
    ds_read_b64_tr_b16 v[104:105], v15 offset:0
    ds_read_b64_tr_b16 v[106:107], v15 offset:1024
    ds_read_b64_tr_b16 v[108:109], v16 offset:0
    ds_read_b64_tr_b16 v[110:111], v16 offset:1024
    ds_read_b64_tr_b16 v[112:113], v17 offset:0
    ds_read_b64_tr_b16 v[114:115], v17 offset:1024
    s_waitcnt vmcnt(11) lgkmcnt(14)
    v_mfma_f32_16x16x32_bf16 v[116:119], v[52:55], v[84:87], v[116:119]
    s_waitcnt vmcnt(10)
    v_mfma_f32_16x16x32_bf16 v[120:123], v[56:59], v[84:87], v[120:123]
    s_waitcnt lgkmcnt(10)
    v_mfma_f32_16x16x32_bf16 v[124:127], v[52:55], v[92:95], v[124:127]
    v_mfma_f32_16x16x32_bf16 v[128:131], v[56:59], v[92:95], v[128:131]
    s_waitcnt lgkmcnt(6)
    v_mfma_f32_16x16x32_bf16 v[132:135], v[52:55], v[100:103], v[132:135]
    v_mfma_f32_16x16x32_bf16 v[136:139], v[56:59], v[100:103], v[136:139]
    s_waitcnt lgkmcnt(2)
    v_mfma_f32_16x16x32_bf16 v[140:143], v[52:55], v[108:111], v[140:143]
    v_mfma_f32_16x16x32_bf16 v[144:147], v[56:59], v[108:111], v[144:147]
    s_waitcnt vmcnt(9)
    v_mfma_f32_16x16x32_bf16 v[116:119], v[60:63], v[88:91], v[116:119]
    s_waitcnt vmcnt(8)
    v_mfma_f32_16x16x32_bf16 v[120:123], v[64:67], v[88:91], v[120:123]
    v_mfma_f32_16x16x32_bf16 v[124:127], v[60:63], v[96:99], v[124:127]
    v_mfma_f32_16x16x32_bf16 v[128:131], v[64:67], v[96:99], v[128:131]
    v_mfma_f32_16x16x32_bf16 v[132:135], v[60:63], v[104:107], v[132:135]
    v_mfma_f32_16x16x32_bf16 v[136:139], v[64:67], v[104:107], v[136:139]
    s_waitcnt lgkmcnt(0)
    v_mfma_f32_16x16x32_bf16 v[140:143], v[60:63], v[112:115], v[140:143]
    v_mfma_f32_16x16x32_bf16 v[144:147], v[64:67], v[112:115], v[144:147]
    s_add_u32 s25, s21, 0
    buffer_load_dwordx4 v[20:23], v5, s[12:15], s25 offen
    s_add_u32 s25, s21, 32768
    buffer_load_dwordx4 v[24:27], v5, s[12:15], s25 offen
    s_add_u32 s25, s21, 65536
    buffer_load_dwordx4 v[28:31], v5, s[12:15], s25 offen
    s_add_u32 s25, s21, 98304
    buffer_load_dwordx4 v[32:35], v5, s[12:15], s25 offen
    buffer_load_dwordx4 v[52:55], v7, s[28:31], s22 offen offset:0
    buffer_load_dwordx4 v[56:59], v8, s[28:31], s22 offen offset:0
    buffer_load_dwordx4 v[60:63], v7, s[28:31], s22 offen offset:64
    buffer_load_dwordx4 v[64:67], v8, s[28:31], s22 offen offset:64
    s_add_u32 s21, s21, 524288
    s_add_u32 s22, s22, 128
    s_waitcnt vmcnt(15)
    ds_write_b128 v6, v[36:39] offset:16384
    s_waitcnt vmcnt(14)
    ds_write_b128 v6, v[40:43] offset:17408
    s_waitcnt vmcnt(13)
    ds_write_b128 v6, v[44:47] offset:18432
    s_waitcnt vmcnt(12)
    ds_write_b128 v6, v[48:51] offset:19456
    s_waitcnt lgkmcnt(0)
    s_barrier
    ds_read_b64_tr_b16 v[84:85], v10 offset:16384
    ds_read_b64_tr_b16 v[86:87], v10 offset:17408
    ds_read_b64_tr_b16 v[88:89], v11 offset:16384
    ds_read_b64_tr_b16 v[90:91], v11 offset:17408
    ds_read_b64_tr_b16 v[92:93], v12 offset:16384
    ds_read_b64_tr_b16 v[94:95], v12 offset:17408
    ds_read_b64_tr_b16 v[96:97], v13 offset:16384
    ds_read_b64_tr_b16 v[98:99], v13 offset:17408
    ds_read_b64_tr_b16 v[100:101], v14 offset:16384
    ds_read_b64_tr_b16 v[102:103], v14 offset:17408
    ds_read_b64_tr_b16 v[104:105], v15 offset:16384
    ds_read_b64_tr_b16 v[106:107], v15 offset:17408
    ds_read_b64_tr_b16 v[108:109], v16 offset:16384
    ds_read_b64_tr_b16 v[110:111], v16 offset:17408
    ds_read_b64_tr_b16 v[112:113], v17 offset:16384
    ds_read_b64_tr_b16 v[114:115], v17 offset:17408
    s_waitcnt vmcnt(11) lgkmcnt(14)
    v_mfma_f32_16x16x32_bf16 v[116:119], v[68:71], v[84:87], v[116:119]
    s_waitcnt vmcnt(10)
    v_mfma_f32_16x16x32_bf16 v[120:123], v[72:75], v[84:87], v[120:123]
    s_waitcnt lgkmcnt(10)
    v_mfma_f32_16x16x32_bf16 v[124:127], v[68:71], v[92:95], v[124:127]
    v_mfma_f32_16x16x32_bf16 v[128:131], v[72:75], v[92:95], v[128:131]
    s_waitcnt lgkmcnt(6)
    v_mfma_f32_16x16x32_bf16 v[132:135], v[68:71], v[100:103], v[132:135]
    v_mfma_f32_16x16x32_bf16 v[136:139], v[72:75], v[100:103], v[136:139]
    s_waitcnt lgkmcnt(2)
    v_mfma_f32_16x16x32_bf16 v[140:143], v[68:71], v[108:111], v[140:143]
    v_mfma_f32_16x16x32_bf16 v[144:147], v[72:75], v[108:111], v[144:147]
    s_waitcnt vmcnt(9)
    v_mfma_f32_16x16x32_bf16 v[116:119], v[76:79], v[88:91], v[116:119]
    s_waitcnt vmcnt(8)
    v_mfma_f32_16x16x32_bf16 v[120:123], v[80:83], v[88:91], v[120:123]
    v_mfma_f32_16x16x32_bf16 v[124:127], v[76:79], v[96:99], v[124:127]
    v_mfma_f32_16x16x32_bf16 v[128:131], v[80:83], v[96:99], v[128:131]
    v_mfma_f32_16x16x32_bf16 v[132:135], v[76:79], v[104:107], v[132:135]
    v_mfma_f32_16x16x32_bf16 v[136:139], v[80:83], v[104:107], v[136:139]
    s_waitcnt lgkmcnt(0)
    v_mfma_f32_16x16x32_bf16 v[140:143], v[76:79], v[112:115], v[140:143]
    v_mfma_f32_16x16x32_bf16 v[144:147], v[80:83], v[112:115], v[144:147]
    s_add_u32 s25, s21, 0
    buffer_load_dwordx4 v[36:39], v5, s[12:15], s25 offen
    s_add_u32 s25, s21, 32768
    buffer_load_dwordx4 v[40:43], v5, s[12:15], s25 offen
    s_add_u32 s25, s21, 65536
    buffer_load_dwordx4 v[44:47], v5, s[12:15], s25 offen
    s_add_u32 s25, s21, 98304
    buffer_load_dwordx4 v[48:51], v5, s[12:15], s25 offen
    buffer_load_dwordx4 v[68:71], v7, s[28:31], s22 offen offset:0
    buffer_load_dwordx4 v[72:75], v8, s[28:31], s22 offen offset:0
    buffer_load_dwordx4 v[76:79], v7, s[28:31], s22 offen offset:64
    buffer_load_dwordx4 v[80:83], v8, s[28:31], s22 offen offset:64
    s_add_u32 s21, s21, 524288
    s_add_u32 s22, s22, 128
    s_add_u32 s23, s23, 2
    s_cmp_lt_u32 s23, 10
    s_nop 3
    s_cbranch_scc1 kdl_188
    s_waitcnt vmcnt(0)
    s_nop 9
    s_lshl_b32 s24, s5, 1
    s_add_u32 s24, s24, s26
    s_lshl_b32 s24, s24, 5
    s_add_u32 s24, s24, s7
    s_lshl_b32 s24, s24, 13
    s_lshl_b32 s25, s20, 12
    s_add_u32 s24, s24, s25
    s_add_u32 s24, s24, 33554432
    v_cvt_pk_bf16_f32 v84, v116, v117
    v_cvt_pk_bf16_f32 v85, v118, v119
    v_cvt_pk_bf16_f32 v86, v120, v121
    v_cvt_pk_bf16_f32 v87, v122, v123
    s_add_u32 s25, s24, 0
    buffer_store_dwordx4 v[84:87], v2, s[8:11], s25 offen sc1
    v_cvt_pk_bf16_f32 v88, v124, v125
    v_cvt_pk_bf16_f32 v89, v126, v127
    v_cvt_pk_bf16_f32 v90, v128, v129
    v_cvt_pk_bf16_f32 v91, v130, v131
    s_add_u32 s25, s24, 1024
    buffer_store_dwordx4 v[88:91], v2, s[8:11], s25 offen sc1
    v_cvt_pk_bf16_f32 v92, v132, v133
    v_cvt_pk_bf16_f32 v93, v134, v135
    v_cvt_pk_bf16_f32 v94, v136, v137
    v_cvt_pk_bf16_f32 v95, v138, v139
    s_add_u32 s25, s24, 2048
    buffer_store_dwordx4 v[92:95], v2, s[8:11], s25 offen sc1
    v_cvt_pk_bf16_f32 v96, v140, v141
    v_cvt_pk_bf16_f32 v97, v142, v143
    v_cvt_pk_bf16_f32 v98, v144, v145
    v_cvt_pk_bf16_f32 v99, v146, v147
    s_add_u32 s25, s24, 3072
    buffer_store_dwordx4 v[96:99], v2, s[8:11], s25 offen sc1
    s_waitcnt vmcnt(0) lgkmcnt(0)
    s_lshl_b32 s21, s5, 3
    s_lshl_b32 s21, 1, s21
    s_cmp_lg_u32 s4, 0
    s_cbranch_scc1 tki_189
    s_lshl_b32 s93, s83, 2
    s_add_u32 s93, s93, 176
    v_mov_b32 v250, s93
    v_mov_b32 v251, 1
    s_mov_b64 exec, 1
    global_atomic_add v249, v250, v251, s[98:99] sc0 sc1
    s_mov_b64 exec, -1
tki_189:
    s_waitcnt vmcnt(0) lgkmcnt(0)
    s_barrier
    s_cmp_lg_u32 s4, 0
    s_cbranch_scc1 sig_190
    v_mov_b32 v250, 252
    v_mov_b32 v251, s21
    s_mov_b64 exec, 1
    global_atomic_add v250, v251, s[98:99] sc1
    s_mov_b64 exec, -1
sig_190:
    s_branch L_next
LBK_93:
    s_bitcmp1_b32 s92, 0
    s_cbranch_scc1 dep_191
    s_cmp_lg_u32 s4, 0
    s_cbranch_scc1 wfd_193
    v_mov_b32 v250, 12
wf_192:
    global_load_dword v251, v250, s[98:99] sc1
    s_waitcnt vmcnt(0)
    v_lshrrev_b32 v251, 0, v251
    v_and_b32 v251, 0xffff, v251
    v_cmp_gt_u32 vcc, 192, v251
    s_cbranch_vccz wf_192x
    s_sleep 32
    s_branch wf_192
wf_192x:
wfd_193:
    s_cmp_lg_u32 s4, 0
    s_cbranch_scc1 acq_194
    buffer_inv sc1
    s_waitcnt vmcnt(0)
acq_194:
    s_barrier
    s_bitset1_b32 s92, 0
dep_191:
    s_mov_b32 s58, 0
    s_mov_b32 s59, 67108864
    s_mov_b32 s80, 262144
    s_mov_b32 s81, 125829120
    s_mov_b32 s82, 5
    s_branch LMAINCT_101
LBQ_95:
    s_bitcmp1_b32 s92, 1
    s_cbranch_scc1 dep_195
    s_cmp_lg_u32 s4, 0
    s_cbranch_scc1 wfd_197
    v_mov_b32 v250, 12
wf_196:
    global_load_dword v251, v250, s[98:99] sc1
    s_waitcnt vmcnt(0)
    v_lshrrev_b32 v251, 16, v251
    v_and_b32 v251, 0xffff, v251
    v_cmp_gt_u32 vcc, 420, v251
    s_cbranch_vccz wf_196x
    s_sleep 32
    s_branch wf_196
wf_196x:
wfd_197:
    s_cmp_lg_u32 s4, 0
    s_cbranch_scc1 acq_198
    buffer_inv sc1
    s_waitcnt vmcnt(0)
acq_198:
    s_barrier
    s_bitset1_b32 s92, 1
dep_195:
    s_mov_b32 s58, 1
    s_mov_b32 s59, 79691776
    s_mov_b32 s80, 262144
    s_mov_b32 s81, 125829120
    s_mov_b32 s82, 5
    s_branch LMAINCT_101
LAQK_96:
    s_bitcmp1_b32 s92, 1
    s_cbranch_scc1 dep_199
    s_cmp_lg_u32 s4, 0
    s_cbranch_scc1 wfd_201
    v_mov_b32 v250, 12
wf_200:
    global_load_dword v251, v250, s[98:99] sc1
    s_waitcnt vmcnt(0)
    v_lshrrev_b32 v251, 16, v251
    v_and_b32 v251, 0xffff, v251
    v_cmp_gt_u32 vcc, 420, v251
    s_cbranch_vccz wf_200x
    s_sleep 32
    s_branch wf_200
wf_200x:
wfd_201:
    s_cmp_lg_u32 s4, 0
    s_cbranch_scc1 acq_202
    buffer_inv sc1
    s_waitcnt vmcnt(0)
acq_202:
    s_barrier
    s_bitset1_b32 s92, 1
dep_199:
    s_mov_b32 s58, 2
    s_mov_b32 s59, 85983232
    s_mov_b32 s80, 131072
    s_mov_b32 s81, 125829120
    s_mov_b32 s82, 5
    s_branch LMAINCT_101
LBV_94:
    s_bitcmp1_b32 s92, 0
    s_cbranch_scc1 dep_203
    s_cmp_lg_u32 s4, 0
    s_cbranch_scc1 wfd_205
    v_mov_b32 v250, 12
wf_204:
    global_load_dword v251, v250, s[98:99] sc1
    s_waitcnt vmcnt(0)
    v_lshrrev_b32 v251, 0, v251
    v_and_b32 v251, 0xffff, v251
    v_cmp_gt_u32 vcc, 192, v251
    s_cbranch_vccz wf_204x
    s_sleep 32
    s_branch wf_204
wf_204x:
wfd_205:
    s_cmp_lg_u32 s4, 0
    s_cbranch_scc1 acq_206
    buffer_inv sc1
    s_waitcnt vmcnt(0)
acq_206:
    s_barrier
    s_bitset1_b32 s92, 0
dep_203:
    s_mov_b32 s58, 3
    s_mov_b32 s59, 73400320
    s_mov_b32 s80, 262144
    s_mov_b32 s81, 125829120
    s_mov_b32 s82, 5
    s_branch LMAINC_102
LAV_97:
    s_bitcmp1_b32 s92, 1
    s_cbranch_scc1 dep_207
    s_cmp_lg_u32 s4, 0
    s_cbranch_scc1 wfd_209
    v_mov_b32 v250, 12
wf_208:
    global_load_dword v251, v250, s[98:99] sc1
    s_waitcnt vmcnt(0)
    v_lshrrev_b32 v251, 16, v251
    v_and_b32 v251, 0xffff, v251
    v_cmp_gt_u32 vcc, 420, v251
    s_cbranch_vccz wf_208x
    s_sleep 32
    s_branch wf_208
wf_208x:
wfd_209:
    s_cmp_lg_u32 s4, 0
    s_cbranch_scc1 acq_210
    buffer_inv sc1
    s_waitcnt vmcnt(0)
acq_210:
    s_barrier
    s_bitset1_b32 s92, 1
dep_207:
    s_mov_b32 s58, 4
    s_mov_b32 s59, 89128960
    s_mov_b32 s80, 65536
    s_mov_b32 s81, 125829120
    s_mov_b32 s82, 5
    s_branch LMAINC_102
LT4A_99:
    s_lshr_b32 s20, s5, 1
    s_lshl_b32 s20, s20, 2
    s_add_u32 s20, s20, 52
    s_and_b32 s21, s5, 1
    s_lshl_b32 s21, s21, 4
    s_add_u32 s17, s5, 16
    s_bitcmp1_b32 s92, s17
    s_cbranch_scc1 dep_211
    s_cmp_lg_u32 s4, 0
    s_cbranch_scc1 wfd_213
    v_mov_b32 v250, s20
wf_212:
    global_load_dword v251, v250, s[98:99] sc1
    s_waitcnt vmcnt(0)
    v_lshrrev_b32 v251, s21, v251
    v_and_b32 v251, 0xffff, v251
    v_cmp_gt_u32 vcc, 32, v251
    s_cbranch_vccz wf_212x
    s_sleep 32
    s_branch wf_212
wf_212x:
wfd_213:
    s_cmp_lg_u32 s4, 0
    s_cbranch_scc1 acq_214
    buffer_inv sc1
    s_waitcnt vmcnt(0)
acq_214:
    s_barrier
    s_bitset1_b32 s92, s17
dep_211:
    s_mov_b32 s58, 5
    s_mov_b32 s59, 97517568
    s_mov_b32 s80, 40960
    s_mov_b32 s81, 113246208
    s_mov_b32 s82, 8
    s_branch LMAINCT_101
LMAINCT_101:
    s_and_b32 s20, s4, 1
    s_lshr_b32 s21, s4, 1
    s_lshl_b32 s33, s5, 14
    s_lshl_b32 s22, s4, 12
    s_add_u32 s33, s33, s22
    s_add_u32 s33, s33, s81
    s_lshl_b32 s32, s7, 13
    s_lshl_b32 s22, s4, 11
    s_add_u32 s32, s32, s22
    s_add_u32 s32, s32, s59
    s_lshl_b32 s34, s4, 11
    s_lshl_b32 s35, s4, 12
    s_add_u32 s35, s35, 8192
    s_mov_b32 s25, 0
    s_lshl_b32 s22, s20, 12
    v_add_u32 v5, s22, v2
    s_lshl_b32 s22, s21, 13
    s_add_u32 s22, s22, 8192
    v_add_u32 v6, s22, v2
    v_add_u32 v105, 49152, v5
    v_add_u32 v106, 49152, v6
    v_accvgpr_write_b32 a0, 0
    v_accvgpr_write_b32 a1, 0
    v_accvgpr_write_b32 a2, 0
    v_accvgpr_write_b32 a3, 0
    v_accvgpr_write_b32 a4, 0
    v_accvgpr_write_b32 a5, 0
    v_accvgpr_write_b32 a6, 0
    v_accvgpr_write_b32 a7, 0
    v_accvgpr_write_b32 a8, 0
    v_accvgpr_write_b32 a9, 0
    v_accvgpr_write_b32 a10, 0
    v_accvgpr_write_b32 a11, 0
    v_accvgpr_write_b32 a12, 0
    v_accvgpr_write_b32 a13, 0
    v_accvgpr_write_b32 a14, 0
    v_accvgpr_write_b32 a15, 0
    v_accvgpr_write_b32 a16, 0
    v_accvgpr_write_b32 a17, 0
    v_accvgpr_write_b32 a18, 0
    v_accvgpr_write_b32 a19, 0
    v_accvgpr_write_b32 a20, 0
    v_accvgpr_write_b32 a21, 0
    v_accvgpr_write_b32 a22, 0
    v_accvgpr_write_b32 a23, 0
    v_accvgpr_write_b32 a24, 0
    v_accvgpr_write_b32 a25, 0
    v_accvgpr_write_b32 a26, 0
    v_accvgpr_write_b32 a27, 0
    v_accvgpr_write_b32 a28, 0
    v_accvgpr_write_b32 a29, 0
    v_accvgpr_write_b32 a30, 0
    v_accvgpr_write_b32 a31, 0
    v_accvgpr_write_b32 a32, 0
    v_accvgpr_write_b32 a33, 0
    v_accvgpr_write_b32 a34, 0
    v_accvgpr_write_b32 a35, 0
    v_accvgpr_write_b32 a36, 0
    v_accvgpr_write_b32 a37, 0
    v_accvgpr_write_b32 a38, 0
    v_accvgpr_write_b32 a39, 0
    v_accvgpr_write_b32 a40, 0
    v_accvgpr_write_b32 a41, 0
    v_accvgpr_write_b32 a42, 0
    v_accvgpr_write_b32 a43, 0
    v_accvgpr_write_b32 a44, 0
    v_accvgpr_write_b32 a45, 0
    v_accvgpr_write_b32 a46, 0
    v_accvgpr_write_b32 a47, 0
    v_accvgpr_write_b32 a48, 0
    v_accvgpr_write_b32 a49, 0
    v_accvgpr_write_b32 a50, 0
    v_accvgpr_write_b32 a51, 0
    v_accvgpr_write_b32 a52, 0
    v_accvgpr_write_b32 a53, 0
    v_accvgpr_write_b32 a54, 0
    v_accvgpr_write_b32 a55, 0
    v_accvgpr_write_b32 a56, 0
    v_accvgpr_write_b32 a57, 0
    v_accvgpr_write_b32 a58, 0
    v_accvgpr_write_b32 a59, 0
    v_accvgpr_write_b32 a60, 0
    v_accvgpr_write_b32 a61, 0
    v_accvgpr_write_b32 a62, 0
    v_accvgpr_write_b32 a63, 0
    v_accvgpr_write_b32 a64, 0
    v_accvgpr_write_b32 a65, 0
    v_accvgpr_write_b32 a66, 0
    v_accvgpr_write_b32 a67, 0
    v_accvgpr_write_b32 a68, 0
    v_accvgpr_write_b32 a69, 0
    v_accvgpr_write_b32 a70, 0
    v_accvgpr_write_b32 a71, 0
    v_accvgpr_write_b32 a72, 0
    v_accvgpr_write_b32 a73, 0
    v_accvgpr_write_b32 a74, 0
    v_accvgpr_write_b32 a75, 0
    v_accvgpr_write_b32 a76, 0
    v_accvgpr_write_b32 a77, 0
    v_accvgpr_write_b32 a78, 0
    v_accvgpr_write_b32 a79, 0
    v_accvgpr_write_b32 a80, 0
    v_accvgpr_write_b32 a81, 0
    v_accvgpr_write_b32 a82, 0
    v_accvgpr_write_b32 a83, 0
    v_accvgpr_write_b32 a84, 0
    v_accvgpr_write_b32 a85, 0
    v_accvgpr_write_b32 a86, 0
    v_accvgpr_write_b32 a87, 0
    v_accvgpr_write_b32 a88, 0
    v_accvgpr_write_b32 a89, 0
    v_accvgpr_write_b32 a90, 0
    v_accvgpr_write_b32 a91, 0
    v_accvgpr_write_b32 a92, 0
    v_accvgpr_write_b32 a93, 0
    v_accvgpr_write_b32 a94, 0
    v_accvgpr_write_b32 a95, 0
    v_accvgpr_write_b32 a96, 0
    v_accvgpr_write_b32 a97, 0
    v_accvgpr_write_b32 a98, 0
    v_accvgpr_write_b32 a99, 0
    v_accvgpr_write_b32 a100, 0
    v_accvgpr_write_b32 a101, 0
    v_accvgpr_write_b32 a102, 0
    v_accvgpr_write_b32 a103, 0
    v_accvgpr_write_b32 a104, 0
    v_accvgpr_write_b32 a105, 0
    v_accvgpr_write_b32 a106, 0
    v_accvgpr_write_b32 a107, 0
    v_accvgpr_write_b32 a108, 0
    v_accvgpr_write_b32 a109, 0
    v_accvgpr_write_b32 a110, 0
    v_accvgpr_write_b32 a111, 0
    v_accvgpr_write_b32 a112, 0
    v_accvgpr_write_b32 a113, 0
    v_accvgpr_write_b32 a114, 0
    v_accvgpr_write_b32 a115, 0
    v_accvgpr_write_b32 a116, 0
    v_accvgpr_write_b32 a117, 0
    v_accvgpr_write_b32 a118, 0
    v_accvgpr_write_b32 a119, 0
    v_accvgpr_write_b32 a120, 0
    v_accvgpr_write_b32 a121, 0
    v_accvgpr_write_b32 a122, 0
    v_accvgpr_write_b32 a123, 0
    v_accvgpr_write_b32 a124, 0
    v_accvgpr_write_b32 a125, 0
    v_accvgpr_write_b32 a126, 0
    v_accvgpr_write_b32 a127, 0
    s_add_u32 m0, s34, 0
    s_nop 0
    buffer_load_dwordx4 v2, s[8:11], s32 offen offset:0 lds
    buffer_load_dwordx4 v2, s[8:11], s32 offen offset:1024 lds
    s_add_u32 m0, s35, 0
    s_nop 0
    buffer_load_dwordx4 v2, s[8:11], s33 offen offset:0 lds
    buffer_load_dwordx4 v2, s[8:11], s33 offen offset:1024 lds
    buffer_load_dwordx4 v2, s[8:11], s33 offen offset:2048 lds
    buffer_load_dwordx4 v2, s[8:11], s33 offen offset:3072 lds
    s_add_u32 s32, s32, s80
    s_add_u32 s33, s33, 131072
    s_add_u32 m0, s34, 24576
    s_nop 0
    buffer_load_dwordx4 v2, s[8:11], s32 offen offset:0 lds
    buffer_load_dwordx4 v2, s[8:11], s32 offen offset:1024 lds
    s_add_u32 m0, s35, 24576
    s_nop 0
    buffer_load_dwordx4 v2, s[8:11], s33 offen offset:0 lds
    buffer_load_dwordx4 v2, s[8:11], s33 offen offset:1024 lds
    buffer_load_dwordx4 v2, s[8:11], s33 offen offset:2048 lds
    buffer_load_dwordx4 v2, s[8:11], s33 offen offset:3072 lds
    s_add_u32 s32, s32, s80
    s_add_u32 s33, s33, 131072
    s_add_u32 m0, s34, 49152
    s_nop 0
    buffer_load_dwordx4 v2, s[8:11], s32 offen offset:0 lds
    buffer_load_dwordx4 v2, s[8:11], s32 offen offset:1024 lds
    s_add_u32 m0, s35, 49152
    s_nop 0
    buffer_load_dwordx4 v2, s[8:11], s33 offen offset:0 lds
    buffer_load_dwordx4 v2, s[8:11], s33 offen offset:1024 lds
    buffer_load_dwordx4 v2, s[8:11], s33 offen offset:2048 lds
    buffer_load_dwordx4 v2, s[8:11], s33 offen offset:3072 lds
    s_add_u32 s32, s32, s80
    s_add_u32 s33, s33, 131072
    s_add_u32 m0, s34, 73728
    s_nop 0
    buffer_load_dwordx4 v2, s[8:11], s32 offen offset:0 lds
    buffer_load_dwordx4 v2, s[8:11], s32 offen offset:1024 lds
    s_add_u32 m0, s35, 73728
    s_nop 0
    buffer_load_dwordx4 v2, s[8:11], s33 offen offset:0 lds
    buffer_load_dwordx4 v2, s[8:11], s33 offen offset:1024 lds
    buffer_load_dwordx4 v2, s[8:11], s33 offen offset:2048 lds
    buffer_load_dwordx4 v2, s[8:11], s33 offen offset:3072 lds
    s_add_u32 s32, s32, s80
    s_add_u32 s33, s33, 131072
    s_waitcnt vmcnt(18)
    s_barrier
    ds_read_b128 v[8:11], v5 offset:0
    ds_read_b128 v[12:15], v5 offset:1024
    ds_read_b128 v[16:19], v5 offset:2048
    ds_read_b128 v[20:23], v5 offset:3072
    ds_read_b128 v[24:27], v6 offset:0
    ds_read_b128 v[28:31], v6 offset:1024
    ds_read_b128 v[32:35], v6 offset:2048
    ds_read_b128 v[36:39], v6 offset:3072
    ds_read_b128 v[40:43], v6 offset:4096
    ds_read_b128 v[44:47], v6 offset:5120
    ds_read_b128 v[48:51], v6 offset:6144
    ds_read_b128 v[52:55], v6 offset:7168
t1l_215:
    s_waitcnt vmcnt(12) lgkmcnt(0)
    s_barrier
    v_mfma_f32_16x16x32_bf16 a[0:3], v[8:11], v[24:27], a[0:3]
    ds_read_b128 v[56:59], v5 offset:24576
    v_mfma_f32_16x16x32_bf16 a[32:35], v[12:15], v[24:27], a[32:35]
    ds_read_b128 v[60:63], v5 offset:25600
    v_mfma_f32_16x16x32_bf16 a[64:67], v[16:19], v[24:27], a[64:67]
    ds_read_b128 v[64:67], v5 offset:26624
    v_mfma_f32_16x16x32_bf16 a[96:99], v[20:23], v[24:27], a[96:99]
    ds_read_b128 v[68:71], v5 offset:27648
    v_mfma_f32_16x16x32_bf16 a[4:7], v[8:11], v[28:31], a[4:7]
    s_add_u32 m0, s34, 0
    v_mfma_f32_16x16x32_bf16 a[36:39], v[12:15], v[28:31], a[36:39]
    buffer_load_dwordx4 v2, s[8:11], s32 offen offset:0 lds
    v_mfma_f32_16x16x32_bf16 a[68:71], v[16:19], v[28:31], a[68:71]
    buffer_load_dwordx4 v2, s[8:11], s32 offen offset:1024 lds
    v_mfma_f32_16x16x32_bf16 a[100:103], v[20:23], v[28:31], a[100:103]
    s_add_u32 m0, s35, 0
    v_mfma_f32_16x16x32_bf16 a[8:11], v[8:11], v[32:35], a[8:11]
    buffer_load_dwordx4 v2, s[8:11], s33 offen offset:0 lds
    v_mfma_f32_16x16x32_bf16 a[40:43], v[12:15], v[32:35], a[40:43]
    buffer_load_dwordx4 v2, s[8:11], s33 offen offset:1024 lds
    v_mfma_f32_16x16x32_bf16 a[72:75], v[16:19], v[32:35], a[72:75]
    buffer_load_dwordx4 v2, s[8:11], s33 offen offset:2048 lds
    v_mfma_f32_16x16x32_bf16 a[104:107], v[20:23], v[32:35], a[104:107]
    buffer_load_dwordx4 v2, s[8:11], s33 offen offset:3072 lds
    v_mfma_f32_16x16x32_bf16 a[12:15], v[8:11], v[36:39], a[12:15]
    s_add_u32 s32, s32, s80
    v_mfma_f32_16x16x32_bf16 a[44:47], v[12:15], v[36:39], a[44:47]
    s_add_u32 s33, s33, 131072
    v_mfma_f32_16x16x32_bf16 a[76:79], v[16:19], v[36:39], a[76:79]
    ds_read_b128 v[72:75], v6 offset:24576
    v_mfma_f32_16x16x32_bf16 a[108:111], v[20:23], v[36:39], a[108:111]
    ds_read_b128 v[76:79], v6 offset:25600
    v_mfma_f32_16x16x32_bf16 a[16:19], v[8:11], v[40:43], a[16:19]
    ds_read_b128 v[80:83], v6 offset:26624
    v_mfma_f32_16x16x32_bf16 a[48:51], v[12:15], v[40:43], a[48:51]
    ds_read_b128 v[84:87], v6 offset:27648
    v_mfma_f32_16x16x32_bf16 a[80:83], v[16:19], v[40:43], a[80:83]
    ds_read_b128 v[88:91], v6 offset:28672
    v_mfma_f32_16x16x32_bf16 a[112:115], v[20:23], v[40:43], a[112:115]
    ds_read_b128 v[92:95], v6 offset:29696
    v_mfma_f32_16x16x32_bf16 a[20:23], v[8:11], v[44:47], a[20:23]
    ds_read_b128 v[96:99], v6 offset:30720
    v_mfma_f32_16x16x32_bf16 a[52:55], v[12:15], v[44:47], a[52:55]
    ds_read_b128 v[100:103], v6 offset:31744
    v_mfma_f32_16x16x32_bf16 a[84:87], v[16:19], v[44:47], a[84:87]
    v_mfma_f32_16x16x32_bf16 a[116:119], v[20:23], v[44:47], a[116:119]
    v_mfma_f32_16x16x32_bf16 a[24:27], v[8:11], v[48:51], a[24:27]
    v_mfma_f32_16x16x32_bf16 a[56:59], v[12:15], v[48:51], a[56:59]
    v_mfma_f32_16x16x32_bf16 a[88:91], v[16:19], v[48:51], a[88:91]
    v_mfma_f32_16x16x32_bf16 a[120:123], v[20:23], v[48:51], a[120:123]
    v_mfma_f32_16x16x32_bf16 a[28:31], v[8:11], v[52:55], a[28:31]
    v_mfma_f32_16x16x32_bf16 a[60:63], v[12:15], v[52:55], a[60:63]
    v_mfma_f32_16x16x32_bf16 a[92:95], v[16:19], v[52:55], a[92:95]
    v_mfma_f32_16x16x32_bf16 a[124:127], v[20:23], v[52:55], a[124:127]
    s_waitcnt vmcnt(12) lgkmcnt(0)
    s_barrier
    v_mfma_f32_16x16x32_bf16 a[0:3], v[56:59], v[72:75], a[0:3]
    ds_read_b128 v[8:11], v105 offset:0
    v_mfma_f32_16x16x32_bf16 a[32:35], v[60:63], v[72:75], a[32:35]
    ds_read_b128 v[12:15], v105 offset:1024
    v_mfma_f32_16x16x32_bf16 a[64:67], v[64:67], v[72:75], a[64:67]
    ds_read_b128 v[16:19], v105 offset:2048
    v_mfma_f32_16x16x32_bf16 a[96:99], v[68:71], v[72:75], a[96:99]
    ds_read_b128 v[20:23], v105 offset:3072
    v_mfma_f32_16x16x32_bf16 a[4:7], v[56:59], v[76:79], a[4:7]
    s_add_u32 m0, s34, 24576
    v_mfma_f32_16x16x32_bf16 a[36:39], v[60:63], v[76:79], a[36:39]
    buffer_load_dwordx4 v2, s[8:11], s32 offen offset:0 lds
    v_mfma_f32_16x16x32_bf16 a[68:71], v[64:67], v[76:79], a[68:71]
    buffer_load_dwordx4 v2, s[8:11], s32 offen offset:1024 lds
    v_mfma_f32_16x16x32_bf16 a[100:103], v[68:71], v[76:79], a[100:103]
    s_add_u32 m0, s35, 24576
    v_mfma_f32_16x16x32_bf16 a[8:11], v[56:59], v[80:83], a[8:11]
    buffer_load_dwordx4 v2, s[8:11], s33 offen offset:0 lds
    v_mfma_f32_16x16x32_bf16 a[40:43], v[60:63], v[80:83], a[40:43]
    buffer_load_dwordx4 v2, s[8:11], s33 offen offset:1024 lds
    v_mfma_f32_16x16x32_bf16 a[72:75], v[64:67], v[80:83], a[72:75]
    buffer_load_dwordx4 v2, s[8:11], s33 offen offset:2048 lds
    v_mfma_f32_16x16x32_bf16 a[104:107], v[68:71], v[80:83], a[104:107]
    buffer_load_dwordx4 v2, s[8:11], s33 offen offset:3072 lds
    v_mfma_f32_16x16x32_bf16 a[12:15], v[56:59], v[84:87], a[12:15]
    s_add_u32 s32, s32, s80
    v_mfma_f32_16x16x32_bf16 a[44:47], v[60:63], v[84:87], a[44:47]
    s_add_u32 s33, s33, 131072
    v_mfma_f32_16x16x32_bf16 a[76:79], v[64:67], v[84:87], a[76:79]
    ds_read_b128 v[24:27], v106 offset:0
    v_mfma_f32_16x16x32_bf16 a[108:111], v[68:71], v[84:87], a[108:111]
    ds_read_b128 v[28:31], v106 offset:1024
    v_mfma_f32_16x16x32_bf16 a[16:19], v[56:59], v[88:91], a[16:19]
    ds_read_b128 v[32:35], v106 offset:2048
    v_mfma_f32_16x16x32_bf16 a[48:51], v[60:63], v[88:91], a[48:51]
    ds_read_b128 v[36:39], v106 offset:3072
    v_mfma_f32_16x16x32_bf16 a[80:83], v[64:67], v[88:91], a[80:83]
    ds_read_b128 v[40:43], v106 offset:4096
    v_mfma_f32_16x16x32_bf16 a[112:115], v[68:71], v[88:91], a[112:115]
    ds_read_b128 v[44:47], v106 offset:5120
    v_mfma_f32_16x16x32_bf16 a[20:23], v[56:59], v[92:95], a[20:23]
    ds_read_b128 v[48:51], v106 offset:6144
    v_mfma_f32_16x16x32_bf16 a[52:55], v[60:63], v[92:95], a[52:55]
    ds_read_b128 v[52:55], v106 offset:7168
    v_mfma_f32_16x16x32_bf16 a[84:87], v[64:67], v[92:95], a[84:87]
    v_mfma_f32_16x16x32_bf16 a[116:119], v[68:71], v[92:95], a[116:119]
    v_mfma_f32_16x16x32_bf16 a[24:27], v[56:59], v[96:99], a[24:27]
    v_mfma_f32_16x16x32_bf16 a[56:59], v[60:63], v[96:99], a[56:59]
    v_mfma_f32_16x16x32_bf16 a[88:91], v[64:67], v[96:99], a[88:91]
    v_mfma_f32_16x16x32_bf16 a[120:123], v[68:71], v[96:99], a[120:123]
    v_mfma_f32_16x16x32_bf16 a[28:31], v[56:59], v[100:103], a[28:31]
    v_mfma_f32_16x16x32_bf16 a[60:63], v[60:63], v[100:103], a[60:63]
    v_mfma_f32_16x16x32_bf16 a[92:95], v[64:67], v[100:103], a[92:95]
    v_mfma_f32_16x16x32_bf16 a[124:127], v[68:71], v[100:103], a[124:127]
    s_waitcnt vmcnt(12) lgkmcnt(0)
    s_barrier
    v_mfma_f32_16x16x32_bf16 a[0:3], v[8:11], v[24:27], a[0:3]
    ds_read_b128 v[56:59], v105 offset:24576
    v_mfma_f32_16x16x32_bf16 a[32:35], v[12:15], v[24:27], a[32:35]
    ds_read_b128 v[60:63], v105 offset:25600
    v_mfma_f32_16x16x32_bf16 a[64:67], v[16:19], v[24:27], a[64:67]
    ds_read_b128 v[64:67], v105 offset:26624
    v_mfma_f32_16x16x32_bf16 a[96:99], v[20:23], v[24:27], a[96:99]
    ds_read_b128 v[68:71], v105 offset:27648
    v_mfma_f32_16x16x32_bf16 a[4:7], v[8:11], v[28:31], a[4:7]
    s_add_u32 m0, s34, 49152
    v_mfma_f32_16x16x32_bf16 a[36:39], v[12:15], v[28:31], a[36:39]
    buffer_load_dwordx4 v2, s[8:11], s32 offen offset:0 lds
    v_mfma_f32_16x16x32_bf16 a[68:71], v[16:19], v[28:31], a[68:71]
    buffer_load_dwordx4 v2, s[8:11], s32 offen offset:1024 lds
    v_mfma_f32_16x16x32_bf16 a[100:103], v[20:23], v[28:31], a[100:103]
    s_add_u32 m0, s35, 49152
    v_mfma_f32_16x16x32_bf16 a[8:11], v[8:11], v[32:35], a[8:11]
    buffer_load_dwordx4 v2, s[8:11], s33 offen offset:0 lds
    v_mfma_f32_16x16x32_bf16 a[40:43], v[12:15], v[32:35], a[40:43]
    buffer_load_dwordx4 v2, s[8:11], s33 offen offset:1024 lds
    v_mfma_f32_16x16x32_bf16 a[72:75], v[16:19], v[32:35], a[72:75]
    buffer_load_dwordx4 v2, s[8:11], s33 offen offset:2048 lds
    v_mfma_f32_16x16x32_bf16 a[104:107], v[20:23], v[32:35], a[104:107]
    buffer_load_dwordx4 v2, s[8:11], s33 offen offset:3072 lds
    v_mfma_f32_16x16x32_bf16 a[12:15], v[8:11], v[36:39], a[12:15]
    s_add_u32 s32, s32, s80
    v_mfma_f32_16x16x32_bf16 a[44:47], v[12:15], v[36:39], a[44:47]
    s_add_u32 s33, s33, 131072
    v_mfma_f32_16x16x32_bf16 a[76:79], v[16:19], v[36:39], a[76:79]
    ds_read_b128 v[72:75], v106 offset:24576
    v_mfma_f32_16x16x32_bf16 a[108:111], v[20:23], v[36:39], a[108:111]
    ds_read_b128 v[76:79], v106 offset:25600
    v_mfma_f32_16x16x32_bf16 a[16:19], v[8:11], v[40:43], a[16:19]
    ds_read_b128 v[80:83], v106 offset:26624
    v_mfma_f32_16x16x32_bf16 a[48:51], v[12:15], v[40:43], a[48:51]
    ds_read_b128 v[84:87], v106 offset:27648
    v_mfma_f32_16x16x32_bf16 a[80:83], v[16:19], v[40:43], a[80:83]
    ds_read_b128 v[88:91], v106 offset:28672
    v_mfma_f32_16x16x32_bf16 a[112:115], v[20:23], v[40:43], a[112:115]
    ds_read_b128 v[92:95], v106 offset:29696
    v_mfma_f32_16x16x32_bf16 a[20:23], v[8:11], v[44:47], a[20:23]
    ds_read_b128 v[96:99], v106 offset:30720
    v_mfma_f32_16x16x32_bf16 a[52:55], v[12:15], v[44:47], a[52:55]
    ds_read_b128 v[100:103], v106 offset:31744
    v_mfma_f32_16x16x32_bf16 a[84:87], v[16:19], v[44:47], a[84:87]
    v_mfma_f32_16x16x32_bf16 a[116:119], v[20:23], v[44:47], a[116:119]
    v_mfma_f32_16x16x32_bf16 a[24:27], v[8:11], v[48:51], a[24:27]
    v_mfma_f32_16x16x32_bf16 a[56:59], v[12:15], v[48:51], a[56:59]
    v_mfma_f32_16x16x32_bf16 a[88:91], v[16:19], v[48:51], a[88:91]
    v_mfma_f32_16x16x32_bf16 a[120:123], v[20:23], v[48:51], a[120:123]
    v_mfma_f32_16x16x32_bf16 a[28:31], v[8:11], v[52:55], a[28:31]
    v_mfma_f32_16x16x32_bf16 a[60:63], v[12:15], v[52:55], a[60:63]
    v_mfma_f32_16x16x32_bf16 a[92:95], v[16:19], v[52:55], a[92:95]
    v_mfma_f32_16x16x32_bf16 a[124:127], v[20:23], v[52:55], a[124:127]
    s_waitcnt vmcnt(12) lgkmcnt(0)
    s_barrier
    v_mfma_f32_16x16x32_bf16 a[0:3], v[56:59], v[72:75], a[0:3]
    ds_read_b128 v[8:11], v5 offset:0
    v_mfma_f32_16x16x32_bf16 a[32:35], v[60:63], v[72:75], a[32:35]
    ds_read_b128 v[12:15], v5 offset:1024
    v_mfma_f32_16x16x32_bf16 a[64:67], v[64:67], v[72:75], a[64:67]
    ds_read_b128 v[16:19], v5 offset:2048
    v_mfma_f32_16x16x32_bf16 a[96:99], v[68:71], v[72:75], a[96:99]
    ds_read_b128 v[20:23], v5 offset:3072
    v_mfma_f32_16x16x32_bf16 a[4:7], v[56:59], v[76:79], a[4:7]
    s_add_u32 m0, s34, 73728
    v_mfma_f32_16x16x32_bf16 a[36:39], v[60:63], v[76:79], a[36:39]
    buffer_load_dwordx4 v2, s[8:11], s32 offen offset:0 lds
    v_mfma_f32_16x16x32_bf16 a[68:71], v[64:67], v[76:79], a[68:71]
    buffer_load_dwordx4 v2, s[8:11], s32 offen offset:1024 lds
    v_mfma_f32_16x16x32_bf16 a[100:103], v[68:71], v[76:79], a[100:103]
    s_add_u32 m0, s35, 73728
    v_mfma_f32_16x16x32_bf16 a[8:11], v[56:59], v[80:83], a[8:11]
    buffer_load_dwordx4 v2, s[8:11], s33 offen offset:0 lds
    v_mfma_f32_16x16x32_bf16 a[40:43], v[60:63], v[80:83], a[40:43]
    buffer_load_dwordx4 v2, s[8:11], s33 offen offset:1024 lds
    v_mfma_f32_16x16x32_bf16 a[72:75], v[64:67], v[80:83], a[72:75]
    buffer_load_dwordx4 v2, s[8:11], s33 offen offset:2048 lds
    v_mfma_f32_16x16x32_bf16 a[104:107], v[68:71], v[80:83], a[104:107]
    buffer_load_dwordx4 v2, s[8:11], s33 offen offset:3072 lds
    v_mfma_f32_16x16x32_bf16 a[12:15], v[56:59], v[84:87], a[12:15]
    s_add_u32 s32, s32, s80
    v_mfma_f32_16x16x32_bf16 a[44:47], v[60:63], v[84:87], a[44:47]
    s_add_u32 s33, s33, 131072
    v_mfma_f32_16x16x32_bf16 a[76:79], v[64:67], v[84:87], a[76:79]
    ds_read_b128 v[24:27], v6 offset:0
    v_mfma_f32_16x16x32_bf16 a[108:111], v[68:71], v[84:87], a[108:111]
    ds_read_b128 v[28:31], v6 offset:1024
    v_mfma_f32_16x16x32_bf16 a[16:19], v[56:59], v[88:91], a[16:19]
    ds_read_b128 v[32:35], v6 offset:2048
    v_mfma_f32_16x16x32_bf16 a[48:51], v[60:63], v[88:91], a[48:51]
    ds_read_b128 v[36:39], v6 offset:3072
    v_mfma_f32_16x16x32_bf16 a[80:83], v[64:67], v[88:91], a[80:83]
    ds_read_b128 v[40:43], v6 offset:4096
    v_mfma_f32_16x16x32_bf16 a[112:115], v[68:71], v[88:91], a[112:115]
    ds_read_b128 v[44:47], v6 offset:5120
    v_mfma_f32_16x16x32_bf16 a[20:23], v[56:59], v[92:95], a[20:23]
    ds_read_b128 v[48:51], v6 offset:6144
    v_mfma_f32_16x16x32_bf16 a[52:55], v[60:63], v[92:95], a[52:55]
    ds_read_b128 v[52:55], v6 offset:7168
    v_mfma_f32_16x16x32_bf16 a[84:87], v[64:67], v[92:95], a[84:87]
    v_mfma_f32_16x16x32_bf16 a[116:119], v[68:71], v[92:95], a[116:119]
    v_mfma_f32_16x16x32_bf16 a[24:27], v[56:59], v[96:99], a[24:27]
    v_mfma_f32_16x16x32_bf16 a[56:59], v[60:63], v[96:99], a[56:59]
    v_mfma_f32_16x16x32_bf16 a[88:91], v[64:67], v[96:99], a[88:91]
    v_mfma_f32_16x16x32_bf16 a[120:123], v[68:71], v[96:99], a[120:123]
    v_mfma_f32_16x16x32_bf16 a[28:31], v[56:59], v[100:103], a[28:31]
    v_mfma_f32_16x16x32_bf16 a[60:63], v[60:63], v[100:103], a[60:63]
    v_mfma_f32_16x16x32_bf16 a[92:95], v[64:67], v[100:103], a[92:95]
    v_mfma_f32_16x16x32_bf16 a[124:127], v[68:71], v[100:103], a[124:127]
    s_add_u32 s25, s25, 1
    s_cmp_lt_u32 s25, s82
    s_cbranch_scc1 t1l_215
    s_waitcnt vmcnt(0) lgkmcnt(0)
    s_barrier
    s_cmp_lg_u32 s58, 0
    s_cbranch_scc1 ep_216
    s_nop 11
    s_lshl_b32 s52, s5, 3
    s_lshl_b32 s22, s21, 2
    s_add_u32 s52, s52, s22
    s_lshl_b32 s52, s52, 5
    s_add_u32 s52, s52, s7
    s_lshl_b32 s52, s52, 13
    s_lshl_b32 s22, s20, 11
    s_add_u32 s52, s52, s22
    s_add_u32 s52, s52, 16777216
    v_accvgpr_read_b32 v8, a0
    v_accvgpr_read_b32 v9, a1
    v_accvgpr_read_b32 v10, a2
    v_accvgpr_read_b32 v11, a3
    v_accvgpr_read_b32 v12, a32
    v_accvgpr_read_b32 v13, a33
    v_accvgpr_read_b32 v14, a34
    v_accvgpr_read_b32 v15, a35
    v_cvt_pk_bf16_f32 v16, v8, v9
    v_cvt_pk_bf16_f32 v17, v10, v11
    v_cvt_pk_bf16_f32 v18, v12, v13
    v_cvt_pk_bf16_f32 v19, v14, v15
    s_add_u32 s54, s52, 0
    buffer_store_dwordx4 v[16:19], v2, s[8:11], s54 offen sc1
    v_accvgpr_read_b32 v20, a64
    v_accvgpr_read_b32 v21, a65
    v_accvgpr_read_b32 v22, a66
    v_accvgpr_read_b32 v23, a67
    v_accvgpr_read_b32 v24, a96
    v_accvgpr_read_b32 v25, a97
    v_accvgpr_read_b32 v26, a98
    v_accvgpr_read_b32 v27, a99
    v_cvt_pk_bf16_f32 v28, v20, v21
    v_cvt_pk_bf16_f32 v29, v22, v23
    v_cvt_pk_bf16_f32 v30, v24, v25
    v_cvt_pk_bf16_f32 v31, v26, v27
    s_add_u32 s54, s52, 1024
    buffer_store_dwordx4 v[28:31], v2, s[8:11], s54 offen sc1
    v_accvgpr_read_b32 v32, a4
    v_accvgpr_read_b32 v33, a5
    v_accvgpr_read_b32 v34, a6
    v_accvgpr_read_b32 v35, a7
    v_accvgpr_read_b32 v36, a36
    v_accvgpr_read_b32 v37, a37
    v_accvgpr_read_b32 v38, a38
    v_accvgpr_read_b32 v39, a39
    v_cvt_pk_bf16_f32 v40, v32, v33
    v_cvt_pk_bf16_f32 v41, v34, v35
    v_cvt_pk_bf16_f32 v42, v36, v37
    v_cvt_pk_bf16_f32 v43, v38, v39
    s_add_u32 s54, s52, 4096
    buffer_store_dwordx4 v[40:43], v2, s[8:11], s54 offen sc1
    v_accvgpr_read_b32 v44, a68
    v_accvgpr_read_b32 v45, a69
    v_accvgpr_read_b32 v46, a70
    v_accvgpr_read_b32 v47, a71
    v_accvgpr_read_b32 v48, a100
    v_accvgpr_read_b32 v49, a101
    v_accvgpr_read_b32 v50, a102
    v_accvgpr_read_b32 v51, a103
    v_cvt_pk_bf16_f32 v52, v44, v45
    v_cvt_pk_bf16_f32 v53, v46, v47
    v_cvt_pk_bf16_f32 v54, v48, v49
    v_cvt_pk_bf16_f32 v55, v50, v51
    s_add_u32 s54, s52, 5120
    buffer_store_dwordx4 v[52:55], v2, s[8:11], s54 offen sc1
    v_accvgpr_read_b32 v8, a8
    v_accvgpr_read_b32 v9, a9
    v_accvgpr_read_b32 v10, a10
    v_accvgpr_read_b32 v11, a11
    v_accvgpr_read_b32 v12, a40
    v_accvgpr_read_b32 v13, a41
    v_accvgpr_read_b32 v14, a42
    v_accvgpr_read_b32 v15, a43
    v_cvt_pk_bf16_f32 v16, v8, v9
    v_cvt_pk_bf16_f32 v17, v10, v11
    v_cvt_pk_bf16_f32 v18, v12, v13
    v_cvt_pk_bf16_f32 v19, v14, v15
    s_add_u32 s54, s52, 262144
    buffer_store_dwordx4 v[16:19], v2, s[8:11], s54 offen sc1
    v_accvgpr_read_b32 v20, a72
    v_accvgpr_read_b32 v21, a73
    v_accvgpr_read_b32 v22, a74
    v_accvgpr_read_b32 v23, a75
    v_accvgpr_read_b32 v24, a104
    v_accvgpr_read_b32 v25, a105
    v_accvgpr_read_b32 v26, a106
    v_accvgpr_read_b32 v27, a107
    v_cvt_pk_bf16_f32 v28, v20, v21
    v_cvt_pk_bf16_f32 v29, v22, v23
    v_cvt_pk_bf16_f32 v30, v24, v25
    v_cvt_pk_bf16_f32 v31, v26, v27
    s_add_u32 s54, s52, 263168
    buffer_store_dwordx4 v[28:31], v2, s[8:11], s54 offen sc1
    v_accvgpr_read_b32 v32, a12
    v_accvgpr_read_b32 v33, a13
    v_accvgpr_read_b32 v34, a14
    v_accvgpr_read_b32 v35, a15
    v_accvgpr_read_b32 v36, a44
    v_accvgpr_read_b32 v37, a45
    v_accvgpr_read_b32 v38, a46
    v_accvgpr_read_b32 v39, a47
    v_cvt_pk_bf16_f32 v40, v32, v33
    v_cvt_pk_bf16_f32 v41, v34, v35
    v_cvt_pk_bf16_f32 v42, v36, v37
    v_cvt_pk_bf16_f32 v43, v38, v39
    s_add_u32 s54, s52, 266240
    buffer_store_dwordx4 v[40:43], v2, s[8:11], s54 offen sc1
    v_accvgpr_read_b32 v44, a76
    v_accvgpr_read_b32 v45, a77
    v_accvgpr_read_b32 v46, a78
    v_accvgpr_read_b32 v47, a79
    v_accvgpr_read_b32 v48, a108
    v_accvgpr_read_b32 v49, a109
    v_accvgpr_read_b32 v50, a110
    v_accvgpr_read_b32 v51, a111
    v_cvt_pk_bf16_f32 v52, v44, v45
    v_cvt_pk_bf16_f32 v53, v46, v47
    v_cvt_pk_bf16_f32 v54, v48, v49
    v_cvt_pk_bf16_f32 v55, v50, v51
    s_add_u32 s54, s52, 267264
    buffer_store_dwordx4 v[52:55], v2, s[8:11], s54 offen sc1
    v_accvgpr_read_b32 v8, a16
    v_accvgpr_read_b32 v9, a17
    v_accvgpr_read_b32 v10, a18
    v_accvgpr_read_b32 v11, a19
    v_accvgpr_read_b32 v12, a48
    v_accvgpr_read_b32 v13, a49
    v_accvgpr_read_b32 v14, a50
    v_accvgpr_read_b32 v15, a51
    v_cvt_pk_bf16_f32 v16, v8, v9
    v_cvt_pk_bf16_f32 v17, v10, v11
    v_cvt_pk_bf16_f32 v18, v12, v13
    v_cvt_pk_bf16_f32 v19, v14, v15
    s_add_u32 s54, s52, 524288
    buffer_store_dwordx4 v[16:19], v2, s[8:11], s54 offen sc1
    v_accvgpr_read_b32 v20, a80
    v_accvgpr_read_b32 v21, a81
    v_accvgpr_read_b32 v22, a82
    v_accvgpr_read_b32 v23, a83
    v_accvgpr_read_b32 v24, a112
    v_accvgpr_read_b32 v25, a113
    v_accvgpr_read_b32 v26, a114
    v_accvgpr_read_b32 v27, a115
    v_cvt_pk_bf16_f32 v28, v20, v21
    v_cvt_pk_bf16_f32 v29, v22, v23
    v_cvt_pk_bf16_f32 v30, v24, v25
    v_cvt_pk_bf16_f32 v31, v26, v27
    s_add_u32 s54, s52, 525312
    buffer_store_dwordx4 v[28:31], v2, s[8:11], s54 offen sc1
    v_accvgpr_read_b32 v32, a20
    v_accvgpr_read_b32 v33, a21
    v_accvgpr_read_b32 v34, a22
    v_accvgpr_read_b32 v35, a23
    v_accvgpr_read_b32 v36, a52
    v_accvgpr_read_b32 v37, a53
    v_accvgpr_read_b32 v38, a54
    v_accvgpr_read_b32 v39, a55
    v_cvt_pk_bf16_f32 v40, v32, v33
    v_cvt_pk_bf16_f32 v41, v34, v35
    v_cvt_pk_bf16_f32 v42, v36, v37
    v_cvt_pk_bf16_f32 v43, v38, v39
    s_add_u32 s54, s52, 528384
    buffer_store_dwordx4 v[40:43], v2, s[8:11], s54 offen sc1
    v_accvgpr_read_b32 v44, a84
    v_accvgpr_read_b32 v45, a85
    v_accvgpr_read_b32 v46, a86
    v_accvgpr_read_b32 v47, a87
    v_accvgpr_read_b32 v48, a116
    v_accvgpr_read_b32 v49, a117
    v_accvgpr_read_b32 v50, a118
    v_accvgpr_read_b32 v51, a119
    v_cvt_pk_bf16_f32 v52, v44, v45
    v_cvt_pk_bf16_f32 v53, v46, v47
    v_cvt_pk_bf16_f32 v54, v48, v49
    v_cvt_pk_bf16_f32 v55, v50, v51
    s_add_u32 s54, s52, 529408
    buffer_store_dwordx4 v[52:55], v2, s[8:11], s54 offen sc1
    v_accvgpr_read_b32 v8, a24
    v_accvgpr_read_b32 v9, a25
    v_accvgpr_read_b32 v10, a26
    v_accvgpr_read_b32 v11, a27
    v_accvgpr_read_b32 v12, a56
    v_accvgpr_read_b32 v13, a57
    v_accvgpr_read_b32 v14, a58
    v_accvgpr_read_b32 v15, a59
    v_cvt_pk_bf16_f32 v16, v8, v9
    v_cvt_pk_bf16_f32 v17, v10, v11
    v_cvt_pk_bf16_f32 v18, v12, v13
    v_cvt_pk_bf16_f32 v19, v14, v15
    s_add_u32 s54, s52, 786432
    buffer_store_dwordx4 v[16:19], v2, s[8:11], s54 offen sc1
    v_accvgpr_read_b32 v20, a88
    v_accvgpr_read_b32 v21, a89
    v_accvgpr_read_b32 v22, a90
    v_accvgpr_read_b32 v23, a91
    v_accvgpr_read_b32 v24, a120
    v_accvgpr_read_b32 v25, a121
    v_accvgpr_read_b32 v26, a122
    v_accvgpr_read_b32 v27, a123
    v_cvt_pk_bf16_f32 v28, v20, v21
    v_cvt_pk_bf16_f32 v29, v22, v23
    v_cvt_pk_bf16_f32 v30, v24, v25
    v_cvt_pk_bf16_f32 v31, v26, v27
    s_add_u32 s54, s52, 787456
    buffer_store_dwordx4 v[28:31], v2, s[8:11], s54 offen sc1
    v_accvgpr_read_b32 v32, a28
    v_accvgpr_read_b32 v33, a29
    v_accvgpr_read_b32 v34, a30
    v_accvgpr_read_b32 v35, a31
    v_accvgpr_read_b32 v36, a60
    v_accvgpr_read_b32 v37, a61
    v_accvgpr_read_b32 v38, a62
    v_accvgpr_read_b32 v39, a63
    v_cvt_pk_bf16_f32 v40, v32, v33
    v_cvt_pk_bf16_f32 v41, v34, v35
    v_cvt_pk_bf16_f32 v42, v36, v37
    v_cvt_pk_bf16_f32 v43, v38, v39
    s_add_u32 s54, s52, 790528
    buffer_store_dwordx4 v[40:43], v2, s[8:11], s54 offen sc1
    v_accvgpr_read_b32 v44, a92
    v_accvgpr_read_b32 v45, a93
    v_accvgpr_read_b32 v46, a94
    v_accvgpr_read_b32 v47, a95
    v_accvgpr_read_b32 v48, a124
    v_accvgpr_read_b32 v49, a125
    v_accvgpr_read_b32 v50, a126
    v_accvgpr_read_b32 v51, a127
    v_cvt_pk_bf16_f32 v52, v44, v45
    v_cvt_pk_bf16_f32 v53, v46, v47
    v_cvt_pk_bf16_f32 v54, v48, v49
    v_cvt_pk_bf16_f32 v55, v50, v51
    s_add_u32 s54, s52, 791552
    buffer_store_dwordx4 v[52:55], v2, s[8:11], s54 offen sc1
    s_waitcnt vmcnt(0)
    s_lshr_b32 s20, s5, 1
    s_lshl_b32 s20, s20, 2
    s_add_u32 s20, s20, 16
    s_and_b32 s21, s5, 1
    s_lshl_b32 s21, s21, 4
    s_lshl_b32 s21, 1, s21
    s_cmp_lg_u32 s4, 0
    s_cbranch_scc1 tki_217
    s_lshl_b32 s93, s83, 2
    s_add_u32 s93, s93, 176
    v_mov_b32 v250, s93
    v_mov_b32 v251, 1
    s_mov_b64 exec, 1
    global_atomic_add v249, v250, v251, s[98:99] sc0 sc1
    s_mov_b64 exec, -1
tki_217:
    s_waitcnt vmcnt(0) lgkmcnt(0)
    s_barrier
    s_cmp_lg_u32 s4, 0
    s_cbranch_scc1 sig_218
    v_mov_b32 v250, s20
    v_mov_b32 v251, s21
    s_mov_b64 exec, 1
    global_atomic_add v250, v251, s[98:99] sc1
    s_mov_b64 exec, -1
sig_218:
    s_branch L_next
ep_216:
    s_cmp_lg_u32 s58, 1
    s_cbranch_scc1 ep_219
    s_nop 11
    s_lshl_b32 s52, s5, 3
    s_lshl_b32 s22, s21, 2
    s_add_u32 s52, s52, s22
    s_lshl_b32 s52, s52, 5
    s_add_u32 s52, s52, s7
    s_lshl_b32 s52, s52, 13
    s_lshl_b32 s22, s20, 11
    s_add_u32 s52, s52, s22
    s_add_u32 s52, s52, 50331648
    s_mov_b32 s53, 0x3e0293ee
    v_accvgpr_read_b32 v8, a0
    v_accvgpr_read_b32 v9, a1
    v_accvgpr_read_b32 v10, a2
    v_accvgpr_read_b32 v11, a3
    v_mul_f32 v8, s53, v8
    v_mul_f32 v9, s53, v9
    v_mul_f32 v10, s53, v10
    v_mul_f32 v11, s53, v11
    v_accvgpr_read_b32 v12, a32
    v_accvgpr_read_b32 v13, a33
    v_accvgpr_read_b32 v14, a34
    v_accvgpr_read_b32 v15, a35
    v_mul_f32 v12, s53, v12
    v_mul_f32 v13, s53, v13
    v_mul_f32 v14, s53, v14
    v_mul_f32 v15, s53, v15
    v_cvt_pk_bf16_f32 v16, v8, v9
    v_cvt_pk_bf16_f32 v17, v10, v11
    v_cvt_pk_bf16_f32 v18, v12, v13
    v_cvt_pk_bf16_f32 v19, v14, v15
    s_add_u32 s54, s52, 0
    buffer_store_dwordx4 v[16:19], v2, s[8:11], s54 offen sc1
    v_accvgpr_read_b32 v20, a64
    v_accvgpr_read_b32 v21, a65
    v_accvgpr_read_b32 v22, a66
    v_accvgpr_read_b32 v23, a67
    v_mul_f32 v20, s53, v20
    v_mul_f32 v21, s53, v21
    v_mul_f32 v22, s53, v22
    v_mul_f32 v23, s53, v23
    v_accvgpr_read_b32 v24, a96
    v_accvgpr_read_b32 v25, a97
    v_accvgpr_read_b32 v26, a98
    v_accvgpr_read_b32 v27, a99
    v_mul_f32 v24, s53, v24
    v_mul_f32 v25, s53, v25
    v_mul_f32 v26, s53, v26
    v_mul_f32 v27, s53, v27
    v_cvt_pk_bf16_f32 v28, v20, v21
    v_cvt_pk_bf16_f32 v29, v22, v23
    v_cvt_pk_bf16_f32 v30, v24, v25
    v_cvt_pk_bf16_f32 v31, v26, v27
    s_add_u32 s54, s52, 1024
    buffer_store_dwordx4 v[28:31], v2, s[8:11], s54 offen sc1
    v_accvgpr_read_b32 v32, a4
    v_accvgpr_read_b32 v33, a5
    v_accvgpr_read_b32 v34, a6
    v_accvgpr_read_b32 v35, a7
    v_mul_f32 v32, s53, v32
    v_mul_f32 v33, s53, v33
    v_mul_f32 v34, s53, v34
    v_mul_f32 v35, s53, v35
    v_accvgpr_read_b32 v36, a36
    v_accvgpr_read_b32 v37, a37
    v_accvgpr_read_b32 v38, a38
    v_accvgpr_read_b32 v39, a39
    v_mul_f32 v36, s53, v36
    v_mul_f32 v37, s53, v37
    v_mul_f32 v38, s53, v38
    v_mul_f32 v39, s53, v39
    v_cvt_pk_bf16_f32 v40, v32, v33
    v_cvt_pk_bf16_f32 v41, v34, v35
    v_cvt_pk_bf16_f32 v42, v36, v37
    v_cvt_pk_bf16_f32 v43, v38, v39
    s_add_u32 s54, s52, 4096
    buffer_store_dwordx4 v[40:43], v2, s[8:11], s54 offen sc1
    v_accvgpr_read_b32 v44, a68
    v_accvgpr_read_b32 v45, a69
    v_accvgpr_read_b32 v46, a70
    v_accvgpr_read_b32 v47, a71
    v_mul_f32 v44, s53, v44
    v_mul_f32 v45, s53, v45
    v_mul_f32 v46, s53, v46
    v_mul_f32 v47, s53, v47
    v_accvgpr_read_b32 v48, a100
    v_accvgpr_read_b32 v49, a101
    v_accvgpr_read_b32 v50, a102
    v_accvgpr_read_b32 v51, a103
    v_mul_f32 v48, s53, v48
    v_mul_f32 v49, s53, v49
    v_mul_f32 v50, s53, v50
    v_mul_f32 v51, s53, v51
    v_cvt_pk_bf16_f32 v52, v44, v45
    v_cvt_pk_bf16_f32 v53, v46, v47
    v_cvt_pk_bf16_f32 v54, v48, v49
    v_cvt_pk_bf16_f32 v55, v50, v51
    s_add_u32 s54, s52, 5120
    buffer_store_dwordx4 v[52:55], v2, s[8:11], s54 offen sc1
    v_accvgpr_read_b32 v8, a8
    v_accvgpr_read_b32 v9, a9
    v_accvgpr_read_b32 v10, a10
    v_accvgpr_read_b32 v11, a11
    v_mul_f32 v8, s53, v8
    v_mul_f32 v9, s53, v9
    v_mul_f32 v10, s53, v10
    v_mul_f32 v11, s53, v11
    v_accvgpr_read_b32 v12, a40
    v_accvgpr_read_b32 v13, a41
    v_accvgpr_read_b32 v14, a42
    v_accvgpr_read_b32 v15, a43
    v_mul_f32 v12, s53, v12
    v_mul_f32 v13, s53, v13
    v_mul_f32 v14, s53, v14
    v_mul_f32 v15, s53, v15
    v_cvt_pk_bf16_f32 v16, v8, v9
    v_cvt_pk_bf16_f32 v17, v10, v11
    v_cvt_pk_bf16_f32 v18, v12, v13
    v_cvt_pk_bf16_f32 v19, v14, v15
    s_add_u32 s54, s52, 262144
    buffer_store_dwordx4 v[16:19], v2, s[8:11], s54 offen sc1
    v_accvgpr_read_b32 v20, a72
    v_accvgpr_read_b32 v21, a73
    v_accvgpr_read_b32 v22, a74
    v_accvgpr_read_b32 v23, a75
    v_mul_f32 v20, s53, v20
    v_mul_f32 v21, s53, v21
    v_mul_f32 v22, s53, v22
    v_mul_f32 v23, s53, v23
    v_accvgpr_read_b32 v24, a104
    v_accvgpr_read_b32 v25, a105
    v_accvgpr_read_b32 v26, a106
    v_accvgpr_read_b32 v27, a107
    v_mul_f32 v24, s53, v24
    v_mul_f32 v25, s53, v25
    v_mul_f32 v26, s53, v26
    v_mul_f32 v27, s53, v27
    v_cvt_pk_bf16_f32 v28, v20, v21
    v_cvt_pk_bf16_f32 v29, v22, v23
    v_cvt_pk_bf16_f32 v30, v24, v25
    v_cvt_pk_bf16_f32 v31, v26, v27
    s_add_u32 s54, s52, 263168
    buffer_store_dwordx4 v[28:31], v2, s[8:11], s54 offen sc1
    v_accvgpr_read_b32 v32, a12
    v_accvgpr_read_b32 v33, a13
    v_accvgpr_read_b32 v34, a14
    v_accvgpr_read_b32 v35, a15
    v_mul_f32 v32, s53, v32
    v_mul_f32 v33, s53, v33
    v_mul_f32 v34, s53, v34
    v_mul_f32 v35, s53, v35
    v_accvgpr_read_b32 v36, a44
    v_accvgpr_read_b32 v37, a45
    v_accvgpr_read_b32 v38, a46
    v_accvgpr_read_b32 v39, a47
    v_mul_f32 v36, s53, v36
    v_mul_f32 v37, s53, v37
    v_mul_f32 v38, s53, v38
    v_mul_f32 v39, s53, v39
    v_cvt_pk_bf16_f32 v40, v32, v33
    v_cvt_pk_bf16_f32 v41, v34, v35
    v_cvt_pk_bf16_f32 v42, v36, v37
    v_cvt_pk_bf16_f32 v43, v38, v39
    s_add_u32 s54, s52, 266240
    buffer_store_dwordx4 v[40:43], v2, s[8:11], s54 offen sc1
    v_accvgpr_read_b32 v44, a76
    v_accvgpr_read_b32 v45, a77
    v_accvgpr_read_b32 v46, a78
    v_accvgpr_read_b32 v47, a79
    v_mul_f32 v44, s53, v44
    v_mul_f32 v45, s53, v45
    v_mul_f32 v46, s53, v46
    v_mul_f32 v47, s53, v47
    v_accvgpr_read_b32 v48, a108
    v_accvgpr_read_b32 v49, a109
    v_accvgpr_read_b32 v50, a110
    v_accvgpr_read_b32 v51, a111
    v_mul_f32 v48, s53, v48
    v_mul_f32 v49, s53, v49
    v_mul_f32 v50, s53, v50
    v_mul_f32 v51, s53, v51
    v_cvt_pk_bf16_f32 v52, v44, v45
    v_cvt_pk_bf16_f32 v53, v46, v47
    v_cvt_pk_bf16_f32 v54, v48, v49
    v_cvt_pk_bf16_f32 v55, v50, v51
    s_add_u32 s54, s52, 267264
    buffer_store_dwordx4 v[52:55], v2, s[8:11], s54 offen sc1
    v_accvgpr_read_b32 v8, a16
    v_accvgpr_read_b32 v9, a17
    v_accvgpr_read_b32 v10, a18
    v_accvgpr_read_b32 v11, a19
    v_mul_f32 v8, s53, v8
    v_mul_f32 v9, s53, v9
    v_mul_f32 v10, s53, v10
    v_mul_f32 v11, s53, v11
    v_accvgpr_read_b32 v12, a48
    v_accvgpr_read_b32 v13, a49
    v_accvgpr_read_b32 v14, a50
    v_accvgpr_read_b32 v15, a51
    v_mul_f32 v12, s53, v12
    v_mul_f32 v13, s53, v13
    v_mul_f32 v14, s53, v14
    v_mul_f32 v15, s53, v15
    v_cvt_pk_bf16_f32 v16, v8, v9
    v_cvt_pk_bf16_f32 v17, v10, v11
    v_cvt_pk_bf16_f32 v18, v12, v13
    v_cvt_pk_bf16_f32 v19, v14, v15
    s_add_u32 s54, s52, 524288
    buffer_store_dwordx4 v[16:19], v2, s[8:11], s54 offen sc1
    v_accvgpr_read_b32 v20, a80
    v_accvgpr_read_b32 v21, a81
    v_accvgpr_read_b32 v22, a82
    v_accvgpr_read_b32 v23, a83
    v_mul_f32 v20, s53, v20
    v_mul_f32 v21, s53, v21
    v_mul_f32 v22, s53, v22
    v_mul_f32 v23, s53, v23
    v_accvgpr_read_b32 v24, a112
    v_accvgpr_read_b32 v25, a113
    v_accvgpr_read_b32 v26, a114
    v_accvgpr_read_b32 v27, a115
    v_mul_f32 v24, s53, v24
    v_mul_f32 v25, s53, v25
    v_mul_f32 v26, s53, v26
    v_mul_f32 v27, s53, v27
    v_cvt_pk_bf16_f32 v28, v20, v21
    v_cvt_pk_bf16_f32 v29, v22, v23
    v_cvt_pk_bf16_f32 v30, v24, v25
    v_cvt_pk_bf16_f32 v31, v26, v27
    s_add_u32 s54, s52, 525312
    buffer_store_dwordx4 v[28:31], v2, s[8:11], s54 offen sc1
    v_accvgpr_read_b32 v32, a20
    v_accvgpr_read_b32 v33, a21
    v_accvgpr_read_b32 v34, a22
    v_accvgpr_read_b32 v35, a23
    v_mul_f32 v32, s53, v32
    v_mul_f32 v33, s53, v33
    v_mul_f32 v34, s53, v34
    v_mul_f32 v35, s53, v35
    v_accvgpr_read_b32 v36, a52
    v_accvgpr_read_b32 v37, a53
    v_accvgpr_read_b32 v38, a54
    v_accvgpr_read_b32 v39, a55
    v_mul_f32 v36, s53, v36
    v_mul_f32 v37, s53, v37
    v_mul_f32 v38, s53, v38
    v_mul_f32 v39, s53, v39
    v_cvt_pk_bf16_f32 v40, v32, v33
    v_cvt_pk_bf16_f32 v41, v34, v35
    v_cvt_pk_bf16_f32 v42, v36, v37
    v_cvt_pk_bf16_f32 v43, v38, v39
    s_add_u32 s54, s52, 528384
    buffer_store_dwordx4 v[40:43], v2, s[8:11], s54 offen sc1
    v_accvgpr_read_b32 v44, a84
    v_accvgpr_read_b32 v45, a85
    v_accvgpr_read_b32 v46, a86
    v_accvgpr_read_b32 v47, a87
    v_mul_f32 v44, s53, v44
    v_mul_f32 v45, s53, v45
    v_mul_f32 v46, s53, v46
    v_mul_f32 v47, s53, v47
    v_accvgpr_read_b32 v48, a116
    v_accvgpr_read_b32 v49, a117
    v_accvgpr_read_b32 v50, a118
    v_accvgpr_read_b32 v51, a119
    v_mul_f32 v48, s53, v48
    v_mul_f32 v49, s53, v49
    v_mul_f32 v50, s53, v50
    v_mul_f32 v51, s53, v51
    v_cvt_pk_bf16_f32 v52, v44, v45
    v_cvt_pk_bf16_f32 v53, v46, v47
    v_cvt_pk_bf16_f32 v54, v48, v49
    v_cvt_pk_bf16_f32 v55, v50, v51
    s_add_u32 s54, s52, 529408
    buffer_store_dwordx4 v[52:55], v2, s[8:11], s54 offen sc1
    v_accvgpr_read_b32 v8, a24
    v_accvgpr_read_b32 v9, a25
    v_accvgpr_read_b32 v10, a26
    v_accvgpr_read_b32 v11, a27
    v_mul_f32 v8, s53, v8
    v_mul_f32 v9, s53, v9
    v_mul_f32 v10, s53, v10
    v_mul_f32 v11, s53, v11
    v_accvgpr_read_b32 v12, a56
    v_accvgpr_read_b32 v13, a57
    v_accvgpr_read_b32 v14, a58
    v_accvgpr_read_b32 v15, a59
    v_mul_f32 v12, s53, v12
    v_mul_f32 v13, s53, v13
    v_mul_f32 v14, s53, v14
    v_mul_f32 v15, s53, v15
    v_cvt_pk_bf16_f32 v16, v8, v9
    v_cvt_pk_bf16_f32 v17, v10, v11
    v_cvt_pk_bf16_f32 v18, v12, v13
    v_cvt_pk_bf16_f32 v19, v14, v15
    s_add_u32 s54, s52, 786432
    buffer_store_dwordx4 v[16:19], v2, s[8:11], s54 offen sc1
    v_accvgpr_read_b32 v20, a88
    v_accvgpr_read_b32 v21, a89
    v_accvgpr_read_b32 v22, a90
    v_accvgpr_read_b32 v23, a91
    v_mul_f32 v20, s53, v20
    v_mul_f32 v21, s53, v21
    v_mul_f32 v22, s53, v22
    v_mul_f32 v23, s53, v23
    v_accvgpr_read_b32 v24, a120
    v_accvgpr_read_b32 v25, a121
    v_accvgpr_read_b32 v26, a122
    v_accvgpr_read_b32 v27, a123
    v_mul_f32 v24, s53, v24
    v_mul_f32 v25, s53, v25
    v_mul_f32 v26, s53, v26
    v_mul_f32 v27, s53, v27
    v_cvt_pk_bf16_f32 v28, v20, v21
    v_cvt_pk_bf16_f32 v29, v22, v23
    v_cvt_pk_bf16_f32 v30, v24, v25
    v_cvt_pk_bf16_f32 v31, v26, v27
    s_add_u32 s54, s52, 787456
    buffer_store_dwordx4 v[28:31], v2, s[8:11], s54 offen sc1
    v_accvgpr_read_b32 v32, a28
    v_accvgpr_read_b32 v33, a29
    v_accvgpr_read_b32 v34, a30
    v_accvgpr_read_b32 v35, a31
    v_mul_f32 v32, s53, v32
    v_mul_f32 v33, s53, v33
    v_mul_f32 v34, s53, v34
    v_mul_f32 v35, s53, v35
    v_accvgpr_read_b32 v36, a60
    v_accvgpr_read_b32 v37, a61
    v_accvgpr_read_b32 v38, a62
    v_accvgpr_read_b32 v39, a63
    v_mul_f32 v36, s53, v36
    v_mul_f32 v37, s53, v37
    v_mul_f32 v38, s53, v38
    v_mul_f32 v39, s53, v39
    v_cvt_pk_bf16_f32 v40, v32, v33
    v_cvt_pk_bf16_f32 v41, v34, v35
    v_cvt_pk_bf16_f32 v42, v36, v37
    v_cvt_pk_bf16_f32 v43, v38, v39
    s_add_u32 s54, s52, 790528
    buffer_store_dwordx4 v[40:43], v2, s[8:11], s54 offen sc1
    v_accvgpr_read_b32 v44, a92
    v_accvgpr_read_b32 v45, a93
    v_accvgpr_read_b32 v46, a94
    v_accvgpr_read_b32 v47, a95
    v_mul_f32 v44, s53, v44
    v_mul_f32 v45, s53, v45
    v_mul_f32 v46, s53, v46
    v_mul_f32 v47, s53, v47
    v_accvgpr_read_b32 v48, a124
    v_accvgpr_read_b32 v49, a125
    v_accvgpr_read_b32 v50, a126
    v_accvgpr_read_b32 v51, a127
    v_mul_f32 v48, s53, v48
    v_mul_f32 v49, s53, v49
    v_mul_f32 v50, s53, v50
    v_mul_f32 v51, s53, v51
    v_cvt_pk_bf16_f32 v52, v44, v45
    v_cvt_pk_bf16_f32 v53, v46, v47
    v_cvt_pk_bf16_f32 v54, v48, v49
    v_cvt_pk_bf16_f32 v55, v50, v51
    s_add_u32 s54, s52, 791552
    buffer_store_dwordx4 v[52:55], v2, s[8:11], s54 offen sc1
    s_waitcnt vmcnt(0)
    s_lshr_b32 s20, s5, 1
    s_lshl_b32 s20, s20, 2
    s_add_u32 s20, s20, 32
    s_and_b32 s21, s5, 1
    s_lshl_b32 s21, s21, 4
    s_lshl_b32 s21, 1, s21
    s_cmp_lg_u32 s4, 0
    s_cbranch_scc1 tki_220
    s_lshl_b32 s93, s83, 2
    s_add_u32 s93, s93, 176
    v_mov_b32 v250, s93
    v_mov_b32 v251, 1
    s_mov_b64 exec, 1
    global_atomic_add v249, v250, v251, s[98:99] sc0 sc1
    s_mov_b64 exec, -1
tki_220:
    s_waitcnt vmcnt(0) lgkmcnt(0)
    s_barrier
    s_cmp_lg_u32 s4, 0
    s_cbranch_scc1 sig_221
    v_mov_b32 v250, s20
    v_mov_b32 v251, s21
    s_mov_b64 exec, 1
    global_atomic_add v250, v251, s[98:99] sc1
    s_mov_b64 exec, -1
sig_221:
    s_branch L_next
ep_219:
    s_cmp_lg_u32 s58, 2
    s_cbranch_scc1 ep_222
    s_nop 11
    s_lshl_b32 s52, s5, 4
    s_lshl_b32 s22, s21, 3
    s_add_u32 s52, s52, s22
    s_lshl_b32 s52, s52, 5
    s_lshl_b32 s22, s7, 1
    s_add_u32 s52, s52, s22
    s_add_u32 s52, s52, s20
    s_lshl_b32 s52, s52, 10
    s_mov_b32 s53, 0x3ea52b5c
    v_accvgpr_read_b32 v8, a0
    v_accvgpr_read_b32 v9, a1
    v_accvgpr_read_b32 v10, a2
    v_accvgpr_read_b32 v11, a3
    v_mul_f32 v8, s53, v8
    v_mul_f32 v9, s53, v9
    v_mul_f32 v10, s53, v10
    v_mul_f32 v11, s53, v11
    v_accvgpr_read_b32 v12, a32
    v_accvgpr_read_b32 v13, a33
    v_accvgpr_read_b32 v14, a34
    v_accvgpr_read_b32 v15, a35
    v_mul_f32 v12, s53, v12
    v_mul_f32 v13, s53, v13
    v_mul_f32 v14, s53, v14
    v_mul_f32 v15, s53, v15
    v_cvt_pk_bf16_f32 v16, v8, v9
    v_cvt_pk_bf16_f32 v17, v10, v11
    v_cvt_pk_bf16_f32 v18, v12, v13
    v_cvt_pk_bf16_f32 v19, v14, v15
    s_add_u32 s54, s52, 100663296
    buffer_store_dwordx4 v[16:19], v2, s[8:11], s54 offen sc1
    v_accvgpr_read_b32 v20, a64
    v_accvgpr_read_b32 v21, a65
    v_accvgpr_read_b32 v22, a66
    v_accvgpr_read_b32 v23, a67
    v_accvgpr_read_b32 v24, a96
    v_accvgpr_read_b32 v25, a97
    v_accvgpr_read_b32 v26, a98
    v_accvgpr_read_b32 v27, a99
    v_cvt_pk_bf16_f32 v28, v20, v21
    v_cvt_pk_bf16_f32 v29, v22, v23
    v_cvt_pk_bf16_f32 v30, v24, v25
    v_cvt_pk_bf16_f32 v31, v26, v27
    s_add_u32 s54, s52, 104857600
    buffer_store_dwordx4 v[28:31], v2, s[8:11], s54 offen sc1
    v_accvgpr_read_b32 v32, a4
    v_accvgpr_read_b32 v33, a5
    v_accvgpr_read_b32 v34, a6
    v_accvgpr_read_b32 v35, a7
    v_mul_f32 v32, s53, v32
    v_mul_f32 v33, s53, v33
    v_mul_f32 v34, s53, v34
    v_mul_f32 v35, s53, v35
    v_accvgpr_read_b32 v36, a36
    v_accvgpr_read_b32 v37, a37
    v_accvgpr_read_b32 v38, a38
    v_accvgpr_read_b32 v39, a39
    v_mul_f32 v36, s53, v36
    v_mul_f32 v37, s53, v37
    v_mul_f32 v38, s53, v38
    v_mul_f32 v39, s53, v39
    v_cvt_pk_bf16_f32 v40, v32, v33
    v_cvt_pk_bf16_f32 v41, v34, v35
    v_cvt_pk_bf16_f32 v42, v36, v37
    v_cvt_pk_bf16_f32 v43, v38, v39
    s_add_u32 s54, s52, 100696064
    buffer_store_dwordx4 v[40:43], v2, s[8:11], s54 offen sc1
    v_accvgpr_read_b32 v44, a68
    v_accvgpr_read_b32 v45, a69
    v_accvgpr_read_b32 v46, a70
    v_accvgpr_read_b32 v47, a71
    v_accvgpr_read_b32 v48, a100
    v_accvgpr_read_b32 v49, a101
    v_accvgpr_read_b32 v50, a102
    v_accvgpr_read_b32 v51, a103
    v_cvt_pk_bf16_f32 v52, v44, v45
    v_cvt_pk_bf16_f32 v53, v46, v47
    v_cvt_pk_bf16_f32 v54, v48, v49
    v_cvt_pk_bf16_f32 v55, v50, v51
    s_add_u32 s54, s52, 104890368
    buffer_store_dwordx4 v[52:55], v2, s[8:11], s54 offen sc1
    v_accvgpr_read_b32 v8, a8
    v_accvgpr_read_b32 v9, a9
    v_accvgpr_read_b32 v10, a10
    v_accvgpr_read_b32 v11, a11
    v_mul_f32 v8, s53, v8
    v_mul_f32 v9, s53, v9
    v_mul_f32 v10, s53, v10
    v_mul_f32 v11, s53, v11
    v_accvgpr_read_b32 v12, a40
    v_accvgpr_read_b32 v13, a41
    v_accvgpr_read_b32 v14, a42
    v_accvgpr_read_b32 v15, a43
    v_mul_f32 v12, s53, v12
    v_mul_f32 v13, s53, v13
    v_mul_f32 v14, s53, v14
    v_mul_f32 v15, s53, v15
    v_cvt_pk_bf16_f32 v16, v8, v9
    v_cvt_pk_bf16_f32 v17, v10, v11
    v_cvt_pk_bf16_f32 v18, v12, v13
    v_cvt_pk_bf16_f32 v19, v14, v15
    s_add_u32 s54, s52, 100728832
    buffer_store_dwordx4 v[16:19], v2, s[8:11], s54 offen sc1
    v_accvgpr_read_b32 v20, a72
    v_accvgpr_read_b32 v21, a73
    v_accvgpr_read_b32 v22, a74
    v_accvgpr_read_b32 v23, a75
    v_accvgpr_read_b32 v24, a104
    v_accvgpr_read_b32 v25, a105
    v_accvgpr_read_b32 v26, a106
    v_accvgpr_read_b32 v27, a107
    v_cvt_pk_bf16_f32 v28, v20, v21
    v_cvt_pk_bf16_f32 v29, v22, v23
    v_cvt_pk_bf16_f32 v30, v24, v25
    v_cvt_pk_bf16_f32 v31, v26, v27
    s_add_u32 s54, s52, 104923136
    buffer_store_dwordx4 v[28:31], v2, s[8:11], s54 offen sc1
    v_accvgpr_read_b32 v32, a12
    v_accvgpr_read_b32 v33, a13
    v_accvgpr_read_b32 v34, a14
    v_accvgpr_read_b32 v35, a15
    v_mul_f32 v32, s53, v32
    v_mul_f32 v33, s53, v33
    v_mul_f32 v34, s53, v34
    v_mul_f32 v35, s53, v35
    v_accvgpr_read_b32 v36, a44
    v_accvgpr_read_b32 v37, a45
    v_accvgpr_read_b32 v38, a46
    v_accvgpr_read_b32 v39, a47
    v_mul_f32 v36, s53, v36
    v_mul_f32 v37, s53, v37
    v_mul_f32 v38, s53, v38
    v_mul_f32 v39, s53, v39
    v_cvt_pk_bf16_f32 v40, v32, v33
    v_cvt_pk_bf16_f32 v41, v34, v35
    v_cvt_pk_bf16_f32 v42, v36, v37
    v_cvt_pk_bf16_f32 v43, v38, v39
    s_add_u32 s54, s52, 100761600
    buffer_store_dwordx4 v[40:43], v2, s[8:11], s54 offen sc1
    v_accvgpr_read_b32 v44, a76
    v_accvgpr_read_b32 v45, a77
    v_accvgpr_read_b32 v46, a78
    v_accvgpr_read_b32 v47, a79
    v_accvgpr_read_b32 v48, a108
    v_accvgpr_read_b32 v49, a109
    v_accvgpr_read_b32 v50, a110
    v_accvgpr_read_b32 v51, a111
    v_cvt_pk_bf16_f32 v52, v44, v45
    v_cvt_pk_bf16_f32 v53, v46, v47
    v_cvt_pk_bf16_f32 v54, v48, v49
    v_cvt_pk_bf16_f32 v55, v50, v51
    s_add_u32 s54, s52, 104955904
    buffer_store_dwordx4 v[52:55], v2, s[8:11], s54 offen sc1
    v_accvgpr_read_b32 v8, a16
    v_accvgpr_read_b32 v9, a17
    v_accvgpr_read_b32 v10, a18
    v_accvgpr_read_b32 v11, a19
    v_mul_f32 v8, s53, v8
    v_mul_f32 v9, s53, v9
    v_mul_f32 v10, s53, v10
    v_mul_f32 v11, s53, v11
    v_accvgpr_read_b32 v12, a48
    v_accvgpr_read_b32 v13, a49
    v_accvgpr_read_b32 v14, a50
    v_accvgpr_read_b32 v15, a51
    v_mul_f32 v12, s53, v12
    v_mul_f32 v13, s53, v13
    v_mul_f32 v14, s53, v14
    v_mul_f32 v15, s53, v15
    v_cvt_pk_bf16_f32 v16, v8, v9
    v_cvt_pk_bf16_f32 v17, v10, v11
    v_cvt_pk_bf16_f32 v18, v12, v13
    v_cvt_pk_bf16_f32 v19, v14, v15
    s_add_u32 s54, s52, 100794368
    buffer_store_dwordx4 v[16:19], v2, s[8:11], s54 offen sc1
    v_accvgpr_read_b32 v20, a80
    v_accvgpr_read_b32 v21, a81
    v_accvgpr_read_b32 v22, a82
    v_accvgpr_read_b32 v23, a83
    v_accvgpr_read_b32 v24, a112
    v_accvgpr_read_b32 v25, a113
    v_accvgpr_read_b32 v26, a114
    v_accvgpr_read_b32 v27, a115
    v_cvt_pk_bf16_f32 v28, v20, v21
    v_cvt_pk_bf16_f32 v29, v22, v23
    v_cvt_pk_bf16_f32 v30, v24, v25
    v_cvt_pk_bf16_f32 v31, v26, v27
    s_add_u32 s54, s52, 104988672
    buffer_store_dwordx4 v[28:31], v2, s[8:11], s54 offen sc1
    v_accvgpr_read_b32 v32, a20
    v_accvgpr_read_b32 v33, a21
    v_accvgpr_read_b32 v34, a22
    v_accvgpr_read_b32 v35, a23
    v_mul_f32 v32, s53, v32
    v_mul_f32 v33, s53, v33
    v_mul_f32 v34, s53, v34
    v_mul_f32 v35, s53, v35
    v_accvgpr_read_b32 v36, a52
    v_accvgpr_read_b32 v37, a53
    v_accvgpr_read_b32 v38, a54
    v_accvgpr_read_b32 v39, a55
    v_mul_f32 v36, s53, v36
    v_mul_f32 v37, s53, v37
    v_mul_f32 v38, s53, v38
    v_mul_f32 v39, s53, v39
    v_cvt_pk_bf16_f32 v40, v32, v33
    v_cvt_pk_bf16_f32 v41, v34, v35
    v_cvt_pk_bf16_f32 v42, v36, v37
    v_cvt_pk_bf16_f32 v43, v38, v39
    s_add_u32 s54, s52, 100827136
    buffer_store_dwordx4 v[40:43], v2, s[8:11], s54 offen sc1
    v_accvgpr_read_b32 v44, a84
    v_accvgpr_read_b32 v45, a85
    v_accvgpr_read_b32 v46, a86
    v_accvgpr_read_b32 v47, a87
    v_accvgpr_read_b32 v48, a116
    v_accvgpr_read_b32 v49, a117
    v_accvgpr_read_b32 v50, a118
    v_accvgpr_read_b32 v51, a119
    v_cvt_pk_bf16_f32 v52, v44, v45
    v_cvt_pk_bf16_f32 v53, v46, v47
    v_cvt_pk_bf16_f32 v54, v48, v49
    v_cvt_pk_bf16_f32 v55, v50, v51
    s_add_u32 s54, s52, 105021440
    buffer_store_dwordx4 v[52:55], v2, s[8:11], s54 offen sc1
    v_accvgpr_read_b32 v8, a24
    v_accvgpr_read_b32 v9, a25
    v_accvgpr_read_b32 v10, a26
    v_accvgpr_read_b32 v11, a27
    v_mul_f32 v8, s53, v8
    v_mul_f32 v9, s53, v9
    v_mul_f32 v10, s53, v10
    v_mul_f32 v11, s53, v11
    v_accvgpr_read_b32 v12, a56
    v_accvgpr_read_b32 v13, a57
    v_accvgpr_read_b32 v14, a58
    v_accvgpr_read_b32 v15, a59
    v_mul_f32 v12, s53, v12
    v_mul_f32 v13, s53, v13
    v_mul_f32 v14, s53, v14
    v_mul_f32 v15, s53, v15
    v_cvt_pk_bf16_f32 v16, v8, v9
    v_cvt_pk_bf16_f32 v17, v10, v11
    v_cvt_pk_bf16_f32 v18, v12, v13
    v_cvt_pk_bf16_f32 v19, v14, v15
    s_add_u32 s54, s52, 100859904
    buffer_store_dwordx4 v[16:19], v2, s[8:11], s54 offen sc1
    v_accvgpr_read_b32 v20, a88
    v_accvgpr_read_b32 v21, a89
    v_accvgpr_read_b32 v22, a90
    v_accvgpr_read_b32 v23, a91
    v_accvgpr_read_b32 v24, a120
    v_accvgpr_read_b32 v25, a121
    v_accvgpr_read_b32 v26, a122
    v_accvgpr_read_b32 v27, a123
    v_cvt_pk_bf16_f32 v28, v20, v21
    v_cvt_pk_bf16_f32 v29, v22, v23
    v_cvt_pk_bf16_f32 v30, v24, v25
    v_cvt_pk_bf16_f32 v31, v26, v27
    s_add_u32 s54, s52, 105054208
    buffer_store_dwordx4 v[28:31], v2, s[8:11], s54 offen sc1
    v_accvgpr_read_b32 v32, a28
    v_accvgpr_read_b32 v33, a29
    v_accvgpr_read_b32 v34, a30
    v_accvgpr_read_b32 v35, a31
    v_mul_f32 v32, s53, v32
    v_mul_f32 v33, s53, v33
    v_mul_f32 v34, s53, v34
    v_mul_f32 v35, s53, v35
    v_accvgpr_read_b32 v36, a60
    v_accvgpr_read_b32 v37, a61
    v_accvgpr_read_b32 v38, a62
    v_accvgpr_read_b32 v39, a63
    v_mul_f32 v36, s53, v36
    v_mul_f32 v37, s53, v37
    v_mul_f32 v38, s53, v38
    v_mul_f32 v39, s53, v39
    v_cvt_pk_bf16_f32 v40, v32, v33
    v_cvt_pk_bf16_f32 v41, v34, v35
    v_cvt_pk_bf16_f32 v42, v36, v37
    v_cvt_pk_bf16_f32 v43, v38, v39
    s_add_u32 s54, s52, 100892672
    buffer_store_dwordx4 v[40:43], v2, s[8:11], s54 offen sc1
    v_accvgpr_read_b32 v44, a92
    v_accvgpr_read_b32 v45, a93
    v_accvgpr_read_b32 v46, a94
    v_accvgpr_read_b32 v47, a95
    v_accvgpr_read_b32 v48, a124
    v_accvgpr_read_b32 v49, a125
    v_accvgpr_read_b32 v50, a126
    v_accvgpr_read_b32 v51, a127
    v_cvt_pk_bf16_f32 v52, v44, v45
    v_cvt_pk_bf16_f32 v53, v46, v47
    v_cvt_pk_bf16_f32 v54, v48, v49
    v_cvt_pk_bf16_f32 v55, v50, v51
    s_add_u32 s54, s52, 105086976
    buffer_store_dwordx4 v[52:55], v2, s[8:11], s54 offen sc1
    s_waitcnt vmcnt(0)
    s_cmp_lg_u32 s4, 0
    s_cbranch_scc1 tki_223
    s_lshl_b32 s93, s83, 2
    s_add_u32 s93, s93, 176
    v_mov_b32 v250, s93
    v_mov_b32 v251, 1
    s_mov_b64 exec, 1
    global_atomic_add v249, v250, v251, s[98:99] sc0 sc1
    s_mov_b64 exec, -1
tki_223:
    s_waitcnt vmcnt(0) lgkmcnt(0)
    s_barrier
    s_cmp_lg_u32 s4, 0
    s_cbranch_scc1 sig_224
    v_mov_b32 v250, 48
    v_mov_b32 v251, 1
    s_mov_b64 exec, 1
    global_atomic_add v250, v251, s[98:99] sc1
    s_mov_b64 exec, -1
sig_224:
    s_branch L_next
ep_222:
    s_cmp_lg_u32 s58, 5
    s_cbranch_scc1 ep_225
    s_nop 11
    s_lshl_b32 s52, s5, 4
    s_lshl_b32 s22, s21, 3
    s_add_u32 s52, s52, s22
    s_mul_i32 s52, s52, 40960
    s_lshl_b32 s22, s7, 13
    s_add_u32 s52, s52, s22
    s_lshl_b32 s22, s20, 12
    s_add_u32 s52, s52, s22
    s_add_u32 s52, s52, 117440512
    s_add_u32 s54, s52, 0
    buffer_store_dwordx4 a[0:3], v2, s[8:11], s54 offen sc1
    s_add_u32 s54, s52, 1024
    buffer_store_dwordx4 a[32:35], v2, s[8:11], s54 offen sc1
    s_add_u32 s54, s52, 2048
    buffer_store_dwordx4 a[64:67], v2, s[8:11], s54 offen sc1
    s_add_u32 s54, s52, 3072
    buffer_store_dwordx4 a[96:99], v2, s[8:11], s54 offen sc1
    s_add_u32 s54, s52, 40960
    buffer_store_dwordx4 a[4:7], v2, s[8:11], s54 offen sc1
    s_add_u32 s54, s52, 41984
    buffer_store_dwordx4 a[36:39], v2, s[8:11], s54 offen sc1
    s_add_u32 s54, s52, 43008
    buffer_store_dwordx4 a[68:71], v2, s[8:11], s54 offen sc1
    s_add_u32 s54, s52, 44032
    buffer_store_dwordx4 a[100:103], v2, s[8:11], s54 offen sc1
    s_add_u32 s54, s52, 81920
    buffer_store_dwordx4 a[8:11], v2, s[8:11], s54 offen sc1
    s_add_u32 s54, s52, 82944
    buffer_store_dwordx4 a[40:43], v2, s[8:11], s54 offen sc1
    s_add_u32 s54, s52, 83968
    buffer_store_dwordx4 a[72:75], v2, s[8:11], s54 offen sc1
    s_add_u32 s54, s52, 84992
    buffer_store_dwordx4 a[104:107], v2, s[8:11], s54 offen sc1
    s_add_u32 s54, s52, 122880
    buffer_store_dwordx4 a[12:15], v2, s[8:11], s54 offen sc1
    s_add_u32 s54, s52, 123904
    buffer_store_dwordx4 a[44:47], v2, s[8:11], s54 offen sc1
    s_add_u32 s54, s52, 124928
    buffer_store_dwordx4 a[76:79], v2, s[8:11], s54 offen sc1
    s_add_u32 s54, s52, 125952
    buffer_store_dwordx4 a[108:111], v2, s[8:11], s54 offen sc1
    s_add_u32 s54, s52, 163840
    buffer_store_dwordx4 a[16:19], v2, s[8:11], s54 offen sc1
    s_add_u32 s54, s52, 164864
    buffer_store_dwordx4 a[48:51], v2, s[8:11], s54 offen sc1
    s_add_u32 s54, s52, 165888
    buffer_store_dwordx4 a[80:83], v2, s[8:11], s54 offen sc1
    s_add_u32 s54, s52, 166912
    buffer_store_dwordx4 a[112:115], v2, s[8:11], s54 offen sc1
    s_add_u32 s54, s52, 204800
    buffer_store_dwordx4 a[20:23], v2, s[8:11], s54 offen sc1
    s_add_u32 s54, s52, 205824
    buffer_store_dwordx4 a[52:55], v2, s[8:11], s54 offen sc1
    s_add_u32 s54, s52, 206848
    buffer_store_dwordx4 a[84:87], v2, s[8:11], s54 offen sc1
    s_add_u32 s54, s52, 207872
    buffer_store_dwordx4 a[116:119], v2, s[8:11], s54 offen sc1
    s_add_u32 s54, s52, 245760
    buffer_store_dwordx4 a[24:27], v2, s[8:11], s54 offen sc1
    s_add_u32 s54, s52, 246784
    buffer_store_dwordx4 a[56:59], v2, s[8:11], s54 offen sc1
    s_add_u32 s54, s52, 247808
    buffer_store_dwordx4 a[88:91], v2, s[8:11], s54 offen sc1
    s_add_u32 s54, s52, 248832
    buffer_store_dwordx4 a[120:123], v2, s[8:11], s54 offen sc1
    s_add_u32 s54, s52, 286720
    buffer_store_dwordx4 a[28:31], v2, s[8:11], s54 offen sc1
    s_add_u32 s54, s52, 287744
    buffer_store_dwordx4 a[60:63], v2, s[8:11], s54 offen sc1
    s_add_u32 s54, s52, 288768
    buffer_store_dwordx4 a[92:95], v2, s[8:11], s54 offen sc1
    s_add_u32 s54, s52, 289792
    buffer_store_dwordx4 a[124:127], v2, s[8:11], s54 offen sc1
    s_waitcnt vmcnt(0)
    s_lshl_b32 s21, s5, 2
    s_lshl_b32 s21, 1, s21
    s_cmp_lg_u32 s4, 0
    s_cbranch_scc1 tki_226
    s_lshl_b32 s93, s83, 2
    s_add_u32 s93, s93, 176
    v_mov_b32 v250, s93
    v_mov_b32 v251, 1
    s_mov_b64 exec, 1
    global_atomic_add v249, v250, v251, s[98:99] sc0 sc1
    s_mov_b64 exec, -1
tki_226:
    s_waitcnt vmcnt(0) lgkmcnt(0)
    s_barrier
    s_cmp_lg_u32 s4, 0
    s_cbranch_scc1 sig_227
    v_mov_b32 v250, 68
    v_mov_b32 v251, s21
    s_mov_b64 exec, 1
    global_atomic_add v250, v251, s[98:99] sc1
    s_mov_b64 exec, -1
sig_227:
    s_branch L_next
ep_225:
    s_branch L_next
LMAINC_102:
    s_and_b32 s20, s4, 1
    s_lshr_b32 s21, s4, 1
    s_lshl_b32 s33, s5, 14
    s_lshl_b32 s22, s4, 12
    s_add_u32 s33, s33, s22
    s_add_u32 s33, s33, s81
    s_lshl_b32 s32, s7, 13
    s_lshl_b32 s22, s4, 11
    s_add_u32 s32, s32, s22
    s_add_u32 s32, s32, s59
    s_lshl_b32 s34, s4, 11
    s_lshl_b32 s35, s4, 12
    s_add_u32 s35, s35, 8192
    s_mov_b32 s25, 0
    s_lshl_b32 s22, s20, 12
    v_add_u32 v5, s22, v2
    s_lshl_b32 s22, s21, 13
    s_add_u32 s22, s22, 8192
    v_add_u32 v6, s22, v2
    v_add_u32 v105, 49152, v5
    v_add_u32 v106, 49152, v6
    v_accvgpr_write_b32 a0, 0
    v_accvgpr_write_b32 a1, 0
    v_accvgpr_write_b32 a2, 0
    v_accvgpr_write_b32 a3, 0
    v_accvgpr_write_b32 a4, 0
    v_accvgpr_write_b32 a5, 0
    v_accvgpr_write_b32 a6, 0
    v_accvgpr_write_b32 a7, 0
    v_accvgpr_write_b32 a8, 0
    v_accvgpr_write_b32 a9, 0
    v_accvgpr_write_b32 a10, 0
    v_accvgpr_write_b32 a11, 0
    v_accvgpr_write_b32 a12, 0
    v_accvgpr_write_b32 a13, 0
    v_accvgpr_write_b32 a14, 0
    v_accvgpr_write_b32 a15, 0
    v_accvgpr_write_b32 a16, 0
    v_accvgpr_write_b32 a17, 0
    v_accvgpr_write_b32 a18, 0
    v_accvgpr_write_b32 a19, 0
    v_accvgpr_write_b32 a20, 0
    v_accvgpr_write_b32 a21, 0
    v_accvgpr_write_b32 a22, 0
    v_accvgpr_write_b32 a23, 0
    v_accvgpr_write_b32 a24, 0
    v_accvgpr_write_b32 a25, 0
    v_accvgpr_write_b32 a26, 0
    v_accvgpr_write_b32 a27, 0
    v_accvgpr_write_b32 a28, 0
    v_accvgpr_write_b32 a29, 0
    v_accvgpr_write_b32 a30, 0
    v_accvgpr_write_b32 a31, 0
    v_accvgpr_write_b32 a32, 0
    v_accvgpr_write_b32 a33, 0
    v_accvgpr_write_b32 a34, 0
    v_accvgpr_write_b32 a35, 0
    v_accvgpr_write_b32 a36, 0
    v_accvgpr_write_b32 a37, 0
    v_accvgpr_write_b32 a38, 0
    v_accvgpr_write_b32 a39, 0
    v_accvgpr_write_b32 a40, 0
    v_accvgpr_write_b32 a41, 0
    v_accvgpr_write_b32 a42, 0
    v_accvgpr_write_b32 a43, 0
    v_accvgpr_write_b32 a44, 0
    v_accvgpr_write_b32 a45, 0
    v_accvgpr_write_b32 a46, 0
    v_accvgpr_write_b32 a47, 0
    v_accvgpr_write_b32 a48, 0
    v_accvgpr_write_b32 a49, 0
    v_accvgpr_write_b32 a50, 0
    v_accvgpr_write_b32 a51, 0
    v_accvgpr_write_b32 a52, 0
    v_accvgpr_write_b32 a53, 0
    v_accvgpr_write_b32 a54, 0
    v_accvgpr_write_b32 a55, 0
    v_accvgpr_write_b32 a56, 0
    v_accvgpr_write_b32 a57, 0
    v_accvgpr_write_b32 a58, 0
    v_accvgpr_write_b32 a59, 0
    v_accvgpr_write_b32 a60, 0
    v_accvgpr_write_b32 a61, 0
    v_accvgpr_write_b32 a62, 0
    v_accvgpr_write_b32 a63, 0
    v_accvgpr_write_b32 a64, 0
    v_accvgpr_write_b32 a65, 0
    v_accvgpr_write_b32 a66, 0
    v_accvgpr_write_b32 a67, 0
    v_accvgpr_write_b32 a68, 0
    v_accvgpr_write_b32 a69, 0
    v_accvgpr_write_b32 a70, 0
    v_accvgpr_write_b32 a71, 0
    v_accvgpr_write_b32 a72, 0
    v_accvgpr_write_b32 a73, 0
    v_accvgpr_write_b32 a74, 0
    v_accvgpr_write_b32 a75, 0
    v_accvgpr_write_b32 a76, 0
    v_accvgpr_write_b32 a77, 0
    v_accvgpr_write_b32 a78, 0
    v_accvgpr_write_b32 a79, 0
    v_accvgpr_write_b32 a80, 0
    v_accvgpr_write_b32 a81, 0
    v_accvgpr_write_b32 a82, 0
    v_accvgpr_write_b32 a83, 0
    v_accvgpr_write_b32 a84, 0
    v_accvgpr_write_b32 a85, 0
    v_accvgpr_write_b32 a86, 0
    v_accvgpr_write_b32 a87, 0
    v_accvgpr_write_b32 a88, 0
    v_accvgpr_write_b32 a89, 0
    v_accvgpr_write_b32 a90, 0
    v_accvgpr_write_b32 a91, 0
    v_accvgpr_write_b32 a92, 0
    v_accvgpr_write_b32 a93, 0
    v_accvgpr_write_b32 a94, 0
    v_accvgpr_write_b32 a95, 0
    v_accvgpr_write_b32 a96, 0
    v_accvgpr_write_b32 a97, 0
    v_accvgpr_write_b32 a98, 0
    v_accvgpr_write_b32 a99, 0
    v_accvgpr_write_b32 a100, 0
    v_accvgpr_write_b32 a101, 0
    v_accvgpr_write_b32 a102, 0
    v_accvgpr_write_b32 a103, 0
    v_accvgpr_write_b32 a104, 0
    v_accvgpr_write_b32 a105, 0
    v_accvgpr_write_b32 a106, 0
    v_accvgpr_write_b32 a107, 0
    v_accvgpr_write_b32 a108, 0
    v_accvgpr_write_b32 a109, 0
    v_accvgpr_write_b32 a110, 0
    v_accvgpr_write_b32 a111, 0
    v_accvgpr_write_b32 a112, 0
    v_accvgpr_write_b32 a113, 0
    v_accvgpr_write_b32 a114, 0
    v_accvgpr_write_b32 a115, 0
    v_accvgpr_write_b32 a116, 0
    v_accvgpr_write_b32 a117, 0
    v_accvgpr_write_b32 a118, 0
    v_accvgpr_write_b32 a119, 0
    v_accvgpr_write_b32 a120, 0
    v_accvgpr_write_b32 a121, 0
    v_accvgpr_write_b32 a122, 0
    v_accvgpr_write_b32 a123, 0
    v_accvgpr_write_b32 a124, 0
    v_accvgpr_write_b32 a125, 0
    v_accvgpr_write_b32 a126, 0
    v_accvgpr_write_b32 a127, 0
    s_add_u32 m0, s34, 0
    s_nop 0
    buffer_load_dwordx4 v2, s[8:11], s32 offen offset:0 lds
    buffer_load_dwordx4 v2, s[8:11], s32 offen offset:1024 lds
    s_add_u32 m0, s35, 0
    s_nop 0
    buffer_load_dwordx4 v2, s[8:11], s33 offen offset:0 lds
    buffer_load_dwordx4 v2, s[8:11], s33 offen offset:1024 lds
    buffer_load_dwordx4 v2, s[8:11], s33 offen offset:2048 lds
    buffer_load_dwordx4 v2, s[8:11], s33 offen offset:3072 lds
    s_add_u32 s32, s32, s80
    s_add_u32 s33, s33, 131072
    s_add_u32 m0, s34, 24576
    s_nop 0
    buffer_load_dwordx4 v2, s[8:11], s32 offen offset:0 lds
    buffer_load_dwordx4 v2, s[8:11], s32 offen offset:1024 lds
    s_add_u32 m0, s35, 24576
    s_nop 0
    buffer_load_dwordx4 v2, s[8:11], s33 offen offset:0 lds
    buffer_load_dwordx4 v2, s[8:11], s33 offen offset:1024 lds
    buffer_load_dwordx4 v2, s[8:11], s33 offen offset:2048 lds
    buffer_load_dwordx4 v2, s[8:11], s33 offen offset:3072 lds
    s_add_u32 s32, s32, s80
    s_add_u32 s33, s33, 131072
    s_add_u32 m0, s34, 49152
    s_nop 0
    buffer_load_dwordx4 v2, s[8:11], s32 offen offset:0 lds
    buffer_load_dwordx4 v2, s[8:11], s32 offen offset:1024 lds
    s_add_u32 m0, s35, 49152
    s_nop 0
    buffer_load_dwordx4 v2, s[8:11], s33 offen offset:0 lds
    buffer_load_dwordx4 v2, s[8:11], s33 offen offset:1024 lds
    buffer_load_dwordx4 v2, s[8:11], s33 offen offset:2048 lds
    buffer_load_dwordx4 v2, s[8:11], s33 offen offset:3072 lds
    s_add_u32 s32, s32, s80
    s_add_u32 s33, s33, 131072
    s_add_u32 m0, s34, 73728
    s_nop 0
    buffer_load_dwordx4 v2, s[8:11], s32 offen offset:0 lds
    buffer_load_dwordx4 v2, s[8:11], s32 offen offset:1024 lds
    s_add_u32 m0, s35, 73728
    s_nop 0
    buffer_load_dwordx4 v2, s[8:11], s33 offen offset:0 lds
    buffer_load_dwordx4 v2, s[8:11], s33 offen offset:1024 lds
    buffer_load_dwordx4 v2, s[8:11], s33 offen offset:2048 lds
    buffer_load_dwordx4 v2, s[8:11], s33 offen offset:3072 lds
    s_add_u32 s32, s32, s80
    s_add_u32 s33, s33, 131072
    s_waitcnt vmcnt(18)
    s_barrier
    ds_read_b128 v[8:11], v5 offset:0
    ds_read_b128 v[12:15], v5 offset:1024
    ds_read_b128 v[16:19], v5 offset:2048
    ds_read_b128 v[20:23], v5 offset:3072
    ds_read_b128 v[24:27], v6 offset:0
    ds_read_b128 v[28:31], v6 offset:1024
    ds_read_b128 v[32:35], v6 offset:2048
    ds_read_b128 v[36:39], v6 offset:3072
    ds_read_b128 v[40:43], v6 offset:4096
    ds_read_b128 v[44:47], v6 offset:5120
    ds_read_b128 v[48:51], v6 offset:6144
    ds_read_b128 v[52:55], v6 offset:7168
t1l_228:
    s_waitcnt vmcnt(12) lgkmcnt(0)
    s_barrier
    v_mfma_f32_16x16x32_bf16 a[0:3], v[24:27], v[8:11], a[0:3]
    ds_read_b128 v[56:59], v5 offset:24576
    v_mfma_f32_16x16x32_bf16 a[32:35], v[24:27], v[12:15], a[32:35]
    ds_read_b128 v[60:63], v5 offset:25600
    v_mfma_f32_16x16x32_bf16 a[64:67], v[24:27], v[16:19], a[64:67]
    ds_read_b128 v[64:67], v5 offset:26624
    v_mfma_f32_16x16x32_bf16 a[96:99], v[24:27], v[20:23], a[96:99]
    ds_read_b128 v[68:71], v5 offset:27648
    v_mfma_f32_16x16x32_bf16 a[4:7], v[28:31], v[8:11], a[4:7]
    s_add_u32 m0, s34, 0
    v_mfma_f32_16x16x32_bf16 a[36:39], v[28:31], v[12:15], a[36:39]
    buffer_load_dwordx4 v2, s[8:11], s32 offen offset:0 lds
    v_mfma_f32_16x16x32_bf16 a[68:71], v[28:31], v[16:19], a[68:71]
    buffer_load_dwordx4 v2, s[8:11], s32 offen offset:1024 lds
    v_mfma_f32_16x16x32_bf16 a[100:103], v[28:31], v[20:23], a[100:103]
    s_add_u32 m0, s35, 0
    v_mfma_f32_16x16x32_bf16 a[8:11], v[32:35], v[8:11], a[8:11]
    buffer_load_dwordx4 v2, s[8:11], s33 offen offset:0 lds
    v_mfma_f32_16x16x32_bf16 a[40:43], v[32:35], v[12:15], a[40:43]
    buffer_load_dwordx4 v2, s[8:11], s33 offen offset:1024 lds
    v_mfma_f32_16x16x32_bf16 a[72:75], v[32:35], v[16:19], a[72:75]
    buffer_load_dwordx4 v2, s[8:11], s33 offen offset:2048 lds
    v_mfma_f32_16x16x32_bf16 a[104:107], v[32:35], v[20:23], a[104:107]
    buffer_load_dwordx4 v2, s[8:11], s33 offen offset:3072 lds
    v_mfma_f32_16x16x32_bf16 a[12:15], v[36:39], v[8:11], a[12:15]
    s_add_u32 s32, s32, s80
    v_mfma_f32_16x16x32_bf16 a[44:47], v[36:39], v[12:15], a[44:47]
    s_add_u32 s33, s33, 131072
    v_mfma_f32_16x16x32_bf16 a[76:79], v[36:39], v[16:19], a[76:79]
    ds_read_b128 v[72:75], v6 offset:24576
    v_mfma_f32_16x16x32_bf16 a[108:111], v[36:39], v[20:23], a[108:111]
    ds_read_b128 v[76:79], v6 offset:25600
    v_mfma_f32_16x16x32_bf16 a[16:19], v[40:43], v[8:11], a[16:19]
    ds_read_b128 v[80:83], v6 offset:26624
    v_mfma_f32_16x16x32_bf16 a[48:51], v[40:43], v[12:15], a[48:51]
    ds_read_b128 v[84:87], v6 offset:27648
    v_mfma_f32_16x16x32_bf16 a[80:83], v[40:43], v[16:19], a[80:83]
    ds_read_b128 v[88:91], v6 offset:28672
    v_mfma_f32_16x16x32_bf16 a[112:115], v[40:43], v[20:23], a[112:115]
    ds_read_b128 v[92:95], v6 offset:29696
    v_mfma_f32_16x16x32_bf16 a[20:23], v[44:47], v[8:11], a[20:23]
    ds_read_b128 v[96:99], v6 offset:30720
    v_mfma_f32_16x16x32_bf16 a[52:55], v[44:47], v[12:15], a[52:55]
    ds_read_b128 v[100:103], v6 offset:31744
    v_mfma_f32_16x16x32_bf16 a[84:87], v[44:47], v[16:19], a[84:87]
    v_mfma_f32_16x16x32_bf16 a[116:119], v[44:47], v[20:23], a[116:119]
    v_mfma_f32_16x16x32_bf16 a[24:27], v[48:51], v[8:11], a[24:27]
    v_mfma_f32_16x16x32_bf16 a[56:59], v[48:51], v[12:15], a[56:59]
    v_mfma_f32_16x16x32_bf16 a[88:91], v[48:51], v[16:19], a[88:91]
    v_mfma_f32_16x16x32_bf16 a[120:123], v[48:51], v[20:23], a[120:123]
    v_mfma_f32_16x16x32_bf16 a[28:31], v[52:55], v[8:11], a[28:31]
    v_mfma_f32_16x16x32_bf16 a[60:63], v[52:55], v[12:15], a[60:63]
    v_mfma_f32_16x16x32_bf16 a[92:95], v[52:55], v[16:19], a[92:95]
    v_mfma_f32_16x16x32_bf16 a[124:127], v[52:55], v[20:23], a[124:127]
    s_waitcnt vmcnt(12) lgkmcnt(0)
    s_barrier
    v_mfma_f32_16x16x32_bf16 a[0:3], v[72:75], v[56:59], a[0:3]
    ds_read_b128 v[8:11], v105 offset:0
    v_mfma_f32_16x16x32_bf16 a[32:35], v[72:75], v[60:63], a[32:35]
    ds_read_b128 v[12:15], v105 offset:1024
    v_mfma_f32_16x16x32_bf16 a[64:67], v[72:75], v[64:67], a[64:67]
    ds_read_b128 v[16:19], v105 offset:2048
    v_mfma_f32_16x16x32_bf16 a[96:99], v[72:75], v[68:71], a[96:99]
    ds_read_b128 v[20:23], v105 offset:3072
    v_mfma_f32_16x16x32_bf16 a[4:7], v[76:79], v[56:59], a[4:7]
    s_add_u32 m0, s34, 24576
    v_mfma_f32_16x16x32_bf16 a[36:39], v[76:79], v[60:63], a[36:39]
    buffer_load_dwordx4 v2, s[8:11], s32 offen offset:0 lds
    v_mfma_f32_16x16x32_bf16 a[68:71], v[76:79], v[64:67], a[68:71]
    buffer_load_dwordx4 v2, s[8:11], s32 offen offset:1024 lds
    v_mfma_f32_16x16x32_bf16 a[100:103], v[76:79], v[68:71], a[100:103]
    s_add_u32 m0, s35, 24576
    v_mfma_f32_16x16x32_bf16 a[8:11], v[80:83], v[56:59], a[8:11]
    buffer_load_dwordx4 v2, s[8:11], s33 offen offset:0 lds
    v_mfma_f32_16x16x32_bf16 a[40:43], v[80:83], v[60:63], a[40:43]
    buffer_load_dwordx4 v2, s[8:11], s33 offen offset:1024 lds
    v_mfma_f32_16x16x32_bf16 a[72:75], v[80:83], v[64:67], a[72:75]
    buffer_load_dwordx4 v2, s[8:11], s33 offen offset:2048 lds
    v_mfma_f32_16x16x32_bf16 a[104:107], v[80:83], v[68:71], a[104:107]
    buffer_load_dwordx4 v2, s[8:11], s33 offen offset:3072 lds
    v_mfma_f32_16x16x32_bf16 a[12:15], v[84:87], v[56:59], a[12:15]
    s_add_u32 s32, s32, s80
    v_mfma_f32_16x16x32_bf16 a[44:47], v[84:87], v[60:63], a[44:47]
    s_add_u32 s33, s33, 131072
    v_mfma_f32_16x16x32_bf16 a[76:79], v[84:87], v[64:67], a[76:79]
    ds_read_b128 v[24:27], v106 offset:0
    v_mfma_f32_16x16x32_bf16 a[108:111], v[84:87], v[68:71], a[108:111]
    ds_read_b128 v[28:31], v106 offset:1024
    v_mfma_f32_16x16x32_bf16 a[16:19], v[88:91], v[56:59], a[16:19]
    ds_read_b128 v[32:35], v106 offset:2048
    v_mfma_f32_16x16x32_bf16 a[48:51], v[88:91], v[60:63], a[48:51]
    ds_read_b128 v[36:39], v106 offset:3072
    v_mfma_f32_16x16x32_bf16 a[80:83], v[88:91], v[64:67], a[80:83]
    ds_read_b128 v[40:43], v106 offset:4096
    v_mfma_f32_16x16x32_bf16 a[112:115], v[88:91], v[68:71], a[112:115]
    ds_read_b128 v[44:47], v106 offset:5120
    v_mfma_f32_16x16x32_bf16 a[20:23], v[92:95], v[56:59], a[20:23]
    ds_read_b128 v[48:51], v106 offset:6144
    v_mfma_f32_16x16x32_bf16 a[52:55], v[92:95], v[60:63], a[52:55]
    ds_read_b128 v[52:55], v106 offset:7168
    v_mfma_f32_16x16x32_bf16 a[84:87], v[92:95], v[64:67], a[84:87]
    v_mfma_f32_16x16x32_bf16 a[116:119], v[92:95], v[68:71], a[116:119]
    v_mfma_f32_16x16x32_bf16 a[24:27], v[96:99], v[56:59], a[24:27]
    v_mfma_f32_16x16x32_bf16 a[56:59], v[96:99], v[60:63], a[56:59]
    v_mfma_f32_16x16x32_bf16 a[88:91], v[96:99], v[64:67], a[88:91]
    v_mfma_f32_16x16x32_bf16 a[120:123], v[96:99], v[68:71], a[120:123]
    v_mfma_f32_16x16x32_bf16 a[28:31], v[100:103], v[56:59], a[28:31]
    v_mfma_f32_16x16x32_bf16 a[60:63], v[100:103], v[60:63], a[60:63]
    v_mfma_f32_16x16x32_bf16 a[92:95], v[100:103], v[64:67], a[92:95]
    v_mfma_f32_16x16x32_bf16 a[124:127], v[100:103], v[68:71], a[124:127]
    s_waitcnt vmcnt(12) lgkmcnt(0)
    s_barrier
    v_mfma_f32_16x16x32_bf16 a[0:3], v[24:27], v[8:11], a[0:3]
    ds_read_b128 v[56:59], v105 offset:24576
    v_mfma_f32_16x16x32_bf16 a[32:35], v[24:27], v[12:15], a[32:35]
    ds_read_b128 v[60:63], v105 offset:25600
    v_mfma_f32_16x16x32_bf16 a[64:67], v[24:27], v[16:19], a[64:67]
    ds_read_b128 v[64:67], v105 offset:26624
    v_mfma_f32_16x16x32_bf16 a[96:99], v[24:27], v[20:23], a[96:99]
    ds_read_b128 v[68:71], v105 offset:27648
    v_mfma_f32_16x16x32_bf16 a[4:7], v[28:31], v[8:11], a[4:7]
    s_add_u32 m0, s34, 49152
    v_mfma_f32_16x16x32_bf16 a[36:39], v[28:31], v[12:15], a[36:39]
    buffer_load_dwordx4 v2, s[8:11], s32 offen offset:0 lds
    v_mfma_f32_16x16x32_bf16 a[68:71], v[28:31], v[16:19], a[68:71]
    buffer_load_dwordx4 v2, s[8:11], s32 offen offset:1024 lds
    v_mfma_f32_16x16x32_bf16 a[100:103], v[28:31], v[20:23], a[100:103]
    s_add_u32 m0, s35, 49152
    v_mfma_f32_16x16x32_bf16 a[8:11], v[32:35], v[8:11], a[8:11]
    buffer_load_dwordx4 v2, s[8:11], s33 offen offset:0 lds
    v_mfma_f32_16x16x32_bf16 a[40:43], v[32:35], v[12:15], a[40:43]
    buffer_load_dwordx4 v2, s[8:11], s33 offen offset:1024 lds
    v_mfma_f32_16x16x32_bf16 a[72:75], v[32:35], v[16:19], a[72:75]
    buffer_load_dwordx4 v2, s[8:11], s33 offen offset:2048 lds
    v_mfma_f32_16x16x32_bf16 a[104:107], v[32:35], v[20:23], a[104:107]
    buffer_load_dwordx4 v2, s[8:11], s33 offen offset:3072 lds
    v_mfma_f32_16x16x32_bf16 a[12:15], v[36:39], v[8:11], a[12:15]
    s_add_u32 s32, s32, s80
    v_mfma_f32_16x16x32_bf16 a[44:47], v[36:39], v[12:15], a[44:47]
    s_add_u32 s33, s33, 131072
    v_mfma_f32_16x16x32_bf16 a[76:79], v[36:39], v[16:19], a[76:79]
    ds_read_b128 v[72:75], v106 offset:24576
    v_mfma_f32_16x16x32_bf16 a[108:111], v[36:39], v[20:23], a[108:111]
    ds_read_b128 v[76:79], v106 offset:25600
    v_mfma_f32_16x16x32_bf16 a[16:19], v[40:43], v[8:11], a[16:19]
    ds_read_b128 v[80:83], v106 offset:26624
    v_mfma_f32_16x16x32_bf16 a[48:51], v[40:43], v[12:15], a[48:51]
    ds_read_b128 v[84:87], v106 offset:27648
    v_mfma_f32_16x16x32_bf16 a[80:83], v[40:43], v[16:19], a[80:83]
    ds_read_b128 v[88:91], v106 offset:28672
    v_mfma_f32_16x16x32_bf16 a[112:115], v[40:43], v[20:23], a[112:115]
    ds_read_b128 v[92:95], v106 offset:29696
    v_mfma_f32_16x16x32_bf16 a[20:23], v[44:47], v[8:11], a[20:23]
    ds_read_b128 v[96:99], v106 offset:30720
    v_mfma_f32_16x16x32_bf16 a[52:55], v[44:47], v[12:15], a[52:55]
    ds_read_b128 v[100:103], v106 offset:31744
    v_mfma_f32_16x16x32_bf16 a[84:87], v[44:47], v[16:19], a[84:87]
    v_mfma_f32_16x16x32_bf16 a[116:119], v[44:47], v[20:23], a[116:119]
    v_mfma_f32_16x16x32_bf16 a[24:27], v[48:51], v[8:11], a[24:27]
    v_mfma_f32_16x16x32_bf16 a[56:59], v[48:51], v[12:15], a[56:59]
    v_mfma_f32_16x16x32_bf16 a[88:91], v[48:51], v[16:19], a[88:91]
    v_mfma_f32_16x16x32_bf16 a[120:123], v[48:51], v[20:23], a[120:123]
    v_mfma_f32_16x16x32_bf16 a[28:31], v[52:55], v[8:11], a[28:31]
    v_mfma_f32_16x16x32_bf16 a[60:63], v[52:55], v[12:15], a[60:63]
    v_mfma_f32_16x16x32_bf16 a[92:95], v[52:55], v[16:19], a[92:95]
    v_mfma_f32_16x16x32_bf16 a[124:127], v[52:55], v[20:23], a[124:127]
    s_waitcnt vmcnt(12) lgkmcnt(0)
    s_barrier
    v_mfma_f32_16x16x32_bf16 a[0:3], v[72:75], v[56:59], a[0:3]
    ds_read_b128 v[8:11], v5 offset:0
    v_mfma_f32_16x16x32_bf16 a[32:35], v[72:75], v[60:63], a[32:35]
    ds_read_b128 v[12:15], v5 offset:1024
    v_mfma_f32_16x16x32_bf16 a[64:67], v[72:75], v[64:67], a[64:67]
    ds_read_b128 v[16:19], v5 offset:2048
    v_mfma_f32_16x16x32_bf16 a[96:99], v[72:75], v[68:71], a[96:99]
    ds_read_b128 v[20:23], v5 offset:3072
    v_mfma_f32_16x16x32_bf16 a[4:7], v[76:79], v[56:59], a[4:7]
    s_add_u32 m0, s34, 73728
    v_mfma_f32_16x16x32_bf16 a[36:39], v[76:79], v[60:63], a[36:39]
    buffer_load_dwordx4 v2, s[8:11], s32 offen offset:0 lds
    v_mfma_f32_16x16x32_bf16 a[68:71], v[76:79], v[64:67], a[68:71]
    buffer_load_dwordx4 v2, s[8:11], s32 offen offset:1024 lds
    v_mfma_f32_16x16x32_bf16 a[100:103], v[76:79], v[68:71], a[100:103]
    s_add_u32 m0, s35, 73728
    v_mfma_f32_16x16x32_bf16 a[8:11], v[80:83], v[56:59], a[8:11]
    buffer_load_dwordx4 v2, s[8:11], s33 offen offset:0 lds
    v_mfma_f32_16x16x32_bf16 a[40:43], v[80:83], v[60:63], a[40:43]
    buffer_load_dwordx4 v2, s[8:11], s33 offen offset:1024 lds
    v_mfma_f32_16x16x32_bf16 a[72:75], v[80:83], v[64:67], a[72:75]
    buffer_load_dwordx4 v2, s[8:11], s33 offen offset:2048 lds
    v_mfma_f32_16x16x32_bf16 a[104:107], v[80:83], v[68:71], a[104:107]
    buffer_load_dwordx4 v2, s[8:11], s33 offen offset:3072 lds
    v_mfma_f32_16x16x32_bf16 a[12:15], v[84:87], v[56:59], a[12:15]
    s_add_u32 s32, s32, s80
    v_mfma_f32_16x16x32_bf16 a[44:47], v[84:87], v[60:63], a[44:47]
    s_add_u32 s33, s33, 131072
    v_mfma_f32_16x16x32_bf16 a[76:79], v[84:87], v[64:67], a[76:79]
    ds_read_b128 v[24:27], v6 offset:0
    v_mfma_f32_16x16x32_bf16 a[108:111], v[84:87], v[68:71], a[108:111]
    ds_read_b128 v[28:31], v6 offset:1024
    v_mfma_f32_16x16x32_bf16 a[16:19], v[88:91], v[56:59], a[16:19]
    ds_read_b128 v[32:35], v6 offset:2048
    v_mfma_f32_16x16x32_bf16 a[48:51], v[88:91], v[60:63], a[48:51]
    ds_read_b128 v[36:39], v6 offset:3072
    v_mfma_f32_16x16x32_bf16 a[80:83], v[88:91], v[64:67], a[80:83]
    ds_read_b128 v[40:43], v6 offset:4096
    v_mfma_f32_16x16x32_bf16 a[112:115], v[88:91], v[68:71], a[112:115]
    ds_read_b128 v[44:47], v6 offset:5120
    v_mfma_f32_16x16x32_bf16 a[20:23], v[92:95], v[56:59], a[20:23]
    ds_read_b128 v[48:51], v6 offset:6144
    v_mfma_f32_16x16x32_bf16 a[52:55], v[92:95], v[60:63], a[52:55]
    ds_read_b128 v[52:55], v6 offset:7168
    v_mfma_f32_16x16x32_bf16 a[84:87], v[92:95], v[64:67], a[84:87]
    v_mfma_f32_16x16x32_bf16 a[116:119], v[92:95], v[68:71], a[116:119]
    v_mfma_f32_16x16x32_bf16 a[24:27], v[96:99], v[56:59], a[24:27]
    v_mfma_f32_16x16x32_bf16 a[56:59], v[96:99], v[60:63], a[56:59]
    v_mfma_f32_16x16x32_bf16 a[88:91], v[96:99], v[64:67], a[88:91]
    v_mfma_f32_16x16x32_bf16 a[120:123], v[96:99], v[68:71], a[120:123]
    v_mfma_f32_16x16x32_bf16 a[28:31], v[100:103], v[56:59], a[28:31]
    v_mfma_f32_16x16x32_bf16 a[60:63], v[100:103], v[60:63], a[60:63]
    v_mfma_f32_16x16x32_bf16 a[92:95], v[100:103], v[64:67], a[92:95]
    v_mfma_f32_16x16x32_bf16 a[124:127], v[100:103], v[68:71], a[124:127]
    s_add_u32 s25, s25, 1
    s_cmp_lt_u32 s25, s82
    s_cbranch_scc1 t1l_228
    s_waitcnt vmcnt(0) lgkmcnt(0)
    s_barrier
    s_cmp_lg_u32 s58, 3
    s_cbranch_scc1 ep_229
    s_nop 11
    s_lshl_b32 s52, s5, 3
    s_lshl_b32 s22, s21, 2
    s_add_u32 s52, s52, s22
    s_lshl_b32 s52, s52, 5
    s_add_u32 s52, s52, s7
    s_lshl_b32 s52, s52, 13
    s_lshl_b32 s22, s20, 12
    s_add_u32 s52, s52, s22
    s_add_u32 s52, s52, 33554432
    v_accvgpr_read_b32 v8, a0
    v_accvgpr_read_b32 v9, a1
    v_accvgpr_read_b32 v10, a2
    v_accvgpr_read_b32 v11, a3
    v_accvgpr_read_b32 v12, a4
    v_accvgpr_read_b32 v13, a5
    v_accvgpr_read_b32 v14, a6
    v_accvgpr_read_b32 v15, a7
    v_cvt_pk_bf16_f32 v16, v8, v9
    v_cvt_pk_bf16_f32 v17, v10, v11
    v_cvt_pk_bf16_f32 v18, v12, v13
    v_cvt_pk_bf16_f32 v19, v14, v15
    s_add_u32 s54, s52, 0
    buffer_store_dwordx4 v[16:19], v2, s[8:11], s54 offen sc1
    v_accvgpr_read_b32 v20, a32
    v_accvgpr_read_b32 v21, a33
    v_accvgpr_read_b32 v22, a34
    v_accvgpr_read_b32 v23, a35
    v_accvgpr_read_b32 v24, a36
    v_accvgpr_read_b32 v25, a37
    v_accvgpr_read_b32 v26, a38
    v_accvgpr_read_b32 v27, a39
    v_cvt_pk_bf16_f32 v28, v20, v21
    v_cvt_pk_bf16_f32 v29, v22, v23
    v_cvt_pk_bf16_f32 v30, v24, v25
    v_cvt_pk_bf16_f32 v31, v26, v27
    s_add_u32 s54, s52, 1024
    buffer_store_dwordx4 v[28:31], v2, s[8:11], s54 offen sc1
    v_accvgpr_read_b32 v32, a64
    v_accvgpr_read_b32 v33, a65
    v_accvgpr_read_b32 v34, a66
    v_accvgpr_read_b32 v35, a67
    v_accvgpr_read_b32 v36, a68
    v_accvgpr_read_b32 v37, a69
    v_accvgpr_read_b32 v38, a70
    v_accvgpr_read_b32 v39, a71
    v_cvt_pk_bf16_f32 v40, v32, v33
    v_cvt_pk_bf16_f32 v41, v34, v35
    v_cvt_pk_bf16_f32 v42, v36, v37
    v_cvt_pk_bf16_f32 v43, v38, v39
    s_add_u32 s54, s52, 2048
    buffer_store_dwordx4 v[40:43], v2, s[8:11], s54 offen sc1
    v_accvgpr_read_b32 v44, a96
    v_accvgpr_read_b32 v45, a97
    v_accvgpr_read_b32 v46, a98
    v_accvgpr_read_b32 v47, a99
    v_accvgpr_read_b32 v48, a100
    v_accvgpr_read_b32 v49, a101
    v_accvgpr_read_b32 v50, a102
    v_accvgpr_read_b32 v51, a103
    v_cvt_pk_bf16_f32 v52, v44, v45
    v_cvt_pk_bf16_f32 v53, v46, v47
    v_cvt_pk_bf16_f32 v54, v48, v49
    v_cvt_pk_bf16_f32 v55, v50, v51
    s_add_u32 s54, s52, 3072
    buffer_store_dwordx4 v[52:55], v2, s[8:11], s54 offen sc1
    v_accvgpr_read_b32 v8, a8
    v_accvgpr_read_b32 v9, a9
    v_accvgpr_read_b32 v10, a10
    v_accvgpr_read_b32 v11, a11
    v_accvgpr_read_b32 v12, a12
    v_accvgpr_read_b32 v13, a13
    v_accvgpr_read_b32 v14, a14
    v_accvgpr_read_b32 v15, a15
    v_cvt_pk_bf16_f32 v16, v8, v9
    v_cvt_pk_bf16_f32 v17, v10, v11
    v_cvt_pk_bf16_f32 v18, v12, v13
    v_cvt_pk_bf16_f32 v19, v14, v15
    s_add_u32 s54, s52, 262144
    buffer_store_dwordx4 v[16:19], v2, s[8:11], s54 offen sc1
    v_accvgpr_read_b32 v20, a40
    v_accvgpr_read_b32 v21, a41
    v_accvgpr_read_b32 v22, a42
    v_accvgpr_read_b32 v23, a43
    v_accvgpr_read_b32 v24, a44
    v_accvgpr_read_b32 v25, a45
    v_accvgpr_read_b32 v26, a46
    v_accvgpr_read_b32 v27, a47
    v_cvt_pk_bf16_f32 v28, v20, v21
    v_cvt_pk_bf16_f32 v29, v22, v23
    v_cvt_pk_bf16_f32 v30, v24, v25
    v_cvt_pk_bf16_f32 v31, v26, v27
    s_add_u32 s54, s52, 263168
    buffer_store_dwordx4 v[28:31], v2, s[8:11], s54 offen sc1
    v_accvgpr_read_b32 v32, a72
    v_accvgpr_read_b32 v33, a73
    v_accvgpr_read_b32 v34, a74
    v_accvgpr_read_b32 v35, a75
    v_accvgpr_read_b32 v36, a76
    v_accvgpr_read_b32 v37, a77
    v_accvgpr_read_b32 v38, a78
    v_accvgpr_read_b32 v39, a79
    v_cvt_pk_bf16_f32 v40, v32, v33
    v_cvt_pk_bf16_f32 v41, v34, v35
    v_cvt_pk_bf16_f32 v42, v36, v37
    v_cvt_pk_bf16_f32 v43, v38, v39
    s_add_u32 s54, s52, 264192
    buffer_store_dwordx4 v[40:43], v2, s[8:11], s54 offen sc1
    v_accvgpr_read_b32 v44, a104
    v_accvgpr_read_b32 v45, a105
    v_accvgpr_read_b32 v46, a106
    v_accvgpr_read_b32 v47, a107
    v_accvgpr_read_b32 v48, a108
    v_accvgpr_read_b32 v49, a109
    v_accvgpr_read_b32 v50, a110
    v_accvgpr_read_b32 v51, a111
    v_cvt_pk_bf16_f32 v52, v44, v45
    v_cvt_pk_bf16_f32 v53, v46, v47
    v_cvt_pk_bf16_f32 v54, v48, v49
    v_cvt_pk_bf16_f32 v55, v50, v51
    s_add_u32 s54, s52, 265216
    buffer_store_dwordx4 v[52:55], v2, s[8:11], s54 offen sc1
    v_accvgpr_read_b32 v8, a16
    v_accvgpr_read_b32 v9, a17
    v_accvgpr_read_b32 v10, a18
    v_accvgpr_read_b32 v11, a19
    v_accvgpr_read_b32 v12, a20
    v_accvgpr_read_b32 v13, a21
    v_accvgpr_read_b32 v14, a22
    v_accvgpr_read_b32 v15, a23
    v_cvt_pk_bf16_f32 v16, v8, v9
    v_cvt_pk_bf16_f32 v17, v10, v11
    v_cvt_pk_bf16_f32 v18, v12, v13
    v_cvt_pk_bf16_f32 v19, v14, v15
    s_add_u32 s54, s52, 524288
    buffer_store_dwordx4 v[16:19], v2, s[8:11], s54 offen sc1
    v_accvgpr_read_b32 v20, a48
    v_accvgpr_read_b32 v21, a49
    v_accvgpr_read_b32 v22, a50
    v_accvgpr_read_b32 v23, a51
    v_accvgpr_read_b32 v24, a52
    v_accvgpr_read_b32 v25, a53
    v_accvgpr_read_b32 v26, a54
    v_accvgpr_read_b32 v27, a55
    v_cvt_pk_bf16_f32 v28, v20, v21
    v_cvt_pk_bf16_f32 v29, v22, v23
    v_cvt_pk_bf16_f32 v30, v24, v25
    v_cvt_pk_bf16_f32 v31, v26, v27
    s_add_u32 s54, s52, 525312
    buffer_store_dwordx4 v[28:31], v2, s[8:11], s54 offen sc1
    v_accvgpr_read_b32 v32, a80
    v_accvgpr_read_b32 v33, a81
    v_accvgpr_read_b32 v34, a82
    v_accvgpr_read_b32 v35, a83
    v_accvgpr_read_b32 v36, a84
    v_accvgpr_read_b32 v37, a85
    v_accvgpr_read_b32 v38, a86
    v_accvgpr_read_b32 v39, a87
    v_cvt_pk_bf16_f32 v40, v32, v33
    v_cvt_pk_bf16_f32 v41, v34, v35
    v_cvt_pk_bf16_f32 v42, v36, v37
    v_cvt_pk_bf16_f32 v43, v38, v39
    s_add_u32 s54, s52, 526336
    buffer_store_dwordx4 v[40:43], v2, s[8:11], s54 offen sc1
    v_accvgpr_read_b32 v44, a112
    v_accvgpr_read_b32 v45, a113
    v_accvgpr_read_b32 v46, a114
    v_accvgpr_read_b32 v47, a115
    v_accvgpr_read_b32 v48, a116
    v_accvgpr_read_b32 v49, a117
    v_accvgpr_read_b32 v50, a118
    v_accvgpr_read_b32 v51, a119
    v_cvt_pk_bf16_f32 v52, v44, v45
    v_cvt_pk_bf16_f32 v53, v46, v47
    v_cvt_pk_bf16_f32 v54, v48, v49
    v_cvt_pk_bf16_f32 v55, v50, v51
    s_add_u32 s54, s52, 527360
    buffer_store_dwordx4 v[52:55], v2, s[8:11], s54 offen sc1
    v_accvgpr_read_b32 v8, a24
    v_accvgpr_read_b32 v9, a25
    v_accvgpr_read_b32 v10, a26
    v_accvgpr_read_b32 v11, a27
    v_accvgpr_read_b32 v12, a28
    v_accvgpr_read_b32 v13, a29
    v_accvgpr_read_b32 v14, a30
    v_accvgpr_read_b32 v15, a31
    v_cvt_pk_bf16_f32 v16, v8, v9
    v_cvt_pk_bf16_f32 v17, v10, v11
    v_cvt_pk_bf16_f32 v18, v12, v13
    v_cvt_pk_bf16_f32 v19, v14, v15
    s_add_u32 s54, s52, 786432
    buffer_store_dwordx4 v[16:19], v2, s[8:11], s54 offen sc1
    v_accvgpr_read_b32 v20, a56
    v_accvgpr_read_b32 v21, a57
    v_accvgpr_read_b32 v22, a58
    v_accvgpr_read_b32 v23, a59
    v_accvgpr_read_b32 v24, a60
    v_accvgpr_read_b32 v25, a61
    v_accvgpr_read_b32 v26, a62
    v_accvgpr_read_b32 v27, a63
    v_cvt_pk_bf16_f32 v28, v20, v21
    v_cvt_pk_bf16_f32 v29, v22, v23
    v_cvt_pk_bf16_f32 v30, v24, v25
    v_cvt_pk_bf16_f32 v31, v26, v27
    s_add_u32 s54, s52, 787456
    buffer_store_dwordx4 v[28:31], v2, s[8:11], s54 offen sc1
    v_accvgpr_read_b32 v32, a88
    v_accvgpr_read_b32 v33, a89
    v_accvgpr_read_b32 v34, a90
    v_accvgpr_read_b32 v35, a91
    v_accvgpr_read_b32 v36, a92
    v_accvgpr_read_b32 v37, a93
    v_accvgpr_read_b32 v38, a94
    v_accvgpr_read_b32 v39, a95
    v_cvt_pk_bf16_f32 v40, v32, v33
    v_cvt_pk_bf16_f32 v41, v34, v35
    v_cvt_pk_bf16_f32 v42, v36, v37
    v_cvt_pk_bf16_f32 v43, v38, v39
    s_add_u32 s54, s52, 788480
    buffer_store_dwordx4 v[40:43], v2, s[8:11], s54 offen sc1
    v_accvgpr_read_b32 v44, a120
    v_accvgpr_read_b32 v45, a121
    v_accvgpr_read_b32 v46, a122
    v_accvgpr_read_b32 v47, a123
    v_accvgpr_read_b32 v48, a124
    v_accvgpr_read_b32 v49, a125
    v_accvgpr_read_b32 v50, a126
    v_accvgpr_read_b32 v51, a127
    v_cvt_pk_bf16_f32 v52, v44, v45
    v_cvt_pk_bf16_f32 v53, v46, v47
    v_cvt_pk_bf16_f32 v54, v48, v49
    v_cvt_pk_bf16_f32 v55, v50, v51
    s_add_u32 s54, s52, 789504
    buffer_store_dwordx4 v[52:55], v2, s[8:11], s54 offen sc1
    s_waitcnt vmcnt(0)
    s_lshr_b32 s20, s5, 1
    s_lshl_b32 s20, s20, 2
    s_add_u32 s20, s20, 16
    s_and_b32 s21, s5, 1
    s_lshl_b32 s21, s21, 4
    s_lshl_b32 s21, 1, s21
    s_cmp_lg_u32 s4, 0
    s_cbranch_scc1 tki_230
    s_lshl_b32 s93, s83, 2
    s_add_u32 s93, s93, 176
    v_mov_b32 v250, s93
    v_mov_b32 v251, 1
    s_mov_b64 exec, 1
    global_atomic_add v249, v250, v251, s[98:99] sc0 sc1
    s_mov_b64 exec, -1
tki_230:
    s_waitcnt vmcnt(0) lgkmcnt(0)
    s_barrier
    s_cmp_lg_u32 s4, 0
    s_cbranch_scc1 sig_231
    v_mov_b32 v250, s20
    v_mov_b32 v251, s21
    s_mov_b64 exec, 1
    global_atomic_add v250, v251, s[98:99] sc1
    s_mov_b64 exec, -1
sig_231:
    s_branch L_next
ep_229:
    s_cmp_lg_u32 s58, 4
    s_cbranch_scc1 ep_232
    s_nop 11
    s_lshl_b32 s52, s5, 3
    s_lshl_b32 s22, s21, 2
    s_add_u32 s52, s52, s22
    s_lshl_b32 s52, s52, 6
    s_lshl_b32 s22, s7, 3
    s_add_u32 s52, s52, s22
    s_lshl_b32 s22, s20, 2
    s_add_u32 s52, s52, s22
    s_lshl_b32 s52, s52, 10
    s_add_u32 s52, s52, 109051904
    v_cmp_eq_u32 s[56:57], 4, v3
    v_mov_b32 v6, 0x3f803f80
    v_accvgpr_read_b32 v8, a0
    v_accvgpr_read_b32 v9, a1
    v_accvgpr_read_b32 v10, a2
    v_accvgpr_read_b32 v11, a3
    v_accvgpr_read_b32 v12, a4
    v_accvgpr_read_b32 v13, a5
    v_accvgpr_read_b32 v14, a6
    v_accvgpr_read_b32 v15, a7
    v_cvt_pk_bf16_f32 v16, v8, v9
    v_cvt_pk_bf16_f32 v17, v10, v11
    v_cvt_pk_bf16_f32 v18, v12, v13
    v_cvt_pk_bf16_f32 v19, v14, v15
    s_add_u32 s54, s52, 0
    buffer_store_dwordx4 v[16:19], v2, s[8:11], s54 offen sc1
    v_accvgpr_read_b32 v20, a32
    v_accvgpr_read_b32 v21, a33
    v_accvgpr_read_b32 v22, a34
    v_accvgpr_read_b32 v23, a35
    v_accvgpr_read_b32 v24, a36
    v_accvgpr_read_b32 v25, a37
    v_accvgpr_read_b32 v26, a38
    v_accvgpr_read_b32 v27, a39
    v_cvt_pk_bf16_f32 v28, v20, v21
    v_cvt_pk_bf16_f32 v29, v22, v23
    v_cvt_pk_bf16_f32 v30, v24, v25
    v_cvt_pk_bf16_f32 v31, v26, v27
    v_cndmask_b32 v28, v28, v6, s[56:57]
    v_cndmask_b32 v29, v29, v6, s[56:57]
    v_cndmask_b32 v30, v30, v6, s[56:57]
    v_cndmask_b32 v31, v31, v6, s[56:57]
    s_add_u32 s54, s52, 1024
    buffer_store_dwordx4 v[28:31], v2, s[8:11], s54 offen sc1
    v_accvgpr_read_b32 v32, a64
    v_accvgpr_read_b32 v33, a65
    v_accvgpr_read_b32 v34, a66
    v_accvgpr_read_b32 v35, a67
    v_accvgpr_read_b32 v36, a68
    v_accvgpr_read_b32 v37, a69
    v_accvgpr_read_b32 v38, a70
    v_accvgpr_read_b32 v39, a71
    v_cvt_pk_bf16_f32 v40, v32, v33
    v_cvt_pk_bf16_f32 v41, v34, v35
    v_cvt_pk_bf16_f32 v42, v36, v37
    v_cvt_pk_bf16_f32 v43, v38, v39
    s_add_u32 s54, s52, 2048
    buffer_store_dwordx4 v[40:43], v2, s[8:11], s54 offen sc1
    v_accvgpr_read_b32 v44, a96
    v_accvgpr_read_b32 v45, a97
    v_accvgpr_read_b32 v46, a98
    v_accvgpr_read_b32 v47, a99
    v_accvgpr_read_b32 v48, a100
    v_accvgpr_read_b32 v49, a101
    v_accvgpr_read_b32 v50, a102
    v_accvgpr_read_b32 v51, a103
    v_cvt_pk_bf16_f32 v52, v44, v45
    v_cvt_pk_bf16_f32 v53, v46, v47
    v_cvt_pk_bf16_f32 v54, v48, v49
    v_cvt_pk_bf16_f32 v55, v50, v51
    v_cndmask_b32 v52, v52, v6, s[56:57]
    v_cndmask_b32 v53, v53, v6, s[56:57]
    v_cndmask_b32 v54, v54, v6, s[56:57]
    v_cndmask_b32 v55, v55, v6, s[56:57]
    s_add_u32 s54, s52, 3072
    buffer_store_dwordx4 v[52:55], v2, s[8:11], s54 offen sc1
    v_accvgpr_read_b32 v8, a8
    v_accvgpr_read_b32 v9, a9
    v_accvgpr_read_b32 v10, a10
    v_accvgpr_read_b32 v11, a11
    v_accvgpr_read_b32 v12, a12
    v_accvgpr_read_b32 v13, a13
    v_accvgpr_read_b32 v14, a14
    v_accvgpr_read_b32 v15, a15
    v_cvt_pk_bf16_f32 v16, v8, v9
    v_cvt_pk_bf16_f32 v17, v10, v11
    v_cvt_pk_bf16_f32 v18, v12, v13
    v_cvt_pk_bf16_f32 v19, v14, v15
    s_add_u32 s54, s52, 65536
    buffer_store_dwordx4 v[16:19], v2, s[8:11], s54 offen sc1
    v_accvgpr_read_b32 v20, a40
    v_accvgpr_read_b32 v21, a41
    v_accvgpr_read_b32 v22, a42
    v_accvgpr_read_b32 v23, a43
    v_accvgpr_read_b32 v24, a44
    v_accvgpr_read_b32 v25, a45
    v_accvgpr_read_b32 v26, a46
    v_accvgpr_read_b32 v27, a47
    v_cvt_pk_bf16_f32 v28, v20, v21
    v_cvt_pk_bf16_f32 v29, v22, v23
    v_cvt_pk_bf16_f32 v30, v24, v25
    v_cvt_pk_bf16_f32 v31, v26, v27
    v_cndmask_b32 v28, v28, v6, s[56:57]
    v_cndmask_b32 v29, v29, v6, s[56:57]
    v_cndmask_b32 v30, v30, v6, s[56:57]
    v_cndmask_b32 v31, v31, v6, s[56:57]
    s_add_u32 s54, s52, 66560
    buffer_store_dwordx4 v[28:31], v2, s[8:11], s54 offen sc1
    v_accvgpr_read_b32 v32, a72
    v_accvgpr_read_b32 v33, a73
    v_accvgpr_read_b32 v34, a74
    v_accvgpr_read_b32 v35, a75
    v_accvgpr_read_b32 v36, a76
    v_accvgpr_read_b32 v37, a77
    v_accvgpr_read_b32 v38, a78
    v_accvgpr_read_b32 v39, a79
    v_cvt_pk_bf16_f32 v40, v32, v33
    v_cvt_pk_bf16_f32 v41, v34, v35
    v_cvt_pk_bf16_f32 v42, v36, v37
    v_cvt_pk_bf16_f32 v43, v38, v39
    s_add_u32 s54, s52, 67584
    buffer_store_dwordx4 v[40:43], v2, s[8:11], s54 offen sc1
    v_accvgpr_read_b32 v44, a104
    v_accvgpr_read_b32 v45, a105
    v_accvgpr_read_b32 v46, a106
    v_accvgpr_read_b32 v47, a107
    v_accvgpr_read_b32 v48, a108
    v_accvgpr_read_b32 v49, a109
    v_accvgpr_read_b32 v50, a110
    v_accvgpr_read_b32 v51, a111
    v_cvt_pk_bf16_f32 v52, v44, v45
    v_cvt_pk_bf16_f32 v53, v46, v47
    v_cvt_pk_bf16_f32 v54, v48, v49
    v_cvt_pk_bf16_f32 v55, v50, v51
    v_cndmask_b32 v52, v52, v6, s[56:57]
    v_cndmask_b32 v53, v53, v6, s[56:57]
    v_cndmask_b32 v54, v54, v6, s[56:57]
    v_cndmask_b32 v55, v55, v6, s[56:57]
    s_add_u32 s54, s52, 68608
    buffer_store_dwordx4 v[52:55], v2, s[8:11], s54 offen sc1
    v_accvgpr_read_b32 v8, a16
    v_accvgpr_read_b32 v9, a17
    v_accvgpr_read_b32 v10, a18
    v_accvgpr_read_b32 v11, a19
    v_accvgpr_read_b32 v12, a20
    v_accvgpr_read_b32 v13, a21
    v_accvgpr_read_b32 v14, a22
    v_accvgpr_read_b32 v15, a23
    v_cvt_pk_bf16_f32 v16, v8, v9
    v_cvt_pk_bf16_f32 v17, v10, v11
    v_cvt_pk_bf16_f32 v18, v12, v13
    v_cvt_pk_bf16_f32 v19, v14, v15
    s_add_u32 s54, s52, 131072
    buffer_store_dwordx4 v[16:19], v2, s[8:11], s54 offen sc1
    v_accvgpr_read_b32 v20, a48
    v_accvgpr_read_b32 v21, a49
    v_accvgpr_read_b32 v22, a50
    v_accvgpr_read_b32 v23, a51
    v_accvgpr_read_b32 v24, a52
    v_accvgpr_read_b32 v25, a53
    v_accvgpr_read_b32 v26, a54
    v_accvgpr_read_b32 v27, a55
    v_cvt_pk_bf16_f32 v28, v20, v21
    v_cvt_pk_bf16_f32 v29, v22, v23
    v_cvt_pk_bf16_f32 v30, v24, v25
    v_cvt_pk_bf16_f32 v31, v26, v27
    v_cndmask_b32 v28, v28, v6, s[56:57]
    v_cndmask_b32 v29, v29, v6, s[56:57]
    v_cndmask_b32 v30, v30, v6, s[56:57]
    v_cndmask_b32 v31, v31, v6, s[56:57]
    s_add_u32 s54, s52, 132096
    buffer_store_dwordx4 v[28:31], v2, s[8:11], s54 offen sc1
    v_accvgpr_read_b32 v32, a80
    v_accvgpr_read_b32 v33, a81
    v_accvgpr_read_b32 v34, a82
    v_accvgpr_read_b32 v35, a83
    v_accvgpr_read_b32 v36, a84
    v_accvgpr_read_b32 v37, a85
    v_accvgpr_read_b32 v38, a86
    v_accvgpr_read_b32 v39, a87
    v_cvt_pk_bf16_f32 v40, v32, v33
    v_cvt_pk_bf16_f32 v41, v34, v35
    v_cvt_pk_bf16_f32 v42, v36, v37
    v_cvt_pk_bf16_f32 v43, v38, v39
    s_add_u32 s54, s52, 133120
    buffer_store_dwordx4 v[40:43], v2, s[8:11], s54 offen sc1
    v_accvgpr_read_b32 v44, a112
    v_accvgpr_read_b32 v45, a113
    v_accvgpr_read_b32 v46, a114
    v_accvgpr_read_b32 v47, a115
    v_accvgpr_read_b32 v48, a116
    v_accvgpr_read_b32 v49, a117
    v_accvgpr_read_b32 v50, a118
    v_accvgpr_read_b32 v51, a119
    v_cvt_pk_bf16_f32 v52, v44, v45
    v_cvt_pk_bf16_f32 v53, v46, v47
    v_cvt_pk_bf16_f32 v54, v48, v49
    v_cvt_pk_bf16_f32 v55, v50, v51
    v_cndmask_b32 v52, v52, v6, s[56:57]
    v_cndmask_b32 v53, v53, v6, s[56:57]
    v_cndmask_b32 v54, v54, v6, s[56:57]
    v_cndmask_b32 v55, v55, v6, s[56:57]
    s_add_u32 s54, s52, 134144
    buffer_store_dwordx4 v[52:55], v2, s[8:11], s54 offen sc1
    v_accvgpr_read_b32 v8, a24
    v_accvgpr_read_b32 v9, a25
    v_accvgpr_read_b32 v10, a26
    v_accvgpr_read_b32 v11, a27
    v_accvgpr_read_b32 v12, a28
    v_accvgpr_read_b32 v13, a29
    v_accvgpr_read_b32 v14, a30
    v_accvgpr_read_b32 v15, a31
    v_cvt_pk_bf16_f32 v16, v8, v9
    v_cvt_pk_bf16_f32 v17, v10, v11
    v_cvt_pk_bf16_f32 v18, v12, v13
    v_cvt_pk_bf16_f32 v19, v14, v15
    s_add_u32 s54, s52, 196608
    buffer_store_dwordx4 v[16:19], v2, s[8:11], s54 offen sc1
    v_accvgpr_read_b32 v20, a56
    v_accvgpr_read_b32 v21, a57
    v_accvgpr_read_b32 v22, a58
    v_accvgpr_read_b32 v23, a59
    v_accvgpr_read_b32 v24, a60
    v_accvgpr_read_b32 v25, a61
    v_accvgpr_read_b32 v26, a62
    v_accvgpr_read_b32 v27, a63
    v_cvt_pk_bf16_f32 v28, v20, v21
    v_cvt_pk_bf16_f32 v29, v22, v23
    v_cvt_pk_bf16_f32 v30, v24, v25
    v_cvt_pk_bf16_f32 v31, v26, v27
    v_cndmask_b32 v28, v28, v6, s[56:57]
    v_cndmask_b32 v29, v29, v6, s[56:57]
    v_cndmask_b32 v30, v30, v6, s[56:57]
    v_cndmask_b32 v31, v31, v6, s[56:57]
    s_add_u32 s54, s52, 197632
    buffer_store_dwordx4 v[28:31], v2, s[8:11], s54 offen sc1
    v_accvgpr_read_b32 v32, a88
    v_accvgpr_read_b32 v33, a89
    v_accvgpr_read_b32 v34, a90
    v_accvgpr_read_b32 v35, a91
    v_accvgpr_read_b32 v36, a92
    v_accvgpr_read_b32 v37, a93
    v_accvgpr_read_b32 v38, a94
    v_accvgpr_read_b32 v39, a95
    v_cvt_pk_bf16_f32 v40, v32, v33
    v_cvt_pk_bf16_f32 v41, v34, v35
    v_cvt_pk_bf16_f32 v42, v36, v37
    v_cvt_pk_bf16_f32 v43, v38, v39
    s_add_u32 s54, s52, 198656
    buffer_store_dwordx4 v[40:43], v2, s[8:11], s54 offen sc1
    v_accvgpr_read_b32 v44, a120
    v_accvgpr_read_b32 v45, a121
    v_accvgpr_read_b32 v46, a122
    v_accvgpr_read_b32 v47, a123
    v_accvgpr_read_b32 v48, a124
    v_accvgpr_read_b32 v49, a125
    v_accvgpr_read_b32 v50, a126
    v_accvgpr_read_b32 v51, a127
    v_cvt_pk_bf16_f32 v52, v44, v45
    v_cvt_pk_bf16_f32 v53, v46, v47
    v_cvt_pk_bf16_f32 v54, v48, v49
    v_cvt_pk_bf16_f32 v55, v50, v51
    v_cndmask_b32 v52, v52, v6, s[56:57]
    v_cndmask_b32 v53, v53, v6, s[56:57]
    v_cndmask_b32 v54, v54, v6, s[56:57]
    v_cndmask_b32 v55, v55, v6, s[56:57]
    s_add_u32 s54, s52, 199680
    buffer_store_dwordx4 v[52:55], v2, s[8:11], s54 offen sc1
    s_waitcnt vmcnt(0)
    s_cmp_lg_u32 s4, 0
    s_cbranch_scc1 tki_233
    s_lshl_b32 s93, s83, 2
    s_add_u32 s93, s93, 176
    v_mov_b32 v250, s93
    v_mov_b32 v251, 1
    s_mov_b64 exec, 1
    global_atomic_add v249, v250, v251, s[98:99] sc0 sc1
    s_mov_b64 exec, -1
tki_233:
    s_waitcnt vmcnt(0) lgkmcnt(0)
    s_barrier
    s_cmp_lg_u32 s4, 0
    s_cbranch_scc1 sig_234
    v_mov_b32 v250, 48
    v_mov_b32 v251, 1
    s_mov_b64 exec, 1
    global_atomic_add v250, v251, s[98:99] sc1
    s_mov_b64 exec, -1
sig_234:
    s_branch L_next
ep_232:
    s_branch L_next
LT2_98:
    s_bitcmp1_b32 s92, 2
    s_cbranch_scc1 dep_235
    s_cmp_lg_u32 s4, 0
    s_cbranch_scc1 wfd_237
    v_mov_b32 v250, 48
wf_236:
    global_load_dword v251, v250, s[98:99] sc1
    s_waitcnt vmcnt(0)
    v_lshrrev_b32 v251, 0, v251
    v_and_b32 v251, 0xffff, v251
    v_cmp_gt_u32 vcc, 192, v251
    s_cbranch_vccz wf_236x
    s_sleep 32
    s_branch wf_236
wf_236x:
wfd_237:
    s_cmp_lg_u32 s4, 0
    s_cbranch_scc1 acq_238
    buffer_inv sc1
    s_waitcnt vmcnt(0)
acq_238:
    s_barrier
    s_bitset1_b32 s92, 2
dep_235:
    s_lshl_b32 s22, s7, 4
    s_lshl_b32 s24, s4, 2
    s_add_u32 s22, s22, s24
    s_lshl_b32 s26, s22, 6
    s_add_u32 s26, s26, 123731968
    s_lshl_b32 s40, s5, 7
    s_add_u32 s40, s40, s22
    s_lshl_b32 s40, s40, 10
    s_lshl_b32 s22, s22, 5
    s_add_u32 s22, s22, s5
    s_lshl_b32 s22, s22, 10
    s_mov_b32 s25, 0
    s_add_u32 s24, s22, 100663296
    buffer_load_dwordx4 v[8:11], v2, s[8:11], s24 offen
    s_add_u32 s24, s22, 100696064
    buffer_load_dwordx4 v[12:15], v2, s[8:11], s24 offen
    s_add_u32 s24, s22, 100728832
    buffer_load_dwordx4 v[16:19], v2, s[8:11], s24 offen
    s_add_u32 s24, s22, 100761600
    buffer_load_dwordx4 v[20:23], v2, s[8:11], s24 offen
    v_mov_b32 v24, 0
    v_mov_b32 v25, 0
    v_mov_b32 v26, 0
    v_mov_b32 v27, 0
    v_mov_b32 v28, 0
    v_mov_b32 v29, 0
    v_mov_b32 v30, 0
    v_mov_b32 v31, 0
    v_mov_b32 v32, 0
    v_mov_b32 v33, 0
    v_mov_b32 v34, 0
    v_mov_b32 v35, 0
    v_mov_b32 v36, 0
    v_mov_b32 v37, 0
    v_mov_b32 v38, 0
    v_mov_b32 v39, 0
t2main_239:
    s_waitcnt vmcnt(0)
    v_mov_b32 v40, 0
    v_mov_b32 v41, 0
    v_mov_b32 v42, 0
    v_mov_b32 v43, 0
    v_mov_b32 v44, 0
    v_mov_b32 v45, 0
    v_mov_b32 v46, 0
    v_mov_b32 v47, 0
    v_mov_b32 v48, 0
    v_mov_b32 v49, 0
    v_mov_b32 v50, 0
    v_mov_b32 v51, 0
    v_mov_b32 v52, 0
    v_mov_b32 v53, 0
    v_mov_b32 v54, 0
    v_mov_b32 v55, 0
    v_mov_b32 v56, 0
    v_mov_b32 v57, 0
    v_mov_b32 v58, 0
    v_mov_b32 v59, 0
    v_mov_b32 v60, 0
    v_mov_b32 v61, 0
    v_mov_b32 v62, 0
    v_mov_b32 v63, 0
    v_mov_b32 v64, 0
    v_mov_b32 v65, 0
    v_mov_b32 v66, 0
    v_mov_b32 v67, 0
    v_mov_b32 v68, 0
    v_mov_b32 v69, 0
    v_mov_b32 v70, 0
    v_mov_b32 v71, 0
    s_lshl_b32 s20, s5, 10
    s_add_u32 s20, s20, 104857600
    s_lshl_b32 s21, s5, 11
    s_add_u32 s21, s21, 109051904
    v_add_u32 v5, 32768, v2
    s_mov_b32 s23, 0
    s_mov_b32 s30, s20
    s_mov_b32 s31, s21
    buffer_load_dwordx4 a[0:3], v2, s[8:11], s30 offen
    buffer_load_dwordx4 a[4:7], v5, s[8:11], s30 offen
    buffer_load_dwordx4 a[8:11], v2, s[8:11], s31 offen
    buffer_load_dwordx4 a[12:15], v2, s[8:11], s31 offen offset:1024
    s_add_u32 s30, s30, 65536
    s_add_u32 s31, s31, 65536
    buffer_load_dwordx4 a[16:19], v2, s[8:11], s30 offen
    buffer_load_dwordx4 a[20:23], v5, s[8:11], s30 offen
    buffer_load_dwordx4 a[24:27], v2, s[8:11], s31 offen
    buffer_load_dwordx4 a[28:31], v2, s[8:11], s31 offen offset:1024
    s_add_u32 s30, s30, 65536
    s_add_u32 s31, s31, 65536
    buffer_load_dwordx4 a[32:35], v2, s[8:11], s30 offen
    buffer_load_dwordx4 a[36:39], v5, s[8:11], s30 offen
    buffer_load_dwordx4 a[40:43], v2, s[8:11], s31 offen
    buffer_load_dwordx4 a[44:47], v2, s[8:11], s31 offen offset:1024
    s_add_u32 s30, s30, 65536
    s_add_u32 s31, s31, 65536
    buffer_load_dwordx4 a[48:51], v2, s[8:11], s30 offen
    buffer_load_dwordx4 a[52:55], v5, s[8:11], s30 offen
    buffer_load_dwordx4 a[56:59], v2, s[8:11], s31 offen
    buffer_load_dwordx4 a[60:63], v2, s[8:11], s31 offen offset:1024
    s_add_u32 s30, s30, 65536
    s_add_u32 s31, s31, 65536
    buffer_load_dwordx4 a[64:67], v2, s[8:11], s30 offen
    buffer_load_dwordx4 a[68:71], v5, s[8:11], s30 offen
    buffer_load_dwordx4 a[72:75], v2, s[8:11], s31 offen
    buffer_load_dwordx4 a[76:79], v2, s[8:11], s31 offen offset:1024
    s_add_u32 s30, s30, 65536
    s_add_u32 s31, s31, 65536
    buffer_load_dwordx4 a[80:83], v2, s[8:11], s30 offen
    buffer_load_dwordx4 a[84:87], v5, s[8:11], s30 offen
    buffer_load_dwordx4 a[88:91], v2, s[8:11], s31 offen
    buffer_load_dwordx4 a[92:95], v2, s[8:11], s31 offen offset:1024
    s_add_u32 s30, s30, 65536
    s_add_u32 s31, s31, 65536
t2loop_240:
    buffer_load_dwordx4 a[96:99], v2, s[8:11], s30 offen
    buffer_load_dwordx4 a[100:103], v5, s[8:11], s30 offen
    buffer_load_dwordx4 a[104:107], v2, s[8:11], s31 offen
    buffer_load_dwordx4 a[108:111], v2, s[8:11], s31 offen offset:1024
    s_add_u32 s30, s30, 65536
    buffer_load_dwordx4 a[112:115], v2, s[8:11], s30 offen
    buffer_load_dwordx4 a[116:119], v5, s[8:11], s30 offen
    s_add_u32 s31, s31, 65536
    buffer_load_dwordx4 a[120:123], v2, s[8:11], s31 offen
    buffer_load_dwordx4 a[124:127], v2, s[8:11], s31 offen offset:1024
    s_waitcnt vmcnt(31)
    v_mfma_f32_16x16x32_bf16 v[72:75], a[0:3], v[8:11], v[24:27]
    s_add_u32 s30, s30, 65536
    s_add_u32 s31, s31, 65536
    s_waitcnt vmcnt(30)
    v_mfma_f32_16x16x32_bf16 v[88:91], a[4:7], v[8:11], v[24:27]
    v_mfma_f32_16x16x32_bf16 v[76:79], a[0:3], v[12:15], v[28:31]
    v_exp_f32 v72, v72
    v_mfma_f32_16x16x32_bf16 v[92:95], a[4:7], v[12:15], v[28:31]
    v_exp_f32 v73, v73
    v_mfma_f32_16x16x32_bf16 v[80:83], a[0:3], v[16:19], v[32:35]
    v_exp_f32 v74, v74
    v_mfma_f32_16x16x32_bf16 v[96:99], a[4:7], v[16:19], v[32:35]
    v_exp_f32 v75, v75
    v_mfma_f32_16x16x32_bf16 v[84:87], a[0:3], v[20:23], v[36:39]
    buffer_load_dwordx4 a[0:3], v2, s[8:11], s30 offen
    v_exp_f32 v88, v88
    v_mfma_f32_16x16x32_bf16 v[100:103], a[4:7], v[20:23], v[36:39]
    buffer_load_dwordx4 a[4:7], v5, s[8:11], s30 offen
    v_exp_f32 v89, v89
    s_waitcnt vmcnt(29)
    v_mfma_f32_16x16x32_bf16 v[104:107], a[16:19], v[8:11], v[24:27]
    s_add_u32 s30, s30, 65536
    v_exp_f32 v90, v90
    s_waitcnt vmcnt(28)
    v_mfma_f32_16x16x32_bf16 v[120:123], a[20:23], v[8:11], v[24:27]
    v_exp_f32 v91, v91
    v_mfma_f32_16x16x32_bf16 v[108:111], a[16:19], v[12:15], v[28:31]
    v_exp_f32 v76, v76
    v_mfma_f32_16x16x32_bf16 v[124:127], a[20:23], v[12:15], v[28:31]
    v_exp_f32 v77, v77
    v_mfma_f32_16x16x32_bf16 v[112:115], a[16:19], v[16:19], v[32:35]
    v_exp_f32 v78, v78
    v_mfma_f32_16x16x32_bf16 v[128:131], a[20:23], v[16:19], v[32:35]
    v_exp_f32 v79, v79
    v_mfma_f32_16x16x32_bf16 v[116:119], a[16:19], v[20:23], v[36:39]
    v_exp_f32 v92, v92
    v_mfma_f32_16x16x32_bf16 v[132:135], a[20:23], v[20:23], v[36:39]
    v_exp_f32 v93, v93
    v_exp_f32 v94, v94
    v_exp_f32 v95, v95
    v_exp_f32 v80, v80
    v_exp_f32 v81, v81
    v_exp_f32 v82, v82
    v_exp_f32 v83, v83
    v_exp_f32 v96, v96
    v_exp_f32 v97, v97
    v_exp_f32 v98, v98
    v_exp_f32 v99, v99
    v_exp_f32 v84, v84
    v_exp_f32 v85, v85
    v_exp_f32 v86, v86
    v_exp_f32 v87, v87
    v_exp_f32 v100, v100
    v_exp_f32 v101, v101
    v_exp_f32 v102, v102
    v_exp_f32 v103, v103
    v_cvt_pk_bf16_f32 v136, v72, v73
    v_cvt_pk_bf16_f32 v137, v74, v75
    v_cvt_pk_bf16_f32 v138, v88, v89
    v_cvt_pk_bf16_f32 v139, v90, v91
    v_cvt_pk_bf16_f32 v140, v76, v77
    v_cvt_pk_bf16_f32 v141, v78, v79
    v_cvt_pk_bf16_f32 v142, v92, v93
    v_cvt_pk_bf16_f32 v143, v94, v95
    v_cvt_pk_bf16_f32 v144, v80, v81
    v_cvt_pk_bf16_f32 v145, v82, v83
    v_cvt_pk_bf16_f32 v146, v96, v97
    v_cvt_pk_bf16_f32 v147, v98, v99
    v_cvt_pk_bf16_f32 v148, v84, v85
    v_cvt_pk_bf16_f32 v149, v86, v87
    v_cvt_pk_bf16_f32 v150, v100, v101
    v_cvt_pk_bf16_f32 v151, v102, v103
    v_exp_f32 v104, v104
    v_exp_f32 v105, v105
    v_exp_f32 v106, v106
    v_exp_f32 v107, v107
    v_exp_f32 v120, v120
    v_exp_f32 v121, v121
    v_exp_f32 v122, v122
    v_exp_f32 v123, v123
    v_exp_f32 v108, v108
    v_exp_f32 v109, v109
    v_exp_f32 v110, v110
    v_exp_f32 v111, v111
    v_exp_f32 v124, v124
    v_exp_f32 v125, v125
    v_exp_f32 v126, v126
    v_exp_f32 v127, v127
    v_exp_f32 v112, v112
    v_exp_f32 v113, v113
    v_exp_f32 v114, v114
    v_exp_f32 v115, v115
    v_exp_f32 v128, v128
    v_exp_f32 v129, v129
    v_exp_f32 v130, v130
    v_exp_f32 v131, v131
    v_exp_f32 v116, v116
    v_exp_f32 v117, v117
    v_exp_f32 v118, v118
    v_exp_f32 v119, v119
    v_exp_f32 v132, v132
    v_exp_f32 v133, v133
    v_exp_f32 v134, v134
    v_exp_f32 v135, v135
    s_waitcnt vmcnt(25)
    v_mfma_f32_16x16x32_bf16 v[72:75], a[32:35], v[8:11], v[24:27]
    v_cvt_pk_bf16_f32 v152, v104, v105
    v_cvt_pk_bf16_f32 v153, v106, v107
    s_waitcnt vmcnt(24)
    v_mfma_f32_16x16x32_bf16 v[88:91], a[36:39], v[8:11], v[24:27]
    v_cvt_pk_bf16_f32 v154, v120, v121
    v_cvt_pk_bf16_f32 v155, v122, v123
    v_mfma_f32_16x16x32_bf16 v[76:79], a[32:35], v[12:15], v[28:31]
    v_cvt_pk_bf16_f32 v156, v108, v109
    v_cvt_pk_bf16_f32 v157, v110, v111
    v_mfma_f32_16x16x32_bf16 v[92:95], a[36:39], v[12:15], v[28:31]
    v_cvt_pk_bf16_f32 v158, v124, v125
    v_cvt_pk_bf16_f32 v159, v126, v127
    v_mfma_f32_16x16x32_bf16 v[80:83], a[32:35], v[16:19], v[32:35]
    v_cvt_pk_bf16_f32 v160, v112, v113
    v_cvt_pk_bf16_f32 v161, v114, v115
    v_mfma_f32_16x16x32_bf16 v[96:99], a[36:39], v[16:19], v[32:35]
    v_cvt_pk_bf16_f32 v162, v128, v129
    v_cvt_pk_bf16_f32 v163, v130, v131
    v_mfma_f32_16x16x32_bf16 v[84:87], a[32:35], v[20:23], v[36:39]
    v_cvt_pk_bf16_f32 v164, v116, v117
    v_cvt_pk_bf16_f32 v165, v118, v119
    v_mfma_f32_16x16x32_bf16 v[100:103], a[36:39], v[20:23], v[36:39]
    v_cvt_pk_bf16_f32 v166, v132, v133
    v_cvt_pk_bf16_f32 v167, v134, v135
    s_waitcnt vmcnt(21)
    v_mfma_f32_16x16x32_bf16 v[104:107], a[48:51], v[8:11], v[24:27]
    v_exp_f32 v72, v72
    s_waitcnt vmcnt(20)
    v_mfma_f32_16x16x32_bf16 v[120:123], a[52:55], v[8:11], v[24:27]
    v_exp_f32 v73, v73
    v_mfma_f32_16x16x32_bf16 v[108:111], a[48:51], v[12:15], v[28:31]
    v_exp_f32 v74, v74
    v_mfma_f32_16x16x32_bf16 v[124:127], a[52:55], v[12:15], v[28:31]
    v_exp_f32 v75, v75
    v_mfma_f32_16x16x32_bf16 v[112:115], a[48:51], v[16:19], v[32:35]
    v_exp_f32 v88, v88
    v_mfma_f32_16x16x32_bf16 v[128:131], a[52:55], v[16:19], v[32:35]
    v_exp_f32 v89, v89
    v_mfma_f32_16x16x32_bf16 v[116:119], a[48:51], v[20:23], v[36:39]
    v_exp_f32 v90, v90
    v_mfma_f32_16x16x32_bf16 v[132:135], a[52:55], v[20:23], v[36:39]
    v_exp_f32 v91, v91
    v_exp_f32 v76, v76
    v_exp_f32 v77, v77
    v_exp_f32 v78, v78
    v_exp_f32 v79, v79
    v_exp_f32 v92, v92
    v_exp_f32 v93, v93
    v_exp_f32 v94, v94
    v_exp_f32 v95, v95
    v_exp_f32 v80, v80
    v_exp_f32 v81, v81
    v_exp_f32 v82, v82
    v_exp_f32 v83, v83
    v_exp_f32 v96, v96
    v_exp_f32 v97, v97
    v_exp_f32 v98, v98
    v_exp_f32 v99, v99
    v_exp_f32 v84, v84
    v_exp_f32 v85, v85
    v_exp_f32 v86, v86
    v_exp_f32 v87, v87
    v_exp_f32 v100, v100
    v_exp_f32 v101, v101
    v_exp_f32 v102, v102
    v_exp_f32 v103, v103
    v_mfma_f32_16x16x32_bf16 v[40:43], a[8:11], v[136:139], v[40:43]
    v_exp_f32 v104, v104
    v_mfma_f32_16x16x32_bf16 v[56:59], a[12:15], v[136:139], v[56:59]
    v_cvt_pk_bf16_f32 v136, v72, v73
    v_cvt_pk_bf16_f32 v137, v74, v75
    v_mfma_f32_16x16x32_bf16 v[44:47], a[8:11], v[140:143], v[44:47]
    v_cvt_pk_bf16_f32 v138, v88, v89
    v_cvt_pk_bf16_f32 v139, v90, v91
    v_mfma_f32_16x16x32_bf16 v[60:63], a[12:15], v[140:143], v[60:63]
    v_cvt_pk_bf16_f32 v140, v76, v77
    v_cvt_pk_bf16_f32 v141, v78, v79
    v_mfma_f32_16x16x32_bf16 v[48:51], a[8:11], v[144:147], v[48:51]
    v_cvt_pk_bf16_f32 v142, v92, v93
    v_cvt_pk_bf16_f32 v143, v94, v95
    v_mfma_f32_16x16x32_bf16 v[64:67], a[12:15], v[144:147], v[64:67]
    v_cvt_pk_bf16_f32 v144, v80, v81
    v_cvt_pk_bf16_f32 v145, v82, v83
    v_mfma_f32_16x16x32_bf16 v[52:55], a[8:11], v[148:151], v[52:55]
    buffer_load_dwordx4 a[8:11], v2, s[8:11], s31 offen
    v_cvt_pk_bf16_f32 v146, v96, v97
    v_cvt_pk_bf16_f32 v147, v98, v99
    v_mfma_f32_16x16x32_bf16 v[68:71], a[12:15], v[148:151], v[68:71]
    buffer_load_dwordx4 a[12:15], v2, s[8:11], s31 offen offset:1024
    v_cvt_pk_bf16_f32 v148, v84, v85
    v_cvt_pk_bf16_f32 v149, v86, v87
    v_cvt_pk_bf16_f32 v150, v100, v101
    v_cvt_pk_bf16_f32 v151, v102, v103
    v_exp_f32 v105, v105
    v_exp_f32 v106, v106
    v_exp_f32 v107, v107
    v_exp_f32 v120, v120
    v_exp_f32 v121, v121
    v_exp_f32 v122, v122
    v_exp_f32 v123, v123
    v_exp_f32 v108, v108
    v_exp_f32 v109, v109
    v_exp_f32 v110, v110
    v_exp_f32 v111, v111
    v_exp_f32 v124, v124
    v_exp_f32 v125, v125
    v_exp_f32 v126, v126
    v_exp_f32 v127, v127
    v_exp_f32 v112, v112
    v_exp_f32 v113, v113
    v_exp_f32 v114, v114
    v_exp_f32 v115, v115
    v_exp_f32 v128, v128
    v_exp_f32 v129, v129
    v_exp_f32 v130, v130
    v_exp_f32 v131, v131
    v_exp_f32 v116, v116
    v_exp_f32 v117, v117
    v_exp_f32 v118, v118
    v_exp_f32 v119, v119
    v_exp_f32 v132, v132
    v_exp_f32 v133, v133
    v_exp_f32 v134, v134
    v_exp_f32 v135, v135
    s_waitcnt vmcnt(19)
    v_mfma_f32_16x16x32_bf16 v[72:75], a[64:67], v[8:11], v[24:27]
    buffer_load_dwordx4 a[16:19], v2, s[8:11], s30 offen
    s_add_u32 s31, s31, 65536
    buffer_load_dwordx4 a[20:23], v5, s[8:11], s30 offen
    s_waitcnt vmcnt(20)
    v_mfma_f32_16x16x32_bf16 v[88:91], a[68:71], v[8:11], v[24:27]
    s_add_u32 s30, s30, 65536
    v_mfma_f32_16x16x32_bf16 v[76:79], a[64:67], v[12:15], v[28:31]
    v_exp_f32 v72, v72
    v_mfma_f32_16x16x32_bf16 v[92:95], a[68:71], v[12:15], v[28:31]
    v_exp_f32 v73, v73
    v_mfma_f32_16x16x32_bf16 v[80:83], a[64:67], v[16:19], v[32:35]
    v_exp_f32 v74, v74
    v_mfma_f32_16x16x32_bf16 v[96:99], a[68:71], v[16:19], v[32:35]
    v_exp_f32 v75, v75
    v_mfma_f32_16x16x32_bf16 v[84:87], a[64:67], v[20:23], v[36:39]
    v_exp_f32 v88, v88
    v_mfma_f32_16x16x32_bf16 v[100:103], a[68:71], v[20:23], v[36:39]
    v_exp_f32 v89, v89
    v_mfma_f32_16x16x32_bf16 v[40:43], a[24:27], v[152:155], v[40:43]
    v_exp_f32 v90, v90
    v_mfma_f32_16x16x32_bf16 v[56:59], a[28:31], v[152:155], v[56:59]
    v_cvt_pk_bf16_f32 v152, v104, v105
    v_cvt_pk_bf16_f32 v153, v106, v107
    v_mfma_f32_16x16x32_bf16 v[44:47], a[24:27], v[156:159], v[44:47]
    v_cvt_pk_bf16_f32 v154, v120, v121
    v_cvt_pk_bf16_f32 v155, v122, v123
    v_mfma_f32_16x16x32_bf16 v[60:63], a[28:31], v[156:159], v[60:63]
    v_cvt_pk_bf16_f32 v156, v108, v109
    v_cvt_pk_bf16_f32 v157, v110, v111
    v_mfma_f32_16x16x32_bf16 v[48:51], a[24:27], v[160:163], v[48:51]
    v_cvt_pk_bf16_f32 v158, v124, v125
    v_cvt_pk_bf16_f32 v159, v126, v127
    v_mfma_f32_16x16x32_bf16 v[64:67], a[28:31], v[160:163], v[64:67]
    v_cvt_pk_bf16_f32 v160, v112, v113
    v_cvt_pk_bf16_f32 v161, v114, v115
    v_mfma_f32_16x16x32_bf16 v[52:55], a[24:27], v[164:167], v[52:55]
    buffer_load_dwordx4 a[24:27], v2, s[8:11], s31 offen
    v_cvt_pk_bf16_f32 v162, v128, v129
    v_cvt_pk_bf16_f32 v163, v130, v131
    v_mfma_f32_16x16x32_bf16 v[68:71], a[28:31], v[164:167], v[68:71]
    buffer_load_dwordx4 a[28:31], v2, s[8:11], s31 offen offset:1024
    v_cvt_pk_bf16_f32 v164, v116, v117
    v_cvt_pk_bf16_f32 v165, v118, v119
    v_cvt_pk_bf16_f32 v166, v132, v133
    v_cvt_pk_bf16_f32 v167, v134, v135
    s_waitcnt vmcnt(19)
    v_mfma_f32_16x16x32_bf16 v[104:107], a[80:83], v[8:11], v[24:27]
    buffer_load_dwordx4 a[32:35], v2, s[8:11], s30 offen
    v_exp_f32 v91, v91
    s_waitcnt vmcnt(19)
    v_mfma_f32_16x16x32_bf16 v[120:123], a[84:87], v[8:11], v[24:27]
    s_add_u32 s31, s31, 65536
    v_exp_f32 v76, v76
    v_mfma_f32_16x16x32_bf16 v[108:111], a[80:83], v[12:15], v[28:31]
    buffer_load_dwordx4 a[36:39], v5, s[8:11], s30 offen
    v_exp_f32 v77, v77
    v_mfma_f32_16x16x32_bf16 v[124:127], a[84:87], v[12:15], v[28:31]
    s_add_u32 s30, s30, 65536
    v_exp_f32 v78, v78
    v_mfma_f32_16x16x32_bf16 v[112:115], a[80:83], v[16:19], v[32:35]
    v_exp_f32 v79, v79
    v_mfma_f32_16x16x32_bf16 v[128:131], a[84:87], v[16:19], v[32:35]
    v_exp_f32 v92, v92
    v_mfma_f32_16x16x32_bf16 v[116:119], a[80:83], v[20:23], v[36:39]
    v_exp_f32 v93, v93
    v_mfma_f32_16x16x32_bf16 v[132:135], a[84:87], v[20:23], v[36:39]
    v_exp_f32 v94, v94
    v_exp_f32 v95, v95
    v_exp_f32 v80, v80
    v_exp_f32 v81, v81
    v_exp_f32 v82, v82
    v_exp_f32 v83, v83
    v_exp_f32 v96, v96
    v_exp_f32 v97, v97
    v_exp_f32 v98, v98
    v_exp_f32 v99, v99
    v_exp_f32 v84, v84
    v_exp_f32 v85, v85
    v_exp_f32 v86, v86
    v_exp_f32 v87, v87
    v_exp_f32 v100, v100
    v_exp_f32 v101, v101
    v_exp_f32 v102, v102
    v_exp_f32 v103, v103
    v_mfma_f32_16x16x32_bf16 v[40:43], a[40:43], v[136:139], v[40:43]
    v_exp_f32 v104, v104
    v_mfma_f32_16x16x32_bf16 v[56:59], a[44:47], v[136:139], v[56:59]
    v_cvt_pk_bf16_f32 v136, v72, v73
    v_cvt_pk_bf16_f32 v137, v74, v75
    v_mfma_f32_16x16x32_bf16 v[44:47], a[40:43], v[140:143], v[44:47]
    v_cvt_pk_bf16_f32 v138, v88, v89
    v_cvt_pk_bf16_f32 v139, v90, v91
    v_mfma_f32_16x16x32_bf16 v[60:63], a[44:47], v[140:143], v[60:63]
    v_cvt_pk_bf16_f32 v140, v76, v77
    v_cvt_pk_bf16_f32 v141, v78, v79
    v_mfma_f32_16x16x32_bf16 v[48:51], a[40:43], v[144:147], v[48:51]
    v_cvt_pk_bf16_f32 v142, v92, v93
    v_cvt_pk_bf16_f32 v143, v94, v95
    v_mfma_f32_16x16x32_bf16 v[64:67], a[44:47], v[144:147], v[64:67]
    v_cvt_pk_bf16_f32 v144, v80, v81
    v_cvt_pk_bf16_f32 v145, v82, v83
    v_mfma_f32_16x16x32_bf16 v[52:55], a[40:43], v[148:151], v[52:55]
    buffer_load_dwordx4 a[40:43], v2, s[8:11], s31 offen
    v_cvt_pk_bf16_f32 v146, v96, v97
    v_cvt_pk_bf16_f32 v147, v98, v99
    v_mfma_f32_16x16x32_bf16 v[68:71], a[44:47], v[148:151], v[68:71]
    buffer_load_dwordx4 a[44:47], v2, s[8:11], s31 offen offset:1024
    v_cvt_pk_bf16_f32 v148, v84, v85
    v_cvt_pk_bf16_f32 v149, v86, v87
    v_cvt_pk_bf16_f32 v150, v100, v101
    v_cvt_pk_bf16_f32 v151, v102, v103
    v_exp_f32 v105, v105
    v_exp_f32 v106, v106
    v_exp_f32 v107, v107
    v_exp_f32 v120, v120
    v_exp_f32 v121, v121
    v_exp_f32 v122, v122
    v_exp_f32 v123, v123
    v_exp_f32 v108, v108
    v_exp_f32 v109, v109
    v_exp_f32 v110, v110
    v_exp_f32 v111, v111
    v_exp_f32 v124, v124
    v_exp_f32 v125, v125
    v_exp_f32 v126, v126
    v_exp_f32 v127, v127
    v_exp_f32 v112, v112
    v_exp_f32 v113, v113
    v_exp_f32 v114, v114
    v_exp_f32 v115, v115
    v_exp_f32 v128, v128
    v_exp_f32 v129, v129
    v_exp_f32 v130, v130
    v_exp_f32 v131, v131
    v_exp_f32 v116, v116
    v_exp_f32 v117, v117
    v_exp_f32 v118, v118
    v_exp_f32 v119, v119
    v_exp_f32 v132, v132
    v_exp_f32 v133, v133
    v_exp_f32 v134, v134
    v_exp_f32 v135, v135
    s_waitcnt vmcnt(19)
    v_mfma_f32_16x16x32_bf16 v[72:75], a[96:99], v[8:11], v[24:27]
    buffer_load_dwordx4 a[48:51], v2, s[8:11], s30 offen
    s_add_u32 s31, s31, 65536
    buffer_load_dwordx4 a[52:55], v5, s[8:11], s30 offen
    s_waitcnt vmcnt(20)
    v_mfma_f32_16x16x32_bf16 v[88:91], a[100:103], v[8:11], v[24:27]
    s_add_u32 s30, s30, 65536
    v_mfma_f32_16x16x32_bf16 v[76:79], a[96:99], v[12:15], v[28:31]
    v_exp_f32 v72, v72
    v_mfma_f32_16x16x32_bf16 v[92:95], a[100:103], v[12:15], v[28:31]
    v_exp_f32 v73, v73
    v_mfma_f32_16x16x32_bf16 v[80:83], a[96:99], v[16:19], v[32:35]
    v_exp_f32 v74, v74
    v_mfma_f32_16x16x32_bf16 v[96:99], a[100:103], v[16:19], v[32:35]
    v_exp_f32 v75, v75
    v_mfma_f32_16x16x32_bf16 v[84:87], a[96:99], v[20:23], v[36:39]
    v_exp_f32 v88, v88
    v_mfma_f32_16x16x32_bf16 v[100:103], a[100:103], v[20:23], v[36:39]
    v_exp_f32 v89, v89
    v_mfma_f32_16x16x32_bf16 v[40:43], a[56:59], v[152:155], v[40:43]
    v_exp_f32 v90, v90
    v_mfma_f32_16x16x32_bf16 v[56:59], a[60:63], v[152:155], v[56:59]
    v_cvt_pk_bf16_f32 v152, v104, v105
    v_cvt_pk_bf16_f32 v153, v106, v107
    v_mfma_f32_16x16x32_bf16 v[44:47], a[56:59], v[156:159], v[44:47]
    v_cvt_pk_bf16_f32 v154, v120, v121
    v_cvt_pk_bf16_f32 v155, v122, v123
    v_mfma_f32_16x16x32_bf16 v[60:63], a[60:63], v[156:159], v[60:63]
    v_cvt_pk_bf16_f32 v156, v108, v109
    v_cvt_pk_bf16_f32 v157, v110, v111
    v_mfma_f32_16x16x32_bf16 v[48:51], a[56:59], v[160:163], v[48:51]
    v_cvt_pk_bf16_f32 v158, v124, v125
    v_cvt_pk_bf16_f32 v159, v126, v127
    v_mfma_f32_16x16x32_bf16 v[64:67], a[60:63], v[160:163], v[64:67]
    v_cvt_pk_bf16_f32 v160, v112, v113
    v_cvt_pk_bf16_f32 v161, v114, v115
    v_mfma_f32_16x16x32_bf16 v[52:55], a[56:59], v[164:167], v[52:55]
    buffer_load_dwordx4 a[56:59], v2, s[8:11], s31 offen
    v_cvt_pk_bf16_f32 v162, v128, v129
    v_cvt_pk_bf16_f32 v163, v130, v131
    v_mfma_f32_16x16x32_bf16 v[68:71], a[60:63], v[164:167], v[68:71]
    buffer_load_dwordx4 a[60:63], v2, s[8:11], s31 offen offset:1024
    v_cvt_pk_bf16_f32 v164, v116, v117
    v_cvt_pk_bf16_f32 v165, v118, v119
    v_cvt_pk_bf16_f32 v166, v132, v133
    v_cvt_pk_bf16_f32 v167, v134, v135
    s_waitcnt vmcnt(19)
    v_mfma_f32_16x16x32_bf16 v[104:107], a[112:115], v[8:11], v[24:27]
    buffer_load_dwordx4 a[64:67], v2, s[8:11], s30 offen
    v_exp_f32 v91, v91
    s_waitcnt vmcnt(19)
    v_mfma_f32_16x16x32_bf16 v[120:123], a[116:119], v[8:11], v[24:27]
    s_add_u32 s31, s31, 65536
    v_exp_f32 v76, v76
    v_mfma_f32_16x16x32_bf16 v[108:111], a[112:115], v[12:15], v[28:31]
    buffer_load_dwordx4 a[68:71], v5, s[8:11], s30 offen
    v_exp_f32 v77, v77
    v_mfma_f32_16x16x32_bf16 v[124:127], a[116:119], v[12:15], v[28:31]
    s_add_u32 s30, s30, 65536
    v_exp_f32 v78, v78
    v_mfma_f32_16x16x32_bf16 v[112:115], a[112:115], v[16:19], v[32:35]
    v_exp_f32 v79, v79
    v_mfma_f32_16x16x32_bf16 v[128:131], a[116:119], v[16:19], v[32:35]
    v_exp_f32 v92, v92
    v_mfma_f32_16x16x32_bf16 v[116:119], a[112:115], v[20:23], v[36:39]
    v_exp_f32 v93, v93
    v_mfma_f32_16x16x32_bf16 v[132:135], a[116:119], v[20:23], v[36:39]
    v_exp_f32 v94, v94
    v_mfma_f32_16x16x32_bf16 v[40:43], a[72:75], v[136:139], v[40:43]
    v_exp_f32 v95, v95
    v_mfma_f32_16x16x32_bf16 v[56:59], a[76:79], v[136:139], v[56:59]
    v_exp_f32 v80, v80
    v_mfma_f32_16x16x32_bf16 v[44:47], a[72:75], v[140:143], v[44:47]
    v_exp_f32 v81, v81
    v_mfma_f32_16x16x32_bf16 v[60:63], a[76:79], v[140:143], v[60:63]
    v_exp_f32 v82, v82
    v_mfma_f32_16x16x32_bf16 v[48:51], a[72:75], v[144:147], v[48:51]
    v_exp_f32 v83, v83
    v_mfma_f32_16x16x32_bf16 v[64:67], a[76:79], v[144:147], v[64:67]
    v_exp_f32 v96, v96
    v_mfma_f32_16x16x32_bf16 v[52:55], a[72:75], v[148:151], v[52:55]
    buffer_load_dwordx4 a[72:75], v2, s[8:11], s31 offen
    v_exp_f32 v97, v97
    v_mfma_f32_16x16x32_bf16 v[68:71], a[76:79], v[148:151], v[68:71]
    buffer_load_dwordx4 a[76:79], v2, s[8:11], s31 offen offset:1024
    v_exp_f32 v98, v98
    v_exp_f32 v99, v99
    v_exp_f32 v84, v84
    v_exp_f32 v85, v85
    v_exp_f32 v86, v86
    v_exp_f32 v87, v87
    v_exp_f32 v100, v100
    v_exp_f32 v101, v101
    v_exp_f32 v102, v102
    v_exp_f32 v103, v103
    v_mfma_f32_16x16x32_bf16 v[40:43], a[88:91], v[152:155], v[40:43]
    buffer_load_dwordx4 a[80:83], v2, s[8:11], s30 offen
    v_cvt_pk_bf16_f32 v136, v72, v73
    v_cvt_pk_bf16_f32 v137, v74, v75
    v_mfma_f32_16x16x32_bf16 v[56:59], a[92:95], v[152:155], v[56:59]
    s_add_u32 s31, s31, 65536
    v_cvt_pk_bf16_f32 v138, v88, v89
    v_cvt_pk_bf16_f32 v139, v90, v91
    v_mfma_f32_16x16x32_bf16 v[44:47], a[88:91], v[156:159], v[44:47]
    buffer_load_dwordx4 a[84:87], v5, s[8:11], s30 offen
    v_cvt_pk_bf16_f32 v140, v76, v77
    v_cvt_pk_bf16_f32 v141, v78, v79
    v_mfma_f32_16x16x32_bf16 v[60:63], a[92:95], v[156:159], v[60:63]
    s_add_u32 s30, s30, 65536
    v_cvt_pk_bf16_f32 v142, v92, v93
    v_cvt_pk_bf16_f32 v143, v94, v95
    v_mfma_f32_16x16x32_bf16 v[48:51], a[88:91], v[160:163], v[48:51]
    v_cvt_pk_bf16_f32 v144, v80, v81
    v_cvt_pk_bf16_f32 v145, v82, v83
    v_mfma_f32_16x16x32_bf16 v[64:67], a[92:95], v[160:163], v[64:67]
    v_cvt_pk_bf16_f32 v146, v96, v97
    v_cvt_pk_bf16_f32 v147, v98, v99
    v_mfma_f32_16x16x32_bf16 v[52:55], a[88:91], v[164:167], v[52:55]
    buffer_load_dwordx4 a[88:91], v2, s[8:11], s31 offen
    v_cvt_pk_bf16_f32 v148, v84, v85
    v_cvt_pk_bf16_f32 v149, v86, v87
    v_mfma_f32_16x16x32_bf16 v[68:71], a[92:95], v[164:167], v[68:71]
    buffer_load_dwordx4 a[92:95], v2, s[8:11], s31 offen offset:1024
    v_cvt_pk_bf16_f32 v150, v100, v101
    v_cvt_pk_bf16_f32 v151, v102, v103
    v_exp_f32 v104, v104
    v_exp_f32 v105, v105
    v_exp_f32 v106, v106
    v_exp_f32 v107, v107
    v_exp_f32 v120, v120
    v_exp_f32 v121, v121
    v_exp_f32 v122, v122
    v_exp_f32 v123, v123
    v_exp_f32 v108, v108
    v_exp_f32 v109, v109
    v_exp_f32 v110, v110
    v_exp_f32 v111, v111
    v_exp_f32 v124, v124
    v_exp_f32 v125, v125
    v_exp_f32 v126, v126
    v_exp_f32 v127, v127
    v_exp_f32 v112, v112
    v_exp_f32 v113, v113
    v_exp_f32 v114, v114
    v_exp_f32 v115, v115
    v_exp_f32 v128, v128
    v_exp_f32 v129, v129
    v_exp_f32 v130, v130
    v_exp_f32 v131, v131
    v_exp_f32 v116, v116
    v_exp_f32 v117, v117
    v_exp_f32 v118, v118
    v_exp_f32 v119, v119
    v_exp_f32 v132, v132
    v_exp_f32 v133, v133
    v_exp_f32 v134, v134
    v_exp_f32 v135, v135
    v_mfma_f32_16x16x32_bf16 v[40:43], a[104:107], v[136:139], v[40:43]
    s_add_u32 s31, s31, 65536
    v_cvt_pk_bf16_f32 v152, v104, v105
    v_cvt_pk_bf16_f32 v153, v106, v107
    v_mfma_f32_16x16x32_bf16 v[56:59], a[108:111], v[136:139], v[56:59]
    v_cvt_pk_bf16_f32 v154, v120, v121
    v_cvt_pk_bf16_f32 v155, v122, v123
    v_mfma_f32_16x16x32_bf16 v[44:47], a[104:107], v[140:143], v[44:47]
    v_cvt_pk_bf16_f32 v156, v108, v109
    v_cvt_pk_bf16_f32 v157, v110, v111
    v_mfma_f32_16x16x32_bf16 v[60:63], a[108:111], v[140:143], v[60:63]
    v_cvt_pk_bf16_f32 v158, v124, v125
    v_cvt_pk_bf16_f32 v159, v126, v127
    v_mfma_f32_16x16x32_bf16 v[48:51], a[104:107], v[144:147], v[48:51]
    v_cvt_pk_bf16_f32 v160, v112, v113
    v_cvt_pk_bf16_f32 v161, v114, v115
    v_mfma_f32_16x16x32_bf16 v[64:67], a[108:111], v[144:147], v[64:67]
    v_cvt_pk_bf16_f32 v162, v128, v129
    v_cvt_pk_bf16_f32 v163, v130, v131
    v_mfma_f32_16x16x32_bf16 v[52:55], a[104:107], v[148:151], v[52:55]
    v_cvt_pk_bf16_f32 v164, v116, v117
    v_cvt_pk_bf16_f32 v165, v118, v119
    v_mfma_f32_16x16x32_bf16 v[68:71], a[108:111], v[148:151], v[68:71]
    v_cvt_pk_bf16_f32 v166, v132, v133
    v_cvt_pk_bf16_f32 v167, v134, v135
    s_waitcnt vmcnt(25)
    v_mfma_f32_16x16x32_bf16 v[40:43], a[120:123], v[152:155], v[40:43]
    s_waitcnt vmcnt(24)
    v_mfma_f32_16x16x32_bf16 v[56:59], a[124:127], v[152:155], v[56:59]
    v_mfma_f32_16x16x32_bf16 v[44:47], a[120:123], v[156:159], v[44:47]
    v_mfma_f32_16x16x32_bf16 v[60:63], a[124:127], v[156:159], v[60:63]
    v_mfma_f32_16x16x32_bf16 v[48:51], a[120:123], v[160:163], v[48:51]
    v_mfma_f32_16x16x32_bf16 v[64:67], a[124:127], v[160:163], v[64:67]
    v_mfma_f32_16x16x32_bf16 v[52:55], a[120:123], v[164:167], v[52:55]
    v_mfma_f32_16x16x32_bf16 v[68:71], a[124:127], v[164:167], v[68:71]
    s_add_u32 s23, s23, 8
    s_cmp_lt_u32 s23, 64
    s_nop 7
    s_cbranch_scc1 t2loop_240
    s_waitcnt vmcnt(0)
    s_nop 11
    v_mov_b32 v72, v56
    v_mov_b32 v73, v56
    s_nop 1
    v_permlane16_swap_b32 v72, v73
    v_mov_b32 v72, v73
    s_nop 1
    v_permlane32_swap_b32 v72, v73
    v_mov_b32 v74, v60
    v_mov_b32 v75, v60
    s_nop 1
    v_permlane16_swap_b32 v74, v75
    v_mov_b32 v74, v75
    s_nop 1
    v_permlane32_swap_b32 v74, v75
    v_mov_b32 v76, v64
    v_mov_b32 v77, v64
    s_nop 1
    v_permlane16_swap_b32 v76, v77
    v_mov_b32 v76, v77
    s_nop 1
    v_permlane32_swap_b32 v76, v77
    v_mov_b32 v78, v68
    v_mov_b32 v79, v68
    s_nop 1
    v_permlane16_swap_b32 v78, v79
    v_mov_b32 v78, v79
    s_nop 1
    v_permlane32_swap_b32 v78, v79
    s_cmp_lg_u32 s25, 0
    s_cbranch_scc1 t2fin_241
    s_mov_b32 s27, 0x21800000
    s_mov_b32 s28, 0x5d800000
    s_mov_b64 s[38:39], 0
    v_cmp_nlt_f32 vcc, s27, v72
    s_nop 0
    s_or_b64 s[38:39], s[38:39], vcc
    v_cmp_ngt_f32 vcc, s28, v72
    s_nop 0
    s_or_b64 s[38:39], s[38:39], vcc
    v_cmp_nlt_f32 vcc, s27, v74
    s_nop 0
    s_or_b64 s[38:39], s[38:39], vcc
    v_cmp_ngt_f32 vcc, s28, v74
    s_nop 0
    s_or_b64 s[38:39], s[38:39], vcc
    v_cmp_nlt_f32 vcc, s27, v76
    s_nop 0
    s_or_b64 s[38:39], s[38:39], vcc
    v_cmp_ngt_f32 vcc, s28, v76
    s_nop 0
    s_or_b64 s[38:39], s[38:39], vcc
    v_cmp_nlt_f32 vcc, s27, v78
    s_nop 0
    s_or_b64 s[38:39], s[38:39], vcc
    v_cmp_ngt_f32 vcc, s28, v78
    s_nop 0
    s_or_b64 s[38:39], s[38:39], vcc
    s_cmp_eq_u64 s[38:39], 0
    s_cbranch_scc1 t2fin_241
t2fb_242:
    v_mov_b32 v40, 0xff800000
    v_mov_b32 v41, 0xff800000
    v_mov_b32 v42, 0xff800000
    v_mov_b32 v43, 0xff800000
    s_mov_b32 s23, 0
    s_mov_b32 s30, s20
t2fl_243:
    buffer_load_dwordx4 v[168:171], v2, s[8:11], s30 offen
    buffer_load_dwordx4 v[172:175], v5, s[8:11], s30 offen
    s_waitcnt vmcnt(1)
    v_mfma_f32_16x16x32_bf16 v[72:75], v[168:171], v[8:11], 0
    s_waitcnt vmcnt(0)
    v_mfma_f32_16x16x32_bf16 v[88:91], v[172:175], v[8:11], 0
    v_mfma_f32_16x16x32_bf16 v[76:79], v[168:171], v[12:15], 0
    v_mfma_f32_16x16x32_bf16 v[92:95], v[172:175], v[12:15], 0
    v_mfma_f32_16x16x32_bf16 v[80:83], v[168:171], v[16:19], 0
    v_mfma_f32_16x16x32_bf16 v[96:99], v[172:175], v[16:19], 0
    v_mfma_f32_16x16x32_bf16 v[84:87], v[168:171], v[20:23], 0
    v_mfma_f32_16x16x32_bf16 v[100:103], v[172:175], v[20:23], 0
    v_max3_f32 v40, v72, v73, v40
    v_max3_f32 v40, v74, v75, v40
    v_max3_f32 v40, v88, v89, v40
    v_max3_f32 v40, v90, v91, v40
    v_max3_f32 v41, v76, v77, v41
    v_max3_f32 v41, v78, v79, v41
    v_max3_f32 v41, v92, v93, v41
    v_max3_f32 v41, v94, v95, v41
    v_max3_f32 v42, v80, v81, v42
    v_max3_f32 v42, v82, v83, v42
    v_max3_f32 v42, v96, v97, v42
    v_max3_f32 v42, v98, v99, v42
    v_max3_f32 v43, v84, v85, v43
    v_max3_f32 v43, v86, v87, v43
    v_max3_f32 v43, v100, v101, v43
    v_max3_f32 v43, v102, v103, v43
    s_add_u32 s30, s30, 65536
    s_add_u32 s23, s23, 1
    s_cmp_lt_u32 s23, 64
    s_nop 3
    s_cbranch_scc1 t2fl_243
    v_mov_b32 v72, v40
    s_nop 1
    v_permlane16_swap_b32 v72, v40
    v_max_f32 v40, v40, v72
    v_mov_b32 v72, v40
    s_nop 1
    v_permlane32_swap_b32 v72, v40
    v_max_f32 v40, v40, v72
    v_sub_f32 v24, 0, v40
    v_sub_f32 v25, 0, v40
    v_sub_f32 v26, 0, v40
    v_sub_f32 v27, 0, v40
    v_mov_b32 v72, v41
    s_nop 1
    v_permlane16_swap_b32 v72, v41
    v_max_f32 v41, v41, v72
    v_mov_b32 v72, v41
    s_nop 1
    v_permlane32_swap_b32 v72, v41
    v_max_f32 v41, v41, v72
    v_sub_f32 v28, 0, v41
    v_sub_f32 v29, 0, v41
    v_sub_f32 v30, 0, v41
    v_sub_f32 v31, 0, v41
    v_mov_b32 v72, v42
    s_nop 1
    v_permlane16_swap_b32 v72, v42
    v_max_f32 v42, v42, v72
    v_mov_b32 v72, v42
    s_nop 1
    v_permlane32_swap_b32 v72, v42
    v_max_f32 v42, v42, v72
    v_sub_f32 v32, 0, v42
    v_sub_f32 v33, 0, v42
    v_sub_f32 v34, 0, v42
    v_sub_f32 v35, 0, v42
    v_mov_b32 v72, v43
    s_nop 1
    v_permlane16_swap_b32 v72, v43
    v_max_f32 v43, v43, v72
    v_mov_b32 v72, v43
    s_nop 1
    v_permlane32_swap_b32 v72, v43
    v_max_f32 v43, v43, v72
    v_sub_f32 v36, 0, v43
    v_sub_f32 v37, 0, v43
    v_sub_f32 v38, 0, v43
    v_sub_f32 v39, 0, v43
    s_mov_b32 s25, 1
    s_branch t2main_239
t2fin_241:
    v_lshlrev_b32 v6, 2, v3
    buffer_load_dword v80, v6, s[8:11], s26 offen offset:0
    buffer_load_dword v81, v6, s[8:11], s26 offen offset:64
    buffer_load_dword v82, v6, s[8:11], s26 offen offset:128
    buffer_load_dword v83, v6, s[8:11], s26 offen offset:192
    v_rcp_f32 v72, v72
    s_waitcnt vmcnt(3)
    v_mul_f32 v72, v72, v80
    v_mul_f32 v40, v72, v40
    v_mul_f32 v41, v72, v41
    v_mul_f32 v42, v72, v42
    v_mul_f32 v43, v72, v43
    v_mul_f32 v56, v72, v56
    v_mul_f32 v57, v72, v57
    v_mul_f32 v58, v72, v58
    v_mul_f32 v59, v72, v59
    v_cvt_pk_bf16_f32 v136, v40, v41
    v_cvt_pk_bf16_f32 v137, v42, v43
    v_cvt_pk_bf16_f32 v138, v56, v57
    v_cvt_pk_bf16_f32 v139, v58, v59
    s_add_u32 s24, s40, 113246208
    buffer_store_dwordx4 v[136:139], v2, s[8:11], s24 offen sc1
    v_rcp_f32 v74, v74
    s_waitcnt vmcnt(3)
    v_mul_f32 v74, v74, v81
    v_mul_f32 v44, v74, v44
    v_mul_f32 v45, v74, v45
    v_mul_f32 v46, v74, v46
    v_mul_f32 v47, v74, v47
    v_mul_f32 v60, v74, v60
    v_mul_f32 v61, v74, v61
    v_mul_f32 v62, v74, v62
    v_mul_f32 v63, v74, v63
    v_cvt_pk_bf16_f32 v140, v44, v45
    v_cvt_pk_bf16_f32 v141, v46, v47
    v_cvt_pk_bf16_f32 v142, v60, v61
    v_cvt_pk_bf16_f32 v143, v62, v63
    s_add_u32 s24, s40, 113247232
    buffer_store_dwordx4 v[140:143], v2, s[8:11], s24 offen sc1
    v_rcp_f32 v76, v76
    s_waitcnt vmcnt(3)
    v_mul_f32 v76, v76, v82
    v_mul_f32 v48, v76, v48
    v_mul_f32 v49, v76, v49
    v_mul_f32 v50, v76, v50
    v_mul_f32 v51, v76, v51
    v_mul_f32 v64, v76, v64
    v_mul_f32 v65, v76, v65
    v_mul_f32 v66, v76, v66
    v_mul_f32 v67, v76, v67
    v_cvt_pk_bf16_f32 v144, v48, v49
    v_cvt_pk_bf16_f32 v145, v50, v51
    v_cvt_pk_bf16_f32 v146, v64, v65
    v_cvt_pk_bf16_f32 v147, v66, v67
    s_add_u32 s24, s40, 113248256
    buffer_store_dwordx4 v[144:147], v2, s[8:11], s24 offen sc1
    v_rcp_f32 v78, v78
    s_waitcnt vmcnt(3)
    v_mul_f32 v78, v78, v83
    v_mul_f32 v52, v78, v52
    v_mul_f32 v53, v78, v53
    v_mul_f32 v54, v78, v54
    v_mul_f32 v55, v78, v55
    v_mul_f32 v68, v78, v68
    v_mul_f32 v69, v78, v69
    v_mul_f32 v70, v78, v70
    v_mul_f32 v71, v78, v71
    v_cvt_pk_bf16_f32 v148, v52, v53
    v_cvt_pk_bf16_f32 v149, v54, v55
    v_cvt_pk_bf16_f32 v150, v68, v69
    v_cvt_pk_bf16_f32 v151, v70, v71
    s_add_u32 s24, s40, 113249280
    buffer_store_dwordx4 v[148:151], v2, s[8:11], s24 offen sc1
    s_waitcnt vmcnt(0)
    s_lshr_b32 s20, s7, 1
    s_lshl_b32 s20, s20, 2
    s_add_u32 s20, s20, 52
    s_and_b32 s21, s7, 1
    s_lshl_b32 s21, s21, 4
    s_lshl_b32 s21, 1, s21
    s_cmp_lg_u32 s4, 0
    s_cbranch_scc1 tki_244
    s_lshl_b32 s93, s83, 2
    s_add_u32 s93, s93, 176
    v_mov_b32 v250, s93
    v_mov_b32 v251, 1
    s_mov_b64 exec, 1
    global_atomic_add v249, v250, v251, s[98:99] sc0 sc1
    s_mov_b64 exec, -1
tki_244:
    s_waitcnt vmcnt(0) lgkmcnt(0)
    s_barrier
    s_cmp_lg_u32 s4, 0
    s_cbranch_scc1 sig_245
    v_mov_b32 v250, s20
    v_mov_b32 v251, s21
    s_mov_b64 exec, 1
    global_atomic_add v250, v251, s[98:99] sc1
    s_mov_b64 exec, -1
sig_245:
    s_branch L_next
LT34_100:
L_T34x:
    s_lshr_b32 s19, s5, 2
    s_lshr_b32 s20, s19, 1
    s_lshl_b32 s20, s20, 2
    s_and_b32 s21, s19, 1
    s_lshl_b32 s21, s21, 4
    s_add_u32 s17, s19, 8
    s_bitcmp1_b32 s92, s17
    s_cbranch_scc1 dep_246
    s_add_u32 s18, s20, 32
    s_cmp_lg_u32 s4, 0
    s_cbranch_scc1 wfd_248
    v_mov_b32 v250, s18
wf_247:
    global_load_dword v251, v250, s[98:99] sc1
    s_waitcnt vmcnt(0)
    v_lshrrev_b32 v251, s21, v251
    v_and_b32 v251, 0xffff, v251
    v_cmp_gt_u32 vcc, 32, v251
    s_cbranch_vccz wf_247x
    s_sleep 32
    s_branch wf_247
wf_247x:
wfd_248:
    s_cmp_eq_u32 s19, 0
    s_cbranch_scc1 m0_249
    s_add_u32 s18, s20, 16
    s_cmp_lg_u32 s4, 0
    s_cbranch_scc1 wfd_252
    v_mov_b32 v250, s18
wf_251:
    global_load_dword v251, v250, s[98:99] sc1
    s_waitcnt vmcnt(0)
    v_lshrrev_b32 v251, s21, v251
    v_and_b32 v251, 0xffff, v251
    v_cmp_gt_u32 vcc, 64, v251
    s_cbranch_vccz wf_251x
    s_sleep 32
    s_branch wf_251
wf_251x:
wfd_252:
    s_branch m0d_250
m0_249:
    s_cmp_lg_u32 s4, 0
    s_cbranch_scc1 wfd_254
    v_mov_b32 v250, 252
wf_253:
    global_load_dword v251, v250, s[98:99] sc1
    s_waitcnt vmcnt(0)
    v_lshrrev_b32 v251, 0, v251
    v_and_b32 v251, 0xff, v251
    v_cmp_gt_u32 vcc, 64, v251
    s_cbranch_vccz wf_253x
    s_sleep 32
    s_branch wf_253
wf_253x:
wfd_254:
    s_cmp_lg_u32 s4, 0
    s_cbranch_scc1 wfd_256
    v_mov_b32 v250, 252
wf_255:
    global_load_dword v251, v250, s[98:99] sc1
    s_waitcnt vmcnt(0)
    v_lshrrev_b32 v251, 8, v251
    v_and_b32 v251, 0xff, v251
    v_cmp_gt_u32 vcc, 64, v251
    s_cbranch_vccz wf_255x
    s_sleep 32
    s_branch wf_255
wf_255x:
wfd_256:
    s_cmp_lg_u32 s4, 0
    s_cbranch_scc1 wfd_258
    v_mov_b32 v250, 252
wf_257:
    global_load_dword v251, v250, s[98:99] sc1
    s_waitcnt vmcnt(0)
    v_lshrrev_b32 v251, 16, v251
    v_and_b32 v251, 0xff, v251
    v_cmp_gt_u32 vcc, 64, v251
    s_cbranch_vccz wf_257x
    s_sleep 32
    s_branch wf_257
wf_257x:
wfd_258:
    s_cmp_lg_u32 s4, 0
    s_cbranch_scc1 wfd_260
    v_mov_b32 v250, 252
wf_259:
    global_load_dword v251, v250, s[98:99] sc1
    s_waitcnt vmcnt(0)
    v_lshrrev_b32 v251, 24, v251
    v_and_b32 v251, 0xff, v251
    v_cmp_gt_u32 vcc, 64, v251
    s_cbranch_vccz wf_259x
    s_sleep 32
    s_branch wf_259
wf_259x:
wfd_260:
m0d_250:
    s_cmp_lg_u32 s4, 0
    s_cbranch_scc1 tkb_262
    s_mov_b64 exec, 1
    v_mov_b32 v250, 0
    global_load_dword v251, v250, s[98:99] offset:4 sc1
    global_load_dword v252, v250, s[98:99] sc1
    global_load_dword v253, v250, s[98:99] offset:248 sc1
    s_waitcnt vmcnt(0)
    v_readfirstlane_b32 s23, v251
    v_readfirstlane_b32 s24, v252
    v_readfirstlane_b32 s25, v253
    v_mov_b32 v252, 0xffff
    s_and_b32 s23, s23, 0xffff
    s_cmp_ge_u32 s23, 64
    s_cbranch_scc1 tkg_263
    s_min_u32 s24, s24, s25
    s_cmp_ge_u32 s24, 32
    s_cbranch_scc1 tkg_263
    v_mov_b32 v251, 1
    global_atomic_add v252, v250, v251, s[98:99] sc0 sc1
    s_waitcnt vmcnt(0)
    s_waitcnt vmcnt(0)
    v_cmp_gt_u32 vcc, 32, v252
    s_cbranch_vccnz tkg_263
    global_atomic_add v252, v250, v251, s[98:99] offset:248 sc0 sc1
    s_waitcnt vmcnt(0)
    s_waitcnt vmcnt(0)
    v_cmp_gt_u32 vcc, 32, v252
    v_or_b32 v253, 0x100, v252
    v_mov_b32 v252, 0xffff
    v_cndmask_b32 v252, v252, v253, vcc
tkg_263:
    v_mov_b32 v250, 163836
    ds_write_b32 v250, v252
    s_waitcnt lgkmcnt(0)
    s_mov_b64 exec, -1
tkb_262:
    s_barrier
    v_mov_b32 v250, 163836
    ds_read_b32 v252, v250
    s_waitcnt lgkmcnt(0)
    s_waitcnt lgkmcnt(0)
    v_readfirstlane_b32 s23, v252
    s_barrier
    s_cmp_eq_u32 s23, 0xffff
    s_cbranch_scc1 tko_261
    s_and_b32 s3, s23, 0xff
    s_lshr_b32 s6, s23, 8
    s_mov_b32 s91, 0x10001
    s_lshl_b32 s88, s5, 8
    s_or_b32 s88, s88, s7
    s_or_b32 s88, s88, 0x10000
    s_branch L_chain_far
tko_261:
    s_cmp_lg_u32 s4, 0
    s_cbranch_scc1 wfd_265
    v_mov_b32 v250, 4
wf_264:
    global_load_dword v251, v250, s[98:99] sc1
    s_waitcnt vmcnt(0)
    v_lshrrev_b32 v251, 0, v251
    v_and_b32 v251, 0xffff, v251
    v_cmp_gt_u32 vcc, 64, v251
    s_cbranch_vccz wf_264x
    s_sleep 32
    s_branch wf_264
wf_264x:
wfd_265:
    s_cmp_lg_u32 s4, 0
    s_cbranch_scc1 wfd_267
    v_mov_b32 v250, 12
wf_266:
    global_load_dword v251, v250, s[98:99] sc1
    s_waitcnt vmcnt(0)
    v_lshrrev_b32 v251, 16, v251
    v_and_b32 v251, 0xffff, v251
    v_cmp_gt_u32 vcc, 420, v251
    s_cbranch_vccz wf_266x
    s_sleep 32
    s_branch wf_266
wf_266x:
wfd_267:
    s_cmp_lg_u32 s4, 0
    s_cbranch_scc1 acq_268
    buffer_inv sc1
    s_waitcnt vmcnt(0)
acq_268:
    s_barrier
    s_bitset1_b32 s92, s17
dep_246:
    s_lshl_b32 s23, s7, 4
    s_mul_i32 s23, s23, 40960
    s_mul_i32 s21, s4, 10240
    s_add_u32 s23, s23, s21
    s_add_u32 s23, s23, 91226112
    v_add_u32 v5, 4096, v2
    v_add_u32 v6, 8192, v2
    s_add_u32 s40, s23, 0
    s_add_u32 s41, s23, 40960
    s_add_u32 s42, s23, 81920
    s_add_u32 s43, s23, 122880
    s_add_u32 s44, s23, 163840
    s_add_u32 s45, s23, 204800
    s_add_u32 s46, s23, 245760
    s_add_u32 s47, s23, 286720
    s_add_u32 s48, s23, 327680
    s_add_u32 s49, s23, 368640
    s_add_u32 s50, s23, 409600
    s_add_u32 s51, s23, 450560
    s_add_u32 s52, s23, 491520
    s_add_u32 s53, s23, 532480
    s_add_u32 s54, s23, 573440
    s_add_u32 s55, s23, 614400
    v_lshrrev_b32 v7, 2, v1
    v_lshlrev_b32 v7, 4, v7
    v_and_b32 v250, 1, v1
    v_lshl_add_u32 v7, v250, 3, v7
    s_lshl_b32 s21, s4, 12
    v_add_u32 v7, s21, v7
    v_add_u32 v251, s21, v2
    v_lshlrev_b32 v252, 4, v3
    v_and_b32 v250, 1, v4
    v_lshl_add_u32 v252, v250, 3, v252
    v_lshlrev_b32 v250, 2, v4
    v_cmp_gt_u32 s[28:29], 32, v1
    v_add_u32 v253, 0, v250
    v_cmp_le_u32 s[30:31], v253, v3
    v_add_u32 v253, 1, v250
    v_cmp_le_u32 s[32:33], v253, v3
    v_add_u32 v253, 2, v250
    v_cmp_le_u32 s[34:35], v253, v3
    v_add_u32 v253, 3, v250
    v_cmp_le_u32 s[36:37], v253, v3
    s_lshl_b32 s25, s5, 1
    s_mov_b32 s26, 0
t34l_269:
    s_lshl_b32 s21, s7, 2
    s_add_u32 s21, s21, s4
    s_lshl_b32 s20, s25, 5
    s_add_u32 s20, s20, s21
    s_lshl_b32 s22, s20, 12
    s_add_u32 s22, s22, 8388608
    s_lshl_b32 s20, s20, 13
    s_add_u32 s21, s20, 50331648
    buffer_load_dwordx4 v[8:11], v2, s[8:11], s21 offen offset:0
    buffer_load_dwordx4 v[12:15], v2, s[8:11], s21 offen offset:1024
    buffer_load_dwordx4 v[16:19], v2, s[8:11], s21 offen offset:2048
    buffer_load_dwordx4 v[20:23], v2, s[8:11], s21 offen offset:3072
    buffer_load_dwordx4 v[24:27], v5, s[8:11], s21 offen offset:0
    buffer_load_dwordx4 v[28:31], v5, s[8:11], s21 offen offset:1024
    buffer_load_dwordx4 v[32:35], v5, s[8:11], s21 offen offset:2048
    buffer_load_dwordx4 v[36:39], v5, s[8:11], s21 offen offset:3072
    s_add_u32 s21, s20, 16777216
    buffer_load_dwordx4 v[40:43], v2, s[8:11], s21 offen offset:0
    buffer_load_dwordx4 v[44:47], v2, s[8:11], s21 offen offset:1024
    buffer_load_dwordx4 v[48:51], v2, s[8:11], s21 offen offset:2048
    buffer_load_dwordx4 v[52:55], v2, s[8:11], s21 offen offset:3072
    buffer_load_dwordx4 v[56:59], v5, s[8:11], s21 offen offset:0
    buffer_load_dwordx4 v[60:63], v5, s[8:11], s21 offen offset:1024
    buffer_load_dwordx4 v[64:67], v5, s[8:11], s21 offen offset:2048
    buffer_load_dwordx4 v[68:71], v5, s[8:11], s21 offen offset:3072
    s_add_u32 s21, s20, 33554432
    buffer_load_dwordx4 v[72:75], v2, s[8:11], s21 offen offset:0
    buffer_load_dwordx4 v[76:79], v2, s[8:11], s21 offen offset:1024
    buffer_load_dwordx4 v[80:83], v2, s[8:11], s21 offen offset:2048
    buffer_load_dwordx4 v[84:87], v2, s[8:11], s21 offen offset:3072
    buffer_load_dwordx4 v[88:91], v5, s[8:11], s21 offen offset:0
    buffer_load_dwordx4 v[92:95], v5, s[8:11], s21 offen offset:1024
    buffer_load_dwordx4 v[96:99], v5, s[8:11], s21 offen offset:2048
    buffer_load_dwordx4 v[100:103], v5, s[8:11], s21 offen offset:3072
    s_cmp_lg_u32 s26, 0
    s_cbranch_scc1 t34w_270
    buffer_load_dwordx4 a[0:3], v2, s[8:11], s40 offen offset:0
    buffer_load_dwordx4 a[4:7], v2, s[8:11], s40 offen offset:1024
    buffer_load_dwordx4 a[8:11], v2, s[8:11], s40 offen offset:2048
    buffer_load_dwordx4 a[12:15], v2, s[8:11], s40 offen offset:3072
    buffer_load_dwordx4 a[16:19], v5, s[8:11], s40 offen offset:0
    buffer_load_dwordx4 a[20:23], v5, s[8:11], s40 offen offset:1024
    buffer_load_dwordx4 a[24:27], v5, s[8:11], s40 offen offset:2048
    buffer_load_dwordx4 a[28:31], v5, s[8:11], s40 offen offset:3072
    buffer_load_dwordx4 a[32:35], v6, s[8:11], s40 offen offset:0
    buffer_load_dwordx4 a[36:39], v6, s[8:11], s40 offen offset:1024
    buffer_load_dwordx4 a[40:43], v2, s[8:11], s41 offen offset:0
    buffer_load_dwordx4 a[44:47], v2, s[8:11], s41 offen offset:1024
    buffer_load_dwordx4 a[48:51], v2, s[8:11], s41 offen offset:2048
    buffer_load_dwordx4 a[52:55], v2, s[8:11], s41 offen offset:3072
    buffer_load_dwordx4 a[56:59], v5, s[8:11], s41 offen offset:0
    buffer_load_dwordx4 a[60:63], v5, s[8:11], s41 offen offset:1024
    buffer_load_dwordx4 a[64:67], v5, s[8:11], s41 offen offset:2048
    buffer_load_dwordx4 a[68:71], v5, s[8:11], s41 offen offset:3072
    buffer_load_dwordx4 a[72:75], v6, s[8:11], s41 offen offset:0
    buffer_load_dwordx4 a[76:79], v6, s[8:11], s41 offen offset:1024
    buffer_load_dwordx4 a[80:83], v2, s[8:11], s42 offen offset:0
    buffer_load_dwordx4 a[84:87], v2, s[8:11], s42 offen offset:1024
    buffer_load_dwordx4 a[88:91], v2, s[8:11], s42 offen offset:2048
    buffer_load_dwordx4 a[92:95], v2, s[8:11], s42 offen offset:3072
    buffer_load_dwordx4 a[96:99], v5, s[8:11], s42 offen offset:0
    buffer_load_dwordx4 a[100:103], v5, s[8:11], s42 offen offset:1024
    buffer_load_dwordx4 a[104:107], v5, s[8:11], s42 offen offset:2048
    buffer_load_dwordx4 a[108:111], v5, s[8:11], s42 offen offset:3072
    buffer_load_dwordx4 a[112:115], v6, s[8:11], s42 offen offset:0
    buffer_load_dwordx4 a[116:119], v6, s[8:11], s42 offen offset:1024
    buffer_load_dwordx4 a[120:123], v2, s[8:11], s43 offen offset:0
    buffer_load_dwordx4 a[124:127], v2, s[8:11], s43 offen offset:1024
    buffer_load_dwordx4 a[128:131], v2, s[8:11], s43 offen offset:2048
    buffer_load_dwordx4 a[132:135], v2, s[8:11], s43 offen offset:3072
    buffer_load_dwordx4 a[136:139], v5, s[8:11], s43 offen offset:0
    buffer_load_dwordx4 a[140:143], v5, s[8:11], s43 offen offset:1024
    buffer_load_dwordx4 a[144:147], v5, s[8:11], s43 offen offset:2048
    buffer_load_dwordx4 a[148:151], v5, s[8:11], s43 offen offset:3072
    buffer_load_dwordx4 a[152:155], v6, s[8:11], s43 offen offset:0
    buffer_load_dwordx4 a[156:159], v6, s[8:11], s43 offen offset:1024
    buffer_load_dwordx4 a[160:163], v2, s[8:11], s44 offen offset:0
    buffer_load_dwordx4 a[164:167], v2, s[8:11], s44 offen offset:1024
    buffer_load_dwordx4 a[168:171], v2, s[8:11], s44 offen offset:2048
    buffer_load_dwordx4 a[172:175], v2, s[8:11], s44 offen offset:3072
    buffer_load_dwordx4 a[176:179], v5, s[8:11], s44 offen offset:0
    buffer_load_dwordx4 a[180:183], v5, s[8:11], s44 offen offset:1024
    buffer_load_dwordx4 a[184:187], v5, s[8:11], s44 offen offset:2048
    buffer_load_dwordx4 a[188:191], v5, s[8:11], s44 offen offset:3072
    buffer_load_dwordx4 a[192:195], v6, s[8:11], s44 offen offset:0
    buffer_load_dwordx4 a[196:199], v6, s[8:11], s44 offen offset:1024
    buffer_load_dwordx4 a[200:203], v2, s[8:11], s45 offen offset:0
    buffer_load_dwordx4 a[204:207], v2, s[8:11], s45 offen offset:1024
    buffer_load_dwordx4 a[208:211], v2, s[8:11], s45 offen offset:2048
    buffer_load_dwordx4 a[212:215], v2, s[8:11], s45 offen offset:3072
    buffer_load_dwordx4 a[216:219], v5, s[8:11], s45 offen offset:0
    buffer_load_dwordx4 a[220:223], v5, s[8:11], s45 offen offset:1024
    buffer_load_dwordx4 a[224:227], v5, s[8:11], s45 offen offset:2048
    buffer_load_dwordx4 a[228:231], v5, s[8:11], s45 offen offset:3072
    buffer_load_dwordx4 a[232:235], v6, s[8:11], s45 offen offset:0
    buffer_load_dwordx4 a[236:239], v6, s[8:11], s45 offen offset:1024
t34w_270:
    v_mov_b32 v180, 0x3f803f80
    v_mov_b32 v181, 0x3f803f80
    v_mov_b32 v182, 0x3f803f80
    v_mov_b32 v183, 0x3f803f80
    s_lshl_b32 s56, s25, 5
    s_lshl_b32 s57, s7, 2
    s_add_u32 s56, s56, s57
    s_lshl_b32 s56, s56, 2
    s_add_u32 s56, s56, 1048576
    s_cmp_lg_u32 s4, 0
    s_cbranch_scc1 kfd_272
    v_mov_b32 v254, 0
kf_271:
    buffer_load_dwordx4 v[184:187], v254, s[8:11], s56 offen sc1
    s_waitcnt vmcnt(0)
    v_and_b32 v184, v184, v185
    v_and_b32 v186, v186, v187
    v_and_b32 v184, v184, v186
    v_cmp_ne_u32 vcc, 1, v184
    s_cbranch_vccz kfd_272
    s_sleep 10
    s_branch kf_271
kfd_272:
    s_barrier
    s_waitcnt vmcnt(0)
    buffer_load_dwordx4 v[184:187], v2, s[8:11], s22 offen sc1
    buffer_load_dwordx4 v[188:191], v2, s[8:11], s22 offen offset:1024 sc1
    buffer_load_dwordx2 v[120:121], v252, s[8:11], s22 offen offset:2048 sc1
    buffer_load_dwordx2 v[122:123], v252, s[8:11], s22 offen offset:2304 sc1
    buffer_load_dwordx2 v[124:125], v252, s[8:11], s22 offen offset:2560 sc1
    buffer_load_dwordx2 v[126:127], v252, s[8:11], s22 offen offset:2816 sc1
    buffer_load_dwordx2 v[128:129], v252, s[8:11], s22 offen offset:3072 sc1
    buffer_load_dwordx2 v[130:131], v252, s[8:11], s22 offen offset:3328 sc1
    buffer_load_dwordx2 v[132:133], v252, s[8:11], s22 offen offset:3584 sc1
    buffer_load_dwordx2 v[134:135], v252, s[8:11], s22 offen offset:3840 sc1
    s_waitcnt vmcnt(9)
    ds_write_b128 v251, v[184:187] offset:0
    s_waitcnt vmcnt(8)
    ds_write_b128 v251, v[188:191] offset:1024
    s_waitcnt lgkmcnt(0)
    ds_read_b64_tr_b16 v[104:105], v7 offset:0
    ds_read_b64_tr_b16 v[106:107], v7 offset:256
    ds_read_b64_tr_b16 v[108:109], v7 offset:512
    ds_read_b64_tr_b16 v[110:111], v7 offset:768
    ds_read_b64_tr_b16 v[112:113], v7 offset:1024
    ds_read_b64_tr_b16 v[114:115], v7 offset:1280
    ds_read_b64_tr_b16 v[116:117], v7 offset:1536
    ds_read_b64_tr_b16 v[118:119], v7 offset:1792
    s_waitcnt lgkmcnt(6)
    v_mfma_f32_16x16x32_bf16 v[144:147], v[104:107], v[24:27], 0
    s_lshl_b32 s21, s4, 13
    v_mov_b32 v254, 0xff800000
    v_mov_b32 v162, 0
    v_mfma_f32_16x16x32_bf16 v[148:151], v[40:43], v[24:27], 0
    s_lshl_b32 s27, s26, 15
    v_mov_b32 v163, 0
    s_add_u32 s21, s21, s27
    v_mfma_f32_16x16x32_bf16 v[136:139], v[104:107], v[8:11], 0
    v_add_u32 v250, s21, v2
    v_mfma_f32_16x16x32_bf16 v[140:143], v[40:43], v[8:11], 0
    v_mfma_f32_16x16x32_bf16 v[152:155], v[56:59], v[24:27], 0
    s_waitcnt lgkmcnt(4)
    v_mfma_f32_16x16x32_bf16 v[144:147], v[108:111], v[28:31], v[144:147]
    v_mfma_f32_16x16x32_bf16 v[148:151], v[44:47], v[28:31], v[148:151]
    v_mfma_f32_16x16x32_bf16 v[136:139], v[108:111], v[12:15], v[136:139]
    v_mfma_f32_16x16x32_bf16 v[140:143], v[44:47], v[12:15], v[140:143]
    v_mfma_f32_16x16x32_bf16 v[152:155], v[60:63], v[28:31], v[152:155]
    s_waitcnt lgkmcnt(2)
    v_mfma_f32_16x16x32_bf16 v[144:147], v[112:115], v[32:35], v[144:147]
    v_mfma_f32_16x16x32_bf16 v[148:151], v[48:51], v[32:35], v[148:151]
    v_mfma_f32_16x16x32_bf16 v[136:139], v[112:115], v[16:19], v[136:139]
    v_mfma_f32_16x16x32_bf16 v[140:143], v[48:51], v[16:19], v[140:143]
    v_mfma_f32_16x16x32_bf16 v[152:155], v[64:67], v[32:35], v[152:155]
    s_waitcnt lgkmcnt(0)
    v_mfma_f32_16x16x32_bf16 v[144:147], v[116:119], v[36:39], v[144:147]
    v_mfma_f32_16x16x32_bf16 v[148:151], v[52:55], v[36:39], v[148:151]
    v_mfma_f32_16x16x32_bf16 v[136:139], v[116:119], v[20:23], v[136:139]
    s_nop 1
    v_max3_f32 v158, v144, v145, v146
    v_mfma_f32_16x16x32_bf16 v[140:143], v[52:55], v[20:23], v[140:143]
    v_max3_f32 v158, v147, v148, v158
    v_max3_f32 v158, v149, v150, v158
    v_mfma_f32_16x16x32_bf16 v[152:155], v[68:71], v[36:39], v[152:155]
    v_max3_f32 v156, v136, v137, v138
    s_nop 1
    v_cndmask_b32 v140, v254, v140, s[30:31]
    v_cndmask_b32 v141, v254, v141, s[32:33]
    v_cndmask_b32 v142, v254, v142, s[34:35]
    v_max3_f32 v156, v139, v140, v156
    s_nop 0
    v_cndmask_b32 v152, v254, v152, s[30:31]
    v_cndmask_b32 v153, v254, v153, s[32:33]
    v_cndmask_b32 v154, v254, v154, s[34:35]
    v_max3_f32 v158, v151, v152, v158
    v_cndmask_b32 v143, v254, v143, s[36:37]
    v_cndmask_b32 v155, v254, v155, s[36:37]
    v_max3_f32 v156, v141, v142, v156
    v_max3_f32 v158, v153, v154, v158
    v_max_f32 v156, v143, v156
    v_max_f32 v158, v155, v158
    v_mov_b32 v157, v156
    v_mov_b32 v159, v158
    s_nop 0
    v_permlane16_swap_b32 v157, v156
    v_permlane16_swap_b32 v159, v158
    v_max_f32 v156, v156, v157
    v_max_f32 v158, v158, v159
    v_mov_b32 v157, v156
    v_mov_b32 v159, v158
    s_nop 0
    v_permlane32_swap_b32 v157, v156
    v_permlane32_swap_b32 v159, v158
    v_max_f32 v156, v156, v157
    v_max_f32 v158, v158, v159
    v_sub_f32 v140, v140, v156
    v_sub_f32 v141, v141, v156
    v_sub_f32 v142, v142, v156
    v_sub_f32 v143, v143, v156
    v_sub_f32 v148, v148, v158
    v_sub_f32 v149, v149, v158
    v_sub_f32 v150, v150, v158
    v_sub_f32 v151, v151, v158
    v_sub_f32 v152, v152, v158
    v_sub_f32 v153, v153, v158
    v_sub_f32 v154, v154, v158
    v_sub_f32 v155, v155, v158
    v_exp_f32 v140, v140
    v_exp_f32 v141, v141
    v_exp_f32 v142, v142
    v_exp_f32 v143, v143
    v_exp_f32 v148, v148
    v_exp_f32 v149, v149
    v_exp_f32 v150, v150
    v_exp_f32 v151, v151
    v_exp_f32 v152, v152
    v_exp_f32 v153, v153
    v_exp_f32 v154, v154
    v_exp_f32 v155, v155
    v_sub_f32 v136, v136, v156
    v_sub_f32 v137, v137, v156
    v_sub_f32 v138, v138, v156
    v_sub_f32 v139, v139, v156
    v_sub_f32 v144, v144, v158
    v_sub_f32 v145, v145, v158
    v_sub_f32 v146, v146, v158
    v_sub_f32 v147, v147, v158
    v_exp_f32 v136, v136
    v_exp_f32 v137, v137
    v_exp_f32 v138, v138
    v_exp_f32 v139, v139
    v_exp_f32 v144, v144
    v_exp_f32 v145, v145
    v_exp_f32 v146, v146
    v_exp_f32 v147, v147
    v_cvt_pk_bf16_f32 v160, v140, v141
    v_cvt_pk_bf16_f32 v161, v142, v143
    v_cvt_pk_bf16_f32 v164, v148, v149
    v_cvt_pk_bf16_f32 v165, v150, v151
    v_cvt_pk_bf16_f32 v166, v152, v153
    v_cvt_pk_bf16_f32 v167, v154, v155
    v_cvt_pk_bf16_f32 v168, v136, v137
    v_cvt_pk_bf16_f32 v169, v138, v139
    v_cvt_pk_bf16_f32 v170, v144, v145
    v_cvt_pk_bf16_f32 v171, v146, v147
    v_mfma_f32_16x16x32_bf16 v[172:175], v[180:183], v[160:163], 0
    v_cndmask_b32 v168, 0, v168, s[28:29]
    v_cndmask_b32 v169, 0, v169, s[28:29]
    v_mfma_f32_16x16x32_bf16 v[176:179], v[180:183], v[164:167], 0
    v_cndmask_b32 v170, 0, v170, s[28:29]
    v_cndmask_b32 v171, 0, v171, s[28:29]
    v_mfma_f32_16x16x32_bf16 v[184:187], v[72:75], v[160:163], 0
    v_mfma_f32_16x16x32_bf16 v[192:195], v[76:79], v[160:163], 0
    v_mfma_f32_16x16x32_bf16 v[200:203], v[80:83], v[160:163], 0
    v_mfma_f32_16x16x32_bf16 v[208:211], v[84:87], v[160:163], 0
    v_mfma_f32_16x16x32_bf16 v[216:219], v[88:91], v[160:163], 0
    v_mfma_f32_16x16x32_bf16 v[224:227], v[92:95], v[160:163], 0
    v_mfma_f32_16x16x32_bf16 v[232:235], v[96:99], v[160:163], 0
    v_mfma_f32_16x16x32_bf16 v[240:243], v[100:103], v[160:163], 0
    v_mfma_f32_16x16x32_bf16 v[188:191], v[72:75], v[164:167], 0
    v_mfma_f32_16x16x32_bf16 v[196:199], v[76:79], v[164:167], 0
    v_mfma_f32_16x16x32_bf16 v[204:207], v[80:83], v[164:167], 0
    v_mfma_f32_16x16x32_bf16 v[212:215], v[84:87], v[164:167], 0
    v_mfma_f32_16x16x32_bf16 v[220:223], v[88:91], v[164:167], 0
    v_mfma_f32_16x16x32_bf16 v[228:231], v[92:95], v[164:167], 0
    v_mfma_f32_16x16x32_bf16 v[236:239], v[96:99], v[164:167], 0
    v_mfma_f32_16x16x32_bf16 v[244:247], v[100:103], v[164:167], 0
    v_mfma_f32_16x16x16_bf16 v[172:175], v[180:181], v[168:169], v[172:175]
    v_mfma_f32_16x16x16_bf16 v[176:179], v[180:181], v[170:171], v[176:179]
    s_waitcnt vmcnt(7)
    v_mfma_f32_16x16x16_bf16 v[184:187], v[120:121], v[168:169], v[184:187]
    s_nop 0
    v_rcp_f32 v172, v172
    s_waitcnt vmcnt(6)
    v_mfma_f32_16x16x16_bf16 v[192:195], v[122:123], v[168:169], v[192:195]
    v_rcp_f32 v176, v176
    s_waitcnt vmcnt(5)
    v_mfma_f32_16x16x16_bf16 v[200:203], v[124:125], v[168:169], v[200:203]
    v_mul_f32 v184, v172, v184
    v_mul_f32 v185, v172, v185
    s_waitcnt vmcnt(4)
    v_mfma_f32_16x16x16_bf16 v[208:211], v[126:127], v[168:169], v[208:211]
    v_mul_f32 v186, v172, v186
    v_mul_f32 v187, v172, v187
    s_waitcnt vmcnt(3)
    v_mfma_f32_16x16x16_bf16 v[216:219], v[128:129], v[168:169], v[216:219]
    v_mul_f32 v192, v172, v192
    v_mul_f32 v193, v172, v193
    s_waitcnt vmcnt(2)
    v_mfma_f32_16x16x16_bf16 v[224:227], v[130:131], v[168:169], v[224:227]
    v_mul_f32 v194, v172, v194
    v_mul_f32 v195, v172, v195
    s_waitcnt vmcnt(1)
    v_mfma_f32_16x16x16_bf16 v[232:235], v[132:133], v[168:169], v[232:235]
    v_mul_f32 v200, v172, v200
    v_mul_f32 v201, v172, v201
    s_waitcnt vmcnt(0)
    v_mfma_f32_16x16x16_bf16 v[240:243], v[134:135], v[168:169], v[240:243]
    v_mul_f32 v202, v172, v202
    v_mul_f32 v203, v172, v203
    v_mfma_f32_16x16x16_bf16 v[188:191], v[120:121], v[170:171], v[188:191]
    v_mul_f32 v208, v172, v208
    v_mul_f32 v209, v172, v209
    v_mfma_f32_16x16x16_bf16 v[196:199], v[122:123], v[170:171], v[196:199]
    v_mul_f32 v210, v172, v210
    v_mul_f32 v211, v172, v211
    v_mfma_f32_16x16x16_bf16 v[204:207], v[124:125], v[170:171], v[204:207]
    v_mul_f32 v216, v172, v216
    v_mul_f32 v217, v172, v217
    v_mfma_f32_16x16x16_bf16 v[212:215], v[126:127], v[170:171], v[212:215]
    v_mul_f32 v218, v172, v218
    v_mul_f32 v219, v172, v219
    v_mfma_f32_16x16x16_bf16 v[220:223], v[128:129], v[170:171], v[220:223]
    v_mul_f32 v224, v172, v224
    v_mul_f32 v225, v172, v225
    v_mfma_f32_16x16x16_bf16 v[228:231], v[130:131], v[170:171], v[228:231]
    v_mul_f32 v226, v172, v226
    v_mul_f32 v227, v172, v227
    v_mfma_f32_16x16x16_bf16 v[236:239], v[132:133], v[170:171], v[236:239]
    v_mul_f32 v232, v172, v232
    v_mul_f32 v233, v172, v233
    v_mfma_f32_16x16x16_bf16 v[244:247], v[134:135], v[170:171], v[244:247]
    v_mul_f32 v234, v172, v234
    v_mul_f32 v235, v172, v235
    v_mul_f32 v240, v172, v240
    v_mul_f32 v241, v172, v241
    v_mul_f32 v242, v172, v242
    v_mul_f32 v243, v172, v243
    v_mul_f32 v188, v176, v188
    v_mul_f32 v189, v176, v189
    v_mul_f32 v190, v176, v190
    v_mul_f32 v191, v176, v191
    v_mul_f32 v196, v176, v196
    v_mul_f32 v197, v176, v197
    v_mul_f32 v198, v176, v198
    v_mul_f32 v199, v176, v199
    v_mul_f32 v204, v176, v204
    v_mul_f32 v205, v176, v205
    v_mul_f32 v206, v176, v206
    v_mul_f32 v207, v176, v207
    v_mul_f32 v212, v176, v212
    v_mul_f32 v213, v176, v213
    v_mul_f32 v214, v176, v214
    v_mul_f32 v215, v176, v215
    v_mul_f32 v220, v176, v220
    v_mul_f32 v221, v176, v221
    v_mul_f32 v222, v176, v222
    v_mul_f32 v223, v176, v223
    v_mul_f32 v228, v176, v228
    v_mul_f32 v229, v176, v229
    v_mul_f32 v230, v176, v230
    v_mul_f32 v231, v176, v231
    v_mul_f32 v236, v176, v236
    v_mul_f32 v237, v176, v237
    v_mul_f32 v238, v176, v238
    v_mul_f32 v239, v176, v239
    v_mul_f32 v244, v176, v244
    v_mul_f32 v245, v176, v245
    v_mul_f32 v246, v176, v246
    v_mul_f32 v247, v176, v247
    v_cvt_pk_bf16_f32 v8, v184, v185
    v_cvt_pk_bf16_f32 v9, v186, v187
    v_cvt_pk_bf16_f32 v10, v192, v193
    v_cvt_pk_bf16_f32 v11, v194, v195
    v_cvt_pk_bf16_f32 v12, v200, v201
    v_cvt_pk_bf16_f32 v13, v202, v203
    v_cvt_pk_bf16_f32 v14, v208, v209
    v_cvt_pk_bf16_f32 v15, v210, v211
    v_cvt_pk_bf16_f32 v16, v216, v217
    v_cvt_pk_bf16_f32 v17, v218, v219
    v_cvt_pk_bf16_f32 v18, v224, v225
    v_cvt_pk_bf16_f32 v19, v226, v227
    v_cvt_pk_bf16_f32 v20, v232, v233
    v_cvt_pk_bf16_f32 v21, v234, v235
    v_cvt_pk_bf16_f32 v22, v240, v241
    v_cvt_pk_bf16_f32 v23, v242, v243
    v_cvt_pk_bf16_f32 v24, v188, v189
    v_cvt_pk_bf16_f32 v25, v190, v191
    v_cvt_pk_bf16_f32 v26, v196, v197
    v_cvt_pk_bf16_f32 v27, v198, v199
    v_cvt_pk_bf16_f32 v28, v204, v205
    v_cvt_pk_bf16_f32 v29, v206, v207
    v_cvt_pk_bf16_f32 v30, v212, v213
    v_cvt_pk_bf16_f32 v31, v214, v215
    v_cvt_pk_bf16_f32 v32, v220, v221
    v_cvt_pk_bf16_f32 v33, v222, v223
    v_cvt_pk_bf16_f32 v34, v228, v229
    v_cvt_pk_bf16_f32 v35, v230, v231
    v_cvt_pk_bf16_f32 v36, v236, v237
    v_cvt_pk_bf16_f32 v37, v238, v239
    v_cvt_pk_bf16_f32 v38, v244, v245
    v_cvt_pk_bf16_f32 v39, v246, v247
    ds_write_b128 v250, v[8:11] offset:16384
    ds_write_b128 v250, v[12:15] offset:17408
    ds_write_b128 v250, v[16:19] offset:18432
    ds_write_b128 v250, v[20:23] offset:19456
    ds_write_b128 v250, v[24:27] offset:20480
    ds_write_b128 v250, v[28:31] offset:21504
    ds_write_b128 v250, v[32:35] offset:22528
    ds_write_b128 v250, v[36:39] offset:23552
    s_waitcnt lgkmcnt(0)
    s_add_u32 s25, s25, 1
    s_add_u32 s26, s26, 1
    s_cmp_lt_u32 s26, 2
    s_nop 3
    s_cbranch_scc1 t34l_269
    s_barrier
    v_add_u32 v7, 32768, v2
    ds_read_b128 v[168:171], v2 offset:16384
    ds_read_b128 v[172:175], v2 offset:20480
    ds_read_b128 v[176:179], v7 offset:16384
    ds_read_b128 v[180:183], v7 offset:20480
    ds_read_b128 v[184:187], v2 offset:17408
    ds_read_b128 v[188:191], v2 offset:21504
    ds_read_b128 v[192:195], v7 offset:17408
    ds_read_b128 v[196:199], v7 offset:21504
    ds_read_b128 v[200:203], v2 offset:18432
    s_waitcnt lgkmcnt(8)
    v_mfma_f32_16x16x32_bf16 v[8:11], a[0:3], v[168:171], 0
    ds_read_b128 v[204:207], v2 offset:22528
    s_waitcnt lgkmcnt(8)
    v_mfma_f32_16x16x32_bf16 v[12:15], a[0:3], v[172:175], 0
    ds_read_b128 v[208:211], v7 offset:18432
    s_waitcnt lgkmcnt(8)
    v_mfma_f32_16x16x32_bf16 v[16:19], a[0:3], v[176:179], 0
    ds_read_b128 v[212:215], v7 offset:22528
    s_waitcnt lgkmcnt(8)
    v_mfma_f32_16x16x32_bf16 v[20:23], a[0:3], v[180:183], 0
    buffer_load_dwordx4 a[0:3], v2, s[8:11], s46 offen offset:0
    v_mfma_f32_16x16x32_bf16 v[24:27], a[4:7], v[168:171], 0
    v_mfma_f32_16x16x32_bf16 v[28:31], a[4:7], v[172:175], 0
    v_mfma_f32_16x16x32_bf16 v[32:35], a[4:7], v[176:179], 0
    v_mfma_f32_16x16x32_bf16 v[36:39], a[4:7], v[180:183], 0
    buffer_load_dwordx4 a[4:7], v2, s[8:11], s46 offen offset:1024
    v_mfma_f32_16x16x32_bf16 v[40:43], a[8:11], v[168:171], 0
    v_mfma_f32_16x16x32_bf16 v[44:47], a[8:11], v[172:175], 0
    v_mfma_f32_16x16x32_bf16 v[48:51], a[8:11], v[176:179], 0
    v_mfma_f32_16x16x32_bf16 v[52:55], a[8:11], v[180:183], 0
    buffer_load_dwordx4 a[8:11], v2, s[8:11], s46 offen offset:2048
    v_mfma_f32_16x16x32_bf16 v[56:59], a[12:15], v[168:171], 0
    v_mfma_f32_16x16x32_bf16 v[60:63], a[12:15], v[172:175], 0
    v_mfma_f32_16x16x32_bf16 v[64:67], a[12:15], v[176:179], 0
    v_mfma_f32_16x16x32_bf16 v[68:71], a[12:15], v[180:183], 0
    buffer_load_dwordx4 a[12:15], v2, s[8:11], s46 offen offset:3072
    v_mfma_f32_16x16x32_bf16 v[72:75], a[16:19], v[168:171], 0
    v_mfma_f32_16x16x32_bf16 v[76:79], a[16:19], v[172:175], 0
    v_mfma_f32_16x16x32_bf16 v[80:83], a[16:19], v[176:179], 0
    v_mfma_f32_16x16x32_bf16 v[84:87], a[16:19], v[180:183], 0
    buffer_load_dwordx4 a[16:19], v5, s[8:11], s46 offen offset:0
    v_mfma_f32_16x16x32_bf16 v[88:91], a[20:23], v[168:171], 0
    v_mfma_f32_16x16x32_bf16 v[92:95], a[20:23], v[172:175], 0
    v_mfma_f32_16x16x32_bf16 v[96:99], a[20:23], v[176:179], 0
    v_mfma_f32_16x16x32_bf16 v[100:103], a[20:23], v[180:183], 0
    buffer_load_dwordx4 a[20:23], v5, s[8:11], s46 offen offset:1024
    v_mfma_f32_16x16x32_bf16 v[104:107], a[24:27], v[168:171], 0
    v_mfma_f32_16x16x32_bf16 v[108:111], a[24:27], v[172:175], 0
    v_mfma_f32_16x16x32_bf16 v[112:115], a[24:27], v[176:179], 0
    v_mfma_f32_16x16x32_bf16 v[116:119], a[24:27], v[180:183], 0
    buffer_load_dwordx4 a[24:27], v5, s[8:11], s46 offen offset:2048
    v_mfma_f32_16x16x32_bf16 v[120:123], a[28:31], v[168:171], 0
    v_mfma_f32_16x16x32_bf16 v[124:127], a[28:31], v[172:175], 0
    v_mfma_f32_16x16x32_bf16 v[128:131], a[28:31], v[176:179], 0
    v_mfma_f32_16x16x32_bf16 v[132:135], a[28:31], v[180:183], 0
    buffer_load_dwordx4 a[28:31], v5, s[8:11], s46 offen offset:3072
    v_mfma_f32_16x16x32_bf16 v[136:139], a[32:35], v[168:171], 0
    v_mfma_f32_16x16x32_bf16 v[140:143], a[32:35], v[172:175], 0
    v_mfma_f32_16x16x32_bf16 v[144:147], a[32:35], v[176:179], 0
    v_mfma_f32_16x16x32_bf16 v[148:151], a[32:35], v[180:183], 0
    buffer_load_dwordx4 a[32:35], v6, s[8:11], s46 offen offset:0
    v_mfma_f32_16x16x32_bf16 v[152:155], a[36:39], v[168:171], 0
    ds_read_b128 v[168:171], v2 offset:19456
    v_mfma_f32_16x16x32_bf16 v[156:159], a[36:39], v[172:175], 0
    ds_read_b128 v[172:175], v2 offset:23552
    v_mfma_f32_16x16x32_bf16 v[160:163], a[36:39], v[176:179], 0
    ds_read_b128 v[176:179], v7 offset:19456
    v_mfma_f32_16x16x32_bf16 v[164:167], a[36:39], v[180:183], 0
    ds_read_b128 v[180:183], v7 offset:23552
    buffer_load_dwordx4 a[36:39], v6, s[8:11], s46 offen offset:1024
    s_waitcnt lgkmcnt(11)
    v_mfma_f32_16x16x32_bf16 v[8:11], a[40:43], v[184:187], v[8:11]
    s_waitcnt lgkmcnt(10)
    v_mfma_f32_16x16x32_bf16 v[12:15], a[40:43], v[188:191], v[12:15]
    s_waitcnt lgkmcnt(9)
    v_mfma_f32_16x16x32_bf16 v[16:19], a[40:43], v[192:195], v[16:19]
    s_waitcnt lgkmcnt(8)
    v_mfma_f32_16x16x32_bf16 v[20:23], a[40:43], v[196:199], v[20:23]
    buffer_load_dwordx4 a[40:43], v2, s[8:11], s47 offen offset:0
    v_mfma_f32_16x16x32_bf16 v[24:27], a[44:47], v[184:187], v[24:27]
    v_mfma_f32_16x16x32_bf16 v[28:31], a[44:47], v[188:191], v[28:31]
    v_mfma_f32_16x16x32_bf16 v[32:35], a[44:47], v[192:195], v[32:35]
    v_mfma_f32_16x16x32_bf16 v[36:39], a[44:47], v[196:199], v[36:39]
    buffer_load_dwordx4 a[44:47], v2, s[8:11], s47 offen offset:1024
    v_mfma_f32_16x16x32_bf16 v[40:43], a[48:51], v[184:187], v[40:43]
    v_mfma_f32_16x16x32_bf16 v[44:47], a[48:51], v[188:191], v[44:47]
    v_mfma_f32_16x16x32_bf16 v[48:51], a[48:51], v[192:195], v[48:51]
    v_mfma_f32_16x16x32_bf16 v[52:55], a[48:51], v[196:199], v[52:55]
    buffer_load_dwordx4 a[48:51], v2, s[8:11], s47 offen offset:2048
    v_mfma_f32_16x16x32_bf16 v[56:59], a[52:55], v[184:187], v[56:59]
    v_mfma_f32_16x16x32_bf16 v[60:63], a[52:55], v[188:191], v[60:63]
    v_mfma_f32_16x16x32_bf16 v[64:67], a[52:55], v[192:195], v[64:67]
    v_mfma_f32_16x16x32_bf16 v[68:71], a[52:55], v[196:199], v[68:71]
    buffer_load_dwordx4 a[52:55], v2, s[8:11], s47 offen offset:3072
    v_mfma_f32_16x16x32_bf16 v[72:75], a[56:59], v[184:187], v[72:75]
    v_mfma_f32_16x16x32_bf16 v[76:79], a[56:59], v[188:191], v[76:79]
    v_mfma_f32_16x16x32_bf16 v[80:83], a[56:59], v[192:195], v[80:83]
    v_mfma_f32_16x16x32_bf16 v[84:87], a[56:59], v[196:199], v[84:87]
    buffer_load_dwordx4 a[56:59], v5, s[8:11], s47 offen offset:0
    v_mfma_f32_16x16x32_bf16 v[88:91], a[60:63], v[184:187], v[88:91]
    v_mfma_f32_16x16x32_bf16 v[92:95], a[60:63], v[188:191], v[92:95]
    v_mfma_f32_16x16x32_bf16 v[96:99], a[60:63], v[192:195], v[96:99]
    v_mfma_f32_16x16x32_bf16 v[100:103], a[60:63], v[196:199], v[100:103]
    buffer_load_dwordx4 a[60:63], v5, s[8:11], s47 offen offset:1024
    v_mfma_f32_16x16x32_bf16 v[104:107], a[64:67], v[184:187], v[104:107]
    v_mfma_f32_16x16x32_bf16 v[108:111], a[64:67], v[188:191], v[108:111]
    v_mfma_f32_16x16x32_bf16 v[112:115], a[64:67], v[192:195], v[112:115]
    v_mfma_f32_16x16x32_bf16 v[116:119], a[64:67], v[196:199], v[116:119]
    buffer_load_dwordx4 a[64:67], v5, s[8:11], s47 offen offset:2048
    v_mfma_f32_16x16x32_bf16 v[120:123], a[68:71], v[184:187], v[120:123]
    v_mfma_f32_16x16x32_bf16 v[124:127], a[68:71], v[188:191], v[124:127]
    v_mfma_f32_16x16x32_bf16 v[128:131], a[68:71], v[192:195], v[128:131]
    v_mfma_f32_16x16x32_bf16 v[132:135], a[68:71], v[196:199], v[132:135]
    buffer_load_dwordx4 a[68:71], v5, s[8:11], s47 offen offset:3072
    v_mfma_f32_16x16x32_bf16 v[136:139], a[72:75], v[184:187], v[136:139]
    v_mfma_f32_16x16x32_bf16 v[140:143], a[72:75], v[188:191], v[140:143]
    v_mfma_f32_16x16x32_bf16 v[144:147], a[72:75], v[192:195], v[144:147]
    v_mfma_f32_16x16x32_bf16 v[148:151], a[72:75], v[196:199], v[148:151]
    buffer_load_dwordx4 a[72:75], v6, s[8:11], s47 offen offset:0
    v_mfma_f32_16x16x32_bf16 v[152:155], a[76:79], v[184:187], v[152:155]
    ds_read_b128 v[184:187], v2 offset:24576
    v_mfma_f32_16x16x32_bf16 v[156:159], a[76:79], v[188:191], v[156:159]
    ds_read_b128 v[188:191], v2 offset:28672
    v_mfma_f32_16x16x32_bf16 v[160:163], a[76:79], v[192:195], v[160:163]
    ds_read_b128 v[192:195], v7 offset:24576
    v_mfma_f32_16x16x32_bf16 v[164:167], a[76:79], v[196:199], v[164:167]
    buffer_load_dwordx4 a[76:79], v6, s[8:11], s47 offen offset:1024
    ds_read_b128 v[196:199], v7 offset:28672
    s_waitcnt lgkmcnt(11)
    v_mfma_f32_16x16x32_bf16 v[8:11], a[80:83], v[200:203], v[8:11]
    s_waitcnt lgkmcnt(10)
    v_mfma_f32_16x16x32_bf16 v[12:15], a[80:83], v[204:207], v[12:15]
    s_waitcnt lgkmcnt(9)
    v_mfma_f32_16x16x32_bf16 v[16:19], a[80:83], v[208:211], v[16:19]
    s_waitcnt lgkmcnt(8)
    v_mfma_f32_16x16x32_bf16 v[20:23], a[80:83], v[212:215], v[20:23]
    buffer_load_dwordx4 a[80:83], v2, s[8:11], s48 offen offset:0
    v_mfma_f32_16x16x32_bf16 v[24:27], a[84:87], v[200:203], v[24:27]
    v_mfma_f32_16x16x32_bf16 v[28:31], a[84:87], v[204:207], v[28:31]
    v_mfma_f32_16x16x32_bf16 v[32:35], a[84:87], v[208:211], v[32:35]
    v_mfma_f32_16x16x32_bf16 v[36:39], a[84:87], v[212:215], v[36:39]
    buffer_load_dwordx4 a[84:87], v2, s[8:11], s48 offen offset:1024
    v_mfma_f32_16x16x32_bf16 v[40:43], a[88:91], v[200:203], v[40:43]
    v_mfma_f32_16x16x32_bf16 v[44:47], a[88:91], v[204:207], v[44:47]
    v_mfma_f32_16x16x32_bf16 v[48:51], a[88:91], v[208:211], v[48:51]
    v_mfma_f32_16x16x32_bf16 v[52:55], a[88:91], v[212:215], v[52:55]
    buffer_load_dwordx4 a[88:91], v2, s[8:11], s48 offen offset:2048
    v_mfma_f32_16x16x32_bf16 v[56:59], a[92:95], v[200:203], v[56:59]
    v_mfma_f32_16x16x32_bf16 v[60:63], a[92:95], v[204:207], v[60:63]
    v_mfma_f32_16x16x32_bf16 v[64:67], a[92:95], v[208:211], v[64:67]
    v_mfma_f32_16x16x32_bf16 v[68:71], a[92:95], v[212:215], v[68:71]
    buffer_load_dwordx4 a[92:95], v2, s[8:11], s48 offen offset:3072
    v_mfma_f32_16x16x32_bf16 v[72:75], a[96:99], v[200:203], v[72:75]
    v_mfma_f32_16x16x32_bf16 v[76:79], a[96:99], v[204:207], v[76:79]
    v_mfma_f32_16x16x32_bf16 v[80:83], a[96:99], v[208:211], v[80:83]
    v_mfma_f32_16x16x32_bf16 v[84:87], a[96:99], v[212:215], v[84:87]
    buffer_load_dwordx4 a[96:99], v5, s[8:11], s48 offen offset:0
    v_mfma_f32_16x16x32_bf16 v[88:91], a[100:103], v[200:203], v[88:91]
    v_mfma_f32_16x16x32_bf16 v[92:95], a[100:103], v[204:207], v[92:95]
    v_mfma_f32_16x16x32_bf16 v[96:99], a[100:103], v[208:211], v[96:99]
    v_mfma_f32_16x16x32_bf16 v[100:103], a[100:103], v[212:215], v[100:103]
    buffer_load_dwordx4 a[100:103], v5, s[8:11], s48 offen offset:1024
    v_mfma_f32_16x16x32_bf16 v[104:107], a[104:107], v[200:203], v[104:107]
    v_mfma_f32_16x16x32_bf16 v[108:111], a[104:107], v[204:207], v[108:111]
    v_mfma_f32_16x16x32_bf16 v[112:115], a[104:107], v[208:211], v[112:115]
    v_mfma_f32_16x16x32_bf16 v[116:119], a[104:107], v[212:215], v[116:119]
    buffer_load_dwordx4 a[104:107], v5, s[8:11], s48 offen offset:2048
    v_mfma_f32_16x16x32_bf16 v[120:123], a[108:111], v[200:203], v[120:123]
    v_mfma_f32_16x16x32_bf16 v[124:127], a[108:111], v[204:207], v[124:127]
    v_mfma_f32_16x16x32_bf16 v[128:131], a[108:111], v[208:211], v[128:131]
    v_mfma_f32_16x16x32_bf16 v[132:135], a[108:111], v[212:215], v[132:135]
    buffer_load_dwordx4 a[108:111], v5, s[8:11], s48 offen offset:3072
    v_mfma_f32_16x16x32_bf16 v[136:139], a[112:115], v[200:203], v[136:139]
    v_mfma_f32_16x16x32_bf16 v[140:143], a[112:115], v[204:207], v[140:143]
    v_mfma_f32_16x16x32_bf16 v[144:147], a[112:115], v[208:211], v[144:147]
    v_mfma_f32_16x16x32_bf16 v[148:151], a[112:115], v[212:215], v[148:151]
    buffer_load_dwordx4 a[112:115], v6, s[8:11], s48 offen offset:0
    v_mfma_f32_16x16x32_bf16 v[152:155], a[116:119], v[200:203], v[152:155]
    ds_read_b128 v[200:203], v2 offset:25600
    v_mfma_f32_16x16x32_bf16 v[156:159], a[116:119], v[204:207], v[156:159]
    ds_read_b128 v[204:207], v2 offset:29696
    v_mfma_f32_16x16x32_bf16 v[160:163], a[116:119], v[208:211], v[160:163]
    ds_read_b128 v[208:211], v7 offset:25600
    v_mfma_f32_16x16x32_bf16 v[164:167], a[116:119], v[212:215], v[164:167]
    buffer_load_dwordx4 a[116:119], v6, s[8:11], s48 offen offset:1024
    ds_read_b128 v[212:215], v7 offset:29696
    s_waitcnt lgkmcnt(11)
    v_mfma_f32_16x16x32_bf16 v[8:11], a[120:123], v[168:171], v[8:11]
    s_waitcnt lgkmcnt(10)
    v_mfma_f32_16x16x32_bf16 v[12:15], a[120:123], v[172:175], v[12:15]
    s_waitcnt lgkmcnt(9)
    v_mfma_f32_16x16x32_bf16 v[16:19], a[120:123], v[176:179], v[16:19]
    s_waitcnt lgkmcnt(8)
    v_mfma_f32_16x16x32_bf16 v[20:23], a[120:123], v[180:183], v[20:23]
    buffer_load_dwordx4 a[120:123], v2, s[8:11], s49 offen offset:0
    v_mfma_f32_16x16x32_bf16 v[24:27], a[124:127], v[168:171], v[24:27]
    v_mfma_f32_16x16x32_bf16 v[28:31], a[124:127], v[172:175], v[28:31]
    v_mfma_f32_16x16x32_bf16 v[32:35], a[124:127], v[176:179], v[32:35]
    v_mfma_f32_16x16x32_bf16 v[36:39], a[124:127], v[180:183], v[36:39]
    buffer_load_dwordx4 a[124:127], v2, s[8:11], s49 offen offset:1024
    v_mfma_f32_16x16x32_bf16 v[40:43], a[128:131], v[168:171], v[40:43]
    v_mfma_f32_16x16x32_bf16 v[44:47], a[128:131], v[172:175], v[44:47]
    v_mfma_f32_16x16x32_bf16 v[48:51], a[128:131], v[176:179], v[48:51]
    v_mfma_f32_16x16x32_bf16 v[52:55], a[128:131], v[180:183], v[52:55]
    buffer_load_dwordx4 a[128:131], v2, s[8:11], s49 offen offset:2048
    v_mfma_f32_16x16x32_bf16 v[56:59], a[132:135], v[168:171], v[56:59]
    v_mfma_f32_16x16x32_bf16 v[60:63], a[132:135], v[172:175], v[60:63]
    v_mfma_f32_16x16x32_bf16 v[64:67], a[132:135], v[176:179], v[64:67]
    v_mfma_f32_16x16x32_bf16 v[68:71], a[132:135], v[180:183], v[68:71]
    buffer_load_dwordx4 a[132:135], v2, s[8:11], s49 offen offset:3072
    v_mfma_f32_16x16x32_bf16 v[72:75], a[136:139], v[168:171], v[72:75]
    v_mfma_f32_16x16x32_bf16 v[76:79], a[136:139], v[172:175], v[76:79]
    v_mfma_f32_16x16x32_bf16 v[80:83], a[136:139], v[176:179], v[80:83]
    v_mfma_f32_16x16x32_bf16 v[84:87], a[136:139], v[180:183], v[84:87]
    buffer_load_dwordx4 a[136:139], v5, s[8:11], s49 offen offset:0
    v_mfma_f32_16x16x32_bf16 v[88:91], a[140:143], v[168:171], v[88:91]
    v_mfma_f32_16x16x32_bf16 v[92:95], a[140:143], v[172:175], v[92:95]
    v_mfma_f32_16x16x32_bf16 v[96:99], a[140:143], v[176:179], v[96:99]
    v_mfma_f32_16x16x32_bf16 v[100:103], a[140:143], v[180:183], v[100:103]
    buffer_load_dwordx4 a[140:143], v5, s[8:11], s49 offen offset:1024
    v_mfma_f32_16x16x32_bf16 v[104:107], a[144:147], v[168:171], v[104:107]
    v_mfma_f32_16x16x32_bf16 v[108:111], a[144:147], v[172:175], v[108:111]
    v_mfma_f32_16x16x32_bf16 v[112:115], a[144:147], v[176:179], v[112:115]
    v_mfma_f32_16x16x32_bf16 v[116:119], a[144:147], v[180:183], v[116:119]
    buffer_load_dwordx4 a[144:147], v5, s[8:11], s49 offen offset:2048
    v_mfma_f32_16x16x32_bf16 v[120:123], a[148:151], v[168:171], v[120:123]
    v_mfma_f32_16x16x32_bf16 v[124:127], a[148:151], v[172:175], v[124:127]
    v_mfma_f32_16x16x32_bf16 v[128:131], a[148:151], v[176:179], v[128:131]
    v_mfma_f32_16x16x32_bf16 v[132:135], a[148:151], v[180:183], v[132:135]
    buffer_load_dwordx4 a[148:151], v5, s[8:11], s49 offen offset:3072
    v_mfma_f32_16x16x32_bf16 v[136:139], a[152:155], v[168:171], v[136:139]
    v_mfma_f32_16x16x32_bf16 v[140:143], a[152:155], v[172:175], v[140:143]
    v_mfma_f32_16x16x32_bf16 v[144:147], a[152:155], v[176:179], v[144:147]
    v_mfma_f32_16x16x32_bf16 v[148:151], a[152:155], v[180:183], v[148:151]
    buffer_load_dwordx4 a[152:155], v6, s[8:11], s49 offen offset:0
    v_mfma_f32_16x16x32_bf16 v[152:155], a[156:159], v[168:171], v[152:155]
    ds_read_b128 v[168:171], v2 offset:26624
    v_mfma_f32_16x16x32_bf16 v[156:159], a[156:159], v[172:175], v[156:159]
    ds_read_b128 v[172:175], v2 offset:30720
    v_mfma_f32_16x16x32_bf16 v[160:163], a[156:159], v[176:179], v[160:163]
    ds_read_b128 v[176:179], v7 offset:26624
    v_mfma_f32_16x16x32_bf16 v[164:167], a[156:159], v[180:183], v[164:167]
    buffer_load_dwordx4 a[156:159], v6, s[8:11], s49 offen offset:1024
    ds_read_b128 v[180:183], v7 offset:30720
    s_waitcnt lgkmcnt(11)
    v_mfma_f32_16x16x32_bf16 v[8:11], a[160:163], v[184:187], v[8:11]
    s_waitcnt lgkmcnt(10)
    v_mfma_f32_16x16x32_bf16 v[12:15], a[160:163], v[188:191], v[12:15]
    s_waitcnt lgkmcnt(9)
    v_mfma_f32_16x16x32_bf16 v[16:19], a[160:163], v[192:195], v[16:19]
    s_waitcnt lgkmcnt(8)
    v_mfma_f32_16x16x32_bf16 v[20:23], a[160:163], v[196:199], v[20:23]
    buffer_load_dwordx4 a[160:163], v2, s[8:11], s50 offen offset:0
    v_mfma_f32_16x16x32_bf16 v[24:27], a[164:167], v[184:187], v[24:27]
    v_mfma_f32_16x16x32_bf16 v[28:31], a[164:167], v[188:191], v[28:31]
    v_mfma_f32_16x16x32_bf16 v[32:35], a[164:167], v[192:195], v[32:35]
    v_mfma_f32_16x16x32_bf16 v[36:39], a[164:167], v[196:199], v[36:39]
    buffer_load_dwordx4 a[164:167], v2, s[8:11], s50 offen offset:1024
    v_mfma_f32_16x16x32_bf16 v[40:43], a[168:171], v[184:187], v[40:43]
    v_mfma_f32_16x16x32_bf16 v[44:47], a[168:171], v[188:191], v[44:47]
    v_mfma_f32_16x16x32_bf16 v[48:51], a[168:171], v[192:195], v[48:51]
    v_mfma_f32_16x16x32_bf16 v[52:55], a[168:171], v[196:199], v[52:55]
    buffer_load_dwordx4 a[168:171], v2, s[8:11], s50 offen offset:2048
    v_mfma_f32_16x16x32_bf16 v[56:59], a[172:175], v[184:187], v[56:59]
    v_mfma_f32_16x16x32_bf16 v[60:63], a[172:175], v[188:191], v[60:63]
    v_mfma_f32_16x16x32_bf16 v[64:67], a[172:175], v[192:195], v[64:67]
    v_mfma_f32_16x16x32_bf16 v[68:71], a[172:175], v[196:199], v[68:71]
    buffer_load_dwordx4 a[172:175], v2, s[8:11], s50 offen offset:3072
    v_mfma_f32_16x16x32_bf16 v[72:75], a[176:179], v[184:187], v[72:75]
    v_mfma_f32_16x16x32_bf16 v[76:79], a[176:179], v[188:191], v[76:79]
    v_mfma_f32_16x16x32_bf16 v[80:83], a[176:179], v[192:195], v[80:83]
    v_mfma_f32_16x16x32_bf16 v[84:87], a[176:179], v[196:199], v[84:87]
    buffer_load_dwordx4 a[176:179], v5, s[8:11], s50 offen offset:0
    v_mfma_f32_16x16x32_bf16 v[88:91], a[180:183], v[184:187], v[88:91]
    v_mfma_f32_16x16x32_bf16 v[92:95], a[180:183], v[188:191], v[92:95]
    v_mfma_f32_16x16x32_bf16 v[96:99], a[180:183], v[192:195], v[96:99]
    v_mfma_f32_16x16x32_bf16 v[100:103], a[180:183], v[196:199], v[100:103]
    buffer_load_dwordx4 a[180:183], v5, s[8:11], s50 offen offset:1024
    v_mfma_f32_16x16x32_bf16 v[104:107], a[184:187], v[184:187], v[104:107]
    v_mfma_f32_16x16x32_bf16 v[108:111], a[184:187], v[188:191], v[108:111]
    v_mfma_f32_16x16x32_bf16 v[112:115], a[184:187], v[192:195], v[112:115]
    v_mfma_f32_16x16x32_bf16 v[116:119], a[184:187], v[196:199], v[116:119]
    buffer_load_dwordx4 a[184:187], v5, s[8:11], s50 offen offset:2048
    v_mfma_f32_16x16x32_bf16 v[120:123], a[188:191], v[184:187], v[120:123]
    v_mfma_f32_16x16x32_bf16 v[124:127], a[188:191], v[188:191], v[124:127]
    v_mfma_f32_16x16x32_bf16 v[128:131], a[188:191], v[192:195], v[128:131]
    v_mfma_f32_16x16x32_bf16 v[132:135], a[188:191], v[196:199], v[132:135]
    buffer_load_dwordx4 a[188:191], v5, s[8:11], s50 offen offset:3072
    v_mfma_f32_16x16x32_bf16 v[136:139], a[192:195], v[184:187], v[136:139]
    v_mfma_f32_16x16x32_bf16 v[140:143], a[192:195], v[188:191], v[140:143]
    v_mfma_f32_16x16x32_bf16 v[144:147], a[192:195], v[192:195], v[144:147]
    v_mfma_f32_16x16x32_bf16 v[148:151], a[192:195], v[196:199], v[148:151]
    buffer_load_dwordx4 a[192:195], v6, s[8:11], s50 offen offset:0
    v_mfma_f32_16x16x32_bf16 v[152:155], a[196:199], v[184:187], v[152:155]
    ds_read_b128 v[184:187], v2 offset:27648
    v_mfma_f32_16x16x32_bf16 v[156:159], a[196:199], v[188:191], v[156:159]
    ds_read_b128 v[188:191], v2 offset:31744
    v_mfma_f32_16x16x32_bf16 v[160:163], a[196:199], v[192:195], v[160:163]
    ds_read_b128 v[192:195], v7 offset:27648
    v_mfma_f32_16x16x32_bf16 v[164:167], a[196:199], v[196:199], v[164:167]
    ds_read_b128 v[196:199], v7 offset:31744
    buffer_load_dwordx4 a[196:199], v6, s[8:11], s50 offen offset:1024
    s_waitcnt lgkmcnt(11)
    v_mfma_f32_16x16x32_bf16 v[8:11], a[200:203], v[200:203], v[8:11]
    s_waitcnt lgkmcnt(10)
    v_mfma_f32_16x16x32_bf16 v[12:15], a[200:203], v[204:207], v[12:15]
    s_waitcnt lgkmcnt(9)
    v_mfma_f32_16x16x32_bf16 v[16:19], a[200:203], v[208:211], v[16:19]
    s_waitcnt lgkmcnt(8)
    v_mfma_f32_16x16x32_bf16 v[20:23], a[200:203], v[212:215], v[20:23]
    buffer_load_dwordx4 a[200:203], v2, s[8:11], s51 offen offset:0
    v_mfma_f32_16x16x32_bf16 v[24:27], a[204:207], v[200:203], v[24:27]
    v_mfma_f32_16x16x32_bf16 v[28:31], a[204:207], v[204:207], v[28:31]
    v_mfma_f32_16x16x32_bf16 v[32:35], a[204:207], v[208:211], v[32:35]
    v_mfma_f32_16x16x32_bf16 v[36:39], a[204:207], v[212:215], v[36:39]
    buffer_load_dwordx4 a[204:207], v2, s[8:11], s51 offen offset:1024
    v_mfma_f32_16x16x32_bf16 v[40:43], a[208:211], v[200:203], v[40:43]
    v_mfma_f32_16x16x32_bf16 v[44:47], a[208:211], v[204:207], v[44:47]
    v_mfma_f32_16x16x32_bf16 v[48:51], a[208:211], v[208:211], v[48:51]
    v_mfma_f32_16x16x32_bf16 v[52:55], a[208:211], v[212:215], v[52:55]
    buffer_load_dwordx4 a[208:211], v2, s[8:11], s51 offen offset:2048
    v_mfma_f32_16x16x32_bf16 v[56:59], a[212:215], v[200:203], v[56:59]
    v_mfma_f32_16x16x32_bf16 v[60:63], a[212:215], v[204:207], v[60:63]
    v_mfma_f32_16x16x32_bf16 v[64:67], a[212:215], v[208:211], v[64:67]
    v_mfma_f32_16x16x32_bf16 v[68:71], a[212:215], v[212:215], v[68:71]
    buffer_load_dwordx4 a[212:215], v2, s[8:11], s51 offen offset:3072
    v_mfma_f32_16x16x32_bf16 v[72:75], a[216:219], v[200:203], v[72:75]
    v_mfma_f32_16x16x32_bf16 v[76:79], a[216:219], v[204:207], v[76:79]
    v_mfma_f32_16x16x32_bf16 v[80:83], a[216:219], v[208:211], v[80:83]
    v_mfma_f32_16x16x32_bf16 v[84:87], a[216:219], v[212:215], v[84:87]
    buffer_load_dwordx4 a[216:219], v5, s[8:11], s51 offen offset:0
    v_mfma_f32_16x16x32_bf16 v[88:91], a[220:223], v[200:203], v[88:91]
    v_mfma_f32_16x16x32_bf16 v[92:95], a[220:223], v[204:207], v[92:95]
    v_mfma_f32_16x16x32_bf16 v[96:99], a[220:223], v[208:211], v[96:99]
    v_mfma_f32_16x16x32_bf16 v[100:103], a[220:223], v[212:215], v[100:103]
    buffer_load_dwordx4 a[220:223], v5, s[8:11], s51 offen offset:1024
    v_mfma_f32_16x16x32_bf16 v[104:107], a[224:227], v[200:203], v[104:107]
    v_mfma_f32_16x16x32_bf16 v[108:111], a[224:227], v[204:207], v[108:111]
    v_mfma_f32_16x16x32_bf16 v[112:115], a[224:227], v[208:211], v[112:115]
    v_mfma_f32_16x16x32_bf16 v[116:119], a[224:227], v[212:215], v[116:119]
    buffer_load_dwordx4 a[224:227], v5, s[8:11], s51 offen offset:2048
    v_mfma_f32_16x16x32_bf16 v[120:123], a[228:231], v[200:203], v[120:123]
    v_mfma_f32_16x16x32_bf16 v[124:127], a[228:231], v[204:207], v[124:127]
    v_mfma_f32_16x16x32_bf16 v[128:131], a[228:231], v[208:211], v[128:131]
    v_mfma_f32_16x16x32_bf16 v[132:135], a[228:231], v[212:215], v[132:135]
    buffer_load_dwordx4 a[228:231], v5, s[8:11], s51 offen offset:3072
    v_mfma_f32_16x16x32_bf16 v[136:139], a[232:235], v[200:203], v[136:139]
    v_mfma_f32_16x16x32_bf16 v[140:143], a[232:235], v[204:207], v[140:143]
    v_mfma_f32_16x16x32_bf16 v[144:147], a[232:235], v[208:211], v[144:147]
    v_mfma_f32_16x16x32_bf16 v[148:151], a[232:235], v[212:215], v[148:151]
    buffer_load_dwordx4 a[232:235], v6, s[8:11], s51 offen offset:0
    v_mfma_f32_16x16x32_bf16 v[152:155], a[236:239], v[200:203], v[152:155]
    ds_read_b128 v[200:203], v2 offset:32768
    v_mfma_f32_16x16x32_bf16 v[156:159], a[236:239], v[204:207], v[156:159]
    ds_read_b128 v[204:207], v2 offset:36864
    v_mfma_f32_16x16x32_bf16 v[160:163], a[236:239], v[208:211], v[160:163]
    ds_read_b128 v[208:211], v7 offset:32768
    v_mfma_f32_16x16x32_bf16 v[164:167], a[236:239], v[212:215], v[164:167]
    ds_read_b128 v[212:215], v7 offset:36864
    buffer_load_dwordx4 a[236:239], v6, s[8:11], s51 offen offset:1024
    s_waitcnt vmcnt(59) lgkmcnt(11)
    v_mfma_f32_16x16x32_bf16 v[8:11], a[0:3], v[168:171], v[8:11]
    s_waitcnt lgkmcnt(10)
    v_mfma_f32_16x16x32_bf16 v[12:15], a[0:3], v[172:175], v[12:15]
    s_waitcnt lgkmcnt(9)
    v_mfma_f32_16x16x32_bf16 v[16:19], a[0:3], v[176:179], v[16:19]
    s_waitcnt lgkmcnt(8)
    v_mfma_f32_16x16x32_bf16 v[20:23], a[0:3], v[180:183], v[20:23]
    buffer_load_dwordx4 a[0:3], v2, s[8:11], s52 offen offset:0
    s_waitcnt vmcnt(59)
    v_mfma_f32_16x16x32_bf16 v[24:27], a[4:7], v[168:171], v[24:27]
    v_mfma_f32_16x16x32_bf16 v[28:31], a[4:7], v[172:175], v[28:31]
    v_mfma_f32_16x16x32_bf16 v[32:35], a[4:7], v[176:179], v[32:35]
    v_mfma_f32_16x16x32_bf16 v[36:39], a[4:7], v[180:183], v[36:39]
    buffer_load_dwordx4 a[4:7], v2, s[8:11], s52 offen offset:1024
    s_waitcnt vmcnt(59)
    v_mfma_f32_16x16x32_bf16 v[40:43], a[8:11], v[168:171], v[40:43]
    v_mfma_f32_16x16x32_bf16 v[44:47], a[8:11], v[172:175], v[44:47]
    v_mfma_f32_16x16x32_bf16 v[48:51], a[8:11], v[176:179], v[48:51]
    v_mfma_f32_16x16x32_bf16 v[52:55], a[8:11], v[180:183], v[52:55]
    buffer_load_dwordx4 a[8:11], v2, s[8:11], s52 offen offset:2048
    s_waitcnt vmcnt(59)
    v_mfma_f32_16x16x32_bf16 v[56:59], a[12:15], v[168:171], v[56:59]
    v_mfma_f32_16x16x32_bf16 v[60:63], a[12:15], v[172:175], v[60:63]
    v_mfma_f32_16x16x32_bf16 v[64:67], a[12:15], v[176:179], v[64:67]
    v_mfma_f32_16x16x32_bf16 v[68:71], a[12:15], v[180:183], v[68:71]
    buffer_load_dwordx4 a[12:15], v2, s[8:11], s52 offen offset:3072
    s_waitcnt vmcnt(59)
    v_mfma_f32_16x16x32_bf16 v[72:75], a[16:19], v[168:171], v[72:75]
    v_mfma_f32_16x16x32_bf16 v[76:79], a[16:19], v[172:175], v[76:79]
    v_mfma_f32_16x16x32_bf16 v[80:83], a[16:19], v[176:179], v[80:83]
    v_mfma_f32_16x16x32_bf16 v[84:87], a[16:19], v[180:183], v[84:87]
    buffer_load_dwordx4 a[16:19], v5, s[8:11], s52 offen offset:0
    s_waitcnt vmcnt(59)
    v_mfma_f32_16x16x32_bf16 v[88:91], a[20:23], v[168:171], v[88:91]
    v_mfma_f32_16x16x32_bf16 v[92:95], a[20:23], v[172:175], v[92:95]
    v_mfma_f32_16x16x32_bf16 v[96:99], a[20:23], v[176:179], v[96:99]
    v_mfma_f32_16x16x32_bf16 v[100:103], a[20:23], v[180:183], v[100:103]
    buffer_load_dwordx4 a[20:23], v5, s[8:11], s52 offen offset:1024
    s_waitcnt vmcnt(59)
    v_mfma_f32_16x16x32_bf16 v[104:107], a[24:27], v[168:171], v[104:107]
    v_mfma_f32_16x16x32_bf16 v[108:111], a[24:27], v[172:175], v[108:111]
    v_mfma_f32_16x16x32_bf16 v[112:115], a[24:27], v[176:179], v[112:115]
    v_mfma_f32_16x16x32_bf16 v[116:119], a[24:27], v[180:183], v[116:119]
    buffer_load_dwordx4 a[24:27], v5, s[8:11], s52 offen offset:2048
    s_waitcnt vmcnt(59)
    v_mfma_f32_16x16x32_bf16 v[120:123], a[28:31], v[168:171], v[120:123]
    v_mfma_f32_16x16x32_bf16 v[124:127], a[28:31], v[172:175], v[124:127]
    v_mfma_f32_16x16x32_bf16 v[128:131], a[28:31], v[176:179], v[128:131]
    v_mfma_f32_16x16x32_bf16 v[132:135], a[28:31], v[180:183], v[132:135]
    buffer_load_dwordx4 a[28:31], v5, s[8:11], s52 offen offset:3072
    s_waitcnt vmcnt(59)
    v_mfma_f32_16x16x32_bf16 v[136:139], a[32:35], v[168:171], v[136:139]
    v_mfma_f32_16x16x32_bf16 v[140:143], a[32:35], v[172:175], v[140:143]
    v_mfma_f32_16x16x32_bf16 v[144:147], a[32:35], v[176:179], v[144:147]
    v_mfma_f32_16x16x32_bf16 v[148:151], a[32:35], v[180:183], v[148:151]
    buffer_load_dwordx4 a[32:35], v6, s[8:11], s52 offen offset:0
    s_waitcnt vmcnt(59)
    v_mfma_f32_16x16x32_bf16 v[152:155], a[36:39], v[168:171], v[152:155]
    ds_read_b128 v[168:171], v2 offset:33792
    v_mfma_f32_16x16x32_bf16 v[156:159], a[36:39], v[172:175], v[156:159]
    ds_read_b128 v[172:175], v2 offset:37888
    v_mfma_f32_16x16x32_bf16 v[160:163], a[36:39], v[176:179], v[160:163]
    ds_read_b128 v[176:179], v7 offset:33792
    v_mfma_f32_16x16x32_bf16 v[164:167], a[36:39], v[180:183], v[164:167]
    ds_read_b128 v[180:183], v7 offset:37888
    buffer_load_dwordx4 a[36:39], v6, s[8:11], s52 offen offset:1024
    s_waitcnt vmcnt(59) lgkmcnt(11)
    v_mfma_f32_16x16x32_bf16 v[8:11], a[40:43], v[184:187], v[8:11]
    s_waitcnt lgkmcnt(10)
    v_mfma_f32_16x16x32_bf16 v[12:15], a[40:43], v[188:191], v[12:15]
    s_waitcnt lgkmcnt(9)
    v_mfma_f32_16x16x32_bf16 v[16:19], a[40:43], v[192:195], v[16:19]
    s_waitcnt lgkmcnt(8)
    v_mfma_f32_16x16x32_bf16 v[20:23], a[40:43], v[196:199], v[20:23]
    buffer_load_dwordx4 a[40:43], v2, s[8:11], s53 offen offset:0
    s_waitcnt vmcnt(59)
    v_mfma_f32_16x16x32_bf16 v[24:27], a[44:47], v[184:187], v[24:27]
    v_mfma_f32_16x16x32_bf16 v[28:31], a[44:47], v[188:191], v[28:31]
    v_mfma_f32_16x16x32_bf16 v[32:35], a[44:47], v[192:195], v[32:35]
    v_mfma_f32_16x16x32_bf16 v[36:39], a[44:47], v[196:199], v[36:39]
    buffer_load_dwordx4 a[44:47], v2, s[8:11], s53 offen offset:1024
    s_waitcnt vmcnt(59)
    v_mfma_f32_16x16x32_bf16 v[40:43], a[48:51], v[184:187], v[40:43]
    v_mfma_f32_16x16x32_bf16 v[44:47], a[48:51], v[188:191], v[44:47]
    v_mfma_f32_16x16x32_bf16 v[48:51], a[48:51], v[192:195], v[48:51]
    v_mfma_f32_16x16x32_bf16 v[52:55], a[48:51], v[196:199], v[52:55]
    buffer_load_dwordx4 a[48:51], v2, s[8:11], s53 offen offset:2048
    s_waitcnt vmcnt(59)
    v_mfma_f32_16x16x32_bf16 v[56:59], a[52:55], v[184:187], v[56:59]
    v_mfma_f32_16x16x32_bf16 v[60:63], a[52:55], v[188:191], v[60:63]
    v_mfma_f32_16x16x32_bf16 v[64:67], a[52:55], v[192:195], v[64:67]
    v_mfma_f32_16x16x32_bf16 v[68:71], a[52:55], v[196:199], v[68:71]
    buffer_load_dwordx4 a[52:55], v2, s[8:11], s53 offen offset:3072
    s_waitcnt vmcnt(59)
    v_mfma_f32_16x16x32_bf16 v[72:75], a[56:59], v[184:187], v[72:75]
    v_mfma_f32_16x16x32_bf16 v[76:79], a[56:59], v[188:191], v[76:79]
    v_mfma_f32_16x16x32_bf16 v[80:83], a[56:59], v[192:195], v[80:83]
    v_mfma_f32_16x16x32_bf16 v[84:87], a[56:59], v[196:199], v[84:87]
    buffer_load_dwordx4 a[56:59], v5, s[8:11], s53 offen offset:0
    s_waitcnt vmcnt(59)
    v_mfma_f32_16x16x32_bf16 v[88:91], a[60:63], v[184:187], v[88:91]
    v_mfma_f32_16x16x32_bf16 v[92:95], a[60:63], v[188:191], v[92:95]
    v_mfma_f32_16x16x32_bf16 v[96:99], a[60:63], v[192:195], v[96:99]
    v_mfma_f32_16x16x32_bf16 v[100:103], a[60:63], v[196:199], v[100:103]
    buffer_load_dwordx4 a[60:63], v5, s[8:11], s53 offen offset:1024
    s_waitcnt vmcnt(59)
    v_mfma_f32_16x16x32_bf16 v[104:107], a[64:67], v[184:187], v[104:107]
    v_mfma_f32_16x16x32_bf16 v[108:111], a[64:67], v[188:191], v[108:111]
    v_mfma_f32_16x16x32_bf16 v[112:115], a[64:67], v[192:195], v[112:115]
    v_mfma_f32_16x16x32_bf16 v[116:119], a[64:67], v[196:199], v[116:119]
    buffer_load_dwordx4 a[64:67], v5, s[8:11], s53 offen offset:2048
    s_waitcnt vmcnt(59)
    v_mfma_f32_16x16x32_bf16 v[120:123], a[68:71], v[184:187], v[120:123]
    v_mfma_f32_16x16x32_bf16 v[124:127], a[68:71], v[188:191], v[124:127]
    v_mfma_f32_16x16x32_bf16 v[128:131], a[68:71], v[192:195], v[128:131]
    v_mfma_f32_16x16x32_bf16 v[132:135], a[68:71], v[196:199], v[132:135]
    buffer_load_dwordx4 a[68:71], v5, s[8:11], s53 offen offset:3072
    s_waitcnt vmcnt(59)
    v_mfma_f32_16x16x32_bf16 v[136:139], a[72:75], v[184:187], v[136:139]
    v_mfma_f32_16x16x32_bf16 v[140:143], a[72:75], v[188:191], v[140:143]
    v_mfma_f32_16x16x32_bf16 v[144:147], a[72:75], v[192:195], v[144:147]
    v_mfma_f32_16x16x32_bf16 v[148:151], a[72:75], v[196:199], v[148:151]
    buffer_load_dwordx4 a[72:75], v6, s[8:11], s53 offen offset:0
    s_waitcnt vmcnt(59)
    v_mfma_f32_16x16x32_bf16 v[152:155], a[76:79], v[184:187], v[152:155]
    ds_read_b128 v[184:187], v2 offset:34816
    v_mfma_f32_16x16x32_bf16 v[156:159], a[76:79], v[188:191], v[156:159]
    ds_read_b128 v[188:191], v2 offset:38912
    v_mfma_f32_16x16x32_bf16 v[160:163], a[76:79], v[192:195], v[160:163]
    ds_read_b128 v[192:195], v7 offset:34816
    v_mfma_f32_16x16x32_bf16 v[164:167], a[76:79], v[196:199], v[164:167]
    buffer_load_dwordx4 a[76:79], v6, s[8:11], s53 offen offset:1024
    ds_read_b128 v[196:199], v7 offset:38912
    s_waitcnt vmcnt(59) lgkmcnt(11)
    v_mfma_f32_16x16x32_bf16 v[8:11], a[80:83], v[200:203], v[8:11]
    s_waitcnt lgkmcnt(10)
    v_mfma_f32_16x16x32_bf16 v[12:15], a[80:83], v[204:207], v[12:15]
    s_waitcnt lgkmcnt(9)
    v_mfma_f32_16x16x32_bf16 v[16:19], a[80:83], v[208:211], v[16:19]
    s_waitcnt lgkmcnt(8)
    v_mfma_f32_16x16x32_bf16 v[20:23], a[80:83], v[212:215], v[20:23]
    buffer_load_dwordx4 a[80:83], v2, s[8:11], s54 offen offset:0
    s_waitcnt vmcnt(59)
    v_mfma_f32_16x16x32_bf16 v[24:27], a[84:87], v[200:203], v[24:27]
    v_mfma_f32_16x16x32_bf16 v[28:31], a[84:87], v[204:207], v[28:31]
    v_mfma_f32_16x16x32_bf16 v[32:35], a[84:87], v[208:211], v[32:35]
    v_mfma_f32_16x16x32_bf16 v[36:39], a[84:87], v[212:215], v[36:39]
    buffer_load_dwordx4 a[84:87], v2, s[8:11], s54 offen offset:1024
    s_waitcnt vmcnt(59)
    v_mfma_f32_16x16x32_bf16 v[40:43], a[88:91], v[200:203], v[40:43]
    v_mfma_f32_16x16x32_bf16 v[44:47], a[88:91], v[204:207], v[44:47]
    v_mfma_f32_16x16x32_bf16 v[48:51], a[88:91], v[208:211], v[48:51]
    v_mfma_f32_16x16x32_bf16 v[52:55], a[88:91], v[212:215], v[52:55]
    buffer_load_dwordx4 a[88:91], v2, s[8:11], s54 offen offset:2048
    s_waitcnt vmcnt(59)
    v_mfma_f32_16x16x32_bf16 v[56:59], a[92:95], v[200:203], v[56:59]
    v_mfma_f32_16x16x32_bf16 v[60:63], a[92:95], v[204:207], v[60:63]
    v_mfma_f32_16x16x32_bf16 v[64:67], a[92:95], v[208:211], v[64:67]
    v_mfma_f32_16x16x32_bf16 v[68:71], a[92:95], v[212:215], v[68:71]
    buffer_load_dwordx4 a[92:95], v2, s[8:11], s54 offen offset:3072
    s_waitcnt vmcnt(59)
    v_mfma_f32_16x16x32_bf16 v[72:75], a[96:99], v[200:203], v[72:75]
    v_mfma_f32_16x16x32_bf16 v[76:79], a[96:99], v[204:207], v[76:79]
    v_mfma_f32_16x16x32_bf16 v[80:83], a[96:99], v[208:211], v[80:83]
    v_mfma_f32_16x16x32_bf16 v[84:87], a[96:99], v[212:215], v[84:87]
    buffer_load_dwordx4 a[96:99], v5, s[8:11], s54 offen offset:0
    s_waitcnt vmcnt(59)
    v_mfma_f32_16x16x32_bf16 v[88:91], a[100:103], v[200:203], v[88:91]
    v_mfma_f32_16x16x32_bf16 v[92:95], a[100:103], v[204:207], v[92:95]
    v_mfma_f32_16x16x32_bf16 v[96:99], a[100:103], v[208:211], v[96:99]
    v_mfma_f32_16x16x32_bf16 v[100:103], a[100:103], v[212:215], v[100:103]
    buffer_load_dwordx4 a[100:103], v5, s[8:11], s54 offen offset:1024
    s_waitcnt vmcnt(59)
    v_mfma_f32_16x16x32_bf16 v[104:107], a[104:107], v[200:203], v[104:107]
    v_mfma_f32_16x16x32_bf16 v[108:111], a[104:107], v[204:207], v[108:111]
    v_mfma_f32_16x16x32_bf16 v[112:115], a[104:107], v[208:211], v[112:115]
    v_mfma_f32_16x16x32_bf16 v[116:119], a[104:107], v[212:215], v[116:119]
    buffer_load_dwordx4 a[104:107], v5, s[8:11], s54 offen offset:2048
    s_waitcnt vmcnt(59)
    v_mfma_f32_16x16x32_bf16 v[120:123], a[108:111], v[200:203], v[120:123]
    v_mfma_f32_16x16x32_bf16 v[124:127], a[108:111], v[204:207], v[124:127]
    v_mfma_f32_16x16x32_bf16 v[128:131], a[108:111], v[208:211], v[128:131]
    v_mfma_f32_16x16x32_bf16 v[132:135], a[108:111], v[212:215], v[132:135]
    buffer_load_dwordx4 a[108:111], v5, s[8:11], s54 offen offset:3072
    s_waitcnt vmcnt(59)
    v_mfma_f32_16x16x32_bf16 v[136:139], a[112:115], v[200:203], v[136:139]
    v_mfma_f32_16x16x32_bf16 v[140:143], a[112:115], v[204:207], v[140:143]
    v_mfma_f32_16x16x32_bf16 v[144:147], a[112:115], v[208:211], v[144:147]
    v_mfma_f32_16x16x32_bf16 v[148:151], a[112:115], v[212:215], v[148:151]
    buffer_load_dwordx4 a[112:115], v6, s[8:11], s54 offen offset:0
    s_waitcnt vmcnt(59)
    v_mfma_f32_16x16x32_bf16 v[152:155], a[116:119], v[200:203], v[152:155]
    ds_read_b128 v[200:203], v2 offset:35840
    v_mfma_f32_16x16x32_bf16 v[156:159], a[116:119], v[204:207], v[156:159]
    ds_read_b128 v[204:207], v2 offset:39936
    v_mfma_f32_16x16x32_bf16 v[160:163], a[116:119], v[208:211], v[160:163]
    ds_read_b128 v[208:211], v7 offset:35840
    v_mfma_f32_16x16x32_bf16 v[164:167], a[116:119], v[212:215], v[164:167]
    buffer_load_dwordx4 a[116:119], v6, s[8:11], s54 offen offset:1024
    ds_read_b128 v[212:215], v7 offset:39936
    s_waitcnt vmcnt(59) lgkmcnt(11)
    v_mfma_f32_16x16x32_bf16 v[8:11], a[120:123], v[168:171], v[8:11]
    s_waitcnt lgkmcnt(10)
    v_mfma_f32_16x16x32_bf16 v[12:15], a[120:123], v[172:175], v[12:15]
    s_waitcnt lgkmcnt(9)
    v_mfma_f32_16x16x32_bf16 v[16:19], a[120:123], v[176:179], v[16:19]
    s_waitcnt lgkmcnt(8)
    v_mfma_f32_16x16x32_bf16 v[20:23], a[120:123], v[180:183], v[20:23]
    buffer_load_dwordx4 a[120:123], v2, s[8:11], s55 offen offset:0
    s_waitcnt vmcnt(59)
    v_mfma_f32_16x16x32_bf16 v[24:27], a[124:127], v[168:171], v[24:27]
    v_mfma_f32_16x16x32_bf16 v[28:31], a[124:127], v[172:175], v[28:31]
    v_mfma_f32_16x16x32_bf16 v[32:35], a[124:127], v[176:179], v[32:35]
    v_mfma_f32_16x16x32_bf16 v[36:39], a[124:127], v[180:183], v[36:39]
    buffer_load_dwordx4 a[124:127], v2, s[8:11], s55 offen offset:1024
    s_waitcnt vmcnt(59)
    v_mfma_f32_16x16x32_bf16 v[40:43], a[128:131], v[168:171], v[40:43]
    v_mfma_f32_16x16x32_bf16 v[44:47], a[128:131], v[172:175], v[44:47]
    v_mfma_f32_16x16x32_bf16 v[48:51], a[128:131], v[176:179], v[48:51]
    v_mfma_f32_16x16x32_bf16 v[52:55], a[128:131], v[180:183], v[52:55]
    buffer_load_dwordx4 a[128:131], v2, s[8:11], s55 offen offset:2048
    s_waitcnt vmcnt(59)
    v_mfma_f32_16x16x32_bf16 v[56:59], a[132:135], v[168:171], v[56:59]
    v_mfma_f32_16x16x32_bf16 v[60:63], a[132:135], v[172:175], v[60:63]
    v_mfma_f32_16x16x32_bf16 v[64:67], a[132:135], v[176:179], v[64:67]
    v_mfma_f32_16x16x32_bf16 v[68:71], a[132:135], v[180:183], v[68:71]
    buffer_load_dwordx4 a[132:135], v2, s[8:11], s55 offen offset:3072
    s_waitcnt vmcnt(59)
    v_mfma_f32_16x16x32_bf16 v[72:75], a[136:139], v[168:171], v[72:75]
    v_mfma_f32_16x16x32_bf16 v[76:79], a[136:139], v[172:175], v[76:79]
    v_mfma_f32_16x16x32_bf16 v[80:83], a[136:139], v[176:179], v[80:83]
    v_mfma_f32_16x16x32_bf16 v[84:87], a[136:139], v[180:183], v[84:87]
    buffer_load_dwordx4 a[136:139], v5, s[8:11], s55 offen offset:0
    s_waitcnt vmcnt(59)
    v_mfma_f32_16x16x32_bf16 v[88:91], a[140:143], v[168:171], v[88:91]
    v_mfma_f32_16x16x32_bf16 v[92:95], a[140:143], v[172:175], v[92:95]
    v_mfma_f32_16x16x32_bf16 v[96:99], a[140:143], v[176:179], v[96:99]
    v_mfma_f32_16x16x32_bf16 v[100:103], a[140:143], v[180:183], v[100:103]
    buffer_load_dwordx4 a[140:143], v5, s[8:11], s55 offen offset:1024
    s_waitcnt vmcnt(59)
    v_mfma_f32_16x16x32_bf16 v[104:107], a[144:147], v[168:171], v[104:107]
    v_mfma_f32_16x16x32_bf16 v[108:111], a[144:147], v[172:175], v[108:111]
    v_mfma_f32_16x16x32_bf16 v[112:115], a[144:147], v[176:179], v[112:115]
    v_mfma_f32_16x16x32_bf16 v[116:119], a[144:147], v[180:183], v[116:119]
    buffer_load_dwordx4 a[144:147], v5, s[8:11], s55 offen offset:2048
    s_waitcnt vmcnt(59)
    v_mfma_f32_16x16x32_bf16 v[120:123], a[148:151], v[168:171], v[120:123]
    v_mfma_f32_16x16x32_bf16 v[124:127], a[148:151], v[172:175], v[124:127]
    v_mfma_f32_16x16x32_bf16 v[128:131], a[148:151], v[176:179], v[128:131]
    v_mfma_f32_16x16x32_bf16 v[132:135], a[148:151], v[180:183], v[132:135]
    buffer_load_dwordx4 a[148:151], v5, s[8:11], s55 offen offset:3072
    s_waitcnt vmcnt(59)
    v_mfma_f32_16x16x32_bf16 v[136:139], a[152:155], v[168:171], v[136:139]
    v_mfma_f32_16x16x32_bf16 v[140:143], a[152:155], v[172:175], v[140:143]
    v_mfma_f32_16x16x32_bf16 v[144:147], a[152:155], v[176:179], v[144:147]
    v_mfma_f32_16x16x32_bf16 v[148:151], a[152:155], v[180:183], v[148:151]
    buffer_load_dwordx4 a[152:155], v6, s[8:11], s55 offen offset:0
    s_waitcnt vmcnt(59)
    v_mfma_f32_16x16x32_bf16 v[152:155], a[156:159], v[168:171], v[152:155]
    ds_read_b128 v[168:171], v2 offset:40960
    v_mfma_f32_16x16x32_bf16 v[156:159], a[156:159], v[172:175], v[156:159]
    ds_read_b128 v[172:175], v2 offset:45056
    v_mfma_f32_16x16x32_bf16 v[160:163], a[156:159], v[176:179], v[160:163]
    ds_read_b128 v[176:179], v7 offset:40960
    v_mfma_f32_16x16x32_bf16 v[164:167], a[156:159], v[180:183], v[164:167]
    buffer_load_dwordx4 a[156:159], v6, s[8:11], s55 offen offset:1024
    ds_read_b128 v[180:183], v7 offset:45056
    s_waitcnt vmcnt(59) lgkmcnt(11)
    v_mfma_f32_16x16x32_bf16 v[8:11], a[160:163], v[184:187], v[8:11]
    s_waitcnt lgkmcnt(10)
    v_mfma_f32_16x16x32_bf16 v[12:15], a[160:163], v[188:191], v[12:15]
    s_waitcnt lgkmcnt(9)
    v_mfma_f32_16x16x32_bf16 v[16:19], a[160:163], v[192:195], v[16:19]
    s_waitcnt lgkmcnt(8)
    v_mfma_f32_16x16x32_bf16 v[20:23], a[160:163], v[196:199], v[20:23]
    s_waitcnt vmcnt(58)
    v_mfma_f32_16x16x32_bf16 v[24:27], a[164:167], v[184:187], v[24:27]
    v_mfma_f32_16x16x32_bf16 v[28:31], a[164:167], v[188:191], v[28:31]
    v_mfma_f32_16x16x32_bf16 v[32:35], a[164:167], v[192:195], v[32:35]
    v_mfma_f32_16x16x32_bf16 v[36:39], a[164:167], v[196:199], v[36:39]
    s_waitcnt vmcnt(57)
    v_mfma_f32_16x16x32_bf16 v[40:43], a[168:171], v[184:187], v[40:43]
    v_mfma_f32_16x16x32_bf16 v[44:47], a[168:171], v[188:191], v[44:47]
    v_mfma_f32_16x16x32_bf16 v[48:51], a[168:171], v[192:195], v[48:51]
    v_mfma_f32_16x16x32_bf16 v[52:55], a[168:171], v[196:199], v[52:55]
    s_waitcnt vmcnt(56)
    v_mfma_f32_16x16x32_bf16 v[56:59], a[172:175], v[184:187], v[56:59]
    v_mfma_f32_16x16x32_bf16 v[60:63], a[172:175], v[188:191], v[60:63]
    v_mfma_f32_16x16x32_bf16 v[64:67], a[172:175], v[192:195], v[64:67]
    v_mfma_f32_16x16x32_bf16 v[68:71], a[172:175], v[196:199], v[68:71]
    s_waitcnt vmcnt(55)
    v_mfma_f32_16x16x32_bf16 v[72:75], a[176:179], v[184:187], v[72:75]
    v_mfma_f32_16x16x32_bf16 v[76:79], a[176:179], v[188:191], v[76:79]
    v_mfma_f32_16x16x32_bf16 v[80:83], a[176:179], v[192:195], v[80:83]
    v_mfma_f32_16x16x32_bf16 v[84:87], a[176:179], v[196:199], v[84:87]
    s_waitcnt vmcnt(54)
    v_mfma_f32_16x16x32_bf16 v[88:91], a[180:183], v[184:187], v[88:91]
    v_mfma_f32_16x16x32_bf16 v[92:95], a[180:183], v[188:191], v[92:95]
    v_mfma_f32_16x16x32_bf16 v[96:99], a[180:183], v[192:195], v[96:99]
    v_mfma_f32_16x16x32_bf16 v[100:103], a[180:183], v[196:199], v[100:103]
    s_waitcnt vmcnt(53)
    v_mfma_f32_16x16x32_bf16 v[104:107], a[184:187], v[184:187], v[104:107]
    v_mfma_f32_16x16x32_bf16 v[108:111], a[184:187], v[188:191], v[108:111]
    v_mfma_f32_16x16x32_bf16 v[112:115], a[184:187], v[192:195], v[112:115]
    v_mfma_f32_16x16x32_bf16 v[116:119], a[184:187], v[196:199], v[116:119]
    s_waitcnt vmcnt(52)
    v_mfma_f32_16x16x32_bf16 v[120:123], a[188:191], v[184:187], v[120:123]
    v_mfma_f32_16x16x32_bf16 v[124:127], a[188:191], v[188:191], v[124:127]
    v_mfma_f32_16x16x32_bf16 v[128:131], a[188:191], v[192:195], v[128:131]
    v_mfma_f32_16x16x32_bf16 v[132:135], a[188:191], v[196:199], v[132:135]
    s_waitcnt vmcnt(51)
    v_mfma_f32_16x16x32_bf16 v[136:139], a[192:195], v[184:187], v[136:139]
    v_mfma_f32_16x16x32_bf16 v[140:143], a[192:195], v[188:191], v[140:143]
    v_mfma_f32_16x16x32_bf16 v[144:147], a[192:195], v[192:195], v[144:147]
    v_mfma_f32_16x16x32_bf16 v[148:151], a[192:195], v[196:199], v[148:151]
    s_waitcnt vmcnt(50)
    v_mfma_f32_16x16x32_bf16 v[152:155], a[196:199], v[184:187], v[152:155]
    ds_read_b128 v[184:187], v2 offset:41984
    v_mfma_f32_16x16x32_bf16 v[156:159], a[196:199], v[188:191], v[156:159]
    ds_read_b128 v[188:191], v2 offset:46080
    v_mfma_f32_16x16x32_bf16 v[160:163], a[196:199], v[192:195], v[160:163]
    ds_read_b128 v[192:195], v7 offset:41984
    v_mfma_f32_16x16x32_bf16 v[164:167], a[196:199], v[196:199], v[164:167]
    ds_read_b128 v[196:199], v7 offset:46080
    s_waitcnt vmcnt(49) lgkmcnt(11)
    v_mfma_f32_16x16x32_bf16 v[8:11], a[200:203], v[200:203], v[8:11]
    s_waitcnt lgkmcnt(10)
    v_mfma_f32_16x16x32_bf16 v[12:15], a[200:203], v[204:207], v[12:15]
    s_waitcnt lgkmcnt(9)
    v_mfma_f32_16x16x32_bf16 v[16:19], a[200:203], v[208:211], v[16:19]
    s_waitcnt lgkmcnt(8)
    v_mfma_f32_16x16x32_bf16 v[20:23], a[200:203], v[212:215], v[20:23]
    s_waitcnt vmcnt(48)
    v_mfma_f32_16x16x32_bf16 v[24:27], a[204:207], v[200:203], v[24:27]
    v_mfma_f32_16x16x32_bf16 v[28:31], a[204:207], v[204:207], v[28:31]
    v_mfma_f32_16x16x32_bf16 v[32:35], a[204:207], v[208:211], v[32:35]
    v_mfma_f32_16x16x32_bf16 v[36:39], a[204:207], v[212:215], v[36:39]
    s_waitcnt vmcnt(47)
    v_mfma_f32_16x16x32_bf16 v[40:43], a[208:211], v[200:203], v[40:43]
    v_mfma_f32_16x16x32_bf16 v[44:47], a[208:211], v[204:207], v[44:47]
    v_mfma_f32_16x16x32_bf16 v[48:51], a[208:211], v[208:211], v[48:51]
    v_mfma_f32_16x16x32_bf16 v[52:55], a[208:211], v[212:215], v[52:55]
    s_waitcnt vmcnt(46)
    v_mfma_f32_16x16x32_bf16 v[56:59], a[212:215], v[200:203], v[56:59]
    v_mfma_f32_16x16x32_bf16 v[60:63], a[212:215], v[204:207], v[60:63]
    v_mfma_f32_16x16x32_bf16 v[64:67], a[212:215], v[208:211], v[64:67]
    v_mfma_f32_16x16x32_bf16 v[68:71], a[212:215], v[212:215], v[68:71]
    s_waitcnt vmcnt(45)
    v_mfma_f32_16x16x32_bf16 v[72:75], a[216:219], v[200:203], v[72:75]
    v_mfma_f32_16x16x32_bf16 v[76:79], a[216:219], v[204:207], v[76:79]
    v_mfma_f32_16x16x32_bf16 v[80:83], a[216:219], v[208:211], v[80:83]
    v_mfma_f32_16x16x32_bf16 v[84:87], a[216:219], v[212:215], v[84:87]
    s_waitcnt vmcnt(44)
    v_mfma_f32_16x16x32_bf16 v[88:91], a[220:223], v[200:203], v[88:91]
    v_mfma_f32_16x16x32_bf16 v[92:95], a[220:223], v[204:207], v[92:95]
    v_mfma_f32_16x16x32_bf16 v[96:99], a[220:223], v[208:211], v[96:99]
    v_mfma_f32_16x16x32_bf16 v[100:103], a[220:223], v[212:215], v[100:103]
    s_waitcnt vmcnt(43)
    v_mfma_f32_16x16x32_bf16 v[104:107], a[224:227], v[200:203], v[104:107]
    v_mfma_f32_16x16x32_bf16 v[108:111], a[224:227], v[204:207], v[108:111]
    v_mfma_f32_16x16x32_bf16 v[112:115], a[224:227], v[208:211], v[112:115]
    v_mfma_f32_16x16x32_bf16 v[116:119], a[224:227], v[212:215], v[116:119]
    s_waitcnt vmcnt(42)
    v_mfma_f32_16x16x32_bf16 v[120:123], a[228:231], v[200:203], v[120:123]
    v_mfma_f32_16x16x32_bf16 v[124:127], a[228:231], v[204:207], v[124:127]
    v_mfma_f32_16x16x32_bf16 v[128:131], a[228:231], v[208:211], v[128:131]
    v_mfma_f32_16x16x32_bf16 v[132:135], a[228:231], v[212:215], v[132:135]
    s_waitcnt vmcnt(41)
    v_mfma_f32_16x16x32_bf16 v[136:139], a[232:235], v[200:203], v[136:139]
    v_mfma_f32_16x16x32_bf16 v[140:143], a[232:235], v[204:207], v[140:143]
    v_mfma_f32_16x16x32_bf16 v[144:147], a[232:235], v[208:211], v[144:147]
    v_mfma_f32_16x16x32_bf16 v[148:151], a[232:235], v[212:215], v[148:151]
    s_waitcnt vmcnt(40)
    v_mfma_f32_16x16x32_bf16 v[152:155], a[236:239], v[200:203], v[152:155]
    ds_read_b128 v[200:203], v2 offset:43008
    v_mfma_f32_16x16x32_bf16 v[156:159], a[236:239], v[204:207], v[156:159]
    ds_read_b128 v[204:207], v2 offset:47104
    v_mfma_f32_16x16x32_bf16 v[160:163], a[236:239], v[208:211], v[160:163]
    ds_read_b128 v[208:211], v7 offset:43008
    v_mfma_f32_16x16x32_bf16 v[164:167], a[236:239], v[212:215], v[164:167]
    ds_read_b128 v[212:215], v7 offset:47104
    s_waitcnt vmcnt(39) lgkmcnt(11)
    v_mfma_f32_16x16x32_bf16 v[8:11], a[0:3], v[168:171], v[8:11]
    s_waitcnt lgkmcnt(10)
    v_mfma_f32_16x16x32_bf16 v[12:15], a[0:3], v[172:175], v[12:15]
    s_waitcnt lgkmcnt(9)
    v_mfma_f32_16x16x32_bf16 v[16:19], a[0:3], v[176:179], v[16:19]
    s_waitcnt lgkmcnt(8)
    v_mfma_f32_16x16x32_bf16 v[20:23], a[0:3], v[180:183], v[20:23]
    s_waitcnt vmcnt(38)
    v_mfma_f32_16x16x32_bf16 v[24:27], a[4:7], v[168:171], v[24:27]
    v_mfma_f32_16x16x32_bf16 v[28:31], a[4:7], v[172:175], v[28:31]
    v_mfma_f32_16x16x32_bf16 v[32:35], a[4:7], v[176:179], v[32:35]
    v_mfma_f32_16x16x32_bf16 v[36:39], a[4:7], v[180:183], v[36:39]
    s_waitcnt vmcnt(37)
    v_mfma_f32_16x16x32_bf16 v[40:43], a[8:11], v[168:171], v[40:43]
    v_mfma_f32_16x16x32_bf16 v[44:47], a[8:11], v[172:175], v[44:47]
    v_mfma_f32_16x16x32_bf16 v[48:51], a[8:11], v[176:179], v[48:51]
    v_mfma_f32_16x16x32_bf16 v[52:55], a[8:11], v[180:183], v[52:55]
    s_waitcnt vmcnt(36)
    v_mfma_f32_16x16x32_bf16 v[56:59], a[12:15], v[168:171], v[56:59]
    v_mfma_f32_16x16x32_bf16 v[60:63], a[12:15], v[172:175], v[60:63]
    v_mfma_f32_16x16x32_bf16 v[64:67], a[12:15], v[176:179], v[64:67]
    v_mfma_f32_16x16x32_bf16 v[68:71], a[12:15], v[180:183], v[68:71]
    s_waitcnt vmcnt(35)
    v_mfma_f32_16x16x32_bf16 v[72:75], a[16:19], v[168:171], v[72:75]
    v_mfma_f32_16x16x32_bf16 v[76:79], a[16:19], v[172:175], v[76:79]
    v_mfma_f32_16x16x32_bf16 v[80:83], a[16:19], v[176:179], v[80:83]
    v_mfma_f32_16x16x32_bf16 v[84:87], a[16:19], v[180:183], v[84:87]
    s_waitcnt vmcnt(34)
    v_mfma_f32_16x16x32_bf16 v[88:91], a[20:23], v[168:171], v[88:91]
    v_mfma_f32_16x16x32_bf16 v[92:95], a[20:23], v[172:175], v[92:95]
    v_mfma_f32_16x16x32_bf16 v[96:99], a[20:23], v[176:179], v[96:99]
    v_mfma_f32_16x16x32_bf16 v[100:103], a[20:23], v[180:183], v[100:103]
    s_waitcnt vmcnt(33)
    v_mfma_f32_16x16x32_bf16 v[104:107], a[24:27], v[168:171], v[104:107]
    v_mfma_f32_16x16x32_bf16 v[108:111], a[24:27], v[172:175], v[108:111]
    v_mfma_f32_16x16x32_bf16 v[112:115], a[24:27], v[176:179], v[112:115]
    v_mfma_f32_16x16x32_bf16 v[116:119], a[24:27], v[180:183], v[116:119]
    s_waitcnt vmcnt(32)
    v_mfma_f32_16x16x32_bf16 v[120:123], a[28:31], v[168:171], v[120:123]
    v_mfma_f32_16x16x32_bf16 v[124:127], a[28:31], v[172:175], v[124:127]
    v_mfma_f32_16x16x32_bf16 v[128:131], a[28:31], v[176:179], v[128:131]
    v_mfma_f32_16x16x32_bf16 v[132:135], a[28:31], v[180:183], v[132:135]
    s_waitcnt vmcnt(31)
    v_mfma_f32_16x16x32_bf16 v[136:139], a[32:35], v[168:171], v[136:139]
    v_mfma_f32_16x16x32_bf16 v[140:143], a[32:35], v[172:175], v[140:143]
    v_mfma_f32_16x16x32_bf16 v[144:147], a[32:35], v[176:179], v[144:147]
    v_mfma_f32_16x16x32_bf16 v[148:151], a[32:35], v[180:183], v[148:151]
    s_waitcnt vmcnt(30)
    v_mfma_f32_16x16x32_bf16 v[152:155], a[36:39], v[168:171], v[152:155]
    ds_read_b128 v[168:171], v2 offset:44032
    v_mfma_f32_16x16x32_bf16 v[156:159], a[36:39], v[172:175], v[156:159]
    ds_read_b128 v[172:175], v2 offset:48128
    v_mfma_f32_16x16x32_bf16 v[160:163], a[36:39], v[176:179], v[160:163]
    ds_read_b128 v[176:179], v7 offset:44032
    v_mfma_f32_16x16x32_bf16 v[164:167], a[36:39], v[180:183], v[164:167]
    ds_read_b128 v[180:183], v7 offset:48128
    s_waitcnt vmcnt(29) lgkmcnt(11)
    v_mfma_f32_16x16x32_bf16 v[8:11], a[40:43], v[184:187], v[8:11]
    s_waitcnt lgkmcnt(10)
    v_mfma_f32_16x16x32_bf16 v[12:15], a[40:43], v[188:191], v[12:15]
    s_waitcnt lgkmcnt(9)
    v_mfma_f32_16x16x32_bf16 v[16:19], a[40:43], v[192:195], v[16:19]
    s_waitcnt lgkmcnt(8)
    v_mfma_f32_16x16x32_bf16 v[20:23], a[40:43], v[196:199], v[20:23]
    s_waitcnt vmcnt(28)
    v_mfma_f32_16x16x32_bf16 v[24:27], a[44:47], v[184:187], v[24:27]
    v_mfma_f32_16x16x32_bf16 v[28:31], a[44:47], v[188:191], v[28:31]
    v_mfma_f32_16x16x32_bf16 v[32:35], a[44:47], v[192:195], v[32:35]
    v_mfma_f32_16x16x32_bf16 v[36:39], a[44:47], v[196:199], v[36:39]
    s_waitcnt vmcnt(27)
    v_mfma_f32_16x16x32_bf16 v[40:43], a[48:51], v[184:187], v[40:43]
    v_mfma_f32_16x16x32_bf16 v[44:47], a[48:51], v[188:191], v[44:47]
    v_mfma_f32_16x16x32_bf16 v[48:51], a[48:51], v[192:195], v[48:51]
    v_mfma_f32_16x16x32_bf16 v[52:55], a[48:51], v[196:199], v[52:55]
    s_waitcnt vmcnt(26)
    v_mfma_f32_16x16x32_bf16 v[56:59], a[52:55], v[184:187], v[56:59]
    v_mfma_f32_16x16x32_bf16 v[60:63], a[52:55], v[188:191], v[60:63]
    v_mfma_f32_16x16x32_bf16 v[64:67], a[52:55], v[192:195], v[64:67]
    v_mfma_f32_16x16x32_bf16 v[68:71], a[52:55], v[196:199], v[68:71]
    s_waitcnt vmcnt(25)
    v_mfma_f32_16x16x32_bf16 v[72:75], a[56:59], v[184:187], v[72:75]
    v_mfma_f32_16x16x32_bf16 v[76:79], a[56:59], v[188:191], v[76:79]
    v_mfma_f32_16x16x32_bf16 v[80:83], a[56:59], v[192:195], v[80:83]
    v_mfma_f32_16x16x32_bf16 v[84:87], a[56:59], v[196:199], v[84:87]
    s_waitcnt vmcnt(24)
    v_mfma_f32_16x16x32_bf16 v[88:91], a[60:63], v[184:187], v[88:91]
    v_mfma_f32_16x16x32_bf16 v[92:95], a[60:63], v[188:191], v[92:95]
    v_mfma_f32_16x16x32_bf16 v[96:99], a[60:63], v[192:195], v[96:99]
    v_mfma_f32_16x16x32_bf16 v[100:103], a[60:63], v[196:199], v[100:103]
    s_waitcnt vmcnt(23)
    v_mfma_f32_16x16x32_bf16 v[104:107], a[64:67], v[184:187], v[104:107]
    v_mfma_f32_16x16x32_bf16 v[108:111], a[64:67], v[188:191], v[108:111]
    v_mfma_f32_16x16x32_bf16 v[112:115], a[64:67], v[192:195], v[112:115]
    v_mfma_f32_16x16x32_bf16 v[116:119], a[64:67], v[196:199], v[116:119]
    s_waitcnt vmcnt(22)
    v_mfma_f32_16x16x32_bf16 v[120:123], a[68:71], v[184:187], v[120:123]
    v_mfma_f32_16x16x32_bf16 v[124:127], a[68:71], v[188:191], v[124:127]
    v_mfma_f32_16x16x32_bf16 v[128:131], a[68:71], v[192:195], v[128:131]
    v_mfma_f32_16x16x32_bf16 v[132:135], a[68:71], v[196:199], v[132:135]
    s_waitcnt vmcnt(21)
    v_mfma_f32_16x16x32_bf16 v[136:139], a[72:75], v[184:187], v[136:139]
    v_mfma_f32_16x16x32_bf16 v[140:143], a[72:75], v[188:191], v[140:143]
    v_mfma_f32_16x16x32_bf16 v[144:147], a[72:75], v[192:195], v[144:147]
    v_mfma_f32_16x16x32_bf16 v[148:151], a[72:75], v[196:199], v[148:151]
    s_waitcnt vmcnt(20)
    v_mfma_f32_16x16x32_bf16 v[152:155], a[76:79], v[184:187], v[152:155]
    v_mfma_f32_16x16x32_bf16 v[156:159], a[76:79], v[188:191], v[156:159]
    v_mfma_f32_16x16x32_bf16 v[160:163], a[76:79], v[192:195], v[160:163]
    v_mfma_f32_16x16x32_bf16 v[164:167], a[76:79], v[196:199], v[164:167]
    s_waitcnt vmcnt(19) lgkmcnt(7)
    v_mfma_f32_16x16x32_bf16 v[8:11], a[80:83], v[200:203], v[8:11]
    s_waitcnt lgkmcnt(6)
    v_mfma_f32_16x16x32_bf16 v[12:15], a[80:83], v[204:207], v[12:15]
    s_waitcnt lgkmcnt(5)
    v_mfma_f32_16x16x32_bf16 v[16:19], a[80:83], v[208:211], v[16:19]
    s_waitcnt lgkmcnt(4)
    v_mfma_f32_16x16x32_bf16 v[20:23], a[80:83], v[212:215], v[20:23]
    s_waitcnt vmcnt(18)
    v_mfma_f32_16x16x32_bf16 v[24:27], a[84:87], v[200:203], v[24:27]
    v_mfma_f32_16x16x32_bf16 v[28:31], a[84:87], v[204:207], v[28:31]
    v_mfma_f32_16x16x32_bf16 v[32:35], a[84:87], v[208:211], v[32:35]
    v_mfma_f32_16x16x32_bf16 v[36:39], a[84:87], v[212:215], v[36:39]
    s_waitcnt vmcnt(17)
    v_mfma_f32_16x16x32_bf16 v[40:43], a[88:91], v[200:203], v[40:43]
    v_mfma_f32_16x16x32_bf16 v[44:47], a[88:91], v[204:207], v[44:47]
    v_mfma_f32_16x16x32_bf16 v[48:51], a[88:91], v[208:211], v[48:51]
    v_mfma_f32_16x16x32_bf16 v[52:55], a[88:91], v[212:215], v[52:55]
    s_waitcnt vmcnt(16)
    v_mfma_f32_16x16x32_bf16 v[56:59], a[92:95], v[200:203], v[56:59]
    v_mfma_f32_16x16x32_bf16 v[60:63], a[92:95], v[204:207], v[60:63]
    v_mfma_f32_16x16x32_bf16 v[64:67], a[92:95], v[208:211], v[64:67]
    v_mfma_f32_16x16x32_bf16 v[68:71], a[92:95], v[212:215], v[68:71]
    s_waitcnt vmcnt(15)
    v_mfma_f32_16x16x32_bf16 v[72:75], a[96:99], v[200:203], v[72:75]
    v_mfma_f32_16x16x32_bf16 v[76:79], a[96:99], v[204:207], v[76:79]
    v_mfma_f32_16x16x32_bf16 v[80:83], a[96:99], v[208:211], v[80:83]
    v_mfma_f32_16x16x32_bf16 v[84:87], a[96:99], v[212:215], v[84:87]
    s_waitcnt vmcnt(14)
    v_mfma_f32_16x16x32_bf16 v[88:91], a[100:103], v[200:203], v[88:91]
    v_mfma_f32_16x16x32_bf16 v[92:95], a[100:103], v[204:207], v[92:95]
    v_mfma_f32_16x16x32_bf16 v[96:99], a[100:103], v[208:211], v[96:99]
    v_mfma_f32_16x16x32_bf16 v[100:103], a[100:103], v[212:215], v[100:103]
    s_waitcnt vmcnt(13)
    v_mfma_f32_16x16x32_bf16 v[104:107], a[104:107], v[200:203], v[104:107]
    v_mfma_f32_16x16x32_bf16 v[108:111], a[104:107], v[204:207], v[108:111]
    v_mfma_f32_16x16x32_bf16 v[112:115], a[104:107], v[208:211], v[112:115]
    v_mfma_f32_16x16x32_bf16 v[116:119], a[104:107], v[212:215], v[116:119]
    s_waitcnt vmcnt(12)
    v_mfma_f32_16x16x32_bf16 v[120:123], a[108:111], v[200:203], v[120:123]
    v_mfma_f32_16x16x32_bf16 v[124:127], a[108:111], v[204:207], v[124:127]
    v_mfma_f32_16x16x32_bf16 v[128:131], a[108:111], v[208:211], v[128:131]
    v_mfma_f32_16x16x32_bf16 v[132:135], a[108:111], v[212:215], v[132:135]
    s_waitcnt vmcnt(11)
    v_mfma_f32_16x16x32_bf16 v[136:139], a[112:115], v[200:203], v[136:139]
    v_mfma_f32_16x16x32_bf16 v[140:143], a[112:115], v[204:207], v[140:143]
    v_mfma_f32_16x16x32_bf16 v[144:147], a[112:115], v[208:211], v[144:147]
    v_mfma_f32_16x16x32_bf16 v[148:151], a[112:115], v[212:215], v[148:151]
    s_waitcnt vmcnt(10)
    v_mfma_f32_16x16x32_bf16 v[152:155], a[116:119], v[200:203], v[152:155]
    v_mfma_f32_16x16x32_bf16 v[156:159], a[116:119], v[204:207], v[156:159]
    v_mfma_f32_16x16x32_bf16 v[160:163], a[116:119], v[208:211], v[160:163]
    v_mfma_f32_16x16x32_bf16 v[164:167], a[116:119], v[212:215], v[164:167]
    s_waitcnt vmcnt(9) lgkmcnt(3)
    v_mfma_f32_16x16x32_bf16 v[8:11], a[120:123], v[168:171], v[8:11]
    s_waitcnt lgkmcnt(2)
    v_mfma_f32_16x16x32_bf16 v[12:15], a[120:123], v[172:175], v[12:15]
    s_waitcnt lgkmcnt(1)
    v_mfma_f32_16x16x32_bf16 v[16:19], a[120:123], v[176:179], v[16:19]
    s_waitcnt lgkmcnt(0)
    v_mfma_f32_16x16x32_bf16 v[20:23], a[120:123], v[180:183], v[20:23]
    s_waitcnt vmcnt(8)
    v_mfma_f32_16x16x32_bf16 v[24:27], a[124:127], v[168:171], v[24:27]
    v_mfma_f32_16x16x32_bf16 v[28:31], a[124:127], v[172:175], v[28:31]
    v_mfma_f32_16x16x32_bf16 v[32:35], a[124:127], v[176:179], v[32:35]
    v_mfma_f32_16x16x32_bf16 v[36:39], a[124:127], v[180:183], v[36:39]
    s_waitcnt vmcnt(7)
    v_mfma_f32_16x16x32_bf16 v[40:43], a[128:131], v[168:171], v[40:43]
    v_mfma_f32_16x16x32_bf16 v[44:47], a[128:131], v[172:175], v[44:47]
    v_mfma_f32_16x16x32_bf16 v[48:51], a[128:131], v[176:179], v[48:51]
    v_mfma_f32_16x16x32_bf16 v[52:55], a[128:131], v[180:183], v[52:55]
    s_waitcnt vmcnt(6)
    v_mfma_f32_16x16x32_bf16 v[56:59], a[132:135], v[168:171], v[56:59]
    v_mfma_f32_16x16x32_bf16 v[60:63], a[132:135], v[172:175], v[60:63]
    v_mfma_f32_16x16x32_bf16 v[64:67], a[132:135], v[176:179], v[64:67]
    v_mfma_f32_16x16x32_bf16 v[68:71], a[132:135], v[180:183], v[68:71]
    s_waitcnt vmcnt(5)
    v_mfma_f32_16x16x32_bf16 v[72:75], a[136:139], v[168:171], v[72:75]
    v_mfma_f32_16x16x32_bf16 v[76:79], a[136:139], v[172:175], v[76:79]
    v_mfma_f32_16x16x32_bf16 v[80:83], a[136:139], v[176:179], v[80:83]
    v_mfma_f32_16x16x32_bf16 v[84:87], a[136:139], v[180:183], v[84:87]
    s_waitcnt vmcnt(4)
    v_mfma_f32_16x16x32_bf16 v[88:91], a[140:143], v[168:171], v[88:91]
    v_mfma_f32_16x16x32_bf16 v[92:95], a[140:143], v[172:175], v[92:95]
    v_mfma_f32_16x16x32_bf16 v[96:99], a[140:143], v[176:179], v[96:99]
    v_mfma_f32_16x16x32_bf16 v[100:103], a[140:143], v[180:183], v[100:103]
    s_waitcnt vmcnt(3)
    v_mfma_f32_16x16x32_bf16 v[104:107], a[144:147], v[168:171], v[104:107]
    v_mfma_f32_16x16x32_bf16 v[108:111], a[144:147], v[172:175], v[108:111]
    v_mfma_f32_16x16x32_bf16 v[112:115], a[144:147], v[176:179], v[112:115]
    v_mfma_f32_16x16x32_bf16 v[116:119], a[144:147], v[180:183], v[116:119]
    s_waitcnt vmcnt(2)
    v_mfma_f32_16x16x32_bf16 v[120:123], a[148:151], v[168:171], v[120:123]
    v_mfma_f32_16x16x32_bf16 v[124:127], a[148:151], v[172:175], v[124:127]
    v_mfma_f32_16x16x32_bf16 v[128:131], a[148:151], v[176:179], v[128:131]
    v_mfma_f32_16x16x32_bf16 v[132:135], a[148:151], v[180:183], v[132:135]
    s_waitcnt vmcnt(1)
    v_mfma_f32_16x16x32_bf16 v[136:139], a[152:155], v[168:171], v[136:139]
    v_mfma_f32_16x16x32_bf16 v[140:143], a[152:155], v[172:175], v[140:143]
    v_mfma_f32_16x16x32_bf16 v[144:147], a[152:155], v[176:179], v[144:147]
    v_mfma_f32_16x16x32_bf16 v[148:151], a[152:155], v[180:183], v[148:151]
    s_waitcnt vmcnt(0)
    v_mfma_f32_16x16x32_bf16 v[152:155], a[156:159], v[168:171], v[152:155]
    v_mfma_f32_16x16x32_bf16 v[156:159], a[156:159], v[172:175], v[156:159]
    v_mfma_f32_16x16x32_bf16 v[160:163], a[156:159], v[176:179], v[160:163]
    v_mfma_f32_16x16x32_bf16 v[164:167], a[156:159], v[180:183], v[164:167]
    s_nop 9
    s_lshl_b32 s24, s5, 4
    s_add_u32 s24, s24, s7
    s_mul_i32 s24, s24, 81920
    s_mul_i32 s21, s4, 10240
    s_add_u32 s24, s24, s21
    s_add_u32 s24, s24, 134217728
    s_add_u32 s21, s24, 0
    buffer_store_dwordx4 v[8:11], v2, s[8:11], s21 offen sc1
    s_add_u32 s21, s24, 1024
    buffer_store_dwordx4 v[24:27], v2, s[8:11], s21 offen sc1
    s_add_u32 s21, s24, 2048
    buffer_store_dwordx4 v[40:43], v2, s[8:11], s21 offen sc1
    s_add_u32 s21, s24, 3072
    buffer_store_dwordx4 v[56:59], v2, s[8:11], s21 offen sc1
    s_add_u32 s21, s24, 4096
    buffer_store_dwordx4 v[72:75], v2, s[8:11], s21 offen sc1
    s_add_u32 s21, s24, 5120
    buffer_store_dwordx4 v[88:91], v2, s[8:11], s21 offen sc1
    s_add_u32 s21, s24, 6144
    buffer_store_dwordx4 v[104:107], v2, s[8:11], s21 offen sc1
    s_add_u32 s21, s24, 7168
    buffer_store_dwordx4 v[120:123], v2, s[8:11], s21 offen sc1
    s_add_u32 s21, s24, 8192
    buffer_store_dwordx4 v[136:139], v2, s[8:11], s21 offen sc1
    s_add_u32 s21, s24, 9216
    buffer_store_dwordx4 v[152:155], v2, s[8:11], s21 offen sc1
    s_add_u32 s21, s24, 40960
    buffer_store_dwordx4 v[12:15], v2, s[8:11], s21 offen sc1
    s_add_u32 s21, s24, 41984
    buffer_store_dwordx4 v[28:31], v2, s[8:11], s21 offen sc1
    s_add_u32 s21, s24, 43008
    buffer_store_dwordx4 v[44:47], v2, s[8:11], s21 offen sc1
    s_add_u32 s21, s24, 44032
    buffer_store_dwordx4 v[60:63], v2, s[8:11], s21 offen sc1
    s_add_u32 s21, s24, 45056
    buffer_store_dwordx4 v[76:79], v2, s[8:11], s21 offen sc1
    s_add_u32 s21, s24, 46080
    buffer_store_dwordx4 v[92:95], v2, s[8:11], s21 offen sc1
    s_add_u32 s21, s24, 47104
    buffer_store_dwordx4 v[108:111], v2, s[8:11], s21 offen sc1
    s_add_u32 s21, s24, 48128
    buffer_store_dwordx4 v[124:127], v2, s[8:11], s21 offen sc1
    s_add_u32 s21, s24, 49152
    buffer_store_dwordx4 v[140:143], v2, s[8:11], s21 offen sc1
    s_add_u32 s21, s24, 50176
    buffer_store_dwordx4 v[156:159], v2, s[8:11], s21 offen sc1
    s_add_u32 s21, s24, 655360
    buffer_store_dwordx4 v[16:19], v2, s[8:11], s21 offen sc1
    s_add_u32 s21, s24, 656384
    buffer_store_dwordx4 v[32:35], v2, s[8:11], s21 offen sc1
    s_add_u32 s21, s24, 657408
    buffer_store_dwordx4 v[48:51], v2, s[8:11], s21 offen sc1
    s_add_u32 s21, s24, 658432
    buffer_store_dwordx4 v[64:67], v2, s[8:11], s21 offen sc1
    s_add_u32 s21, s24, 659456
    buffer_store_dwordx4 v[80:83], v2, s[8:11], s21 offen sc1
    s_add_u32 s21, s24, 660480
    buffer_store_dwordx4 v[96:99], v2, s[8:11], s21 offen sc1
    s_add_u32 s21, s24, 661504
    buffer_store_dwordx4 v[112:115], v2, s[8:11], s21 offen sc1
    s_add_u32 s21, s24, 662528
    buffer_store_dwordx4 v[128:131], v2, s[8:11], s21 offen sc1
    s_add_u32 s21, s24, 663552
    buffer_store_dwordx4 v[144:147], v2, s[8:11], s21 offen sc1
    s_add_u32 s21, s24, 664576
    buffer_store_dwordx4 v[160:163], v2, s[8:11], s21 offen sc1
    s_add_u32 s21, s24, 696320
    buffer_store_dwordx4 v[20:23], v2, s[8:11], s21 offen sc1
    s_add_u32 s21, s24, 697344
    buffer_store_dwordx4 v[36:39], v2, s[8:11], s21 offen sc1
    s_add_u32 s21, s24, 698368
    buffer_store_dwordx4 v[52:55], v2, s[8:11], s21 offen sc1
    s_add_u32 s21, s24, 699392
    buffer_store_dwordx4 v[68:71], v2, s[8:11], s21 offen sc1
    s_add_u32 s21, s24, 700416
    buffer_store_dwordx4 v[84:87], v2, s[8:11], s21 offen sc1
    s_add_u32 s21, s24, 701440
    buffer_store_dwordx4 v[100:103], v2, s[8:11], s21 offen sc1
    s_add_u32 s21, s24, 702464
    buffer_store_dwordx4 v[116:119], v2, s[8:11], s21 offen sc1
    s_add_u32 s21, s24, 703488
    buffer_store_dwordx4 v[132:135], v2, s[8:11], s21 offen sc1
    s_add_u32 s21, s24, 704512
    buffer_store_dwordx4 v[148:151], v2, s[8:11], s21 offen sc1
    s_add_u32 s21, s24, 705536
    buffer_store_dwordx4 v[164:167], v2, s[8:11], s21 offen sc1
    s_waitcnt vmcnt(0)
    s_lshr_b32 s20, s5, 1
    s_lshl_b32 s20, s20, 2
    s_add_u32 s20, s20, 72
    s_and_b32 s21, s5, 1
    s_lshl_b32 s21, s21, 4
    s_lshl_b32 s22, 0x101, s21
    s_cmp_lg_u32 s4, 0
    s_cbranch_scc1 tki_273
    s_lshl_b32 s93, s83, 2
    s_add_u32 s93, s93, 176
    v_mov_b32 v250, s93
    v_mov_b32 v251, 1
    s_mov_b64 exec, 1
    global_atomic_add v249, v250, v251, s[98:99] sc0 sc1
    s_mov_b64 exec, -1
tki_273:
    s_waitcnt vmcnt(0) lgkmcnt(0)
    s_barrier
    s_cmp_lg_u32 s4, 0
    s_cbranch_scc1 sig_274
    v_mov_b32 v250, s20
    v_mov_b32 v251, s22
    s_mov_b64 exec, 1
    global_atomic_add v250, v251, s[98:99] sc1
    s_mov_b64 exec, -1
sig_274:
    s_branch L_next
LT34O_106:
    s_lshr_b32 s19, s5, 3
    s_lshr_b32 s20, s19, 1
    s_lshl_b32 s20, s20, 2
    s_and_b32 s21, s19, 1
    s_lshl_b32 s21, s21, 4
    s_add_u32 s17, s19, 8
    s_bitcmp1_b32 s92, s17
    s_cbranch_scc1 dep_275
    s_add_u32 s18, s20, 32
    s_cmp_lg_u32 s4, 0
    s_cbranch_scc1 wfd_277
    v_mov_b32 v250, s18
wf_276:
    global_load_dword v251, v250, s[98:99] sc1
    s_waitcnt vmcnt(0)
    v_lshrrev_b32 v251, s21, v251
    v_and_b32 v251, 0xffff, v251
    v_cmp_gt_u32 vcc, 32, v251
    s_cbranch_vccz wf_276x
    s_sleep 32
    s_branch wf_276
wf_276x:
wfd_277:
    s_add_u32 s18, s20, 16
    s_cmp_lg_u32 s4, 0
    s_cbranch_scc1 wfd_279
    v_mov_b32 v250, s18
wf_278:
    global_load_dword v251, v250, s[98:99] sc1
    s_waitcnt vmcnt(0)
    v_lshrrev_b32 v251, s21, v251
    v_and_b32 v251, 0xffff, v251
    v_cmp_gt_u32 vcc, 64, v251
    s_cbranch_vccz wf_278x
    s_sleep 32
    s_branch wf_278
wf_278x:
wfd_279:
    s_cmp_lg_u32 s4, 0
    s_cbranch_scc1 acq_280
    buffer_inv sc1
    s_waitcnt vmcnt(0)
acq_280:
    s_barrier
    s_bitset1_b32 s92, s17
dep_275:
    s_lshl_b32 s21, s7, 2
    s_add_u32 s21, s21, s4
    s_lshl_b32 s20, s5, 5
    s_add_u32 s20, s20, s21
    s_lshl_b32 s22, s20, 12
    s_add_u32 s22, s22, 8388608
    s_lshl_b32 s20, s20, 13
    v_add_u32 v5, 4096, v2
    v_add_u32 v6, 8192, v2
    s_lshl_b32 s23, s7, 4
    s_mul_i32 s23, s23, 40960
    s_mul_i32 s21, s4, 5120
    s_add_u32 s23, s23, s21
    s_add_u32 s23, s23, 91226112
    s_mul_i32 s58, s59, 20480
    s_add_u32 s23, s23, s58
    s_add_u32 s21, s20, 50331648
    buffer_load_dwordx4 v[8:11], v2, s[8:11], s21 offen offset:0
    buffer_load_dwordx4 v[12:15], v2, s[8:11], s21 offen offset:1024
    buffer_load_dwordx4 v[16:19], v2, s[8:11], s21 offen offset:2048
    buffer_load_dwordx4 v[20:23], v2, s[8:11], s21 offen offset:3072
    buffer_load_dwordx4 v[24:27], v5, s[8:11], s21 offen offset:0
    buffer_load_dwordx4 v[28:31], v5, s[8:11], s21 offen offset:1024
    buffer_load_dwordx4 v[32:35], v5, s[8:11], s21 offen offset:2048
    buffer_load_dwordx4 v[36:39], v5, s[8:11], s21 offen offset:3072
    s_add_u32 s21, s20, 16777216
    buffer_load_dwordx4 v[40:43], v2, s[8:11], s21 offen offset:0
    buffer_load_dwordx4 v[44:47], v2, s[8:11], s21 offen offset:1024
    buffer_load_dwordx4 v[48:51], v2, s[8:11], s21 offen offset:2048
    buffer_load_dwordx4 v[52:55], v2, s[8:11], s21 offen offset:3072
    buffer_load_dwordx4 v[56:59], v5, s[8:11], s21 offen offset:0
    buffer_load_dwordx4 v[60:63], v5, s[8:11], s21 offen offset:1024
    buffer_load_dwordx4 v[64:67], v5, s[8:11], s21 offen offset:2048
    buffer_load_dwordx4 v[68:71], v5, s[8:11], s21 offen offset:3072
    s_add_u32 s21, s20, 33554432
    buffer_load_dwordx4 v[72:75], v2, s[8:11], s21 offen offset:0
    buffer_load_dwordx4 v[76:79], v2, s[8:11], s21 offen offset:1024
    buffer_load_dwordx4 v[80:83], v2, s[8:11], s21 offen offset:2048
    buffer_load_dwordx4 v[84:87], v2, s[8:11], s21 offen offset:3072
    buffer_load_dwordx4 v[88:91], v5, s[8:11], s21 offen offset:0
    buffer_load_dwordx4 v[92:95], v5, s[8:11], s21 offen offset:1024
    buffer_load_dwordx4 v[96:99], v5, s[8:11], s21 offen offset:2048
    buffer_load_dwordx4 v[100:103], v5, s[8:11], s21 offen offset:3072
    s_add_u32 s40, s23, 0
    s_add_u32 s41, s23, 40960
    s_add_u32 s42, s23, 81920
    s_add_u32 s43, s23, 122880
    s_add_u32 s44, s23, 163840
    s_add_u32 s45, s23, 204800
    s_add_u32 s46, s23, 245760
    s_add_u32 s47, s23, 286720
    s_add_u32 s48, s23, 327680
    s_add_u32 s49, s23, 368640
    s_add_u32 s50, s23, 409600
    s_add_u32 s51, s23, 450560
    s_add_u32 s52, s23, 491520
    s_add_u32 s53, s23, 532480
    s_add_u32 s54, s23, 573440
    s_add_u32 s55, s23, 614400
    buffer_load_dwordx4 a[0:3], v2, s[8:11], s40 offen offset:0
    buffer_load_dwordx4 a[4:7], v2, s[8:11], s40 offen offset:1024
    buffer_load_dwordx4 a[8:11], v2, s[8:11], s40 offen offset:2048
    buffer_load_dwordx4 a[12:15], v2, s[8:11], s40 offen offset:3072
    buffer_load_dwordx4 a[16:19], v5, s[8:11], s40 offen offset:0
    buffer_load_dwordx4 a[20:23], v2, s[8:11], s41 offen offset:0
    buffer_load_dwordx4 a[24:27], v2, s[8:11], s41 offen offset:1024
    buffer_load_dwordx4 a[28:31], v2, s[8:11], s41 offen offset:2048
    buffer_load_dwordx4 a[32:35], v2, s[8:11], s41 offen offset:3072
    buffer_load_dwordx4 a[36:39], v5, s[8:11], s41 offen offset:0
    buffer_load_dwordx4 a[40:43], v2, s[8:11], s42 offen offset:0
    buffer_load_dwordx4 a[44:47], v2, s[8:11], s42 offen offset:1024
    buffer_load_dwordx4 a[48:51], v2, s[8:11], s42 offen offset:2048
    buffer_load_dwordx4 a[52:55], v2, s[8:11], s42 offen offset:3072
    buffer_load_dwordx4 a[56:59], v5, s[8:11], s42 offen offset:0
    buffer_load_dwordx4 a[60:63], v2, s[8:11], s43 offen offset:0
    buffer_load_dwordx4 a[64:67], v2, s[8:11], s43 offen offset:1024
    buffer_load_dwordx4 a[68:71], v2, s[8:11], s43 offen offset:2048
    buffer_load_dwordx4 a[72:75], v2, s[8:11], s43 offen offset:3072
    buffer_load_dwordx4 a[76:79], v5, s[8:11], s43 offen offset:0
    buffer_load_dwordx4 a[80:83], v2, s[8:11], s44 offen offset:0
    buffer_load_dwordx4 a[84:87], v2, s[8:11], s44 offen offset:1024
    buffer_load_dwordx4 a[88:91], v2, s[8:11], s44 offen offset:2048
    buffer_load_dwordx4 a[92:95], v2, s[8:11], s44 offen offset:3072
    buffer_load_dwordx4 a[96:99], v5, s[8:11], s44 offen offset:0
    buffer_load_dwordx4 a[100:103], v2, s[8:11], s45 offen offset:0
    buffer_load_dwordx4 a[104:107], v2, s[8:11], s45 offen offset:1024
    buffer_load_dwordx4 a[108:111], v2, s[8:11], s45 offen offset:2048
    buffer_load_dwordx4 a[112:115], v2, s[8:11], s45 offen offset:3072
    buffer_load_dwordx4 a[116:119], v5, s[8:11], s45 offen offset:0
    buffer_load_dwordx4 a[120:123], v2, s[8:11], s46 offen offset:0
    buffer_load_dwordx4 a[124:127], v2, s[8:11], s46 offen offset:1024
    buffer_load_dwordx4 a[128:131], v2, s[8:11], s46 offen offset:2048
    buffer_load_dwordx4 a[132:135], v2, s[8:11], s46 offen offset:3072
    buffer_load_dwordx4 a[136:139], v5, s[8:11], s46 offen offset:0
    buffer_load_dwordx4 a[140:143], v2, s[8:11], s47 offen offset:0
    buffer_load_dwordx4 a[144:147], v2, s[8:11], s47 offen offset:1024
    buffer_load_dwordx4 a[148:151], v2, s[8:11], s47 offen offset:2048
    buffer_load_dwordx4 a[152:155], v2, s[8:11], s47 offen offset:3072
    buffer_load_dwordx4 a[156:159], v5, s[8:11], s47 offen offset:0
    buffer_load_dwordx4 a[160:163], v2, s[8:11], s48 offen offset:0
    buffer_load_dwordx4 a[164:167], v2, s[8:11], s48 offen offset:1024
    buffer_load_dwordx4 a[168:171], v2, s[8:11], s48 offen offset:2048
    buffer_load_dwordx4 a[172:175], v2, s[8:11], s48 offen offset:3072
    buffer_load_dwordx4 a[176:179], v5, s[8:11], s48 offen offset:0
    buffer_load_dwordx4 a[180:183], v2, s[8:11], s49 offen offset:0
    buffer_load_dwordx4 a[184:187], v2, s[8:11], s49 offen offset:1024
    buffer_load_dwordx4 a[188:191], v2, s[8:11], s49 offen offset:2048
    buffer_load_dwordx4 a[192:195], v2, s[8:11], s49 offen offset:3072
    buffer_load_dwordx4 a[196:199], v5, s[8:11], s49 offen offset:0
    buffer_load_dwordx4 a[200:203], v2, s[8:11], s50 offen offset:0
    buffer_load_dwordx4 a[204:207], v2, s[8:11], s50 offen offset:1024
    buffer_load_dwordx4 a[208:211], v2, s[8:11], s50 offen offset:2048
    buffer_load_dwordx4 a[212:215], v2, s[8:11], s50 offen offset:3072
    buffer_load_dwordx4 a[216:219], v5, s[8:11], s50 offen offset:0
    buffer_load_dwordx4 a[220:223], v2, s[8:11], s51 offen offset:0
    buffer_load_dwordx4 a[224:227], v2, s[8:11], s51 offen offset:1024
    buffer_load_dwordx4 a[228:231], v2, s[8:11], s51 offen offset:2048
    buffer_load_dwordx4 a[232:235], v2, s[8:11], s51 offen offset:3072
    buffer_load_dwordx4 a[236:239], v5, s[8:11], s51 offen offset:0
    v_lshrrev_b32 v7, 2, v1
    v_lshlrev_b32 v7, 4, v7
    v_and_b32 v250, 1, v1
    v_lshl_add_u32 v7, v250, 3, v7
    s_lshl_b32 s21, s4, 12
    v_add_u32 v7, s21, v7
    v_add_u32 v251, s21, v2
    v_lshlrev_b32 v252, 4, v3
    v_and_b32 v250, 1, v4
    v_lshl_add_u32 v252, v250, 3, v252
    v_lshlrev_b32 v250, 2, v4
    v_cmp_gt_u32 s[28:29], 32, v1
    v_add_u32 v253, 0, v250
    v_cmp_le_u32 s[30:31], v253, v3
    v_add_u32 v253, 1, v250
    v_cmp_le_u32 s[32:33], v253, v3
    v_add_u32 v253, 2, v250
    v_cmp_le_u32 s[34:35], v253, v3
    v_add_u32 v253, 3, v250
    v_cmp_le_u32 s[36:37], v253, v3
    v_mov_b32 v180, 0x3f803f80
    v_mov_b32 v181, 0x3f803f80
    v_mov_b32 v182, 0x3f803f80
    v_mov_b32 v183, 0x3f803f80
    s_lshl_b32 s56, s5, 5
    s_lshl_b32 s57, s7, 2
    s_add_u32 s56, s56, s57
    s_lshl_b32 s56, s56, 2
    s_add_u32 s56, s56, 1048576
    s_cmp_lg_u32 s4, 0
    s_cbranch_scc1 kfd_282
    v_mov_b32 v254, 0
kf_281:
    buffer_load_dwordx4 v[184:187], v254, s[8:11], s56 offen sc1
    s_waitcnt vmcnt(0)
    v_and_b32 v184, v184, v185
    v_and_b32 v186, v186, v187
    v_and_b32 v184, v184, v186
    v_cmp_ne_u32 vcc, 1, v184
    s_cbranch_vccz kfd_282
    s_sleep 10
    s_branch kf_281
kfd_282:
    s_barrier
    buffer_load_dwordx4 v[184:187], v2, s[8:11], s22 offen sc1
    buffer_load_dwordx4 v[188:191], v2, s[8:11], s22 offen offset:1024 sc1
    buffer_load_dwordx2 v[120:121], v252, s[8:11], s22 offen offset:2048 sc1
    buffer_load_dwordx2 v[122:123], v252, s[8:11], s22 offen offset:2304 sc1
    buffer_load_dwordx2 v[124:125], v252, s[8:11], s22 offen offset:2560 sc1
    buffer_load_dwordx2 v[126:127], v252, s[8:11], s22 offen offset:2816 sc1
    buffer_load_dwordx2 v[128:129], v252, s[8:11], s22 offen offset:3072 sc1
    buffer_load_dwordx2 v[130:131], v252, s[8:11], s22 offen offset:3328 sc1
    buffer_load_dwordx2 v[132:133], v252, s[8:11], s22 offen offset:3584 sc1
    buffer_load_dwordx2 v[134:135], v252, s[8:11], s22 offen offset:3840 sc1
    s_waitcnt vmcnt(9)
    ds_write_b128 v251, v[184:187] offset:0
    s_waitcnt vmcnt(8)
    ds_write_b128 v251, v[188:191] offset:1024
    s_waitcnt lgkmcnt(0)
    ds_read_b64_tr_b16 v[104:105], v7 offset:0
    ds_read_b64_tr_b16 v[106:107], v7 offset:256
    ds_read_b64_tr_b16 v[108:109], v7 offset:512
    ds_read_b64_tr_b16 v[110:111], v7 offset:768
    ds_read_b64_tr_b16 v[112:113], v7 offset:1024
    ds_read_b64_tr_b16 v[114:115], v7 offset:1280
    ds_read_b64_tr_b16 v[116:117], v7 offset:1536
    ds_read_b64_tr_b16 v[118:119], v7 offset:1792
    s_waitcnt lgkmcnt(6)
    v_mfma_f32_16x16x32_bf16 v[144:147], v[104:107], v[24:27], 0
    s_lshl_b32 s21, s4, 13
    v_mov_b32 v254, 0xff800000
    v_mov_b32 v162, 0
    v_mfma_f32_16x16x32_bf16 v[148:151], v[40:43], v[24:27], 0
    v_mov_b32 v163, 0
    v_add_u32 v250, s21, v2
    v_mfma_f32_16x16x32_bf16 v[136:139], v[104:107], v[8:11], 0
    v_mfma_f32_16x16x32_bf16 v[140:143], v[40:43], v[8:11], 0
    v_mfma_f32_16x16x32_bf16 v[152:155], v[56:59], v[24:27], 0
    s_waitcnt lgkmcnt(4)
    v_mfma_f32_16x16x32_bf16 v[144:147], v[108:111], v[28:31], v[144:147]
    v_mfma_f32_16x16x32_bf16 v[148:151], v[44:47], v[28:31], v[148:151]
    v_mfma_f32_16x16x32_bf16 v[136:139], v[108:111], v[12:15], v[136:139]
    v_mfma_f32_16x16x32_bf16 v[140:143], v[44:47], v[12:15], v[140:143]
    v_mfma_f32_16x16x32_bf16 v[152:155], v[60:63], v[28:31], v[152:155]
    s_waitcnt lgkmcnt(2)
    v_mfma_f32_16x16x32_bf16 v[144:147], v[112:115], v[32:35], v[144:147]
    v_mfma_f32_16x16x32_bf16 v[148:151], v[48:51], v[32:35], v[148:151]
    v_mfma_f32_16x16x32_bf16 v[136:139], v[112:115], v[16:19], v[136:139]
    v_mfma_f32_16x16x32_bf16 v[140:143], v[48:51], v[16:19], v[140:143]
    v_mfma_f32_16x16x32_bf16 v[152:155], v[64:67], v[32:35], v[152:155]
    s_waitcnt lgkmcnt(0)
    v_mfma_f32_16x16x32_bf16 v[144:147], v[116:119], v[36:39], v[144:147]
    v_mfma_f32_16x16x32_bf16 v[148:151], v[52:55], v[36:39], v[148:151]
    v_mfma_f32_16x16x32_bf16 v[136:139], v[116:119], v[20:23], v[136:139]
    s_nop 1
    v_max3_f32 v158, v144, v145, v146
    v_mfma_f32_16x16x32_bf16 v[140:143], v[52:55], v[20:23], v[140:143]
    v_max3_f32 v158, v147, v148, v158
    v_max3_f32 v158, v149, v150, v158
    v_mfma_f32_16x16x32_bf16 v[152:155], v[68:71], v[36:39], v[152:155]
    v_max3_f32 v156, v136, v137, v138
    s_nop 1
    v_cndmask_b32 v140, v254, v140, s[30:31]
    v_cndmask_b32 v141, v254, v141, s[32:33]
    v_cndmask_b32 v142, v254, v142, s[34:35]
    v_max3_f32 v156, v139, v140, v156
    s_nop 0
    v_cndmask_b32 v152, v254, v152, s[30:31]
    v_cndmask_b32 v153, v254, v153, s[32:33]
    v_cndmask_b32 v154, v254, v154, s[34:35]
    v_max3_f32 v158, v151, v152, v158
    v_cndmask_b32 v143, v254, v143, s[36:37]
    v_cndmask_b32 v155, v254, v155, s[36:37]
    v_max3_f32 v156, v141, v142, v156
    v_max3_f32 v158, v153, v154, v158
    v_max_f32 v156, v143, v156
    v_max_f32 v158, v155, v158
    v_mov_b32 v157, v156
    v_mov_b32 v159, v158
    s_nop 0
    v_permlane16_swap_b32 v157, v156
    v_permlane16_swap_b32 v159, v158
    v_max_f32 v156, v156, v157
    v_max_f32 v158, v158, v159
    v_mov_b32 v157, v156
    v_mov_b32 v159, v158
    s_nop 0
    v_permlane32_swap_b32 v157, v156
    v_permlane32_swap_b32 v159, v158
    v_max_f32 v156, v156, v157
    v_max_f32 v158, v158, v159
    v_sub_f32 v140, v140, v156
    v_sub_f32 v141, v141, v156
    v_sub_f32 v142, v142, v156
    v_sub_f32 v143, v143, v156
    v_sub_f32 v148, v148, v158
    v_sub_f32 v149, v149, v158
    v_sub_f32 v150, v150, v158
    v_sub_f32 v151, v151, v158
    v_sub_f32 v152, v152, v158
    v_sub_f32 v153, v153, v158
    v_sub_f32 v154, v154, v158
    v_sub_f32 v155, v155, v158
    v_exp_f32 v140, v140
    v_exp_f32 v141, v141
    v_exp_f32 v142, v142
    v_exp_f32 v143, v143
    v_exp_f32 v148, v148
    v_exp_f32 v149, v149
    v_exp_f32 v150, v150
    v_exp_f32 v151, v151
    v_exp_f32 v152, v152
    v_exp_f32 v153, v153
    v_exp_f32 v154, v154
    v_exp_f32 v155, v155
    v_sub_f32 v136, v136, v156
    v_sub_f32 v137, v137, v156
    v_sub_f32 v138, v138, v156
    v_sub_f32 v139, v139, v156
    v_sub_f32 v144, v144, v158
    v_sub_f32 v145, v145, v158
    v_sub_f32 v146, v146, v158
    v_sub_f32 v147, v147, v158
    v_exp_f32 v136, v136
    v_exp_f32 v137, v137
    v_exp_f32 v138, v138
    v_exp_f32 v139, v139
    v_exp_f32 v144, v144
    v_exp_f32 v145, v145
    v_exp_f32 v146, v146
    v_exp_f32 v147, v147
    v_cvt_pk_bf16_f32 v160, v140, v141
    v_cvt_pk_bf16_f32 v161, v142, v143
    v_cvt_pk_bf16_f32 v164, v148, v149
    v_cvt_pk_bf16_f32 v165, v150, v151
    v_cvt_pk_bf16_f32 v166, v152, v153
    v_cvt_pk_bf16_f32 v167, v154, v155
    v_cvt_pk_bf16_f32 v168, v136, v137
    v_cvt_pk_bf16_f32 v169, v138, v139
    v_cvt_pk_bf16_f32 v170, v144, v145
    v_cvt_pk_bf16_f32 v171, v146, v147
    v_mfma_f32_16x16x32_bf16 v[172:175], v[180:183], v[160:163], 0
    v_cndmask_b32 v168, 0, v168, s[28:29]
    v_cndmask_b32 v169, 0, v169, s[28:29]
    v_mfma_f32_16x16x32_bf16 v[176:179], v[180:183], v[164:167], 0
    v_cndmask_b32 v170, 0, v170, s[28:29]
    v_cndmask_b32 v171, 0, v171, s[28:29]
    v_mfma_f32_16x16x32_bf16 v[184:187], v[72:75], v[160:163], 0
    v_mfma_f32_16x16x32_bf16 v[192:195], v[76:79], v[160:163], 0
    v_mfma_f32_16x16x32_bf16 v[200:203], v[80:83], v[160:163], 0
    v_mfma_f32_16x16x32_bf16 v[208:211], v[84:87], v[160:163], 0
    v_mfma_f32_16x16x32_bf16 v[216:219], v[88:91], v[160:163], 0
    v_mfma_f32_16x16x32_bf16 v[224:227], v[92:95], v[160:163], 0
    v_mfma_f32_16x16x32_bf16 v[232:235], v[96:99], v[160:163], 0
    v_mfma_f32_16x16x32_bf16 v[240:243], v[100:103], v[160:163], 0
    v_mfma_f32_16x16x32_bf16 v[188:191], v[72:75], v[164:167], 0
    v_mfma_f32_16x16x32_bf16 v[196:199], v[76:79], v[164:167], 0
    v_mfma_f32_16x16x32_bf16 v[204:207], v[80:83], v[164:167], 0
    v_mfma_f32_16x16x32_bf16 v[212:215], v[84:87], v[164:167], 0
    v_mfma_f32_16x16x32_bf16 v[220:223], v[88:91], v[164:167], 0
    v_mfma_f32_16x16x32_bf16 v[228:231], v[92:95], v[164:167], 0
    v_mfma_f32_16x16x32_bf16 v[236:239], v[96:99], v[164:167], 0
    v_mfma_f32_16x16x32_bf16 v[244:247], v[100:103], v[164:167], 0
    v_mfma_f32_16x16x16_bf16 v[172:175], v[180:181], v[168:169], v[172:175]
    v_mfma_f32_16x16x16_bf16 v[176:179], v[180:181], v[170:171], v[176:179]
    s_waitcnt vmcnt(7)
    v_mfma_f32_16x16x16_bf16 v[184:187], v[120:121], v[168:169], v[184:187]
    s_nop 0
    v_rcp_f32 v172, v172
    s_waitcnt vmcnt(6)
    v_mfma_f32_16x16x16_bf16 v[192:195], v[122:123], v[168:169], v[192:195]
    v_rcp_f32 v176, v176
    s_waitcnt vmcnt(5)
    v_mfma_f32_16x16x16_bf16 v[200:203], v[124:125], v[168:169], v[200:203]
    v_mul_f32 v184, v172, v184
    v_mul_f32 v185, v172, v185
    s_waitcnt vmcnt(4)
    v_mfma_f32_16x16x16_bf16 v[208:211], v[126:127], v[168:169], v[208:211]
    v_mul_f32 v186, v172, v186
    v_mul_f32 v187, v172, v187
    s_waitcnt vmcnt(3)
    v_mfma_f32_16x16x16_bf16 v[216:219], v[128:129], v[168:169], v[216:219]
    v_mul_f32 v192, v172, v192
    v_mul_f32 v193, v172, v193
    s_waitcnt vmcnt(2)
    v_mfma_f32_16x16x16_bf16 v[224:227], v[130:131], v[168:169], v[224:227]
    v_mul_f32 v194, v172, v194
    v_mul_f32 v195, v172, v195
    s_waitcnt vmcnt(1)
    v_mfma_f32_16x16x16_bf16 v[232:235], v[132:133], v[168:169], v[232:235]
    v_mul_f32 v200, v172, v200
    v_mul_f32 v201, v172, v201
    s_waitcnt vmcnt(0)
    v_mfma_f32_16x16x16_bf16 v[240:243], v[134:135], v[168:169], v[240:243]
    v_mul_f32 v202, v172, v202
    v_mul_f32 v203, v172, v203
    v_mfma_f32_16x16x16_bf16 v[188:191], v[120:121], v[170:171], v[188:191]
    v_mul_f32 v208, v172, v208
    v_mul_f32 v209, v172, v209
    v_mfma_f32_16x16x16_bf16 v[196:199], v[122:123], v[170:171], v[196:199]
    v_mul_f32 v210, v172, v210
    v_mul_f32 v211, v172, v211
    v_mfma_f32_16x16x16_bf16 v[204:207], v[124:125], v[170:171], v[204:207]
    v_mul_f32 v216, v172, v216
    v_mul_f32 v217, v172, v217
    v_mfma_f32_16x16x16_bf16 v[212:215], v[126:127], v[170:171], v[212:215]
    v_mul_f32 v218, v172, v218
    v_mul_f32 v219, v172, v219
    v_mfma_f32_16x16x16_bf16 v[220:223], v[128:129], v[170:171], v[220:223]
    v_mul_f32 v224, v172, v224
    v_mul_f32 v225, v172, v225
    v_mfma_f32_16x16x16_bf16 v[228:231], v[130:131], v[170:171], v[228:231]
    v_mul_f32 v226, v172, v226
    v_mul_f32 v227, v172, v227
    v_mfma_f32_16x16x16_bf16 v[236:239], v[132:133], v[170:171], v[236:239]
    v_mul_f32 v232, v172, v232
    v_mul_f32 v233, v172, v233
    v_mfma_f32_16x16x16_bf16 v[244:247], v[134:135], v[170:171], v[244:247]
    v_mul_f32 v234, v172, v234
    v_mul_f32 v235, v172, v235
    v_mul_f32 v240, v172, v240
    v_mul_f32 v241, v172, v241
    v_mul_f32 v242, v172, v242
    v_mul_f32 v243, v172, v243
    v_mul_f32 v188, v176, v188
    v_mul_f32 v189, v176, v189
    v_mul_f32 v190, v176, v190
    v_mul_f32 v191, v176, v191
    v_mul_f32 v196, v176, v196
    v_mul_f32 v197, v176, v197
    v_mul_f32 v198, v176, v198
    v_mul_f32 v199, v176, v199
    v_mul_f32 v204, v176, v204
    v_mul_f32 v205, v176, v205
    v_mul_f32 v206, v176, v206
    v_mul_f32 v207, v176, v207
    v_mul_f32 v212, v176, v212
    v_mul_f32 v213, v176, v213
    v_mul_f32 v214, v176, v214
    v_mul_f32 v215, v176, v215
    v_mul_f32 v220, v176, v220
    v_mul_f32 v221, v176, v221
    v_mul_f32 v222, v176, v222
    v_mul_f32 v223, v176, v223
    v_mul_f32 v228, v176, v228
    v_mul_f32 v229, v176, v229
    v_mul_f32 v230, v176, v230
    v_mul_f32 v231, v176, v231
    v_mul_f32 v236, v176, v236
    v_mul_f32 v237, v176, v237
    v_mul_f32 v238, v176, v238
    v_mul_f32 v239, v176, v239
    v_mul_f32 v244, v176, v244
    v_mul_f32 v245, v176, v245
    v_mul_f32 v246, v176, v246
    v_mul_f32 v247, v176, v247
    v_cvt_pk_bf16_f32 v8, v184, v185
    v_cvt_pk_bf16_f32 v9, v186, v187
    v_cvt_pk_bf16_f32 v10, v192, v193
    v_cvt_pk_bf16_f32 v11, v194, v195
    v_cvt_pk_bf16_f32 v12, v200, v201
    v_cvt_pk_bf16_f32 v13, v202, v203
    v_cvt_pk_bf16_f32 v14, v208, v209
    v_cvt_pk_bf16_f32 v15, v210, v211
    v_cvt_pk_bf16_f32 v16, v216, v217
    v_cvt_pk_bf16_f32 v17, v218, v219
    v_cvt_pk_bf16_f32 v18, v224, v225
    v_cvt_pk_bf16_f32 v19, v226, v227
    v_cvt_pk_bf16_f32 v20, v232, v233
    v_cvt_pk_bf16_f32 v21, v234, v235
    v_cvt_pk_bf16_f32 v22, v240, v241
    v_cvt_pk_bf16_f32 v23, v242, v243
    v_cvt_pk_bf16_f32 v24, v188, v189
    v_cvt_pk_bf16_f32 v25, v190, v191
    v_cvt_pk_bf16_f32 v26, v196, v197
    v_cvt_pk_bf16_f32 v27, v198, v199
    v_cvt_pk_bf16_f32 v28, v204, v205
    v_cvt_pk_bf16_f32 v29, v206, v207
    v_cvt_pk_bf16_f32 v30, v212, v213
    v_cvt_pk_bf16_f32 v31, v214, v215
    v_cvt_pk_bf16_f32 v32, v220, v221
    v_cvt_pk_bf16_f32 v33, v222, v223
    v_cvt_pk_bf16_f32 v34, v228, v229
    v_cvt_pk_bf16_f32 v35, v230, v231
    v_cvt_pk_bf16_f32 v36, v236, v237
    v_cvt_pk_bf16_f32 v37, v238, v239
    v_cvt_pk_bf16_f32 v38, v244, v245
    v_cvt_pk_bf16_f32 v39, v246, v247
    ds_write_b128 v250, v[8:11] offset:16384
    ds_write_b128 v250, v[12:15] offset:17408
    ds_write_b128 v250, v[16:19] offset:18432
    ds_write_b128 v250, v[20:23] offset:19456
    ds_write_b128 v250, v[24:27] offset:20480
    ds_write_b128 v250, v[28:31] offset:21504
    ds_write_b128 v250, v[32:35] offset:22528
    ds_write_b128 v250, v[36:39] offset:23552
    s_waitcnt lgkmcnt(0)
    s_barrier
    ds_read_b128 v[8:11], v2 offset:16384
    ds_read_b128 v[24:27], v2 offset:20480
    ds_read_b128 v[12:15], v2 offset:17408
    ds_read_b128 v[28:31], v2 offset:21504
    ds_read_b128 v[16:19], v2 offset:18432
    ds_read_b128 v[32:35], v2 offset:22528
    ds_read_b128 v[20:23], v2 offset:19456
    s_waitcnt lgkmcnt(6)
    v_mfma_f32_16x16x32_bf16 v[136:139], a[0:3], v[8:11], 0
    ds_read_b128 v[36:39], v2 offset:23552
    s_waitcnt lgkmcnt(6)
    v_mfma_f32_16x16x32_bf16 v[140:143], a[0:3], v[24:27], 0
    buffer_load_dwordx4 a[0:3], v2, s[8:11], s52 offen offset:0
    ds_read_b128 v[40:43], v2 offset:24576
    v_mfma_f32_16x16x32_bf16 v[144:147], a[4:7], v[8:11], 0
    ds_read_b128 v[56:59], v2 offset:28672
    v_mfma_f32_16x16x32_bf16 v[148:151], a[4:7], v[24:27], 0
    buffer_load_dwordx4 a[4:7], v2, s[8:11], s52 offen offset:1024
    ds_read_b128 v[44:47], v2 offset:25600
    v_mfma_f32_16x16x32_bf16 v[152:155], a[8:11], v[8:11], 0
    ds_read_b128 v[60:63], v2 offset:29696
    v_mfma_f32_16x16x32_bf16 v[156:159], a[8:11], v[24:27], 0
    buffer_load_dwordx4 a[8:11], v2, s[8:11], s52 offen offset:2048
    ds_read_b128 v[48:51], v2 offset:26624
    v_mfma_f32_16x16x32_bf16 v[160:163], a[12:15], v[8:11], 0
    ds_read_b128 v[64:67], v2 offset:30720
    v_mfma_f32_16x16x32_bf16 v[164:167], a[12:15], v[24:27], 0
    buffer_load_dwordx4 a[12:15], v2, s[8:11], s52 offen offset:3072
    ds_read_b128 v[52:55], v2 offset:27648
    v_mfma_f32_16x16x32_bf16 v[168:171], a[16:19], v[8:11], 0
    ds_read_b128 v[68:71], v2 offset:31744
    v_mfma_f32_16x16x32_bf16 v[172:175], a[16:19], v[24:27], 0
    buffer_load_dwordx4 a[16:19], v5, s[8:11], s52 offen offset:0
    ds_read_b128 v[72:75], v2 offset:32768
    s_waitcnt lgkmcnt(14)
    v_mfma_f32_16x16x32_bf16 v[136:139], a[20:23], v[12:15], v[136:139]
    ds_read_b128 v[88:91], v2 offset:36864
    s_waitcnt lgkmcnt(14)
    v_mfma_f32_16x16x32_bf16 v[140:143], a[20:23], v[28:31], v[140:143]
    buffer_load_dwordx4 a[20:23], v2, s[8:11], s53 offen offset:0
    ds_read_b128 v[76:79], v2 offset:33792
    v_mfma_f32_16x16x32_bf16 v[144:147], a[24:27], v[12:15], v[144:147]
    ds_read_b128 v[92:95], v2 offset:37888
    v_mfma_f32_16x16x32_bf16 v[148:151], a[24:27], v[28:31], v[148:151]
    buffer_load_dwordx4 a[24:27], v2, s[8:11], s53 offen offset:1024
    ds_read_b128 v[80:83], v2 offset:34816
    v_mfma_f32_16x16x32_bf16 v[152:155], a[28:31], v[12:15], v[152:155]
    ds_read_b128 v[96:99], v2 offset:38912
    v_mfma_f32_16x16x32_bf16 v[156:159], a[28:31], v[28:31], v[156:159]
    buffer_load_dwordx4 a[28:31], v2, s[8:11], s53 offen offset:2048
    ds_read_b128 v[84:87], v2 offset:35840
    v_mfma_f32_16x16x32_bf16 v[160:163], a[32:35], v[12:15], v[160:163]
    ds_read_b128 v[100:103], v2 offset:39936
    v_mfma_f32_16x16x32_bf16 v[164:167], a[32:35], v[28:31], v[164:167]
    buffer_load_dwordx4 a[32:35], v2, s[8:11], s53 offen offset:3072
    ds_read_b128 v[104:107], v2 offset:40960
    v_mfma_f32_16x16x32_bf16 v[168:171], a[36:39], v[12:15], v[168:171]
    ds_read_b128 v[120:123], v2 offset:45056
    v_mfma_f32_16x16x32_bf16 v[172:175], a[36:39], v[28:31], v[172:175]
    buffer_load_dwordx4 a[36:39], v5, s[8:11], s53 offen offset:0
    ds_read_b128 v[108:111], v2 offset:41984
    s_waitcnt lgkmcnt(15)
    v_mfma_f32_16x16x32_bf16 v[136:139], a[40:43], v[16:19], v[136:139]
    ds_read_b128 v[124:127], v2 offset:46080
    v_mfma_f32_16x16x32_bf16 v[140:143], a[40:43], v[32:35], v[140:143]
    buffer_load_dwordx4 a[40:43], v2, s[8:11], s54 offen offset:0
    ds_read_b128 v[112:115], v2 offset:43008
    v_mfma_f32_16x16x32_bf16 v[144:147], a[44:47], v[16:19], v[144:147]
    ds_read_b128 v[128:131], v2 offset:47104
    v_mfma_f32_16x16x32_bf16 v[148:151], a[44:47], v[32:35], v[148:151]
    buffer_load_dwordx4 a[44:47], v2, s[8:11], s54 offen offset:1024
    ds_read_b128 v[116:119], v2 offset:44032
    v_mfma_f32_16x16x32_bf16 v[152:155], a[48:51], v[16:19], v[152:155]
    ds_read_b128 v[132:135], v2 offset:48128
    v_mfma_f32_16x16x32_bf16 v[156:159], a[48:51], v[32:35], v[156:159]
    buffer_load_dwordx4 a[48:51], v2, s[8:11], s54 offen offset:2048
    v_mfma_f32_16x16x32_bf16 v[160:163], a[52:55], v[16:19], v[160:163]
    v_mfma_f32_16x16x32_bf16 v[164:167], a[52:55], v[32:35], v[164:167]
    buffer_load_dwordx4 a[52:55], v2, s[8:11], s54 offen offset:3072
    v_mfma_f32_16x16x32_bf16 v[168:171], a[56:59], v[16:19], v[168:171]
    v_mfma_f32_16x16x32_bf16 v[172:175], a[56:59], v[32:35], v[172:175]
    buffer_load_dwordx4 a[56:59], v5, s[8:11], s54 offen offset:0
    v_mfma_f32_16x16x32_bf16 v[136:139], a[60:63], v[20:23], v[136:139]
    v_mfma_f32_16x16x32_bf16 v[140:143], a[60:63], v[36:39], v[140:143]
    buffer_load_dwordx4 a[60:63], v2, s[8:11], s55 offen offset:0
    v_mfma_f32_16x16x32_bf16 v[144:147], a[64:67], v[20:23], v[144:147]
    v_mfma_f32_16x16x32_bf16 v[148:151], a[64:67], v[36:39], v[148:151]
    buffer_load_dwordx4 a[64:67], v2, s[8:11], s55 offen offset:1024
    v_mfma_f32_16x16x32_bf16 v[152:155], a[68:71], v[20:23], v[152:155]
    v_mfma_f32_16x16x32_bf16 v[156:159], a[68:71], v[36:39], v[156:159]
    buffer_load_dwordx4 a[68:71], v2, s[8:11], s55 offen offset:2048
    v_mfma_f32_16x16x32_bf16 v[160:163], a[72:75], v[20:23], v[160:163]
    v_mfma_f32_16x16x32_bf16 v[164:167], a[72:75], v[36:39], v[164:167]
    buffer_load_dwordx4 a[72:75], v2, s[8:11], s55 offen offset:3072
    v_mfma_f32_16x16x32_bf16 v[168:171], a[76:79], v[20:23], v[168:171]
    v_mfma_f32_16x16x32_bf16 v[172:175], a[76:79], v[36:39], v[172:175]
    buffer_load_dwordx4 a[76:79], v5, s[8:11], s55 offen offset:0
    v_mfma_f32_16x16x32_bf16 v[136:139], a[80:83], v[40:43], v[136:139]
    v_mfma_f32_16x16x32_bf16 v[140:143], a[80:83], v[56:59], v[140:143]
    v_mfma_f32_16x16x32_bf16 v[144:147], a[84:87], v[40:43], v[144:147]
    v_mfma_f32_16x16x32_bf16 v[148:151], a[84:87], v[56:59], v[148:151]
    v_mfma_f32_16x16x32_bf16 v[152:155], a[88:91], v[40:43], v[152:155]
    v_mfma_f32_16x16x32_bf16 v[156:159], a[88:91], v[56:59], v[156:159]
    v_mfma_f32_16x16x32_bf16 v[160:163], a[92:95], v[40:43], v[160:163]
    v_mfma_f32_16x16x32_bf16 v[164:167], a[92:95], v[56:59], v[164:167]
    v_mfma_f32_16x16x32_bf16 v[168:171], a[96:99], v[40:43], v[168:171]
    v_mfma_f32_16x16x32_bf16 v[172:175], a[96:99], v[56:59], v[172:175]
    v_mfma_f32_16x16x32_bf16 v[136:139], a[100:103], v[44:47], v[136:139]
    v_mfma_f32_16x16x32_bf16 v[140:143], a[100:103], v[60:63], v[140:143]
    v_mfma_f32_16x16x32_bf16 v[144:147], a[104:107], v[44:47], v[144:147]
    v_mfma_f32_16x16x32_bf16 v[148:151], a[104:107], v[60:63], v[148:151]
    v_mfma_f32_16x16x32_bf16 v[152:155], a[108:111], v[44:47], v[152:155]
    v_mfma_f32_16x16x32_bf16 v[156:159], a[108:111], v[60:63], v[156:159]
    v_mfma_f32_16x16x32_bf16 v[160:163], a[112:115], v[44:47], v[160:163]
    v_mfma_f32_16x16x32_bf16 v[164:167], a[112:115], v[60:63], v[164:167]
    v_mfma_f32_16x16x32_bf16 v[168:171], a[116:119], v[44:47], v[168:171]
    v_mfma_f32_16x16x32_bf16 v[172:175], a[116:119], v[60:63], v[172:175]
    s_waitcnt lgkmcnt(15)
    v_mfma_f32_16x16x32_bf16 v[136:139], a[120:123], v[48:51], v[136:139]
    v_mfma_f32_16x16x32_bf16 v[140:143], a[120:123], v[64:67], v[140:143]
    v_mfma_f32_16x16x32_bf16 v[144:147], a[124:127], v[48:51], v[144:147]
    v_mfma_f32_16x16x32_bf16 v[148:151], a[124:127], v[64:67], v[148:151]
    v_mfma_f32_16x16x32_bf16 v[152:155], a[128:131], v[48:51], v[152:155]
    v_mfma_f32_16x16x32_bf16 v[156:159], a[128:131], v[64:67], v[156:159]
    v_mfma_f32_16x16x32_bf16 v[160:163], a[132:135], v[48:51], v[160:163]
    v_mfma_f32_16x16x32_bf16 v[164:167], a[132:135], v[64:67], v[164:167]
    v_mfma_f32_16x16x32_bf16 v[168:171], a[136:139], v[48:51], v[168:171]
    v_mfma_f32_16x16x32_bf16 v[172:175], a[136:139], v[64:67], v[172:175]
    v_mfma_f32_16x16x32_bf16 v[136:139], a[140:143], v[52:55], v[136:139]
    v_mfma_f32_16x16x32_bf16 v[140:143], a[140:143], v[68:71], v[140:143]
    v_mfma_f32_16x16x32_bf16 v[144:147], a[144:147], v[52:55], v[144:147]
    v_mfma_f32_16x16x32_bf16 v[148:151], a[144:147], v[68:71], v[148:151]
    v_mfma_f32_16x16x32_bf16 v[152:155], a[148:151], v[52:55], v[152:155]
    v_mfma_f32_16x16x32_bf16 v[156:159], a[148:151], v[68:71], v[156:159]
    v_mfma_f32_16x16x32_bf16 v[160:163], a[152:155], v[52:55], v[160:163]
    v_mfma_f32_16x16x32_bf16 v[164:167], a[152:155], v[68:71], v[164:167]
    v_mfma_f32_16x16x32_bf16 v[168:171], a[156:159], v[52:55], v[168:171]
    v_mfma_f32_16x16x32_bf16 v[172:175], a[156:159], v[68:71], v[172:175]
    v_mfma_f32_16x16x32_bf16 v[136:139], a[160:163], v[72:75], v[136:139]
    s_waitcnt lgkmcnt(14)
    v_mfma_f32_16x16x32_bf16 v[140:143], a[160:163], v[88:91], v[140:143]
    v_mfma_f32_16x16x32_bf16 v[144:147], a[164:167], v[72:75], v[144:147]
    v_mfma_f32_16x16x32_bf16 v[148:151], a[164:167], v[88:91], v[148:151]
    v_mfma_f32_16x16x32_bf16 v[152:155], a[168:171], v[72:75], v[152:155]
    v_mfma_f32_16x16x32_bf16 v[156:159], a[168:171], v[88:91], v[156:159]
    v_mfma_f32_16x16x32_bf16 v[160:163], a[172:175], v[72:75], v[160:163]
    v_mfma_f32_16x16x32_bf16 v[164:167], a[172:175], v[88:91], v[164:167]
    v_mfma_f32_16x16x32_bf16 v[168:171], a[176:179], v[72:75], v[168:171]
    v_mfma_f32_16x16x32_bf16 v[172:175], a[176:179], v[88:91], v[172:175]
    s_waitcnt lgkmcnt(13)
    v_mfma_f32_16x16x32_bf16 v[136:139], a[180:183], v[76:79], v[136:139]
    s_waitcnt lgkmcnt(12)
    v_mfma_f32_16x16x32_bf16 v[140:143], a[180:183], v[92:95], v[140:143]
    v_mfma_f32_16x16x32_bf16 v[144:147], a[184:187], v[76:79], v[144:147]
    v_mfma_f32_16x16x32_bf16 v[148:151], a[184:187], v[92:95], v[148:151]
    v_mfma_f32_16x16x32_bf16 v[152:155], a[188:191], v[76:79], v[152:155]
    v_mfma_f32_16x16x32_bf16 v[156:159], a[188:191], v[92:95], v[156:159]
    v_mfma_f32_16x16x32_bf16 v[160:163], a[192:195], v[76:79], v[160:163]
    v_mfma_f32_16x16x32_bf16 v[164:167], a[192:195], v[92:95], v[164:167]
    v_mfma_f32_16x16x32_bf16 v[168:171], a[196:199], v[76:79], v[168:171]
    v_mfma_f32_16x16x32_bf16 v[172:175], a[196:199], v[92:95], v[172:175]
    s_waitcnt lgkmcnt(11)
    v_mfma_f32_16x16x32_bf16 v[136:139], a[200:203], v[80:83], v[136:139]
    s_waitcnt lgkmcnt(10)
    v_mfma_f32_16x16x32_bf16 v[140:143], a[200:203], v[96:99], v[140:143]
    v_mfma_f32_16x16x32_bf16 v[144:147], a[204:207], v[80:83], v[144:147]
    v_mfma_f32_16x16x32_bf16 v[148:151], a[204:207], v[96:99], v[148:151]
    v_mfma_f32_16x16x32_bf16 v[152:155], a[208:211], v[80:83], v[152:155]
    v_mfma_f32_16x16x32_bf16 v[156:159], a[208:211], v[96:99], v[156:159]
    v_mfma_f32_16x16x32_bf16 v[160:163], a[212:215], v[80:83], v[160:163]
    v_mfma_f32_16x16x32_bf16 v[164:167], a[212:215], v[96:99], v[164:167]
    v_mfma_f32_16x16x32_bf16 v[168:171], a[216:219], v[80:83], v[168:171]
    v_mfma_f32_16x16x32_bf16 v[172:175], a[216:219], v[96:99], v[172:175]
    s_waitcnt lgkmcnt(9)
    v_mfma_f32_16x16x32_bf16 v[136:139], a[220:223], v[84:87], v[136:139]
    s_waitcnt lgkmcnt(8)
    v_mfma_f32_16x16x32_bf16 v[140:143], a[220:223], v[100:103], v[140:143]
    v_mfma_f32_16x16x32_bf16 v[144:147], a[224:227], v[84:87], v[144:147]
    v_mfma_f32_16x16x32_bf16 v[148:151], a[224:227], v[100:103], v[148:151]
    v_mfma_f32_16x16x32_bf16 v[152:155], a[228:231], v[84:87], v[152:155]
    v_mfma_f32_16x16x32_bf16 v[156:159], a[228:231], v[100:103], v[156:159]
    v_mfma_f32_16x16x32_bf16 v[160:163], a[232:235], v[84:87], v[160:163]
    v_mfma_f32_16x16x32_bf16 v[164:167], a[232:235], v[100:103], v[164:167]
    v_mfma_f32_16x16x32_bf16 v[168:171], a[236:239], v[84:87], v[168:171]
    v_mfma_f32_16x16x32_bf16 v[172:175], a[236:239], v[100:103], v[172:175]
    s_waitcnt vmcnt(19) lgkmcnt(7)
    v_mfma_f32_16x16x32_bf16 v[136:139], a[0:3], v[104:107], v[136:139]
    s_waitcnt lgkmcnt(6)
    v_mfma_f32_16x16x32_bf16 v[140:143], a[0:3], v[120:123], v[140:143]
    s_waitcnt vmcnt(18)
    v_mfma_f32_16x16x32_bf16 v[144:147], a[4:7], v[104:107], v[144:147]
    v_mfma_f32_16x16x32_bf16 v[148:151], a[4:7], v[120:123], v[148:151]
    s_waitcnt vmcnt(17)
    v_mfma_f32_16x16x32_bf16 v[152:155], a[8:11], v[104:107], v[152:155]
    v_mfma_f32_16x16x32_bf16 v[156:159], a[8:11], v[120:123], v[156:159]
    s_waitcnt vmcnt(16)
    v_mfma_f32_16x16x32_bf16 v[160:163], a[12:15], v[104:107], v[160:163]
    v_mfma_f32_16x16x32_bf16 v[164:167], a[12:15], v[120:123], v[164:167]
    s_waitcnt vmcnt(15)
    v_mfma_f32_16x16x32_bf16 v[168:171], a[16:19], v[104:107], v[168:171]
    v_mfma_f32_16x16x32_bf16 v[172:175], a[16:19], v[120:123], v[172:175]
    s_waitcnt vmcnt(14) lgkmcnt(5)
    v_mfma_f32_16x16x32_bf16 v[136:139], a[20:23], v[108:111], v[136:139]
    s_waitcnt lgkmcnt(4)
    v_mfma_f32_16x16x32_bf16 v[140:143], a[20:23], v[124:127], v[140:143]
    s_waitcnt vmcnt(13)
    v_mfma_f32_16x16x32_bf16 v[144:147], a[24:27], v[108:111], v[144:147]
    v_mfma_f32_16x16x32_bf16 v[148:151], a[24:27], v[124:127], v[148:151]
    s_waitcnt vmcnt(12)
    v_mfma_f32_16x16x32_bf16 v[152:155], a[28:31], v[108:111], v[152:155]
    v_mfma_f32_16x16x32_bf16 v[156:159], a[28:31], v[124:127], v[156:159]
    s_waitcnt vmcnt(11)
    v_mfma_f32_16x16x32_bf16 v[160:163], a[32:35], v[108:111], v[160:163]
    v_mfma_f32_16x16x32_bf16 v[164:167], a[32:35], v[124:127], v[164:167]
    s_waitcnt vmcnt(10)
    v_mfma_f32_16x16x32_bf16 v[168:171], a[36:39], v[108:111], v[168:171]
    v_mfma_f32_16x16x32_bf16 v[172:175], a[36:39], v[124:127], v[172:175]
    s_waitcnt vmcnt(9) lgkmcnt(3)
    v_mfma_f32_16x16x32_bf16 v[136:139], a[40:43], v[112:115], v[136:139]
    s_waitcnt lgkmcnt(2)
    v_mfma_f32_16x16x32_bf16 v[140:143], a[40:43], v[128:131], v[140:143]
    s_waitcnt vmcnt(8)
    v_mfma_f32_16x16x32_bf16 v[144:147], a[44:47], v[112:115], v[144:147]
    v_mfma_f32_16x16x32_bf16 v[148:151], a[44:47], v[128:131], v[148:151]
    s_waitcnt vmcnt(7)
    v_mfma_f32_16x16x32_bf16 v[152:155], a[48:51], v[112:115], v[152:155]
    v_mfma_f32_16x16x32_bf16 v[156:159], a[48:51], v[128:131], v[156:159]
    s_waitcnt vmcnt(6)
    v_mfma_f32_16x16x32_bf16 v[160:163], a[52:55], v[112:115], v[160:163]
    v_mfma_f32_16x16x32_bf16 v[164:167], a[52:55], v[128:131], v[164:167]
    s_waitcnt vmcnt(5)
    v_mfma_f32_16x16x32_bf16 v[168:171], a[56:59], v[112:115], v[168:171]
    v_mfma_f32_16x16x32_bf16 v[172:175], a[56:59], v[128:131], v[172:175]
    s_waitcnt vmcnt(4) lgkmcnt(1)
    v_mfma_f32_16x16x32_bf16 v[136:139], a[60:63], v[116:119], v[136:139]
    s_waitcnt lgkmcnt(0)
    v_mfma_f32_16x16x32_bf16 v[140:143], a[60:63], v[132:135], v[140:143]
    s_waitcnt vmcnt(3)
    v_mfma_f32_16x16x32_bf16 v[144:147], a[64:67], v[116:119], v[144:147]
    v_mfma_f32_16x16x32_bf16 v[148:151], a[64:67], v[132:135], v[148:151]
    s_waitcnt vmcnt(2)
    v_mfma_f32_16x16x32_bf16 v[152:155], a[68:71], v[116:119], v[152:155]
    v_mfma_f32_16x16x32_bf16 v[156:159], a[68:71], v[132:135], v[156:159]
    s_waitcnt vmcnt(1)
    v_mfma_f32_16x16x32_bf16 v[160:163], a[72:75], v[116:119], v[160:163]
    v_mfma_f32_16x16x32_bf16 v[164:167], a[72:75], v[132:135], v[164:167]
    s_waitcnt vmcnt(0)
    v_mfma_f32_16x16x32_bf16 v[168:171], a[76:79], v[116:119], v[168:171]
    v_mfma_f32_16x16x32_bf16 v[172:175], a[76:79], v[132:135], v[172:175]
    s_lshl_b32 s24, s5, 3
    s_add_u32 s24, s24, s7
    s_mul_i32 s24, s24, 81920
    s_mul_i32 s21, s4, 5120
    s_add_u32 s24, s24, s21
    s_add_u32 s24, s24, 134217728
    s_add_u32 s24, s24, s58
    s_add_u32 s21, s24, 0
    buffer_store_dwordx4 v[136:139], v2, s[8:11], s21 offen sc1
    s_add_u32 s21, s24, 1024
    buffer_store_dwordx4 v[144:147], v2, s[8:11], s21 offen sc1
    s_add_u32 s21, s24, 2048
    buffer_store_dwordx4 v[152:155], v2, s[8:11], s21 offen sc1
    s_add_u32 s21, s24, 3072
    buffer_store_dwordx4 v[160:163], v2, s[8:11], s21 offen sc1
    s_add_u32 s21, s24, 4096
    buffer_store_dwordx4 v[168:171], v2, s[8:11], s21 offen sc1
    s_add_u32 s21, s24, 40960
    buffer_store_dwordx4 v[140:143], v2, s[8:11], s21 offen sc1
    s_add_u32 s21, s24, 41984
    buffer_store_dwordx4 v[148:151], v2, s[8:11], s21 offen sc1
    s_add_u32 s21, s24, 43008
    buffer_store_dwordx4 v[156:159], v2, s[8:11], s21 offen sc1
    s_add_u32 s21, s24, 44032
    buffer_store_dwordx4 v[164:167], v2, s[8:11], s21 offen sc1
    s_add_u32 s21, s24, 45056
    buffer_store_dwordx4 v[172:175], v2, s[8:11], s21 offen sc1
    s_waitcnt vmcnt(0)
    s_lshr_b32 s20, s5, 2
    s_lshl_b32 s20, s20, 2
    s_add_u32 s20, s20, 72
    s_and_b32 s21, s5, 3
    s_lshl_b32 s21, s21, 3
    s_lshl_b32 s22, 1, s21
    s_cmp_lg_u32 s4, 0
    s_cbranch_scc1 tki_283
    s_lshl_b32 s93, s83, 2
    s_add_u32 s93, s93, 176
    v_mov_b32 v250, s93
    v_mov_b32 v251, 1
    s_mov_b64 exec, 1
    global_atomic_add v249, v250, v251, s[98:99] sc0 sc1
    s_mov_b64 exec, -1
tki_283:
    s_waitcnt vmcnt(0) lgkmcnt(0)
    s_barrier
    s_cmp_lg_u32 s4, 0
    s_cbranch_scc1 sig_284
    v_mov_b32 v250, s20
    v_mov_b32 v251, s22
    s_mov_b64 exec, 1
    global_atomic_add v250, v251, s[98:99] sc1
    s_mov_b64 exec, -1
sig_284:
    s_branch L_next
LT5_105:
    s_lshr_b32 s20, s5, 2
    s_lshl_b32 s20, s20, 2
    s_add_u32 s20, s20, 72
    s_and_b32 s21, s5, 3
    s_lshl_b32 s21, s21, 3
    s_cmp_ge_u32 s5, 60
    s_cselect_b32 s23, 16, 8
    s_cmp_lg_u32 s4, 0
    s_cbranch_scc1 wfd_286
    v_mov_b32 v250, s20
wf_285:
    global_load_dword v251, v250, s[98:99] sc1
    s_waitcnt vmcnt(0)
    v_lshrrev_b32 v251, s21, v251
    v_and_b32 v251, 0xff, v251
    v_cmp_gt_u32 vcc, s23, v251
    s_cbranch_vccz wf_285x
    s_sleep 32
    s_branch wf_285
wf_285x:
wfd_286:
    s_lshr_b32 s21, s5, 3
    s_lshl_b32 s21, s21, 2
    s_cmp_lg_u32 s4, 0
    s_cbranch_scc1 wfd_288
    v_mov_b32 v250, 68
wf_287:
    global_load_dword v251, v250, s[98:99] sc1
    s_waitcnt vmcnt(0)
    v_lshrrev_b32 v251, s21, v251
    v_and_b32 v251, 0xf, v251
    v_cmp_gt_u32 vcc, 5, v251
    s_cbranch_vccz wf_287x
    s_sleep 32
    s_branch wf_287
wf_287x:
wfd_288:
    s_barrier
    s_cmp_lg_u32 s4, 0
    s_cbranch_scc1 tki_289
    s_lshl_b32 s93, s83, 2
    s_add_u32 s93, s93, 176
    v_mov_b32 v250, s93
    v_mov_b32 v251, 1
    s_mov_b64 exec, 1
    global_atomic_add v249, v250, v251, s[98:99] sc0 sc1
    s_mov_b64 exec, -1
tki_289:
    s_load_dwordx2 s[16:17], s[0:1], 88
    s_waitcnt lgkmcnt(0)
    s_mov_b32 s12, s16
    s_and_b32 s13, s17, 0xffff
    s_mov_b32 s14, 2621440
    s_mov_b32 s15, 0x00020000
    s_lshr_b32 s25, s7, 1
    s_and_b32 s26, s7, 1
    s_mul_i32 s26, s26, 20
    s_mul_i32 s21, s4, 5
    s_add_u32 s26, s26, s21
    s_mul_i32 s20, s25, 40
    s_add_u32 s20, s20, s26
    s_lshl_b32 s20, s20, 10
    s_mul_i32 s22, s5, 655360
    s_add_u32 s22, s22, s20
    s_add_u32 s22, s22, 134217728
    s_mul_i32 s23, s5, 81920
    s_add_u32 s23, s23, s20
    s_add_u32 s23, s23, 117440512
    s_lshl_b32 s24, s5, 5
    s_lshl_b32 s21, s25, 4
    s_add_u32 s24, s24, s21
    s_lshl_b32 s21, s24, 2
    s_add_u32 s21, s21, 123731968
    v_lshlrev_b32 v5, 2, v3
    buffer_load_dword v6, v5, s[8:11], s21 offen sc1
    v_add_u32 v7, 4096, v2
    buffer_load_dwordx4 v[8:11], v2, s[8:11], s23 offen offset:0 sc1
    s_add_u32 s21, s22, 0
    buffer_load_dwordx4 v[12:15], v2, s[8:11], s21 offen offset:0 sc1
    s_add_u32 s21, s22, 81920
    buffer_load_dwordx4 v[16:19], v2, s[8:11], s21 offen offset:0 sc1
    s_add_u32 s21, s22, 163840
    buffer_load_dwordx4 v[20:23], v2, s[8:11], s21 offen offset:0 sc1
    s_add_u32 s21, s22, 245760
    buffer_load_dwordx4 v[24:27], v2, s[8:11], s21 offen offset:0 sc1
    s_add_u32 s21, s22, 327680
    buffer_load_dwordx4 v[28:31], v2, s[8:11], s21 offen offset:0 sc1
    s_add_u32 s21, s22, 409600
    buffer_load_dwordx4 v[32:35], v2, s[8:11], s21 offen offset:0 sc1
    s_add_u32 s21, s22, 491520
    buffer_load_dwordx4 v[36:39], v2, s[8:11], s21 offen offset:0 sc1
    s_add_u32 s21, s22, 573440
    buffer_load_dwordx4 v[40:43], v2, s[8:11], s21 offen offset:0 sc1
    buffer_load_dwordx4 v[44:47], v2, s[8:11], s23 offen offset:1024 sc1
    s_add_u32 s21, s22, 0
    buffer_load_dwordx4 v[48:51], v2, s[8:11], s21 offen offset:1024 sc1
    s_add_u32 s21, s22, 81920
    buffer_load_dwordx4 v[52:55], v2, s[8:11], s21 offen offset:1024 sc1
    s_add_u32 s21, s22, 163840
    buffer_load_dwordx4 v[56:59], v2, s[8:11], s21 offen offset:1024 sc1
    s_add_u32 s21, s22, 245760
    buffer_load_dwordx4 v[60:63], v2, s[8:11], s21 offen offset:1024 sc1
    s_add_u32 s21, s22, 327680
    buffer_load_dwordx4 v[64:67], v2, s[8:11], s21 offen offset:1024 sc1
    s_add_u32 s21, s22, 409600
    buffer_load_dwordx4 v[68:71], v2, s[8:11], s21 offen offset:1024 sc1
    s_add_u32 s21, s22, 491520
    buffer_load_dwordx4 v[72:75], v2, s[8:11], s21 offen offset:1024 sc1
    s_add_u32 s21, s22, 573440
    buffer_load_dwordx4 v[76:79], v2, s[8:11], s21 offen offset:1024 sc1
    buffer_load_dwordx4 v[80:83], v2, s[8:11], s23 offen offset:2048 sc1
    s_add_u32 s21, s22, 0
    buffer_load_dwordx4 v[84:87], v2, s[8:11], s21 offen offset:2048 sc1
    s_add_u32 s21, s22, 81920
    buffer_load_dwordx4 v[88:91], v2, s[8:11], s21 offen offset:2048 sc1
    s_add_u32 s21, s22, 163840
    buffer_load_dwordx4 v[92:95], v2, s[8:11], s21 offen offset:2048 sc1
    s_add_u32 s21, s22, 245760
    buffer_load_dwordx4 v[96:99], v2, s[8:11], s21 offen offset:2048 sc1
    s_add_u32 s21, s22, 327680
    buffer_load_dwordx4 v[100:103], v2, s[8:11], s21 offen offset:2048 sc1
    s_add_u32 s21, s22, 409600
    buffer_load_dwordx4 v[104:107], v2, s[8:11], s21 offen offset:2048 sc1
    s_add_u32 s21, s22, 491520
    buffer_load_dwordx4 v[108:111], v2, s[8:11], s21 offen offset:2048 sc1
    s_add_u32 s21, s22, 573440
    buffer_load_dwordx4 v[112:115], v2, s[8:11], s21 offen offset:2048 sc1
    buffer_load_dwordx4 v[116:119], v2, s[8:11], s23 offen offset:3072 sc1
    s_add_u32 s21, s22, 0
    buffer_load_dwordx4 v[120:123], v2, s[8:11], s21 offen offset:3072 sc1
    s_add_u32 s21, s22, 81920
    buffer_load_dwordx4 v[124:127], v2, s[8:11], s21 offen offset:3072 sc1
    s_add_u32 s21, s22, 163840
    buffer_load_dwordx4 v[128:131], v2, s[8:11], s21 offen offset:3072 sc1
    s_add_u32 s21, s22, 245760
    buffer_load_dwordx4 v[132:135], v2, s[8:11], s21 offen offset:3072 sc1
    s_add_u32 s21, s22, 327680
    buffer_load_dwordx4 v[136:139], v2, s[8:11], s21 offen offset:3072 sc1
    s_add_u32 s21, s22, 409600
    buffer_load_dwordx4 v[140:143], v2, s[8:11], s21 offen offset:3072 sc1
    s_add_u32 s21, s22, 491520
    buffer_load_dwordx4 v[144:147], v2, s[8:11], s21 offen offset:3072 sc1
    s_add_u32 s21, s22, 573440
    buffer_load_dwordx4 v[148:151], v2, s[8:11], s21 offen offset:3072 sc1
    buffer_load_dwordx4 v[152:155], v7, s[8:11], s23 offen offset:0 sc1
    s_add_u32 s21, s22, 0
    buffer_load_dwordx4 v[156:159], v7, s[8:11], s21 offen offset:0 sc1
    s_add_u32 s21, s22, 81920
    buffer_load_dwordx4 v[160:163], v7, s[8:11], s21 offen offset:0 sc1
    s_add_u32 s21, s22, 163840
    buffer_load_dwordx4 v[164:167], v7, s[8:11], s21 offen offset:0 sc1
    s_add_u32 s21, s22, 245760
    buffer_load_dwordx4 v[168:171], v7, s[8:11], s21 offen offset:0 sc1
    s_add_u32 s21, s22, 327680
    buffer_load_dwordx4 v[172:175], v7, s[8:11], s21 offen offset:0 sc1
    s_add_u32 s21, s22, 409600
    buffer_load_dwordx4 v[176:179], v7, s[8:11], s21 offen offset:0 sc1
    s_add_u32 s21, s22, 491520
    buffer_load_dwordx4 v[180:183], v7, s[8:11], s21 offen offset:0 sc1
    s_add_u32 s21, s22, 573440
    buffer_load_dwordx4 v[184:187], v7, s[8:11], s21 offen offset:0 sc1
    s_waitcnt vmcnt(45)
    v_sub_f32 v6, 1.0, v6
    v_mul_u32_u24 v5, 1280, v3
    v_lshl_add_u32 v5, v4, 3, v5
    s_mul_i32 s24, s24, 1280
    s_lshl_b32 s21, s26, 5
    s_add_u32 s24, s24, s21
    s_waitcnt vmcnt(42)
    v_pk_add_f32 v[12:13], v[12:13], v[16:17]
    v_pk_add_f32 v[14:15], v[14:15], v[18:19]
    s_waitcnt vmcnt(41)
    v_pk_add_f32 v[12:13], v[12:13], v[20:21]
    v_pk_add_f32 v[14:15], v[14:15], v[22:23]
    s_waitcnt vmcnt(40)
    v_pk_add_f32 v[12:13], v[12:13], v[24:25]
    v_pk_add_f32 v[14:15], v[14:15], v[26:27]
    s_waitcnt vmcnt(39)
    v_pk_add_f32 v[12:13], v[12:13], v[28:29]
    v_pk_add_f32 v[14:15], v[14:15], v[30:31]
    s_waitcnt vmcnt(38)
    v_pk_add_f32 v[12:13], v[12:13], v[32:33]
    v_pk_add_f32 v[14:15], v[14:15], v[34:35]
    s_waitcnt vmcnt(37)
    v_pk_add_f32 v[12:13], v[12:13], v[36:37]
    v_pk_add_f32 v[14:15], v[14:15], v[38:39]
    s_waitcnt vmcnt(36)
    v_pk_add_f32 v[12:13], v[12:13], v[40:41]
    v_pk_add_f32 v[14:15], v[14:15], v[42:43]
    v_fma_f32 v12, v6, v12, v8
    v_fma_f32 v13, v6, v13, v9
    v_fma_f32 v14, v6, v14, v10
    v_fma_f32 v15, v6, v15, v11
    v_cvt_pk_bf16_f32 v8, v12, v13
    v_cvt_pk_bf16_f32 v9, v14, v15
    buffer_store_dwordx2 v[8:9], v5, s[12:15], s24 offen offset:0
    s_waitcnt vmcnt(34)
    v_pk_add_f32 v[48:49], v[48:49], v[52:53]
    v_pk_add_f32 v[50:51], v[50:51], v[54:55]
    s_waitcnt vmcnt(33)
    v_pk_add_f32 v[48:49], v[48:49], v[56:57]
    v_pk_add_f32 v[50:51], v[50:51], v[58:59]
    s_waitcnt vmcnt(32)
    v_pk_add_f32 v[48:49], v[48:49], v[60:61]
    v_pk_add_f32 v[50:51], v[50:51], v[62:63]
    s_waitcnt vmcnt(31)
    v_pk_add_f32 v[48:49], v[48:49], v[64:65]
    v_pk_add_f32 v[50:51], v[50:51], v[66:67]
    s_waitcnt vmcnt(30)
    v_pk_add_f32 v[48:49], v[48:49], v[68:69]
    v_pk_add_f32 v[50:51], v[50:51], v[70:71]
    s_waitcnt vmcnt(29)
    v_pk_add_f32 v[48:49], v[48:49], v[72:73]
    v_pk_add_f32 v[50:51], v[50:51], v[74:75]
    s_waitcnt vmcnt(28)
    v_pk_add_f32 v[48:49], v[48:49], v[76:77]
    v_pk_add_f32 v[50:51], v[50:51], v[78:79]
    v_fma_f32 v48, v6, v48, v44
    v_fma_f32 v49, v6, v49, v45
    v_fma_f32 v50, v6, v50, v46
    v_fma_f32 v51, v6, v51, v47
    v_cvt_pk_bf16_f32 v44, v48, v49
    v_cvt_pk_bf16_f32 v45, v50, v51
    buffer_store_dwordx2 v[44:45], v5, s[12:15], s24 offen offset:32
    s_waitcnt vmcnt(26)
    v_pk_add_f32 v[84:85], v[84:85], v[88:89]
    v_pk_add_f32 v[86:87], v[86:87], v[90:91]
    s_waitcnt vmcnt(25)
    v_pk_add_f32 v[84:85], v[84:85], v[92:93]
    v_pk_add_f32 v[86:87], v[86:87], v[94:95]
    s_waitcnt vmcnt(24)
    v_pk_add_f32 v[84:85], v[84:85], v[96:97]
    v_pk_add_f32 v[86:87], v[86:87], v[98:99]
    s_waitcnt vmcnt(23)
    v_pk_add_f32 v[84:85], v[84:85], v[100:101]
    v_pk_add_f32 v[86:87], v[86:87], v[102:103]
    s_waitcnt vmcnt(22)
    v_pk_add_f32 v[84:85], v[84:85], v[104:105]
    v_pk_add_f32 v[86:87], v[86:87], v[106:107]
    s_waitcnt vmcnt(21)
    v_pk_add_f32 v[84:85], v[84:85], v[108:109]
    v_pk_add_f32 v[86:87], v[86:87], v[110:111]
    s_waitcnt vmcnt(20)
    v_pk_add_f32 v[84:85], v[84:85], v[112:113]
    v_pk_add_f32 v[86:87], v[86:87], v[114:115]
    v_fma_f32 v84, v6, v84, v80
    v_fma_f32 v85, v6, v85, v81
    v_fma_f32 v86, v6, v86, v82
    v_fma_f32 v87, v6, v87, v83
    v_cvt_pk_bf16_f32 v80, v84, v85
    v_cvt_pk_bf16_f32 v81, v86, v87
    buffer_store_dwordx2 v[80:81], v5, s[12:15], s24 offen offset:64
    s_waitcnt vmcnt(18)
    v_pk_add_f32 v[120:121], v[120:121], v[124:125]
    v_pk_add_f32 v[122:123], v[122:123], v[126:127]
    s_waitcnt vmcnt(17)
    v_pk_add_f32 v[120:121], v[120:121], v[128:129]
    v_pk_add_f32 v[122:123], v[122:123], v[130:131]
    s_waitcnt vmcnt(16)
    v_pk_add_f32 v[120:121], v[120:121], v[132:133]
    v_pk_add_f32 v[122:123], v[122:123], v[134:135]
    s_waitcnt vmcnt(15)
    v_pk_add_f32 v[120:121], v[120:121], v[136:137]
    v_pk_add_f32 v[122:123], v[122:123], v[138:139]
    s_waitcnt vmcnt(14)
    v_pk_add_f32 v[120:121], v[120:121], v[140:141]
    v_pk_add_f32 v[122:123], v[122:123], v[142:143]
    s_waitcnt vmcnt(13)
    v_pk_add_f32 v[120:121], v[120:121], v[144:145]
    v_pk_add_f32 v[122:123], v[122:123], v[146:147]
    s_waitcnt vmcnt(12)
    v_pk_add_f32 v[120:121], v[120:121], v[148:149]
    v_pk_add_f32 v[122:123], v[122:123], v[150:151]
    v_fma_f32 v120, v6, v120, v116
    v_fma_f32 v121, v6, v121, v117
    v_fma_f32 v122, v6, v122, v118
    v_fma_f32 v123, v6, v123, v119
    v_cvt_pk_bf16_f32 v116, v120, v121
    v_cvt_pk_bf16_f32 v117, v122, v123
    buffer_store_dwordx2 v[116:117], v5, s[12:15], s24 offen offset:96
    s_waitcnt vmcnt(10)
    v_pk_add_f32 v[156:157], v[156:157], v[160:161]
    v_pk_add_f32 v[158:159], v[158:159], v[162:163]
    s_waitcnt vmcnt(9)
    v_pk_add_f32 v[156:157], v[156:157], v[164:165]
    v_pk_add_f32 v[158:159], v[158:159], v[166:167]
    s_waitcnt vmcnt(8)
    v_pk_add_f32 v[156:157], v[156:157], v[168:169]
    v_pk_add_f32 v[158:159], v[158:159], v[170:171]
    s_waitcnt vmcnt(7)
    v_pk_add_f32 v[156:157], v[156:157], v[172:173]
    v_pk_add_f32 v[158:159], v[158:159], v[174:175]
    s_waitcnt vmcnt(6)
    v_pk_add_f32 v[156:157], v[156:157], v[176:177]
    v_pk_add_f32 v[158:159], v[158:159], v[178:179]
    s_waitcnt vmcnt(5)
    v_pk_add_f32 v[156:157], v[156:157], v[180:181]
    v_pk_add_f32 v[158:159], v[158:159], v[182:183]
    s_waitcnt vmcnt(4)
    v_pk_add_f32 v[156:157], v[156:157], v[184:185]
    v_pk_add_f32 v[158:159], v[158:159], v[186:187]
    v_fma_f32 v156, v6, v156, v152
    v_fma_f32 v157, v6, v157, v153
    v_fma_f32 v158, v6, v158, v154
    v_fma_f32 v159, v6, v159, v155
    v_cvt_pk_bf16_f32 v152, v156, v157
    v_cvt_pk_bf16_f32 v153, v158, v159
    buffer_store_dwordx2 v[152:153], v5, s[12:15], s24 offen offset:128
    s_waitcnt vmcnt(0)
    s_branch L_next
L_end:
    s_endpgm

.section .rodata,"a"
.p2align 6
.amdhsa_kernel gated_mix__mha_block__memory_aug_recurrent_mem_tr__prompt_kernel
  .amdhsa_next_free_vgpr 512
  .amdhsa_next_free_sgpr 102
  .amdhsa_accum_offset 256
  .amdhsa_group_segment_fixed_size 0
  .amdhsa_kernarg_size 112
  .amdhsa_user_sgpr_count 2
  .amdhsa_user_sgpr_kernarg_segment_ptr 1
  .amdhsa_system_sgpr_workgroup_id_x 1
.end_amdhsa_kernel
```
